```python
import torch

def _softmax(x, axis=-1):
    return torch.softmax(x, dim=axis)
def _gelu(x):
    return torch.nn.functional.gelu(x, approximate="tanh")
def _silu(x):
    return torch.nn.functional.silu(x)
def _sigmoid(x):
    return torch.sigmoid(x)
def _layernorm(x, axis=-1, eps=1e-5):
    m = x.mean(dim=axis, keepdim=True)
    v = x.var(dim=axis, keepdim=True, unbiased=False)
    return (x - m) / torch.sqrt(v + eps)
def _scatter_add(tgt, idx, src, axis=0):
    return tgt.clone().index_add_(axis, idx, src)
def _segment_sum(src, seg, n):
    out = torch.zeros((n,) + src.shape[1:], dtype=src.dtype)
    return out.index_add_(0, seg, src)
def _pad(x, pw):
    flat = tuple(v for pair in reversed(pw) for v in pair)
    return torch.nn.functional.pad(x, flat)

kernel_name = 'standalone__mha_block_cached__near_ridge'

def setup_inputs():

    _w = (lambda a: (lambda t: t.to(torch.bfloat16) if t.is_floating_point() else t)(torch.as_tensor(a)))
    B, Sq, D = 8, 240, 576
    H, Sk, Dh = 32, 1024, 128
    return {
        "x": _w((lambda *s: torch.randn(*s, dtype=torch.bfloat16) * 0.8)(B, Sq, D)),
        "k_cache": _w((lambda *s: torch.randn(*s, dtype=torch.bfloat16) * 0.8)(B, H, Sk, Dh)),
        "v_cache": _w((lambda *s: torch.randn(*s, dtype=torch.bfloat16) * 0.05)(B, H, Sk, Dh)),
        "wq": _w((lambda *s: torch.randn(*s, dtype=torch.bfloat16) * 0.8)(D, H * Dh) * (D ** -0.5)),
        "wo": _w((lambda *s: torch.randn(*s, dtype=torch.bfloat16) * 0.05)(H * Dh, D) * ((H * Dh) ** -0.5)),
    }

def reference(x, k_cache, v_cache, wq, wo):
    B, Sq, D = x.shape
    H, Dh = 32, 128
    q = (lambda x, *d: x.permute(*d))((x @ wq).reshape(B, Sq, H, Dh), 0, 2, 1, 3)
    scores = torch.einsum("bhqd,bhkd->bhqk", q, k_cache) * (Dh ** -0.5)
    p = _softmax(scores, axis=-1)
    o = torch.einsum("bhqk,bhkd->bhqd", p, v_cache)
    return (lambda x, *d: x.permute(*d))(o, 0, 2, 1, 3).reshape(B, Sq, H * Dh) @ wo
```

```asm
; @launch grid=(256,1,1) block=(256,1,1) lds=163840
.amdgcn_target "amdgcn-amd-amdhsa--gfx950"
.text
.globl standalone__mha_block_cached__near_ridge_kernel
.p2align 8
.type standalone__mha_block_cached__near_ridge_kernel,@function
standalone__mha_block_cached__near_ridge_kernel:
    s_cmp_ge_u32 s2, 256
    s_cbranch_scc1 L_end
    s_mov_b32 s100, 0
L_start:
    s_load_dwordx8 s[4:11], s[0:1], 0
    s_load_dwordx4 s[32:35], s[0:1], 32
    s_load_dwordx4 s[96:99], s[0:1], 48
    v_lshrrev_b32 v1, 6, v0
    v_and_b32 v2, 63, v0
    v_readfirstlane_b32 s3, v1
    s_and_b32 s56, s2, 7
    s_lshr_b32 s57, s2, 3
    s_and_b32 s58, s57, 3
    s_lshr_b32 s59, s57, 2
    s_and_b32 s36, s56, 1
    s_lshl_b32 s36, s36, 2
    s_add_u32 s36, s36, s58
    s_lshr_b32 s37, s56, 1
    s_lshl_b32 s37, s37, 3
    s_add_u32 s37, s37, s59
    s_add_u32 s38, s58, s59
    s_and_b32 s38, s38, 1
    s_lshl_b32 s38, s38, 2
    s_add_u32 s38, s38, s56
    s_sub_u32 s58, s38, 9
    s_cmp_ge_u32 s38, 9
    s_cselect_b32 s38, s58, s38
    s_lshl_b32 s41, s3, 12
    s_lshl_b32 s42, s3, 13
    s_add_u32 s42, s42, 32768
    s_and_b32 s58, s3, 1
    s_lshl_b32 s58, s58, 13
    s_cmp_ge_u32 s3, 2
    s_cselect_b32 s43, 81920, 0
    s_cselect_b32 s44, 65536, 0
    s_add_u32 s43, s43, s58
    s_add_u32 s43, s43, 65536
    s_add_u32 s44, s44, s58
    s_add_u32 s44, s44, 16384
    v_and_b32 v3, 15, v2
    v_lshrrev_b32 v4, 4, v2
    v_and_b32 v5, 7, v2
    v_lshrrev_b32 v6, 3, v2
    v_lshlrev_b32 v10, 1, v4
    v_xor_b32 v10, v3, v10
    v_xor_b32 v11, 8, v10
    v_lshlrev_b32 v10, 4, v10
    v_lshlrev_b32 v11, 4, v11
    s_lshl_b32 s58, s3, 4
    v_add_u32 v12, s58, v4
    v_lshlrev_b32 v12, 13, v12
    v_add_u32 v136, v12, v10
    v_add_u32 v137, v12, v10
    v_add_u32 v137, 31744, v137
    v_add_u32 v138, v12, v11
    v_add_u32 v138, 63488, v138
    v_add_u32 v139, v12, v11
    v_add_u32 v139, 95232, v139
    v_mul_u32_u24 v13, 1152, v6
    s_mul_i32 s58, s3, 73728
    v_add_u32 v7, s58, v13
    v_xor_b32 v8, v5, v4
    v_xor_b32 v9, 4, v8
    v_lshl_add_u32 v8, v8, 4, v7
    v_lshl_add_u32 v9, v9, 4, v7
    v_add_u32 v128, 0, v8
    v_add_u32 v129, 8192, v9
    v_add_u32 v130, 16384, v8
    v_add_u32 v131, 24576, v9
    v_add_u32 v132, 36864, v8
    v_add_u32 v133, 45056, v9
    v_add_u32 v134, 53248, v8
    v_add_u32 v135, 61440, v9
    s_lshl_b32 s58, s37, 8
    s_mul_i32 s59, s36, 276480
    s_lshl_b32 s60, s36, 5
    s_add_u32 s60, s60, s37
    s_lshl_b32 s60, s60, 18
    s_waitcnt lgkmcnt(0)
    s_add_u32 s12, s10, s58
    s_addc_u32 s13, s11, 0
    s_sub_u32 s14, 4718592, s58
    s_mov_b32 s15, 0x20000
    s_add_u32 s16, s6, s60
    s_addc_u32 s17, s7, 0
    s_mov_b32 s18, 0x40000
    s_mov_b32 s19, 0x20000
    s_add_u32 s20, s8, s60
    s_addc_u32 s21, s9, 0
    s_mov_b32 s22, 0x40000
    s_mov_b32 s23, 0x20000
    s_add_u32 s8, s4, s59
    s_addc_u32 s9, s5, 0
    s_mov_b32 s10, 276480
    s_mov_b32 s11, 0x20000
    s_getpc_b64 s[58:59]
L_pc:
    s_mul_i32 s61, s57, 24
    s_mul_i32 s62, s3, 6
    s_add_u32 s61, s61, s62
    v_add_u32 v24, s61, v2
    v_lshlrev_b32 v24, 7, v24
    v_min_u32 v24, L_codeend-L_pc, v24
    s_mov_b64 exec, 63
    global_load_dword v255, v24, s[58:59]
    s_mov_b64 exec, -1
    v_mov_b32 v21, 0x8000
    buffer_load_dword v22, v21, s[16:19], 0 offen nt
    buffer_load_dword v23, v21, s[20:23], 0 offen nt
    s_lshl_b32 s39, s38, 7
    s_lshl_b32 s40, s38, 19
    s_add_u32 m0, s41, 114688
    s_nop 0
    buffer_load_dwordx4 v136, s[12:15], s40 offen offset:0  lds
    s_add_u32 s38, s38, 1
    s_cmp_eq_u32 s38, 9
    s_cselect_b32 s38, 0, s38
    buffer_load_dwordx4 v137, s[12:15], s40 offen offset:1024  lds
    buffer_load_dwordx4 v138, s[12:15], s40 offen offset:2048  lds
    buffer_load_dwordx4 v139, s[12:15], s40 offen offset:3072  lds
    s_mov_b32 m0, s42
    s_nop 0
    buffer_load_dwordx4 v128, s[8:11], s39 offen offset:0  lds
    buffer_load_dwordx4 v129, s[8:11], s39 offen offset:1024  lds
    buffer_load_dwordx4 v130, s[8:11], s39 offen offset:2048  lds
    buffer_load_dwordx4 v131, s[8:11], s39 offen offset:3072  lds
    s_add_u32 m0, s42, 4096
    s_nop 0
    buffer_load_dwordx4 v132, s[8:11], s39 offen offset:0  lds
    buffer_load_dwordx4 v133, s[8:11], s39 offen offset:1024  lds
    buffer_load_dwordx4 v134, s[8:11], s39 offen offset:2048  lds
    buffer_load_dwordx4 v135, s[8:11], s39 offen offset:3072  lds
    s_mov_b32 s48, 0x3e0293ee
    v_lshlrev_b32 v236, 4, v2
    s_mov_b32 s45, 0
    s_mov_b32 s46, 0
    v_lshlrev_b32 v14, 8, v4
    v_add_u32 v14, s41, v14
    v_add_u32 v234, v14, v10
    v_add_u32 v235, v14, v11
    s_and_b32 s58, s3, 1
    s_lshl_b32 s58, s58, 3
    v_xor_b32 v15, v3, v4
    v_xor_b32 v15, s58, v15
    v_xor_b32 v16, 4, v15
    v_lshl_add_u32 v232, v15, 4, v14
    v_lshl_add_u32 v233, v16, 4, v14
    s_mul_i32 s58, s36, 1966080
    s_add_u32 s24, s98, s58
    s_addc_u32 s25, s99, 0
    s_mov_b32 s26, 1966080
    s_mov_b32 s27, 0x20000
    v_lshrrev_b32 v16, 2, v3
    v_and_b32 v17, 3, v3
    v_lshl_add_u32 v18, v16, 3, v17
    v_lshlrev_b32 v18, 8, v18
    v_xor_b32 v19, v4, v3
    v_xor_b32 v20, 0, v19
    v_lshl_add_u32 v220, v20, 4, v18
    v_xor_b32 v20, 4, v19
    v_lshl_add_u32 v221, v20, 4, v18
    v_xor_b32 v20, 8, v19
    v_lshl_add_u32 v222, v20, 4, v18
    v_xor_b32 v20, 12, v19
    v_lshl_add_u32 v223, v20, 4, v18
    v_lshl_add_u32 v18, v4, 3, v16
    v_lshlrev_b32 v18, 8, v18
    v_lshl_add_u32 v18, v17, 3, v18
    v_add_u32 v18, 0x10000, v18
    v_and_b32 v19, 1, v4
    v_lshl_add_u32 v19, v19, 2, v16
    v_xor_b32 v20, 0, v19
    v_lshl_add_u32 v224, v20, 5, v18
    v_xor_b32 v20, 1, v19
    v_lshl_add_u32 v225, v20, 5, v18
    v_xor_b32 v20, 2, v19
    v_lshl_add_u32 v226, v20, 5, v18
    v_xor_b32 v20, 3, v19
    v_lshl_add_u32 v227, v20, 5, v18
    v_xor_b32 v20, 4, v19
    v_lshl_add_u32 v228, v20, 5, v18
    v_xor_b32 v20, 5, v19
    v_lshl_add_u32 v229, v20, 5, v18
    v_xor_b32 v20, 6, v19
    v_lshl_add_u32 v230, v20, 5, v18
    v_xor_b32 v20, 7, v19
    v_lshl_add_u32 v231, v20, 5, v18
    v_lshl_add_u32 v18, v4, 3, v16
    v_lshlrev_b32 v18, 8, v18
    v_add_u32 v18, 98304, v18
    v_lshlrev_b32 v19, 1, v19
    v_xor_b32 v19, v17, v19
    v_xor_b32 v20, 0, v19
    v_lshl_add_u32 v160, v20, 4, v18
    v_xor_b32 v20, 4, v19
    v_lshl_add_u32 v161, v20, 4, v18
    v_xor_b32 v20, 8, v19
    v_lshl_add_u32 v162, v20, 4, v18
    v_xor_b32 v20, 12, v19
    v_lshl_add_u32 v163, v20, 4, v18
    v_lshrrev_b32 v18, 1, v3
    v_xor_b32 v18, v4, v18
    v_lshlrev_b32 v19, 7, v3
    v_xor_b32 v20, 0, v18
    v_lshl_add_u32 v20, v20, 4, v19
    v_add_u32 v140, s42, v20
    v_add_u32 v142, s43, v20
    v_add_u32 v144, s44, v20
    v_add_u32 v146, s41, v20
    v_xor_b32 v20, 4, v18
    v_lshl_add_u32 v20, v20, 4, v19
    v_add_u32 v141, s42, v20
    v_add_u32 v143, s43, v20
    v_add_u32 v145, s44, v20
    v_add_u32 v147, s41, v20
    s_add_u32 s49, s38, 6
    s_sub_u32 s58, s49, 9
    s_cmp_ge_u32 s49, 9
    s_cselect_b32 s49, s58, s49
    s_lshl_b32 s49, s49, 7
    s_add_u32 s50, s38, 7
    s_sub_u32 s58, s50, 9
    s_cmp_ge_u32 s50, 9
    s_cselect_b32 s50, s58, s50
    s_lshl_b32 s50, s50, 7
    s_xor_b32 s58, s56, s57
    s_and_b32 s58, s58, 1
    s_xor_b32 s56, s56, s58
    s_xor_b32 s57, s57, s58
    s_lshr_b32 s28, s57, 3
    s_and_b32 s29, s57, 7
    s_lshr_b32 s58, s29, 1
    s_cmp_ge_u32 s57, 24
    s_cselect_b32 s28, s58, s28
    s_cselect_b32 s29, 8, s29
    s_and_b32 s30, s57, 1
    s_lshl_b32 s30, s30, 2
    s_lshl_b32 s58, s56, 2
    s_lshr_b32 s58, 0x31203120, s58
    s_and_b32 s58, s58, 3
    s_add_u32 s30, s30, s58
    s_lshl_b32 s30, s30, 2
    s_add_u32 s30, s30, s3
    s_lshl_b32 s58, s29, 7
    s_add_u32 s52, s32, s58
    s_addc_u32 s53, s33, 0
    s_sub_u32 s54, 4718592, s58
    s_lshr_b32 s58, 0x15ffffff, s57
    s_and_b32 s58, s58, 1
    s_cselect_b32 s54, s54, 0
    s_mov_b32 s55, 0x20000
    s_lshl_b32 s60, s57, 3
    s_add_u32 s60, s60, s56
    s_lshl_b32 s62, s60, 4
    s_add_u32 s62, s62, s3
    s_lshl_b32 s62, s62, 2
    s_add_u32 s62, s62, 0x9000
    s_mul_i32 s60, s60, 20480
    s_mul_i32 s58, s3, 5120
    s_add_u32 s60, s60, s58
    s_add_u32 s60, s60, 0x10000
    v_lshlrev_b32 v18, 1, v4
    v_xor_b32 v18, v5, v18
    v_lshl_add_u32 v18, v18, 4, v13
    v_add_u32 v237, 0, v18
    v_add_u32 v238, 8192, v18
    v_add_u32 v239, 16384, v18
    v_add_u32 v240, 24576, v18
    v_lshl_add_u32 v18, v4, 2, v16
    v_lshrrev_b32 v19, 1, v18
    v_and_b32 v19, 3, v19
    v_lshlrev_b32 v18, 7, v18
    v_lshl_add_u32 v18, v17, 3, v18
    v_add_u32 v18, s41, v18
    v_xor_b32 v20, 0, v19
    v_lshl_add_u32 v241, v20, 5, v18
    v_add_u32 v245, 0x10000, v241
    v_add_u32 v249, 0x20000, v241
    v_xor_b32 v20, 1, v19
    v_lshl_add_u32 v242, v20, 5, v18
    v_add_u32 v246, 0x10000, v242
    v_add_u32 v250, 0x20000, v242
    v_xor_b32 v20, 2, v19
    v_lshl_add_u32 v243, v20, 5, v18
    v_add_u32 v247, 0x10000, v243
    v_add_u32 v251, 0x20000, v243
    v_xor_b32 v20, 3, v19
    v_lshl_add_u32 v244, v20, 5, v18
    v_add_u32 v248, 0x10000, v244
    v_add_u32 v252, 0x20000, v244
    s_add_u32 s4, s98, 0x1000000
    s_addc_u32 s5, s99, 0
    s_mov_b32 s6, 0x510000
    s_mov_b32 s7, 0x20000
    s_mul_i32 s31, s36, 0x1100
    s_lshl_b32 s58, s37, 2
    s_add_u32 s31, s31, s58
    v_mov_b32 v253, 1
    s_lshr_b32 s58, s57, 1
    s_lshl_b32 s58, s58, 2
    s_add_u32 s58, s58, s3
    s_lshl_b32 s58, s58, 4
    v_lshrrev_b32 v254, 2, v2
    v_add_u32 v254, s58, v254
    v_lshlrev_b32 v254, 7, v254
    s_or_b32 s101, s3, s100
    s_mul_i32 s58, s57, 43
    s_lshr_b32 s58, s58, 7
    s_mul_i32 s58, s58, 3
    s_sub_u32 s63, s57, s58
    s_add_u32 s63, s63, 1
    s_cmp_eq_u32 s101, 0
    s_cselect_b32 s63, s63, 0
    s_cmp_eq_u32 s100, 2
    s_cbranch_scc1 L_keepm
    v_mov_b32 v176, 0
    v_mov_b32 v177, 0
    v_mov_b32 v178, 0
    v_mov_b32 v179, 0
    v_mov_b32 v180, 0
    v_mov_b32 v181, 0
    v_mov_b32 v182, 0
    v_mov_b32 v183, 0
    v_mov_b32 v184, 0
    v_mov_b32 v185, 0
    v_mov_b32 v186, 0
    v_mov_b32 v187, 0
    v_mov_b32 v188, 0
    v_mov_b32 v189, 0
    v_mov_b32 v190, 0
    v_mov_b32 v191, 0
L_keepm:
    v_mov_b32 v192, 0
    v_mov_b32 v196, 0
    v_mov_b32 v200, 0
    v_mov_b32 v204, 0
    v_mov_b32 v216, 0x3f803f80
    v_mov_b32 v217, 0x3f803f80
    v_mov_b32 v218, 0x3f803f80
    v_mov_b32 v219, 0x3f803f80
    s_lshl_b32 s39, s38, 7
    s_lshl_b32 s40, s38, 19
    s_add_u32 m0, s41, 131072
    s_nop 0
    buffer_load_dwordx4 v136, s[12:15], s40 offen offset:0  lds
    s_add_u32 s38, s38, 1
    s_cmp_eq_u32 s38, 9
    s_cselect_b32 s38, 0, s38
    buffer_load_dwordx4 v137, s[12:15], s40 offen offset:1024  lds
    buffer_load_dwordx4 v138, s[12:15], s40 offen offset:2048  lds
    buffer_load_dwordx4 v139, s[12:15], s40 offen offset:3072  lds
    s_waitcnt vmcnt(8)
    s_barrier
    s_cmp_lg_u32 s101, 0
    s_cbranch_scc1 L_noclr
    s_mov_b64 exec, 1
    buffer_store_dword v176, off, s[4:7], s31 sc1
    buffer_store_dwordx4 v[176:179], off, s[4:7], s62 sc1
    s_mov_b64 exec, -1
L_noclr:
    s_cmp_eq_u32 s3, 3
    s_cbranch_scc1 L_w3
    ds_read_b128 a[64:67], v140 offset:0
    ds_read_b128 a[68:71], v141 offset:0
    ds_read_b64_tr_b16 a[192:193], v160 offset:16384
    ds_read_b64_tr_b16 a[194:195], v160 offset:17408
    ds_read_b64_tr_b16 a[224:225], v160 offset:24576
    ds_read_b64_tr_b16 a[226:227], v160 offset:25600
    ds_read_b64_tr_b16 a[196:197], v160 offset:16392
    ds_read_b64_tr_b16 a[198:199], v160 offset:17416
    ds_read_b64_tr_b16 a[228:229], v160 offset:24584
    ds_read_b64_tr_b16 a[230:231], v160 offset:25608
    s_waitcnt lgkmcnt(4)
    v_mfma_f32_16x16x32_bf16 v[0:3], a[192:195], a[64:67], 0
    ds_read_b64_tr_b16 a[200:201], v161 offset:16384
    ds_read_b64_tr_b16 a[202:203], v161 offset:17408
    v_mfma_f32_16x16x32_bf16 v[0:3], a[224:227], a[68:71], v[0:3]
    ds_read_b64_tr_b16 a[232:233], v161 offset:24576
    ds_read_b64_tr_b16 a[234:235], v161 offset:25600
    s_mov_b32 m0, s43
    s_waitcnt lgkmcnt(4)
    v_mfma_f32_16x16x32_bf16 v[4:7], a[196:199], a[64:67], 0
    ds_read_b64_tr_b16 a[204:205], v161 offset:16392
    buffer_load_dwordx4 v128, s[8:11], s39 offen offset:0  lds
    v_mfma_f32_16x16x32_bf16 v[4:7], a[228:231], a[68:71], v[4:7]
    ds_read_b64_tr_b16 a[206:207], v161 offset:17416
    ds_read_b64_tr_b16 a[236:237], v161 offset:24584
    s_waitcnt lgkmcnt(3)
    v_mfma_f32_16x16x32_bf16 v[8:11], a[200:203], a[64:67], 0
    ds_read_b64_tr_b16 a[238:239], v161 offset:25608
    ds_read_b64_tr_b16 a[208:209], v162 offset:16384
    v_mfma_f32_16x16x32_bf16 v[8:11], a[232:235], a[68:71], v[8:11]
    ds_read_b64_tr_b16 a[210:211], v162 offset:17408
    buffer_load_dwordx4 v129, s[8:11], s39 offen offset:1024  lds
    s_waitcnt lgkmcnt(2)
    v_mfma_f32_16x16x32_bf16 v[12:15], a[204:207], a[64:67], 0
    ds_read_b64_tr_b16 a[240:241], v162 offset:24576
    ds_read_b64_tr_b16 a[242:243], v162 offset:25600
    v_mfma_f32_16x16x32_bf16 v[12:15], a[236:239], a[68:71], v[12:15]
    ds_read_b64_tr_b16 a[212:213], v162 offset:16392
    ds_read_b64_tr_b16 a[214:215], v162 offset:17416
    s_waitcnt lgkmcnt(2)
    v_mfma_f32_16x16x32_bf16 v[16:19], a[208:211], a[64:67], 0
    ds_read_b64_tr_b16 a[244:245], v162 offset:24584
    ds_read_b64_tr_b16 a[246:247], v162 offset:25608
    v_mfma_f32_16x16x32_bf16 v[16:19], a[240:243], a[68:71], v[16:19]
    ds_read_b64_tr_b16 a[216:217], v163 offset:16384
    buffer_load_dwordx4 v130, s[8:11], s39 offen offset:2048  lds
    s_waitcnt lgkmcnt(1)
    v_mfma_f32_16x16x32_bf16 v[20:23], a[212:215], a[64:67], 0
    ds_read_b64_tr_b16 a[218:219], v163 offset:17408
    ds_read_b64_tr_b16 a[248:249], v163 offset:24576
    v_mfma_f32_16x16x32_bf16 v[20:23], a[244:247], a[68:71], v[20:23]
    ds_read_b64_tr_b16 a[250:251], v163 offset:25600
    ds_read_b64_tr_b16 a[220:221], v163 offset:16392
    s_waitcnt lgkmcnt(1)
    v_mfma_f32_16x16x32_bf16 v[24:27], a[216:219], a[64:67], 0
    ds_read_b64_tr_b16 a[222:223], v163 offset:17416
    buffer_load_dwordx4 v131, s[8:11], s39 offen offset:3072  lds
    v_mfma_f32_16x16x32_bf16 v[24:27], a[248:251], a[68:71], v[24:27]
    ds_read_b64_tr_b16 a[252:253], v163 offset:24584
    ds_read_b64_tr_b16 a[254:255], v163 offset:25608
    s_waitcnt lgkmcnt(0)
    v_mfma_f32_16x16x32_bf16 v[28:31], a[220:223], a[64:67], 0
    ds_read_b128 a[72:75], v140 offset:2048
    ds_read_b128 a[76:79], v141 offset:2048
    v_mfma_f32_16x16x32_bf16 v[28:31], a[252:255], a[68:71], v[28:31]
    s_add_u32 m0, s43, 4096
    s_waitcnt lgkmcnt(0)
    v_mfma_f32_16x16x32_bf16 v[32:35], a[192:195], a[72:75], 0
    buffer_load_dwordx4 v132, s[8:11], s39 offen offset:0  lds
    v_mfma_f32_16x16x32_bf16 v[32:35], a[224:227], a[76:79], v[32:35]
    v_mfma_f32_16x16x32_bf16 v[36:39], a[196:199], a[72:75], 0
    v_mfma_f32_16x16x32_bf16 v[36:39], a[228:231], a[76:79], v[36:39]
    buffer_load_dwordx4 v133, s[8:11], s39 offen offset:1024  lds
    v_mfma_f32_16x16x32_bf16 v[40:43], a[200:203], a[72:75], 0
    s_waitcnt vmcnt(10)
    ds_read_b128 a[80:83], v140 offset:4096
    v_mfma_f32_16x16x32_bf16 v[40:43], a[232:235], a[76:79], v[40:43]
    ds_read_b128 a[84:87], v141 offset:4096
    v_mfma_f32_16x16x32_bf16 v[44:47], a[204:207], a[72:75], 0
    v_mfma_f32_16x16x32_bf16 v[44:47], a[236:239], a[76:79], v[44:47]
    buffer_load_dwordx4 v134, s[8:11], s39 offen offset:2048  lds
    v_mfma_f32_16x16x32_bf16 v[48:51], a[208:211], a[72:75], 0
    v_mfma_f32_16x16x32_bf16 v[48:51], a[240:243], a[76:79], v[48:51]
    v_mfma_f32_16x16x32_bf16 v[52:55], a[212:215], a[72:75], 0
    buffer_load_dwordx4 v135, s[8:11], s39 offen offset:3072  lds
    v_mfma_f32_16x16x32_bf16 v[52:55], a[244:247], a[76:79], v[52:55]
    v_mfma_f32_16x16x32_bf16 v[56:59], a[216:219], a[72:75], 0
    s_lshl_b32 s39, s38, 7
    v_mfma_f32_16x16x32_bf16 v[56:59], a[248:251], a[76:79], v[56:59]
    s_lshl_b32 s40, s38, 19
    s_add_u32 m0, s41, 98304
    v_mfma_f32_16x16x32_bf16 v[60:63], a[220:223], a[72:75], 0
    s_waitcnt vmcnt(8)
    s_barrier
    buffer_load_dwordx4 v136, s[12:15], s40 offen offset:0  lds
    v_mfma_f32_16x16x32_bf16 v[60:63], a[252:255], a[76:79], v[60:63]
    ds_read_b64_tr_b16 a[128:129], v160 offset:32768
    s_add_u32 s38, s38, 1
    s_waitcnt lgkmcnt(1)
    v_mfma_f32_16x16x32_bf16 v[64:67], a[192:195], a[80:83], 0
    ds_read_b64_tr_b16 a[130:131], v160 offset:33792
    s_cmp_eq_u32 s38, 9
    s_cselect_b32 s38, 0, s38
    v_mfma_f32_16x16x32_bf16 v[64:67], a[224:227], a[84:87], v[64:67]
    buffer_load_dwordx4 v137, s[12:15], s40 offen offset:1024  lds
    v_mfma_f32_16x16x32_bf16 v[68:71], a[196:199], a[80:83], 0
    ds_read_b64_tr_b16 a[160:161], v160 offset:40960
    v_mfma_f32_16x16x32_bf16 v[68:71], a[228:231], a[84:87], v[68:71]
    ds_read_b64_tr_b16 a[162:163], v160 offset:41984
    v_mfma_f32_16x16x32_bf16 v[72:75], a[200:203], a[80:83], 0
    ds_read_b64_tr_b16 a[132:133], v160 offset:32776
    v_mfma_f32_16x16x32_bf16 v[72:75], a[232:235], a[84:87], v[72:75]
    ds_read_b128 a[88:91], v140 offset:6144
    buffer_load_dwordx4 v138, s[12:15], s40 offen offset:2048  lds
    v_mfma_f32_16x16x32_bf16 v[76:79], a[204:207], a[80:83], 0
    ds_read_b64_tr_b16 a[134:135], v160 offset:33800
    ds_read_b128 a[92:95], v141 offset:6144
    v_mfma_f32_16x16x32_bf16 v[76:79], a[236:239], a[84:87], v[76:79]
    ds_read_b64_tr_b16 a[164:165], v160 offset:40968
    v_mfma_f32_16x16x32_bf16 v[80:83], a[208:211], a[80:83], 0
    ds_read_b64_tr_b16 a[166:167], v160 offset:41992
    buffer_load_dwordx4 v139, s[12:15], s40 offen offset:3072  lds
    v_mfma_f32_16x16x32_bf16 v[80:83], a[240:243], a[84:87], v[80:83]
    ds_read_b64_tr_b16 a[136:137], v161 offset:32768
    ds_read_b64_tr_b16 a[138:139], v161 offset:33792
    v_mfma_f32_16x16x32_bf16 v[84:87], a[212:215], a[80:83], 0
    ds_read_b64_tr_b16 a[168:169], v161 offset:40960
    v_mfma_f32_16x16x32_bf16 v[84:87], a[244:247], a[84:87], v[84:87]
    ds_read_b64_tr_b16 a[170:171], v161 offset:41984
    s_mov_b32 m0, s44
    v_mfma_f32_16x16x32_bf16 v[88:91], a[216:219], a[80:83], 0
    ds_read_b64_tr_b16 a[140:141], v161 offset:32776
    buffer_load_dwordx4 v128, s[8:11], s39 offen offset:0  lds
    v_mfma_f32_16x16x32_bf16 v[88:91], a[248:251], a[84:87], v[88:91]
    ds_read_b64_tr_b16 a[142:143], v161 offset:33800
    v_mfma_f32_16x16x32_bf16 v[92:95], a[220:223], a[80:83], 0
    ds_read_b64_tr_b16 a[172:173], v161 offset:40968
    v_mfma_f32_16x16x32_bf16 v[92:95], a[252:255], a[84:87], v[92:95]
    ds_read_b64_tr_b16 a[174:175], v161 offset:41992
    buffer_load_dwordx4 v129, s[8:11], s39 offen offset:1024  lds
    s_waitcnt lgkmcnt(10)
    v_mfma_f32_16x16x32_bf16 v[96:99], a[192:195], a[88:91], 0
    ds_read_b64_tr_b16 a[144:145], v162 offset:32768
    ds_read_b64_tr_b16 a[146:147], v162 offset:33792
    v_mfma_f32_16x16x32_bf16 v[96:99], a[224:227], a[92:95], v[96:99]
    ds_read_b64_tr_b16 a[176:177], v162 offset:40960
    v_mfma_f32_16x16x32_bf16 v[100:103], a[196:199], a[88:91], 0
    ds_read_b64_tr_b16 a[178:179], v162 offset:41984
    v_mfma_f32_16x16x32_bf16 v[100:103], a[228:231], a[92:95], v[100:103]
    ds_read_b64_tr_b16 a[148:149], v162 offset:32776
    buffer_load_dwordx4 v130, s[8:11], s39 offen offset:2048  lds
    v_mfma_f32_16x16x32_bf16 v[104:107], a[200:203], a[88:91], 0
    ds_read_b64_tr_b16 a[150:151], v162 offset:33800
    v_mfma_f32_16x16x32_bf16 v[104:107], a[232:235], a[92:95], v[104:107]
    ds_read_b64_tr_b16 a[180:181], v162 offset:40968
    s_waitcnt vmcnt(11)
    ds_read_b128 a[96:99], v142 offset:0
    v_mfma_f32_16x16x32_bf16 v[108:111], a[204:207], a[88:91], 0
    ds_read_b64_tr_b16 a[182:183], v162 offset:41992
    buffer_load_dwordx4 v131, s[8:11], s39 offen offset:3072  lds
    v_mfma_f32_16x16x32_bf16 v[108:111], a[236:239], a[92:95], v[108:111]
    ds_read_b128 a[100:103], v143 offset:0
    ds_read_b64_tr_b16 a[152:153], v163 offset:32768
    v_mfma_f32_16x16x32_bf16 v[112:115], a[208:211], a[88:91], 0
    ds_read_b64_tr_b16 a[154:155], v163 offset:33792
    ds_read_b64_tr_b16 a[184:185], v163 offset:40960
    v_mfma_f32_16x16x32_bf16 v[112:115], a[240:243], a[92:95], v[112:115]
    ds_read_b64_tr_b16 a[186:187], v163 offset:41984
    s_add_u32 m0, s44, 4096
    v_mfma_f32_16x16x32_bf16 v[116:119], a[212:215], a[88:91], 0
    ds_read_b64_tr_b16 a[156:157], v163 offset:32776
    buffer_load_dwordx4 v132, s[8:11], s39 offen offset:0  lds
    v_mfma_f32_16x16x32_bf16 v[116:119], a[244:247], a[92:95], v[116:119]
    ds_read_b64_tr_b16 a[158:159], v163 offset:33800
    v_mfma_f32_16x16x32_bf16 v[120:123], a[216:219], a[88:91], 0
    ds_read_b64_tr_b16 a[188:189], v163 offset:40968
    v_mfma_f32_16x16x32_bf16 v[120:123], a[248:251], a[92:95], v[120:123]
    ds_read_b64_tr_b16 a[190:191], v163 offset:41992
    buffer_load_dwordx4 v133, s[8:11], s39 offen offset:1024  lds
    v_mfma_f32_16x16x32_bf16 v[124:127], a[220:223], a[88:91], 0
    v_mfma_f32_16x16x32_bf16 v[124:127], a[252:255], a[92:95], v[124:127]
    s_waitcnt lgkmcnt(0)
    v_mfma_f32_16x16x32_bf16 v[0:3], a[128:131], a[96:99], v[0:3]
    v_mfma_f32_16x16x32_bf16 v[0:3], a[160:163], a[100:103], v[0:3]
    buffer_load_dwordx4 v134, s[8:11], s39 offen offset:2048  lds
    v_mfma_f32_16x16x32_bf16 v[4:7], a[132:135], a[96:99], v[4:7]
    v_mfma_f32_16x16x32_bf16 v[4:7], a[164:167], a[100:103], v[4:7]
    ds_read_b128 a[104:107], v142 offset:2048
    v_mfma_f32_16x16x32_bf16 v[8:11], a[136:139], a[96:99], v[8:11]
    buffer_load_dwordx4 v135, s[8:11], s39 offen offset:3072  lds
    v_mfma_f32_16x16x32_bf16 v[8:11], a[168:171], a[100:103], v[8:11]
    ds_read_b128 a[108:111], v143 offset:2048
    v_mfma_f32_16x16x32_bf16 v[12:15], a[140:143], a[96:99], v[12:15]
    v_mfma_f32_16x16x32_bf16 v[12:15], a[172:175], a[100:103], v[12:15]
    s_mov_b32 m0, s41
    v_mfma_f32_16x16x32_bf16 v[16:19], a[144:147], a[96:99], v[16:19]
    buffer_load_dwordx4 v128, s[8:11], s49 offen offset:0  lds
    v_mfma_f32_16x16x32_bf16 v[16:19], a[176:179], a[100:103], v[16:19]
    v_mfma_f32_16x16x32_bf16 v[20:23], a[148:151], a[96:99], v[20:23]
    v_mfma_f32_16x16x32_bf16 v[20:23], a[180:183], a[100:103], v[20:23]
    buffer_load_dwordx4 v129, s[8:11], s49 offen offset:1024  lds
    v_mfma_f32_16x16x32_bf16 v[24:27], a[152:155], a[96:99], v[24:27]
    v_mfma_f32_16x16x32_bf16 v[24:27], a[184:187], a[100:103], v[24:27]
    v_mfma_f32_16x16x32_bf16 v[28:31], a[156:159], a[96:99], v[28:31]
    v_mfma_f32_16x16x32_bf16 v[28:31], a[188:191], a[100:103], v[28:31]
    buffer_load_dwordx4 v130, s[8:11], s49 offen offset:2048  lds
    s_waitcnt lgkmcnt(0)
    v_mfma_f32_16x16x32_bf16 v[32:35], a[128:131], a[104:107], v[32:35]
    v_mfma_f32_16x16x32_bf16 v[32:35], a[160:163], a[108:111], v[32:35]
    v_mfma_f32_16x16x32_bf16 v[36:39], a[132:135], a[104:107], v[36:39]
    buffer_load_dwordx4 v131, s[8:11], s49 offen offset:3072  lds
    v_mfma_f32_16x16x32_bf16 v[36:39], a[164:167], a[108:111], v[36:39]
    s_waitcnt vmcnt(16)
    ds_read_b128 a[112:115], v142 offset:4096
    v_mfma_f32_16x16x32_bf16 v[40:43], a[136:139], a[104:107], v[40:43]
    ds_read_b128 a[116:119], v143 offset:4096
    s_lshl_b32 s39, s38, 7
    v_mfma_f32_16x16x32_bf16 v[40:43], a[168:171], a[108:111], v[40:43]
    s_lshl_b32 s40, s38, 19
    s_add_u32 m0, s41, 114688
    v_mfma_f32_16x16x32_bf16 v[44:47], a[140:143], a[104:107], v[44:47]
    buffer_load_dwordx4 v136, s[12:15], s40 offen offset:0  lds
    v_mfma_f32_16x16x32_bf16 v[44:47], a[172:175], a[108:111], v[44:47]
    s_add_u32 s38, s38, 1
    v_mfma_f32_16x16x32_bf16 v[48:51], a[144:147], a[104:107], v[48:51]
    s_waitcnt vmcnt(13)
    s_barrier
    s_cmp_eq_u32 s38, 9
    s_cselect_b32 s38, 0, s38
    v_mfma_f32_16x16x32_bf16 v[48:51], a[176:179], a[108:111], v[48:51]
    buffer_load_dwordx4 v137, s[12:15], s40 offen offset:1024  lds
    v_mfma_f32_16x16x32_bf16 v[52:55], a[148:151], a[104:107], v[52:55]
    ds_read_b64_tr_b16 a[192:193], v160 offset:0
    v_mfma_f32_16x16x32_bf16 v[52:55], a[180:183], a[108:111], v[52:55]
    ds_read_b64_tr_b16 a[194:195], v160 offset:1024
    v_mfma_f32_16x16x32_bf16 v[56:59], a[152:155], a[104:107], v[56:59]
    ds_read_b64_tr_b16 a[224:225], v160 offset:8192
    v_mfma_f32_16x16x32_bf16 v[56:59], a[184:187], a[108:111], v[56:59]
    buffer_load_dwordx4 v138, s[12:15], s40 offen offset:2048  lds
    v_mfma_f32_16x16x32_bf16 v[60:63], a[156:159], a[104:107], v[60:63]
    ds_read_b64_tr_b16 a[226:227], v160 offset:9216
    v_mfma_f32_16x16x32_bf16 v[60:63], a[188:191], a[108:111], v[60:63]
    ds_read_b64_tr_b16 a[196:197], v160 offset:8
    s_waitcnt lgkmcnt(5)
    v_mfma_f32_16x16x32_bf16 v[64:67], a[128:131], a[112:115], v[64:67]
    buffer_load_dwordx4 v139, s[12:15], s40 offen offset:3072  lds
    v_mfma_f32_16x16x32_bf16 v[64:67], a[160:163], a[116:119], v[64:67]
    ds_read_b64_tr_b16 a[198:199], v160 offset:1032
    v_mfma_f32_16x16x32_bf16 v[68:71], a[132:135], a[112:115], v[68:71]
    ds_read_b64_tr_b16 a[228:229], v160 offset:8200
    v_mfma_f32_16x16x32_bf16 v[68:71], a[164:167], a[116:119], v[68:71]
    ds_read_b64_tr_b16 a[230:231], v160 offset:9224
    s_mov_b32 m0, s42
    v_mfma_f32_16x16x32_bf16 v[72:75], a[136:139], a[112:115], v[72:75]
    ds_read_b64_tr_b16 a[200:201], v161 offset:0
    buffer_load_dwordx4 v128, s[8:11], s39 offen offset:0  lds
    v_mfma_f32_16x16x32_bf16 v[72:75], a[168:171], a[116:119], v[72:75]
    ds_read_b64_tr_b16 a[202:203], v161 offset:1024
    ds_read_b128 a[120:123], v142 offset:6144
    v_mfma_f32_16x16x32_bf16 v[76:79], a[140:143], a[112:115], v[76:79]
    ds_read_b64_tr_b16 a[232:233], v161 offset:8192
    ds_read_b128 a[124:127], v143 offset:6144
    v_mfma_f32_16x16x32_bf16 v[76:79], a[172:175], a[116:119], v[76:79]
    ds_read_b64_tr_b16 a[234:235], v161 offset:9216
    buffer_load_dwordx4 v129, s[8:11], s39 offen offset:1024  lds
    v_mfma_f32_16x16x32_bf16 v[80:83], a[144:147], a[112:115], v[80:83]
    ds_read_b64_tr_b16 a[204:205], v161 offset:8
    v_mfma_f32_16x16x32_bf16 v[80:83], a[176:179], a[116:119], v[80:83]
    ds_read_b64_tr_b16 a[206:207], v161 offset:1032
    v_mfma_f32_16x16x32_bf16 v[84:87], a[148:151], a[112:115], v[84:87]
    ds_read_b64_tr_b16 a[236:237], v161 offset:8200
    v_mfma_f32_16x16x32_bf16 v[84:87], a[180:183], a[116:119], v[84:87]
    ds_read_b64_tr_b16 a[238:239], v161 offset:9224
    buffer_load_dwordx4 v130, s[8:11], s39 offen offset:2048  lds
    v_mfma_f32_16x16x32_bf16 v[88:91], a[152:155], a[112:115], v[88:91]
    ds_read_b64_tr_b16 a[208:209], v162 offset:0
    v_mfma_f32_16x16x32_bf16 v[88:91], a[184:187], a[116:119], v[88:91]
    ds_read_b64_tr_b16 a[210:211], v162 offset:1024
    v_mfma_f32_16x16x32_bf16 v[92:95], a[156:159], a[112:115], v[92:95]
    buffer_load_dwordx4 v131, s[8:11], s39 offen offset:3072  lds
    v_mfma_f32_16x16x32_bf16 v[92:95], a[188:191], a[116:119], v[92:95]
    ds_read_b64_tr_b16 a[240:241], v162 offset:8192
    s_waitcnt lgkmcnt(8)
    v_mfma_f32_16x16x32_bf16 v[96:99], a[128:131], a[120:123], v[96:99]
    ds_read_b64_tr_b16 a[242:243], v162 offset:9216
    v_mfma_f32_16x16x32_bf16 v[96:99], a[160:163], a[124:127], v[96:99]
    ds_read_b64_tr_b16 a[212:213], v162 offset:8
    s_add_u32 m0, s42, 4096
    v_mfma_f32_16x16x32_bf16 v[100:103], a[132:135], a[120:123], v[100:103]
    ds_read_b64_tr_b16 a[214:215], v162 offset:1032
    buffer_load_dwordx4 v132, s[8:11], s39 offen offset:0  lds
    v_mfma_f32_16x16x32_bf16 v[100:103], a[164:167], a[124:127], v[100:103]
    ds_read_b64_tr_b16 a[244:245], v162 offset:8200
    v_mfma_f32_16x16x32_bf16 v[104:107], a[136:139], a[120:123], v[104:107]
    ds_read_b64_tr_b16 a[246:247], v162 offset:9224
    s_waitcnt vmcnt(9)
    ds_read_b128 a[0:3], v146 offset:0
    v_mfma_f32_16x16x32_bf16 v[104:107], a[168:171], a[124:127], v[104:107]
    ds_read_b64_tr_b16 a[216:217], v163 offset:0
    buffer_load_dwordx4 v133, s[8:11], s39 offen offset:1024  lds
    v_mfma_f32_16x16x32_bf16 v[108:111], a[140:143], a[120:123], v[108:111]
    ds_read_b128 a[64:67], v144 offset:0
    ds_read_b128 a[4:7], v147 offset:0
    v_mfma_f32_16x16x32_bf16 v[108:111], a[172:175], a[124:127], v[108:111]
    ds_read_b64_tr_b16 a[218:219], v163 offset:1024
    ds_read_b128 a[68:71], v145 offset:0
    v_mfma_f32_16x16x32_bf16 v[112:115], a[144:147], a[120:123], v[112:115]
    ds_read_b128 a[16:19], v146 offset:2048
    ds_read_b64_tr_b16 a[248:249], v163 offset:8192
    v_mfma_f32_16x16x32_bf16 v[112:115], a[176:179], a[124:127], v[112:115]
    ds_read_b128 a[20:23], v147 offset:2048
    buffer_load_dwordx4 v134, s[8:11], s39 offen offset:2048  lds
    v_mfma_f32_16x16x32_bf16 v[116:119], a[148:151], a[120:123], v[116:119]
    ds_read_b64_tr_b16 a[250:251], v163 offset:9216
    ds_read_b64_tr_b16 a[220:221], v163 offset:8
    v_mfma_f32_16x16x32_bf16 v[116:119], a[180:183], a[124:127], v[116:119]
    ds_read_b64_tr_b16 a[222:223], v163 offset:1032
    ds_read_b64_tr_b16 a[252:253], v163 offset:8200
    v_mfma_f32_16x16x32_bf16 v[120:123], a[152:155], a[120:123], v[120:123]
    ds_read_b64_tr_b16 a[254:255], v163 offset:9224
    buffer_load_dwordx4 v135, s[8:11], s39 offen offset:3072  lds
    v_mfma_f32_16x16x32_bf16 v[120:123], a[184:187], a[124:127], v[120:123]
    v_mfma_f32_16x16x32_bf16 v[124:127], a[156:159], a[120:123], v[124:127]
    v_mfma_f32_16x16x32_bf16 v[124:127], a[188:191], a[124:127], v[124:127]
    s_waitcnt lgkmcnt(5)
    s_mov_b32 m0, s41
    s_waitcnt lgkmcnt(0)
    v_mfma_f32_16x16x32_bf16 v[0:3], a[192:195], a[64:67], v[0:3]
    buffer_load_dwordx4 v132, s[8:11], s49 offen offset:0  lds
    v_mfma_f32_16x16x32_bf16 v[0:3], a[224:227], a[68:71], v[0:3]
    v_mfma_f32_16x16x32_bf16 v[4:7], a[196:199], a[64:67], v[4:7]
    v_mfma_f32_16x16x32_bf16 v[4:7], a[228:231], a[68:71], v[4:7]
    buffer_load_dwordx4 v133, s[8:11], s49 offen offset:1024  lds
    v_mfma_f32_16x16x32_bf16 v[8:11], a[200:203], a[64:67], v[8:11]
    ds_read_b128 a[72:75], v144 offset:2048
    v_mfma_f32_16x16x32_bf16 v[8:11], a[232:235], a[68:71], v[8:11]
    ds_read_b128 a[76:79], v145 offset:2048
    v_mfma_f32_16x16x32_bf16 v[12:15], a[204:207], a[64:67], v[12:15]
    v_mfma_f32_16x16x32_bf16 v[12:15], a[236:239], a[68:71], v[12:15]
    buffer_load_dwordx4 v134, s[8:11], s49 offen offset:2048  lds
    v_mfma_f32_16x16x32_bf16 v[16:19], a[208:211], a[64:67], v[16:19]
    v_mfma_f32_16x16x32_bf16 v[16:19], a[240:243], a[68:71], v[16:19]
    v_mfma_f32_16x16x32_bf16 v[20:23], a[212:215], a[64:67], v[20:23]
    buffer_load_dwordx4 v135, s[8:11], s49 offen offset:3072  lds
    v_mfma_f32_16x16x32_bf16 v[20:23], a[244:247], a[68:71], v[20:23]
    v_mfma_f32_16x16x32_bf16 v[24:27], a[216:219], a[64:67], v[24:27]
    s_lshl_b32 s39, s38, 7
    v_mfma_f32_16x16x32_bf16 v[24:27], a[248:251], a[68:71], v[24:27]
    s_lshl_b32 s40, s38, 19
    s_add_u32 m0, s41, 131072
    v_mfma_f32_16x16x32_bf16 v[28:31], a[220:223], a[64:67], v[28:31]
    buffer_load_dwordx4 v136, s[12:15], s40 offen offset:0  lds
    v_mfma_f32_16x16x32_bf16 v[28:31], a[252:255], a[68:71], v[28:31]
    s_add_u32 s38, s38, 1
    s_waitcnt lgkmcnt(0)
    v_mfma_f32_16x16x32_bf16 v[32:35], a[192:195], a[72:75], v[32:35]
    s_cmp_eq_u32 s38, 9
    s_cselect_b32 s38, 0, s38
    v_mfma_f32_16x16x32_bf16 v[32:35], a[224:227], a[76:79], v[32:35]
    buffer_load_dwordx4 v137, s[12:15], s40 offen offset:1024  lds
    v_mfma_f32_16x16x32_bf16 v[36:39], a[196:199], a[72:75], v[36:39]
    v_mfma_f32_16x16x32_bf16 v[36:39], a[228:231], a[76:79], v[36:39]
    ds_read_b128 a[80:83], v144 offset:4096
    v_mfma_f32_16x16x32_bf16 v[40:43], a[200:203], a[72:75], v[40:43]
    s_waitcnt vmcnt(14)
    s_barrier
    v_mfma_f32_16x16x32_bf16 v[40:43], a[232:235], a[76:79], v[40:43]
    buffer_load_dwordx4 v138, s[12:15], s40 offen offset:2048  lds
    v_mfma_f32_16x16x32_bf16 v[44:47], a[204:207], a[72:75], v[44:47]
    ds_read_b128 a[84:87], v145 offset:4096
    v_mfma_f32_16x16x32_bf16 v[44:47], a[236:239], a[76:79], v[44:47]
    ds_read_b64_tr_b16 a[128:129], v160 offset:16384
    v_mfma_f32_16x16x32_bf16 v[48:51], a[208:211], a[72:75], v[48:51]
    buffer_load_dwordx4 v139, s[12:15], s40 offen offset:3072  lds
    v_mfma_f32_16x16x32_bf16 v[48:51], a[240:243], a[76:79], v[48:51]
    ds_read_b64_tr_b16 a[130:131], v160 offset:17408
    v_mfma_f32_16x16x32_bf16 v[52:55], a[212:215], a[72:75], v[52:55]
    ds_read_b64_tr_b16 a[160:161], v160 offset:24576
    v_mfma_f32_16x16x32_bf16 v[52:55], a[244:247], a[76:79], v[52:55]
    ds_read_b64_tr_b16 a[162:163], v160 offset:25600
    s_mov_b32 m0, s43
    v_mfma_f32_16x16x32_bf16 v[56:59], a[216:219], a[72:75], v[56:59]
    ds_read_b64_tr_b16 a[132:133], v160 offset:16392
    buffer_load_dwordx4 v128, s[8:11], s39 offen offset:0  lds
    v_mfma_f32_16x16x32_bf16 v[56:59], a[248:251], a[76:79], v[56:59]
    ds_read_b64_tr_b16 a[134:135], v160 offset:17416
    v_mfma_f32_16x16x32_bf16 v[60:63], a[220:223], a[72:75], v[60:63]
    ds_read_b64_tr_b16 a[164:165], v160 offset:24584
    v_mfma_f32_16x16x32_bf16 v[60:63], a[252:255], a[76:79], v[60:63]
    buffer_load_dwordx4 v129, s[8:11], s39 offen offset:1024  lds
    s_waitcnt lgkmcnt(7)
    v_mfma_f32_16x16x32_bf16 v[64:67], a[192:195], a[80:83], v[64:67]
    ds_read_b64_tr_b16 a[166:167], v160 offset:25608
    v_mfma_f32_16x16x32_bf16 v[64:67], a[224:227], a[84:87], v[64:67]
    ds_read_b64_tr_b16 a[136:137], v161 offset:16384
    v_mfma_f32_16x16x32_bf16 v[68:71], a[196:199], a[80:83], v[68:71]
    ds_read_b64_tr_b16 a[138:139], v161 offset:17408
    v_mfma_f32_16x16x32_bf16 v[68:71], a[228:231], a[84:87], v[68:71]
    ds_read_b64_tr_b16 a[168:169], v161 offset:24576
    buffer_load_dwordx4 v130, s[8:11], s39 offen offset:2048  lds
    v_mfma_f32_16x16x32_bf16 v[72:75], a[200:203], a[80:83], v[72:75]
    ds_read_b64_tr_b16 a[170:171], v161 offset:25600
    v_mfma_f32_16x16x32_bf16 v[72:75], a[232:235], a[84:87], v[72:75]
    ds_read_b128 a[88:91], v144 offset:6144
    v_mfma_f32_16x16x32_bf16 v[76:79], a[204:207], a[80:83], v[76:79]
    ds_read_b64_tr_b16 a[140:141], v161 offset:16392
    buffer_load_dwordx4 v131, s[8:11], s39 offen offset:3072  lds
    v_mfma_f32_16x16x32_bf16 v[76:79], a[236:239], a[84:87], v[76:79]
    ds_read_b128 a[92:95], v145 offset:6144
    ds_read_b64_tr_b16 a[142:143], v161 offset:17416
    v_mfma_f32_16x16x32_bf16 v[80:83], a[208:211], a[80:83], v[80:83]
    ds_read_b64_tr_b16 a[172:173], v161 offset:24584
    v_mfma_f32_16x16x32_bf16 v[80:83], a[240:243], a[84:87], v[80:83]
    ds_read_b64_tr_b16 a[174:175], v161 offset:25608
    s_add_u32 m0, s43, 4096
    v_mfma_f32_16x16x32_bf16 v[84:87], a[212:215], a[80:83], v[84:87]
    ds_read_b64_tr_b16 a[144:145], v162 offset:16384
    buffer_load_dwordx4 v132, s[8:11], s39 offen offset:0  lds
    v_mfma_f32_16x16x32_bf16 v[84:87], a[244:247], a[84:87], v[84:87]
    ds_read_b64_tr_b16 a[146:147], v162 offset:17408
    v_mfma_f32_16x16x32_bf16 v[88:91], a[216:219], a[80:83], v[88:91]
    s_waitcnt vmcnt(9)
    ds_read_b128 a[32:35], v146 offset:0
    v_mfma_f32_16x16x32_bf16 v[88:91], a[248:251], a[84:87], v[88:91]
    ds_read_b64_tr_b16 a[176:177], v162 offset:24576
    buffer_load_dwordx4 v133, s[8:11], s39 offen offset:1024  lds
    v_mfma_f32_16x16x32_bf16 v[92:95], a[220:223], a[80:83], v[92:95]
    ds_read_b128 a[36:39], v147 offset:0
    ds_read_b64_tr_b16 a[178:179], v162 offset:25600
    v_mfma_f32_16x16x32_bf16 v[92:95], a[252:255], a[84:87], v[92:95]
    ds_read_b128 a[48:51], v146 offset:2048
    ds_read_b64_tr_b16 a[148:149], v162 offset:16392
    s_waitcnt lgkmcnt(11)
    v_mfma_f32_16x16x32_bf16 v[96:99], a[192:195], a[88:91], v[96:99]
    ds_read_b128 a[52:55], v147 offset:2048
    ds_read_b64_tr_b16 a[150:151], v162 offset:17416
    v_mfma_f32_16x16x32_bf16 v[96:99], a[224:227], a[92:95], v[96:99]
    ds_read_b128 a[96:99], v140 offset:0
    buffer_load_dwordx4 v134, s[8:11], s39 offen offset:2048  lds
    v_mfma_f32_16x16x32_bf16 v[100:103], a[196:199], a[88:91], v[100:103]
    ds_read_b128 a[100:103], v141 offset:0
    ds_read_b64_tr_b16 a[180:181], v162 offset:24584
    v_mfma_f32_16x16x32_bf16 v[100:103], a[228:231], a[92:95], v[100:103]
    ds_read_b64_tr_b16 a[182:183], v162 offset:25608
    ds_read_b128 a[104:107], v140 offset:2048
    v_mfma_f32_16x16x32_bf16 v[104:107], a[200:203], a[88:91], v[104:107]
    ds_read_b64_tr_b16 a[152:153], v163 offset:16384
    buffer_load_dwordx4 v135, s[8:11], s39 offen offset:3072  lds
    v_mfma_f32_16x16x32_bf16 v[104:107], a[232:235], a[92:95], v[104:107]
    ds_read_b128 a[108:111], v141 offset:2048
    ds_read_b64_tr_b16 a[154:155], v163 offset:17408
    v_mfma_f32_16x16x32_bf16 v[108:111], a[204:207], a[88:91], v[108:111]
    ds_read_b64_tr_b16 a[184:185], v163 offset:24576
    ds_read_b128 a[112:115], v140 offset:4096
    v_mfma_f32_16x16x32_bf16 v[108:111], a[236:239], a[92:95], v[108:111]
    ds_read_b128 a[116:119], v141 offset:4096
    s_waitcnt lgkmcnt(12)
    s_mov_b32 m0, s41
    v_mfma_f32_16x16x32_bf16 v[112:115], a[208:211], a[88:91], v[112:115]
    ds_read_b64_tr_b16 a[186:187], v163 offset:25600
    buffer_load_dwordx4 v128, s[8:11], s50 offen offset:0  lds
    v_mfma_f32_16x16x32_bf16 v[112:115], a[240:243], a[92:95], v[112:115]
    ds_read_b64_tr_b16 a[156:157], v163 offset:16392
    ds_read_b128 a[120:123], v140 offset:6144
    v_mfma_f32_16x16x32_bf16 v[116:119], a[212:215], a[88:91], v[116:119]
    ds_read_b64_tr_b16 a[158:159], v163 offset:17416
    ds_read_b128 a[124:127], v141 offset:6144
    v_mfma_f32_16x16x32_bf16 v[116:119], a[244:247], a[92:95], v[116:119]
    ds_read_b64_tr_b16 a[188:189], v163 offset:24584
    buffer_load_dwordx4 v129, s[8:11], s50 offen offset:1024  lds
    v_mfma_f32_16x16x32_bf16 v[120:123], a[216:219], a[88:91], v[120:123]
    ds_read_b64_tr_b16 a[190:191], v163 offset:25608
    v_mfma_f32_16x16x32_bf16 v[120:123], a[248:251], a[92:95], v[120:123]
    v_mfma_f32_16x16x32_bf16 v[124:127], a[220:223], a[88:91], v[124:127]
    v_mfma_f32_16x16x32_bf16 v[124:127], a[252:255], a[92:95], v[124:127]
    buffer_load_dwordx4 v130, s[8:11], s50 offen offset:2048  lds
    s_waitcnt lgkmcnt(0)
    v_mfma_f32_16x16x32_bf16 v[0:3], a[128:131], a[96:99], v[0:3]
    v_mfma_f32_16x16x32_bf16 v[0:3], a[160:163], a[100:103], v[0:3]
    v_mfma_f32_16x16x32_bf16 v[4:7], a[132:135], a[96:99], v[4:7]
    buffer_load_dwordx4 v131, s[8:11], s50 offen offset:3072  lds
    v_mfma_f32_16x16x32_bf16 v[4:7], a[164:167], a[100:103], v[4:7]
    v_mfma_f32_16x16x32_bf16 v[8:11], a[136:139], a[96:99], v[8:11]
    s_lshl_b32 s39, s38, 7
    v_mfma_f32_16x16x32_bf16 v[8:11], a[168:171], a[100:103], v[8:11]
    s_lshl_b32 s40, s38, 19
    s_add_u32 m0, s41, 98304
    v_mfma_f32_16x16x32_bf16 v[12:15], a[140:143], a[96:99], v[12:15]
    buffer_load_dwordx4 v136, s[12:15], s40 offen offset:0  lds
    v_mfma_f32_16x16x32_bf16 v[12:15], a[172:175], a[100:103], v[12:15]
    s_add_u32 s38, s38, 1
    v_mfma_f32_16x16x32_bf16 v[16:19], a[144:147], a[96:99], v[16:19]
    s_cmp_eq_u32 s38, 9
    s_cselect_b32 s38, 0, s38
    v_mfma_f32_16x16x32_bf16 v[16:19], a[176:179], a[100:103], v[16:19]
    buffer_load_dwordx4 v137, s[12:15], s40 offen offset:1024  lds
    v_mfma_f32_16x16x32_bf16 v[20:23], a[148:151], a[96:99], v[20:23]
    v_mfma_f32_16x16x32_bf16 v[20:23], a[180:183], a[100:103], v[20:23]
    v_mfma_f32_16x16x32_bf16 v[24:27], a[152:155], a[96:99], v[24:27]
    v_mfma_f32_16x16x32_bf16 v[24:27], a[184:187], a[100:103], v[24:27]
    buffer_load_dwordx4 v138, s[12:15], s40 offen offset:2048  lds
    v_mfma_f32_16x16x32_bf16 v[28:31], a[156:159], a[96:99], v[28:31]
    v_mfma_f32_16x16x32_bf16 v[28:31], a[188:191], a[100:103], v[28:31]
    v_mfma_f32_16x16x32_bf16 v[32:35], a[128:131], a[104:107], v[32:35]
    s_waitcnt vmcnt(15)
    s_barrier
    buffer_load_dwordx4 v139, s[12:15], s40 offen offset:3072  lds
    v_mfma_f32_16x16x32_bf16 v[32:35], a[160:163], a[108:111], v[32:35]
    ds_read_b64_tr_b16 a[192:193], v160 offset:32768
    v_mfma_f32_16x16x32_bf16 v[36:39], a[132:135], a[104:107], v[36:39]
    ds_read_b64_tr_b16 a[194:195], v160 offset:33792
    v_mfma_f32_16x16x32_bf16 v[36:39], a[164:167], a[108:111], v[36:39]
    ds_read_b64_tr_b16 a[224:225], v160 offset:40960
    s_mov_b32 m0, s44
    v_mfma_f32_16x16x32_bf16 v[40:43], a[136:139], a[104:107], v[40:43]
    buffer_load_dwordx4 v128, s[8:11], s39 offen offset:0  lds
    v_mfma_f32_16x16x32_bf16 v[40:43], a[168:171], a[108:111], v[40:43]
    ds_read_b64_tr_b16 a[226:227], v160 offset:41984
    v_mfma_f32_16x16x32_bf16 v[44:47], a[140:143], a[104:107], v[44:47]
    ds_read_b64_tr_b16 a[196:197], v160 offset:32776
    v_mfma_f32_16x16x32_bf16 v[44:47], a[172:175], a[108:111], v[44:47]
    buffer_load_dwordx4 v129, s[8:11], s39 offen offset:1024  lds
    v_mfma_f32_16x16x32_bf16 v[48:51], a[144:147], a[104:107], v[48:51]
    ds_read_b64_tr_b16 a[198:199], v160 offset:33800
    v_mfma_f32_16x16x32_bf16 v[48:51], a[176:179], a[108:111], v[48:51]
    ds_read_b64_tr_b16 a[228:229], v160 offset:40968
    v_mfma_f32_16x16x32_bf16 v[52:55], a[148:151], a[104:107], v[52:55]
    ds_read_b64_tr_b16 a[230:231], v160 offset:41992
    v_mfma_f32_16x16x32_bf16 v[52:55], a[180:183], a[108:111], v[52:55]
    buffer_load_dwordx4 v130, s[8:11], s39 offen offset:2048  lds
    v_mfma_f32_16x16x32_bf16 v[56:59], a[152:155], a[104:107], v[56:59]
    ds_read_b64_tr_b16 a[200:201], v161 offset:32768
    v_mfma_f32_16x16x32_bf16 v[56:59], a[184:187], a[108:111], v[56:59]
    ds_read_b64_tr_b16 a[202:203], v161 offset:33792
    v_mfma_f32_16x16x32_bf16 v[60:63], a[156:159], a[104:107], v[60:63]
    buffer_load_dwordx4 v131, s[8:11], s39 offen offset:3072  lds
    v_mfma_f32_16x16x32_bf16 v[60:63], a[188:191], a[108:111], v[60:63]
    ds_read_b64_tr_b16 a[232:233], v161 offset:40960
    v_mfma_f32_16x16x32_bf16 v[64:67], a[128:131], a[112:115], v[64:67]
    ds_read_b64_tr_b16 a[234:235], v161 offset:41984
    v_mfma_f32_16x16x32_bf16 v[64:67], a[160:163], a[116:119], v[64:67]
    ds_read_b64_tr_b16 a[204:205], v161 offset:32776
    s_add_u32 m0, s44, 4096
    v_mfma_f32_16x16x32_bf16 v[68:71], a[132:135], a[112:115], v[68:71]
    buffer_load_dwordx4 v132, s[8:11], s39 offen offset:0  lds
    v_mfma_f32_16x16x32_bf16 v[68:71], a[164:167], a[116:119], v[68:71]
    s_waitcnt vmcnt(9)
    ds_read_b128 a[8:11], v146 offset:0
    v_mfma_f32_16x16x32_bf16 v[72:75], a[136:139], a[112:115], v[72:75]
    ds_read_b64_tr_b16 a[206:207], v161 offset:33800
    v_mfma_f32_16x16x32_bf16 v[72:75], a[168:171], a[116:119], v[72:75]
    ds_read_b128 a[12:15], v147 offset:0
    buffer_load_dwordx4 v133, s[8:11], s39 offen offset:1024  lds
    v_mfma_f32_16x16x32_bf16 v[76:79], a[140:143], a[112:115], v[76:79]
    ds_read_b64_tr_b16 a[236:237], v161 offset:40968
    ds_read_b128 a[24:27], v146 offset:2048
    v_mfma_f32_16x16x32_bf16 v[76:79], a[172:175], a[116:119], v[76:79]
    ds_read_b64_tr_b16 a[238:239], v161 offset:41992
    ds_read_b128 a[28:31], v147 offset:2048
    v_mfma_f32_16x16x32_bf16 v[80:83], a[144:147], a[112:115], v[80:83]
    ds_read_b64_tr_b16 a[208:209], v162 offset:32768
    v_mfma_f32_16x16x32_bf16 v[80:83], a[176:179], a[116:119], v[80:83]
    buffer_load_dwordx4 v134, s[8:11], s39 offen offset:2048  lds
    v_mfma_f32_16x16x32_bf16 v[84:87], a[148:151], a[112:115], v[84:87]
    ds_read_b64_tr_b16 a[210:211], v162 offset:33792
    v_mfma_f32_16x16x32_bf16 v[84:87], a[180:183], a[116:119], v[84:87]
    ds_read_b64_tr_b16 a[240:241], v162 offset:40960
    v_mfma_f32_16x16x32_bf16 v[88:91], a[152:155], a[112:115], v[88:91]
    ds_read_b64_tr_b16 a[242:243], v162 offset:41984
    buffer_load_dwordx4 v135, s[8:11], s39 offen offset:3072  lds
    v_mfma_f32_16x16x32_bf16 v[88:91], a[184:187], a[116:119], v[88:91]
    ds_read_b64_tr_b16 a[212:213], v162 offset:32776
    v_mfma_f32_16x16x32_bf16 v[92:95], a[156:159], a[112:115], v[92:95]
    ds_read_b64_tr_b16 a[214:215], v162 offset:33800
    v_mfma_f32_16x16x32_bf16 v[92:95], a[188:191], a[116:119], v[92:95]
    ds_read_b64_tr_b16 a[244:245], v162 offset:40968
    s_waitcnt lgkmcnt(7)
    s_mov_b32 m0, s41
    v_mfma_f32_16x16x32_bf16 v[96:99], a[128:131], a[120:123], v[96:99]
    ds_read_b128 a[64:67], v142 offset:0
    buffer_load_dwordx4 v132, s[8:11], s50 offen offset:0  lds
    v_mfma_f32_16x16x32_bf16 v[96:99], a[160:163], a[124:127], v[96:99]
    ds_read_b128 a[68:71], v143 offset:0
    v_mfma_f32_16x16x32_bf16 v[100:103], a[132:135], a[120:123], v[100:103]
    ds_read_b64_tr_b16 a[246:247], v162 offset:41992
    v_mfma_f32_16x16x32_bf16 v[100:103], a[164:167], a[124:127], v[100:103]
    ds_read_b64_tr_b16 a[216:217], v163 offset:32768
    buffer_load_dwordx4 v133, s[8:11], s50 offen offset:1024  lds
    v_mfma_f32_16x16x32_bf16 v[104:107], a[136:139], a[120:123], v[104:107]
    ds_read_b128 a[72:75], v142 offset:2048
    ds_read_b64_tr_b16 a[218:219], v163 offset:33792
    v_mfma_f32_16x16x32_bf16 v[104:107], a[168:171], a[124:127], v[104:107]
    ds_read_b128 a[76:79], v143 offset:2048
    v_mfma_f32_16x16x32_bf16 v[108:111], a[140:143], a[120:123], v[108:111]
    ds_read_b64_tr_b16 a[248:249], v163 offset:40960
    ds_read_b128 a[80:83], v142 offset:4096
    v_mfma_f32_16x16x32_bf16 v[108:111], a[172:175], a[124:127], v[108:111]
    ds_read_b64_tr_b16 a[250:251], v163 offset:41984
    buffer_load_dwordx4 v134, s[8:11], s50 offen offset:2048  lds
    v_mfma_f32_16x16x32_bf16 v[112:115], a[144:147], a[120:123], v[112:115]
    ds_read_b128 a[84:87], v143 offset:4096
    ds_read_b64_tr_b16 a[220:221], v163 offset:32776
    v_mfma_f32_16x16x32_bf16 v[112:115], a[176:179], a[124:127], v[112:115]
    ds_read_b128 a[88:91], v142 offset:6144
    v_mfma_f32_16x16x32_bf16 v[116:119], a[148:151], a[120:123], v[116:119]
    ds_read_b64_tr_b16 a[222:223], v163 offset:33800
    buffer_load_dwordx4 v135, s[8:11], s50 offen offset:3072  lds
    v_mfma_f32_16x16x32_bf16 v[116:119], a[180:183], a[124:127], v[116:119]
    ds_read_b128 a[92:95], v143 offset:6144
    ds_read_b64_tr_b16 a[252:253], v163 offset:40968
    v_mfma_f32_16x16x32_bf16 v[120:123], a[152:155], a[120:123], v[120:123]
    ds_read_b64_tr_b16 a[254:255], v163 offset:41992
    s_lshl_b32 s39, s38, 7
    v_mfma_f32_16x16x32_bf16 v[120:123], a[184:187], a[124:127], v[120:123]
    s_lshl_b32 s40, s38, 19
    s_add_u32 m0, s41, 114688
    v_mfma_f32_16x16x32_bf16 v[124:127], a[156:159], a[120:123], v[124:127]
    buffer_load_dwordx4 v136, s[12:15], s40 offen offset:0  lds
    v_mfma_f32_16x16x32_bf16 v[124:127], a[188:191], a[124:127], v[124:127]
    s_add_u32 s38, s38, 1
    s_waitcnt lgkmcnt(0)
    v_mfma_f32_16x16x32_bf16 v[0:3], a[192:195], a[64:67], v[0:3]
    s_cmp_eq_u32 s38, 9
    s_cselect_b32 s38, 0, s38
    v_mfma_f32_16x16x32_bf16 v[0:3], a[224:227], a[68:71], v[0:3]
    buffer_load_dwordx4 v137, s[12:15], s40 offen offset:1024  lds
    v_mfma_f32_16x16x32_bf16 v[4:7], a[196:199], a[64:67], v[4:7]
    v_mfma_f32_16x16x32_bf16 v[4:7], a[228:231], a[68:71], v[4:7]
    v_mfma_f32_16x16x32_bf16 v[8:11], a[200:203], a[64:67], v[8:11]
    v_mfma_f32_16x16x32_bf16 v[8:11], a[232:235], a[68:71], v[8:11]
    buffer_load_dwordx4 v138, s[12:15], s40 offen offset:2048  lds
    v_mfma_f32_16x16x32_bf16 v[12:15], a[204:207], a[64:67], v[12:15]
    v_mfma_f32_16x16x32_bf16 v[12:15], a[236:239], a[68:71], v[12:15]
    v_mfma_f32_16x16x32_bf16 v[16:19], a[208:211], a[64:67], v[16:19]
    buffer_load_dwordx4 v139, s[12:15], s40 offen offset:3072  lds
    v_mfma_f32_16x16x32_bf16 v[16:19], a[240:243], a[68:71], v[16:19]
    v_mfma_f32_16x16x32_bf16 v[20:23], a[212:215], a[64:67], v[20:23]
    v_mfma_f32_16x16x32_bf16 v[20:23], a[244:247], a[68:71], v[20:23]
    s_mov_b32 m0, s42
    v_mfma_f32_16x16x32_bf16 v[24:27], a[216:219], a[64:67], v[24:27]
    buffer_load_dwordx4 v128, s[8:11], s39 offen offset:0  lds
    v_mfma_f32_16x16x32_bf16 v[24:27], a[248:251], a[68:71], v[24:27]
    v_mfma_f32_16x16x32_bf16 v[28:31], a[220:223], a[64:67], v[28:31]
    v_mfma_f32_16x16x32_bf16 v[28:31], a[252:255], a[68:71], v[28:31]
    buffer_load_dwordx4 v129, s[8:11], s39 offen offset:1024  lds
    v_mfma_f32_16x16x32_bf16 v[32:35], a[192:195], a[72:75], v[32:35]
    s_waitcnt vmcnt(18)
    s_barrier
    v_mfma_f32_16x16x32_bf16 v[32:35], a[224:227], a[76:79], v[32:35]
    ds_read_b64_tr_b16 a[128:129], v160 offset:0
    v_mfma_f32_16x16x32_bf16 v[36:39], a[196:199], a[72:75], v[36:39]
    ds_read_b64_tr_b16 a[130:131], v160 offset:1024
    v_mfma_f32_16x16x32_bf16 v[36:39], a[228:231], a[76:79], v[36:39]
    buffer_load_dwordx4 v130, s[8:11], s39 offen offset:2048  lds
    v_mfma_f32_16x16x32_bf16 v[40:43], a[200:203], a[72:75], v[40:43]
    ds_read_b64_tr_b16 a[160:161], v160 offset:8192
    v_mfma_f32_16x16x32_bf16 v[40:43], a[232:235], a[76:79], v[40:43]
    ds_read_b64_tr_b16 a[162:163], v160 offset:9216
    v_mfma_f32_16x16x32_bf16 v[44:47], a[204:207], a[72:75], v[44:47]
    buffer_load_dwordx4 v131, s[8:11], s39 offen offset:3072  lds
    v_mfma_f32_16x16x32_bf16 v[44:47], a[236:239], a[76:79], v[44:47]
    ds_read_b64_tr_b16 a[132:133], v160 offset:8
    v_mfma_f32_16x16x32_bf16 v[48:51], a[208:211], a[72:75], v[48:51]
    ds_read_b64_tr_b16 a[134:135], v160 offset:1032
    v_mfma_f32_16x16x32_bf16 v[48:51], a[240:243], a[76:79], v[48:51]
    ds_read_b64_tr_b16 a[164:165], v160 offset:8200
    s_add_u32 m0, s42, 4096
    v_mfma_f32_16x16x32_bf16 v[52:55], a[212:215], a[72:75], v[52:55]
    buffer_load_dwordx4 v132, s[8:11], s39 offen offset:0  lds
    v_mfma_f32_16x16x32_bf16 v[52:55], a[244:247], a[76:79], v[52:55]
    s_waitcnt vmcnt(9)
    ds_read_b128 a[40:43], v146 offset:0
    v_mfma_f32_16x16x32_bf16 v[56:59], a[216:219], a[72:75], v[56:59]
    ds_read_b64_tr_b16 a[166:167], v160 offset:9224
    v_mfma_f32_16x16x32_bf16 v[56:59], a[248:251], a[76:79], v[56:59]
    ds_read_b128 a[44:47], v147 offset:0
    buffer_load_dwordx4 v133, s[8:11], s39 offen offset:1024  lds
    v_mfma_f32_16x16x32_bf16 v[60:63], a[220:223], a[72:75], v[60:63]
    ds_read_b64_tr_b16 a[136:137], v161 offset:0
    ds_read_b128 a[56:59], v146 offset:2048
    v_mfma_f32_16x16x32_bf16 v[60:63], a[252:255], a[76:79], v[60:63]
    ds_read_b64_tr_b16 a[138:139], v161 offset:1024
    ds_read_b128 a[60:63], v147 offset:2048
    v_mfma_f32_16x16x32_bf16 v[64:67], a[192:195], a[80:83], v[64:67]
    ds_read_b64_tr_b16 a[168:169], v161 offset:8192
    v_mfma_f32_16x16x32_bf16 v[64:67], a[224:227], a[84:87], v[64:67]
    buffer_load_dwordx4 v134, s[8:11], s39 offen offset:2048  lds
    v_mfma_f32_16x16x32_bf16 v[68:71], a[196:199], a[80:83], v[68:71]
    ds_read_b64_tr_b16 a[170:171], v161 offset:9216
    v_mfma_f32_16x16x32_bf16 v[68:71], a[228:231], a[84:87], v[68:71]
    ds_read_b64_tr_b16 a[140:141], v161 offset:8
    v_mfma_f32_16x16x32_bf16 v[72:75], a[200:203], a[80:83], v[72:75]
    buffer_load_dwordx4 v135, s[8:11], s39 offen offset:3072  lds
    v_mfma_f32_16x16x32_bf16 v[72:75], a[232:235], a[84:87], v[72:75]
    ds_read_b64_tr_b16 a[142:143], v161 offset:1032
    v_mfma_f32_16x16x32_bf16 v[76:79], a[204:207], a[80:83], v[76:79]
    ds_read_b64_tr_b16 a[172:173], v161 offset:8200
    s_lshl_b32 s39, s38, 7
    v_mfma_f32_16x16x32_bf16 v[76:79], a[236:239], a[84:87], v[76:79]
    ds_read_b64_tr_b16 a[174:175], v161 offset:9224
    s_lshl_b32 s40, s38, 19
    s_add_u32 m0, s41, 131072
    v_mfma_f32_16x16x32_bf16 v[80:83], a[208:211], a[80:83], v[80:83]
    ds_read_b64_tr_b16 a[144:145], v162 offset:0
    buffer_load_dwordx4 v136, s[12:15], s40 offen offset:0  lds
    v_mfma_f32_16x16x32_bf16 v[80:83], a[240:243], a[84:87], v[80:83]
    ds_read_b64_tr_b16 a[146:147], v162 offset:1024
    s_add_u32 s38, s38, 1
    v_mfma_f32_16x16x32_bf16 v[84:87], a[212:215], a[80:83], v[84:87]
    ds_read_b64_tr_b16 a[176:177], v162 offset:8192
    s_cmp_eq_u32 s38, 9
    s_cselect_b32 s38, 0, s38
    v_mfma_f32_16x16x32_bf16 v[84:87], a[244:247], a[84:87], v[84:87]
    buffer_load_dwordx4 v137, s[12:15], s40 offen offset:1024  lds
    v_mfma_f32_16x16x32_bf16 v[88:91], a[216:219], a[80:83], v[88:91]
    ds_read_b64_tr_b16 a[178:179], v162 offset:9216
    v_mfma_f32_16x16x32_bf16 v[88:91], a[248:251], a[84:87], v[88:91]
    ds_read_b64_tr_b16 a[148:149], v162 offset:8
    v_mfma_f32_16x16x32_bf16 v[92:95], a[220:223], a[80:83], v[92:95]
    ds_read_b64_tr_b16 a[150:151], v162 offset:1032
    v_mfma_f32_16x16x32_bf16 v[92:95], a[252:255], a[84:87], v[92:95]
    buffer_load_dwordx4 v138, s[12:15], s40 offen offset:2048  lds
    v_mfma_f32_16x16x32_bf16 v[96:99], a[192:195], a[88:91], v[96:99]
    ds_read_b64_tr_b16 a[180:181], v162 offset:8200
    ds_read_b128 a[96:99], v144 offset:0
    v_mfma_f32_16x16x32_bf16 v[96:99], a[224:227], a[92:95], v[96:99]
    ds_read_b128 a[100:103], v145 offset:0
    v_mfma_f32_16x16x32_bf16 v[100:103], a[196:199], a[88:91], v[100:103]
    ds_read_b64_tr_b16 a[182:183], v162 offset:9224
    buffer_load_dwordx4 v139, s[12:15], s40 offen offset:3072  lds
    v_mfma_f32_16x16x32_bf16 v[100:103], a[228:231], a[92:95], v[100:103]
    ds_read_b64_tr_b16 a[152:153], v163 offset:0
    ds_read_b128 a[104:107], v144 offset:2048
    v_mfma_f32_16x16x32_bf16 v[104:107], a[200:203], a[88:91], v[104:107]
    ds_read_b64_tr_b16 a[154:155], v163 offset:1024
    ds_read_b128 a[108:111], v145 offset:2048
    s_lshl_b32 s39, s38, 7
    v_mfma_f32_16x16x32_bf16 v[104:107], a[232:235], a[92:95], v[104:107]
    ds_read_b64_tr_b16 a[184:185], v163 offset:8192
    s_lshl_b32 s40, s38, 19
    s_add_u32 m0, s41, 147456
    v_mfma_f32_16x16x32_bf16 v[108:111], a[204:207], a[88:91], v[108:111]
    ds_read_b128 a[112:115], v144 offset:4096
    buffer_load_dwordx4 v136, s[12:15], s40 offen offset:0  lds
    v_mfma_f32_16x16x32_bf16 v[108:111], a[236:239], a[92:95], v[108:111]
    ds_read_b64_tr_b16 a[186:187], v163 offset:9216
    ds_read_b128 a[116:119], v145 offset:4096
    s_add_u32 s38, s38, 1
    v_mfma_f32_16x16x32_bf16 v[112:115], a[208:211], a[88:91], v[112:115]
    ds_read_b64_tr_b16 a[156:157], v163 offset:8
    s_cmp_eq_u32 s38, 9
    s_cselect_b32 s38, 0, s38
    v_mfma_f32_16x16x32_bf16 v[112:115], a[240:243], a[92:95], v[112:115]
    ds_read_b128 a[120:123], v144 offset:6144
    buffer_load_dwordx4 v137, s[12:15], s40 offen offset:1024  lds
    v_mfma_f32_16x16x32_bf16 v[116:119], a[212:215], a[88:91], v[116:119]
    ds_read_b64_tr_b16 a[158:159], v163 offset:1032
    ds_read_b128 a[124:127], v145 offset:6144
    v_mfma_f32_16x16x32_bf16 v[116:119], a[244:247], a[92:95], v[116:119]
    ds_read_b64_tr_b16 a[188:189], v163 offset:8200
    v_mfma_f32_16x16x32_bf16 v[120:123], a[216:219], a[88:91], v[120:123]
    ds_read_b64_tr_b16 a[190:191], v163 offset:9224
    v_mfma_f32_16x16x32_bf16 v[120:123], a[248:251], a[92:95], v[120:123]
    buffer_load_dwordx4 v138, s[12:15], s40 offen offset:2048  lds
    v_mfma_f32_16x16x32_bf16 v[124:127], a[220:223], a[88:91], v[124:127]
    v_mfma_f32_16x16x32_bf16 v[124:127], a[252:255], a[92:95], v[124:127]
    s_waitcnt lgkmcnt(0)
    v_mfma_f32_16x16x32_bf16 v[0:3], a[128:131], a[96:99], v[0:3]
    buffer_load_dwordx4 v139, s[12:15], s40 offen offset:3072  lds
    v_mfma_f32_16x16x32_bf16 v[0:3], a[160:163], a[100:103], v[0:3]
    v_mfma_f32_16x16x32_bf16 v[4:7], a[132:135], a[96:99], v[4:7]
    v_mfma_f32_16x16x32_bf16 v[4:7], a[164:167], a[100:103], v[4:7]
    s_add_u32 m0, s41, 0
    v_mfma_f32_16x16x32_bf16 v[8:11], a[136:139], a[96:99], v[8:11]
    buffer_load_dwordx4 v232, s[16:19], s45 offen offset:0 nt lds
    v_mfma_f32_16x16x32_bf16 v[8:11], a[168:171], a[100:103], v[8:11]
    v_mfma_f32_16x16x32_bf16 v[12:15], a[140:143], a[96:99], v[12:15]
    v_mfma_f32_16x16x32_bf16 v[12:15], a[172:175], a[100:103], v[12:15]
    v_mfma_f32_16x16x32_bf16 v[16:19], a[144:147], a[96:99], v[16:19]
    v_mfma_f32_16x16x32_bf16 v[16:19], a[176:179], a[100:103], v[16:19]
    v_mfma_f32_16x16x32_bf16 v[20:23], a[148:151], a[96:99], v[20:23]
    v_mfma_f32_16x16x32_bf16 v[20:23], a[180:183], a[100:103], v[20:23]
    v_mfma_f32_16x16x32_bf16 v[24:27], a[152:155], a[96:99], v[24:27]
    v_mfma_f32_16x16x32_bf16 v[24:27], a[184:187], a[100:103], v[24:27]
    v_mfma_f32_16x16x32_bf16 v[28:31], a[156:159], a[96:99], v[28:31]
    v_mfma_f32_16x16x32_bf16 v[28:31], a[188:191], a[100:103], v[28:31]
    buffer_load_dwordx4 v232, s[16:19], s45 offen offset:1024 nt lds
    v_mfma_f32_16x16x32_bf16 v[32:35], a[128:131], a[104:107], v[32:35]
    s_waitcnt vmcnt(18)
    s_barrier
    v_mfma_f32_16x16x32_bf16 v[32:35], a[160:163], a[108:111], v[32:35]
    ds_read_b64_tr_b16 a[192:193], v160 offset:16384
    v_mfma_f32_16x16x32_bf16 v[36:39], a[132:135], a[104:107], v[36:39]
    ds_read_b64_tr_b16 a[194:195], v160 offset:17408
    v_mfma_f32_16x16x32_bf16 v[36:39], a[164:167], a[108:111], v[36:39]
    ds_read_b64_tr_b16 a[224:225], v160 offset:24576
    v_mfma_f32_16x16x32_bf16 v[40:43], a[136:139], a[104:107], v[40:43]
    ds_read_b64_tr_b16 a[226:227], v160 offset:25600
    v_mfma_f32_16x16x32_bf16 v[40:43], a[168:171], a[108:111], v[40:43]
    v_mfma_f32_16x16x32_bf16 v[44:47], a[140:143], a[104:107], v[44:47]
    ds_read_b64_tr_b16 a[196:197], v160 offset:16392
    v_mfma_f32_16x16x32_bf16 v[44:47], a[172:175], a[108:111], v[44:47]
    ds_read_b64_tr_b16 a[198:199], v160 offset:17416
    v_mfma_f32_16x16x32_bf16 v[48:51], a[144:147], a[104:107], v[48:51]
    ds_read_b64_tr_b16 a[228:229], v160 offset:24584
    v_mfma_f32_16x16x32_bf16 v[48:51], a[176:179], a[108:111], v[48:51]
    v_mfma_f32_16x16x32_bf16 v[52:55], a[148:151], a[104:107], v[52:55]
    buffer_load_dwordx4 v233, s[16:19], s45 offen offset:2048 nt lds
    v_mfma_f32_16x16x32_bf16 v[52:55], a[180:183], a[108:111], v[52:55]
    ds_read_b64_tr_b16 a[230:231], v160 offset:25608
    v_mfma_f32_16x16x32_bf16 v[56:59], a[152:155], a[104:107], v[56:59]
    ds_read_b64_tr_b16 a[200:201], v161 offset:16384
    v_mfma_f32_16x16x32_bf16 v[56:59], a[184:187], a[108:111], v[56:59]
    ds_read_b64_tr_b16 a[202:203], v161 offset:17408
    v_mfma_f32_16x16x32_bf16 v[60:63], a[156:159], a[104:107], v[60:63]
    ds_read_b64_tr_b16 a[232:233], v161 offset:24576
    v_mfma_f32_16x16x32_bf16 v[60:63], a[188:191], a[108:111], v[60:63]
    ds_read_b64_tr_b16 a[234:235], v161 offset:25600
    v_mfma_f32_16x16x32_bf16 v[64:67], a[128:131], a[112:115], v[64:67]
    ds_read_b64_tr_b16 a[204:205], v161 offset:16392
    v_mfma_f32_16x16x32_bf16 v[64:67], a[160:163], a[116:119], v[64:67]
    v_mfma_f32_16x16x32_bf16 v[68:71], a[132:135], a[112:115], v[68:71]
    ds_read_b64_tr_b16 a[206:207], v161 offset:17416
    v_mfma_f32_16x16x32_bf16 v[68:71], a[164:167], a[116:119], v[68:71]
    ds_read_b64_tr_b16 a[236:237], v161 offset:24584
    v_mfma_f32_16x16x32_bf16 v[72:75], a[136:139], a[112:115], v[72:75]
    ds_read_b64_tr_b16 a[238:239], v161 offset:25608
    v_mfma_f32_16x16x32_bf16 v[72:75], a[168:171], a[116:119], v[72:75]
    buffer_load_dwordx4 v233, s[16:19], s45 offen offset:3072 nt lds
    v_mfma_f32_16x16x32_bf16 v[76:79], a[140:143], a[112:115], v[76:79]
    ds_read_b64_tr_b16 a[208:209], v162 offset:16384
    v_mfma_f32_16x16x32_bf16 v[76:79], a[172:175], a[116:119], v[76:79]
    ds_read_b64_tr_b16 a[210:211], v162 offset:17408
    v_mfma_f32_16x16x32_bf16 v[80:83], a[144:147], a[112:115], v[80:83]
    ds_read_b64_tr_b16 a[240:241], v162 offset:24576
    v_mfma_f32_16x16x32_bf16 v[80:83], a[176:179], a[116:119], v[80:83]
    ds_read_b64_tr_b16 a[242:243], v162 offset:25600
    v_mfma_f32_16x16x32_bf16 v[84:87], a[148:151], a[112:115], v[84:87]
    v_mfma_f32_16x16x32_bf16 v[84:87], a[180:183], a[116:119], v[84:87]
    ds_read_b64_tr_b16 a[212:213], v162 offset:16392
    v_mfma_f32_16x16x32_bf16 v[88:91], a[152:155], a[112:115], v[88:91]
    ds_read_b64_tr_b16 a[214:215], v162 offset:17416
    v_mfma_f32_16x16x32_bf16 v[88:91], a[184:187], a[116:119], v[88:91]
    ds_read_b64_tr_b16 a[244:245], v162 offset:24584
    v_mfma_f32_16x16x32_bf16 v[92:95], a[156:159], a[112:115], v[92:95]
    s_waitcnt vmcnt(16)
    ds_read_b128 a[64:67], v140 offset:0
    v_mfma_f32_16x16x32_bf16 v[92:95], a[188:191], a[116:119], v[92:95]
    ds_read_b128 a[68:71], v141 offset:0
    s_add_u32 m0, s41, 65536
    v_mfma_f32_16x16x32_bf16 v[96:99], a[128:131], a[120:123], v[96:99]
    buffer_load_dwordx4 v234, s[20:23], s46 offen offset:0 nt lds
    v_mfma_f32_16x16x32_bf16 v[96:99], a[160:163], a[124:127], v[96:99]
    ds_read_b64_tr_b16 a[246:247], v162 offset:25608
    v_mfma_f32_16x16x32_bf16 v[100:103], a[132:135], a[120:123], v[100:103]
    ds_read_b64_tr_b16 a[216:217], v163 offset:16384
    v_mfma_f32_16x16x32_bf16 v[100:103], a[164:167], a[124:127], v[100:103]
    ds_read_b128 a[72:75], v140 offset:2048
    v_mfma_f32_16x16x32_bf16 v[104:107], a[136:139], a[120:123], v[104:107]
    ds_read_b64_tr_b16 a[218:219], v163 offset:17408
    ds_read_b128 a[76:79], v141 offset:2048
    v_mfma_f32_16x16x32_bf16 v[104:107], a[168:171], a[124:127], v[104:107]
    ds_read_b64_tr_b16 a[248:249], v163 offset:24576
    v_mfma_f32_16x16x32_bf16 v[108:111], a[140:143], a[120:123], v[108:111]
    s_waitcnt vmcnt(13)
    ds_read_b128 a[80:83], v140 offset:4096
    v_mfma_f32_16x16x32_bf16 v[108:111], a[172:175], a[124:127], v[108:111]
    ds_read_b64_tr_b16 a[250:251], v163 offset:25600
    ds_read_b128 a[84:87], v141 offset:4096
    v_mfma_f32_16x16x32_bf16 v[112:115], a[144:147], a[120:123], v[112:115]
    ds_read_b64_tr_b16 a[220:221], v163 offset:16392
    v_mfma_f32_16x16x32_bf16 v[112:115], a[176:179], a[124:127], v[112:115]
    ds_read_b128 a[88:91], v140 offset:6144
    v_mfma_f32_16x16x32_bf16 v[116:119], a[148:151], a[120:123], v[116:119]
    ds_read_b64_tr_b16 a[222:223], v163 offset:17416
    ds_read_b128 a[92:95], v141 offset:6144
    v_mfma_f32_16x16x32_bf16 v[116:119], a[180:183], a[124:127], v[116:119]
    ds_read_b64_tr_b16 a[252:253], v163 offset:24584
    buffer_load_dwordx4 v234, s[20:23], s46 offen offset:1024 nt lds
    v_mfma_f32_16x16x32_bf16 v[120:123], a[152:155], a[120:123], v[120:123]
    ds_read_b64_tr_b16 a[254:255], v163 offset:25608
    v_mfma_f32_16x16x32_bf16 v[120:123], a[184:187], a[124:127], v[120:123]
    v_mfma_f32_16x16x32_bf16 v[124:127], a[156:159], a[120:123], v[124:127]
    v_mfma_f32_16x16x32_bf16 v[124:127], a[188:191], a[124:127], v[124:127]
    s_waitcnt lgkmcnt(0)
    v_mfma_f32_16x16x32_bf16 v[0:3], a[192:195], a[64:67], v[0:3]
    v_mfma_f32_16x16x32_bf16 v[0:3], a[224:227], a[68:71], v[0:3]
    v_mfma_f32_16x16x32_bf16 v[4:7], a[196:199], a[64:67], v[4:7]
    v_mfma_f32_16x16x32_bf16 v[4:7], a[228:231], a[68:71], v[4:7]
    v_mfma_f32_16x16x32_bf16 v[8:11], a[200:203], a[64:67], v[8:11]
    v_mfma_f32_16x16x32_bf16 v[8:11], a[232:235], a[68:71], v[8:11]
    v_mfma_f32_16x16x32_bf16 v[12:15], a[204:207], a[64:67], v[12:15]
    buffer_load_dwordx4 v235, s[20:23], s46 offen offset:2048 nt lds
    v_mfma_f32_16x16x32_bf16 v[12:15], a[236:239], a[68:71], v[12:15]
    v_mfma_f32_16x16x32_bf16 v[16:19], a[208:211], a[64:67], v[16:19]
    v_mfma_f32_16x16x32_bf16 v[16:19], a[240:243], a[68:71], v[16:19]
    v_mfma_f32_16x16x32_bf16 v[20:23], a[212:215], a[64:67], v[20:23]
    v_mfma_f32_16x16x32_bf16 v[20:23], a[244:247], a[68:71], v[20:23]
    v_mfma_f32_16x16x32_bf16 v[24:27], a[216:219], a[64:67], v[24:27]
    v_mfma_f32_16x16x32_bf16 v[24:27], a[248:251], a[68:71], v[24:27]
    v_mfma_f32_16x16x32_bf16 v[28:31], a[220:223], a[64:67], v[28:31]
    v_mfma_f32_16x16x32_bf16 v[28:31], a[252:255], a[68:71], v[28:31]
    v_mfma_f32_16x16x32_bf16 v[32:35], a[192:195], a[72:75], v[32:35]
    s_waitcnt vmcnt(7)
    s_barrier
    v_mfma_f32_16x16x32_bf16 v[32:35], a[224:227], a[76:79], v[32:35]
    ds_read_b64_tr_b16 a[128:129], v160 offset:32768
    v_mfma_f32_16x16x32_bf16 v[36:39], a[196:199], a[72:75], v[36:39]
    buffer_load_dwordx4 v235, s[20:23], s46 offen offset:3072 nt lds
    v_mfma_f32_16x16x32_bf16 v[36:39], a[228:231], a[76:79], v[36:39]
    ds_read_b64_tr_b16 a[130:131], v160 offset:33792
    v_mfma_f32_16x16x32_bf16 v[40:43], a[200:203], a[72:75], v[40:43]
    ds_read_b64_tr_b16 a[160:161], v160 offset:40960
    v_mfma_f32_16x16x32_bf16 v[40:43], a[232:235], a[76:79], v[40:43]
    ds_read_b64_tr_b16 a[162:163], v160 offset:41984
    v_mfma_f32_16x16x32_bf16 v[44:47], a[204:207], a[72:75], v[44:47]
    ds_read_b64_tr_b16 a[132:133], v160 offset:32776
    v_mfma_f32_16x16x32_bf16 v[44:47], a[236:239], a[76:79], v[44:47]
    ds_read_b64_tr_b16 a[134:135], v160 offset:33800
    v_mfma_f32_16x16x32_bf16 v[48:51], a[208:211], a[72:75], v[48:51]
    ds_read_b64_tr_b16 a[164:165], v160 offset:40968
    v_mfma_f32_16x16x32_bf16 v[48:51], a[240:243], a[76:79], v[48:51]
    ds_read_b64_tr_b16 a[166:167], v160 offset:41992
    v_mfma_f32_16x16x32_bf16 v[52:55], a[212:215], a[72:75], v[52:55]
    ds_read_b64_tr_b16 a[136:137], v161 offset:32768
    v_mfma_f32_16x16x32_bf16 v[52:55], a[244:247], a[76:79], v[52:55]
    ds_read_b64_tr_b16 a[138:139], v161 offset:33792
    v_mfma_f32_16x16x32_bf16 v[56:59], a[216:219], a[72:75], v[56:59]
    ds_read_b64_tr_b16 a[168:169], v161 offset:40960
    ds_read_b64_tr_b16 a[170:171], v161 offset:41984
    v_mfma_f32_16x16x32_bf16 v[56:59], a[248:251], a[76:79], v[56:59]
    s_add_u32 s45, s45, 16384
    s_add_u32 m0, s41, 16384
    s_nop 0
    buffer_load_dwordx4 v232, s[16:19], s45 offen offset:0 nt lds
    v_mfma_f32_16x16x32_bf16 v[60:63], a[220:223], a[72:75], v[60:63]
    ds_read_b64_tr_b16 a[140:141], v161 offset:32776
    v_mfma_f32_16x16x32_bf16 v[60:63], a[252:255], a[76:79], v[60:63]
    ds_read_b64_tr_b16 a[142:143], v161 offset:33800
    v_mfma_f32_16x16x32_bf16 v[64:67], a[192:195], a[80:83], v[64:67]
    ds_read_b64_tr_b16 a[172:173], v161 offset:40968
    v_mfma_f32_16x16x32_bf16 v[64:67], a[224:227], a[84:87], v[64:67]
    ds_read_b64_tr_b16 a[174:175], v161 offset:41992
    v_mfma_f32_16x16x32_bf16 v[68:71], a[196:199], a[80:83], v[68:71]
    ds_read_b64_tr_b16 a[144:145], v162 offset:32768
    v_mfma_f32_16x16x32_bf16 v[68:71], a[228:231], a[84:87], v[68:71]
    ds_read_b64_tr_b16 a[146:147], v162 offset:33792
    v_mfma_f32_16x16x32_bf16 v[72:75], a[200:203], a[80:83], v[72:75]
    ds_read_b64_tr_b16 a[176:177], v162 offset:40960
    v_mfma_f32_16x16x32_bf16 v[72:75], a[232:235], a[84:87], v[72:75]
    ds_read_b64_tr_b16 a[178:179], v162 offset:41984
    v_mfma_f32_16x16x32_bf16 v[76:79], a[204:207], a[80:83], v[76:79]
    ds_read_b64_tr_b16 a[148:149], v162 offset:32776
    v_mfma_f32_16x16x32_bf16 v[76:79], a[236:239], a[84:87], v[76:79]
    ds_read_b64_tr_b16 a[150:151], v162 offset:33800
    ds_read_b64_tr_b16 a[180:181], v162 offset:40968
    v_mfma_f32_16x16x32_bf16 v[80:83], a[208:211], a[80:83], v[80:83]
    buffer_load_dwordx4 v232, s[16:19], s45 offen offset:1024 nt lds
    v_mfma_f32_16x16x32_bf16 v[80:83], a[240:243], a[84:87], v[80:83]
    ds_read_b64_tr_b16 a[182:183], v162 offset:41992
    v_mfma_f32_16x16x32_bf16 v[84:87], a[212:215], a[80:83], v[84:87]
    ds_read_b64_tr_b16 a[152:153], v163 offset:32768
    v_mfma_f32_16x16x32_bf16 v[84:87], a[244:247], a[84:87], v[84:87]
    ds_read_b64_tr_b16 a[154:155], v163 offset:33792
    v_mfma_f32_16x16x32_bf16 v[88:91], a[216:219], a[80:83], v[88:91]
    ds_read_b64_tr_b16 a[184:185], v163 offset:40960
    v_mfma_f32_16x16x32_bf16 v[88:91], a[248:251], a[84:87], v[88:91]
    ds_read_b64_tr_b16 a[186:187], v163 offset:41984
    v_mfma_f32_16x16x32_bf16 v[92:95], a[220:223], a[80:83], v[92:95]
    ds_read_b64_tr_b16 a[156:157], v163 offset:32776
    v_mfma_f32_16x16x32_bf16 v[92:95], a[252:255], a[84:87], v[92:95]
    ds_read_b64_tr_b16 a[158:159], v163 offset:33800
    v_mfma_f32_16x16x32_bf16 v[96:99], a[192:195], a[88:91], v[96:99]
    ds_read_b64_tr_b16 a[188:189], v163 offset:40968
    v_mfma_f32_16x16x32_bf16 v[96:99], a[224:227], a[92:95], v[96:99]
    ds_read_b64_tr_b16 a[190:191], v163 offset:41992
    v_mfma_f32_16x16x32_bf16 v[100:103], a[196:199], a[88:91], v[100:103]
    buffer_load_dwordx4 v233, s[16:19], s45 offen offset:2048 nt lds
    v_mfma_f32_16x16x32_bf16 v[100:103], a[228:231], a[92:95], v[100:103]
    ds_read_b64_tr_b16 a[192:193], v160 offset:49152
    v_mfma_f32_16x16x32_bf16 v[104:107], a[200:203], a[88:91], v[104:107]
    ds_read_b64_tr_b16 a[194:195], v160 offset:50176
    v_mfma_f32_16x16x32_bf16 v[104:107], a[232:235], a[92:95], v[104:107]
    ds_read_b64_tr_b16 a[224:225], v160 offset:57344
    v_mfma_f32_16x16x32_bf16 v[108:111], a[204:207], a[88:91], v[108:111]
    ds_read_b64_tr_b16 a[226:227], v160 offset:58368
    v_mfma_f32_16x16x32_bf16 v[108:111], a[236:239], a[92:95], v[108:111]
    ds_read_b64_tr_b16 a[196:197], v160 offset:49160
    v_mfma_f32_16x16x32_bf16 v[112:115], a[208:211], a[88:91], v[112:115]
    ds_read_b64_tr_b16 a[198:199], v160 offset:50184
    v_mfma_f32_16x16x32_bf16 v[112:115], a[240:243], a[92:95], v[112:115]
    ds_read_b64_tr_b16 a[228:229], v160 offset:57352
    v_mfma_f32_16x16x32_bf16 v[116:119], a[212:215], a[88:91], v[116:119]
    ds_read_b64_tr_b16 a[230:231], v160 offset:58376
    v_mfma_f32_16x16x32_bf16 v[116:119], a[244:247], a[92:95], v[116:119]
    ds_read_b64_tr_b16 a[200:201], v161 offset:49152
    v_mfma_f32_16x16x32_bf16 v[120:123], a[216:219], a[88:91], v[120:123]
    ds_read_b64_tr_b16 a[202:203], v161 offset:50176
    v_mfma_f32_16x16x32_bf16 v[120:123], a[248:251], a[92:95], v[120:123]
    ds_read_b64_tr_b16 a[232:233], v161 offset:57344
    v_mfma_f32_16x16x32_bf16 v[124:127], a[220:223], a[88:91], v[124:127]
    buffer_load_dwordx4 v233, s[16:19], s45 offen offset:3072 nt lds
    v_mfma_f32_16x16x32_bf16 v[124:127], a[252:255], a[92:95], v[124:127]
    ds_read_b64_tr_b16 a[234:235], v161 offset:58368
    s_waitcnt lgkmcnt(12)
    v_mfma_f32_16x16x32_bf16 v[0:3], a[128:131], a[0:3], v[0:3]
    ds_read_b64_tr_b16 a[204:205], v161 offset:49160
    v_mfma_f32_16x16x32_bf16 v[0:3], a[160:163], a[4:7], v[0:3]
    ds_read_b64_tr_b16 a[206:207], v161 offset:50184
    v_mfma_f32_16x16x32_bf16 v[4:7], a[132:135], a[0:3], v[4:7]
    ds_read_b64_tr_b16 a[236:237], v161 offset:57352
    v_mfma_f32_16x16x32_bf16 v[4:7], a[164:167], a[4:7], v[4:7]
    ds_read_b64_tr_b16 a[238:239], v161 offset:58376
    v_mfma_f32_16x16x32_bf16 v[8:11], a[136:139], a[0:3], v[8:11]
    ds_read_b64_tr_b16 a[208:209], v162 offset:49152
    v_mfma_f32_16x16x32_bf16 v[8:11], a[168:171], a[4:7], v[8:11]
    ds_read_b64_tr_b16 a[210:211], v162 offset:50176
    v_mfma_f32_16x16x32_bf16 v[12:15], a[140:143], a[0:3], v[12:15]
    ds_read_b64_tr_b16 a[240:241], v162 offset:57344
    v_mfma_f32_16x16x32_bf16 v[12:15], a[172:175], a[4:7], v[12:15]
    ds_read_b64_tr_b16 a[242:243], v162 offset:58368
    v_mfma_f32_16x16x32_bf16 v[16:19], a[144:147], a[0:3], v[16:19]
    ds_read_b64_tr_b16 a[212:213], v162 offset:49160
    ds_read_b64_tr_b16 a[214:215], v162 offset:50184
    v_mfma_f32_16x16x32_bf16 v[16:19], a[176:179], a[4:7], v[16:19]
    s_add_u32 s46, s46, 16384
    s_add_u32 m0, s41, 81920
    s_nop 0
    buffer_load_dwordx4 v234, s[20:23], s46 offen offset:0 nt lds
    v_mfma_f32_16x16x32_bf16 v[20:23], a[148:151], a[0:3], v[20:23]
    ds_read_b64_tr_b16 a[244:245], v162 offset:57352
    v_mfma_f32_16x16x32_bf16 v[20:23], a[180:183], a[4:7], v[20:23]
    ds_read_b64_tr_b16 a[246:247], v162 offset:58376
    v_mfma_f32_16x16x32_bf16 v[24:27], a[152:155], a[0:3], v[24:27]
    ds_read_b64_tr_b16 a[216:217], v163 offset:49152
    v_mfma_f32_16x16x32_bf16 v[24:27], a[184:187], a[4:7], v[24:27]
    ds_read_b64_tr_b16 a[218:219], v163 offset:50176
    v_mfma_f32_16x16x32_bf16 v[28:31], a[156:159], a[0:3], v[28:31]
    ds_read_b64_tr_b16 a[248:249], v163 offset:57344
    v_mfma_f32_16x16x32_bf16 v[28:31], a[188:191], a[4:7], v[28:31]
    ds_read_b64_tr_b16 a[250:251], v163 offset:58368
    s_waitcnt lgkmcnt(15)
    v_mfma_f32_16x16x32_bf16 v[0:3], a[192:195], a[8:11], v[0:3]
    ds_read_b64_tr_b16 a[220:221], v163 offset:49160
    v_mfma_f32_16x16x32_bf16 v[0:3], a[224:227], a[12:15], v[0:3]
    ds_read_b64_tr_b16 a[222:223], v163 offset:50184
    v_mfma_f32_16x16x32_bf16 v[4:7], a[196:199], a[8:11], v[4:7]
    ds_read_b64_tr_b16 a[252:253], v163 offset:57352
    v_mfma_f32_16x16x32_bf16 v[4:7], a[228:231], a[12:15], v[4:7]
    ds_read_b64_tr_b16 a[254:255], v163 offset:58376
    s_waitcnt lgkmcnt(15)
    v_mfma_f32_16x16x32_bf16 v[8:11], a[200:203], a[8:11], v[8:11]
    buffer_load_dwordx4 v234, s[20:23], s46 offen offset:1024 nt lds
    v_mfma_f32_16x16x32_bf16 v[8:11], a[232:235], a[12:15], v[8:11]
    v_mfma_f32_16x16x32_bf16 v[12:15], a[204:207], a[8:11], v[12:15]
    v_mfma_f32_16x16x32_bf16 v[12:15], a[236:239], a[12:15], v[12:15]
    s_waitcnt lgkmcnt(8)
    v_mfma_f32_16x16x32_bf16 v[16:19], a[208:211], a[8:11], v[16:19]
    v_mfma_f32_16x16x32_bf16 v[16:19], a[240:243], a[12:15], v[16:19]
    v_mfma_f32_16x16x32_bf16 v[20:23], a[212:215], a[8:11], v[20:23]
    v_mfma_f32_16x16x32_bf16 v[20:23], a[244:247], a[12:15], v[20:23]
    s_waitcnt lgkmcnt(0)
    v_mfma_f32_16x16x32_bf16 v[24:27], a[216:219], a[8:11], v[24:27]
    v_mfma_f32_16x16x32_bf16 v[24:27], a[248:251], a[12:15], v[24:27]
    v_mfma_f32_16x16x32_bf16 v[28:31], a[220:223], a[8:11], v[28:31]
    buffer_load_dwordx4 v235, s[20:23], s46 offen offset:2048 nt lds
    v_mfma_f32_16x16x32_bf16 v[28:31], a[252:255], a[12:15], v[28:31]
    v_mfma_f32_16x16x32_bf16 v[32:35], a[128:131], a[16:19], v[32:35]
    v_mfma_f32_16x16x32_bf16 v[32:35], a[160:163], a[20:23], v[32:35]
    v_mfma_f32_16x16x32_bf16 v[32:35], a[192:195], a[24:27], v[32:35]
    v_mul_f32 v0, s48, v0
    v_mul_f32 v1, s48, v1
    v_mfma_f32_16x16x32_bf16 v[32:35], a[224:227], a[28:31], v[32:35]
    v_mul_f32 v2, s48, v2
    v_mul_f32 v3, s48, v3
    v_mfma_f32_16x16x32_bf16 v[36:39], a[132:135], a[16:19], v[36:39]
    v_mul_f32 v4, s48, v4
    v_mul_f32 v5, s48, v5
    v_mfma_f32_16x16x32_bf16 v[36:39], a[164:167], a[20:23], v[36:39]
    v_mul_f32 v6, s48, v6
    v_mul_f32 v7, s48, v7
    v_mfma_f32_16x16x32_bf16 v[36:39], a[196:199], a[24:27], v[36:39]
    v_cvt_pk_bf16_f32 v0, v0, v1
    v_cvt_pk_bf16_f32 v1, v2, v3
    v_mfma_f32_16x16x32_bf16 v[36:39], a[228:231], a[28:31], v[36:39]
    v_cvt_pk_bf16_f32 v2, v4, v5
    v_cvt_pk_bf16_f32 v3, v6, v7
    v_mfma_f32_16x16x32_bf16 v[40:43], a[136:139], a[16:19], v[40:43]
    v_mul_f32 v8, s48, v8
    v_mul_f32 v9, s48, v9
    v_mul_f32 v10, s48, v10
    v_mfma_f32_16x16x32_bf16 v[40:43], a[168:171], a[20:23], v[40:43]
    buffer_load_dwordx4 v235, s[20:23], s46 offen offset:3072 nt lds
    v_mul_f32 v11, s48, v11
    v_mfma_f32_16x16x32_bf16 v[40:43], a[200:203], a[24:27], v[40:43]
    v_mul_f32 v12, s48, v12
    v_mul_f32 v13, s48, v13
    v_mfma_f32_16x16x32_bf16 v[40:43], a[232:235], a[28:31], v[40:43]
    v_mul_f32 v14, s48, v14
    v_mul_f32 v15, s48, v15
    v_mfma_f32_16x16x32_bf16 v[44:47], a[140:143], a[16:19], v[44:47]
    v_cvt_pk_bf16_f32 v4, v8, v9
    v_cvt_pk_bf16_f32 v5, v10, v11
    v_mfma_f32_16x16x32_bf16 v[44:47], a[172:175], a[20:23], v[44:47]
    v_cvt_pk_bf16_f32 v6, v12, v13
    v_cvt_pk_bf16_f32 v7, v14, v15
    v_mfma_f32_16x16x32_bf16 v[44:47], a[204:207], a[24:27], v[44:47]
    s_waitcnt vmcnt(8)
    s_barrier
    v_mul_f32 v16, s48, v16
    v_mfma_f32_16x16x32_bf16 v[44:47], a[236:239], a[28:31], v[44:47]
    ds_read_b128 a[64:67], v220 offset:0
    v_mul_f32 v17, s48, v17
    v_mul_f32 v18, s48, v18
    v_mfma_f32_16x16x32_bf16 v[48:51], a[144:147], a[16:19], v[48:51]
    ds_read_b128 a[68:71], v221 offset:0
    v_mul_f32 v19, s48, v19
    v_mfma_f32_16x16x32_bf16 v[48:51], a[176:179], a[20:23], v[48:51]
    v_mul_f32 v20, s48, v20
    v_mul_f32 v21, s48, v21
    v_mfma_f32_16x16x32_bf16 v[48:51], a[208:211], a[24:27], v[48:51]
    ds_read_b128 a[72:75], v222 offset:0
    v_mul_f32 v22, s48, v22
    v_mfma_f32_16x16x32_bf16 v[48:51], a[240:243], a[28:31], v[48:51]
    ds_read_b128 a[76:79], v223 offset:0
    v_mul_f32 v23, s48, v23
    v_mfma_f32_16x16x32_bf16 v[52:55], a[148:151], a[16:19], v[52:55]
    s_add_u32 s45, s45, 16384
    s_add_u32 m0, s41, 32768
    s_nop 0
    buffer_load_dwordx4 v232, s[16:19], s45 offen offset:0 nt lds
    v_cvt_pk_bf16_f32 v8, v16, v17
    v_mfma_f32_16x16x32_bf16 v[52:55], a[180:183], a[20:23], v[52:55]
    ds_read_b128 a[80:83], v220 offset:1024
    v_cvt_pk_bf16_f32 v9, v18, v19
    v_cvt_pk_bf16_f32 v10, v20, v21
    v_mfma_f32_16x16x32_bf16 v[52:55], a[212:215], a[24:27], v[52:55]
    ds_read_b128 a[84:87], v221 offset:1024
    v_cvt_pk_bf16_f32 v11, v22, v23
    v_mfma_f32_16x16x32_bf16 v[52:55], a[244:247], a[28:31], v[52:55]
    v_mul_f32 v24, s48, v24
    v_mul_f32 v25, s48, v25
    v_mfma_f32_16x16x32_bf16 v[56:59], a[152:155], a[16:19], v[56:59]
    ds_read_b128 a[88:91], v222 offset:1024
    v_mul_f32 v26, s48, v26
    v_mfma_f32_16x16x32_bf16 v[56:59], a[184:187], a[20:23], v[56:59]
    ds_read_b128 a[92:95], v223 offset:1024
    v_mul_f32 v27, s48, v27
    v_mfma_f32_16x16x32_bf16 v[56:59], a[216:219], a[24:27], v[56:59]
    v_mul_f32 v28, s48, v28
    v_mul_f32 v29, s48, v29
    v_mfma_f32_16x16x32_bf16 v[56:59], a[248:251], a[28:31], v[56:59]
    v_mul_f32 v30, s48, v30
    v_mul_f32 v31, s48, v31
    v_mfma_f32_16x16x32_bf16 v[60:63], a[156:159], a[16:19], v[60:63]
    v_cvt_pk_bf16_f32 v12, v24, v25
    v_cvt_pk_bf16_f32 v13, v26, v27
    v_cvt_pk_bf16_f32 v14, v28, v29
    v_mfma_f32_16x16x32_bf16 v[60:63], a[188:191], a[20:23], v[60:63]
    v_cvt_pk_bf16_f32 v15, v30, v31
    v_mfma_f32_16x16x32_bf16 v[60:63], a[220:223], a[24:27], v[60:63]
    v_mfma_f32_16x16x32_bf16 v[60:63], a[252:255], a[28:31], v[60:63]
    buffer_load_dwordx4 v232, s[16:19], s45 offen offset:1024 nt lds
    s_waitcnt lgkmcnt(0)
    v_mfma_f32_16x16x32_bf16 v[128:131], a[64:67], v[0:3], v[176:179]
    v_mfma_f32_16x16x32_bf16 v[128:131], a[68:71], v[4:7], v[128:131]
    v_mfma_f32_16x16x32_bf16 v[128:131], a[72:75], v[8:11], v[128:131]
    v_mul_f32 v32, s48, v32
    v_mul_f32 v33, s48, v33
    v_mul_f32 v34, s48, v34
    v_mfma_f32_16x16x32_bf16 v[128:131], a[76:79], v[12:15], v[128:131]
    v_mul_f32 v35, s48, v35
    v_mul_f32 v36, s48, v36
    v_mfma_f32_16x16x32_bf16 v[132:135], a[80:83], v[0:3], v[176:179]
    ds_read_b128 a[96:99], v220 offset:8192
    v_mul_f32 v37, s48, v37
    v_mfma_f32_16x16x32_bf16 v[132:135], a[84:87], v[4:7], v[132:135]
    v_mul_f32 v38, s48, v38
    v_mul_f32 v39, s48, v39
    v_mfma_f32_16x16x32_bf16 v[132:135], a[88:91], v[8:11], v[132:135]
    v_cvt_pk_bf16_f32 v16, v32, v33
    v_cvt_pk_bf16_f32 v17, v34, v35
    v_mfma_f32_16x16x32_bf16 v[132:135], a[92:95], v[12:15], v[132:135]
    ds_read_b128 a[100:103], v221 offset:8192
    v_cvt_pk_bf16_f32 v18, v36, v37
    v_cvt_pk_bf16_f32 v19, v38, v39
    v_mfma_f32_16x16x32_bf16 v[64:67], a[128:131], a[32:35], v[64:67]
    v_mul_f32 v40, s48, v40
    v_mul_f32 v41, s48, v41
    v_mfma_f32_16x16x32_bf16 v[64:67], a[160:163], a[36:39], v[64:67]
    v_mul_f32 v42, s48, v42
    v_mul_f32 v43, s48, v43
    v_mfma_f32_16x16x32_bf16 v[64:67], a[192:195], a[40:43], v[64:67]
    ds_read_b128 a[104:107], v222 offset:8192
    v_mul_f32 v44, s48, v44
    v_mfma_f32_16x16x32_bf16 v[64:67], a[224:227], a[44:47], v[64:67]
    buffer_load_dwordx4 v233, s[16:19], s45 offen offset:2048 nt lds
    v_mul_f32 v45, s48, v45
    v_mfma_f32_16x16x32_bf16 v[68:71], a[132:135], a[32:35], v[68:71]
    v_mul_f32 v46, s48, v46
    v_mul_f32 v47, s48, v47
    v_cvt_pk_bf16_f32 v20, v40, v41
    v_mfma_f32_16x16x32_bf16 v[68:71], a[164:167], a[36:39], v[68:71]
    ds_read_b128 a[108:111], v223 offset:8192
    v_cvt_pk_bf16_f32 v21, v42, v43
    v_mfma_f32_16x16x32_bf16 v[68:71], a[196:199], a[40:43], v[68:71]
    v_cvt_pk_bf16_f32 v22, v44, v45
    v_cvt_pk_bf16_f32 v23, v46, v47
    v_mfma_f32_16x16x32_bf16 v[68:71], a[228:231], a[44:47], v[68:71]
    v_mul_f32 v48, s48, v48
    v_mul_f32 v49, s48, v49
    v_mfma_f32_16x16x32_bf16 v[72:75], a[136:139], a[32:35], v[72:75]
    ds_read_b128 a[112:115], v220 offset:9216
    v_mul_f32 v50, s48, v50
    v_mfma_f32_16x16x32_bf16 v[72:75], a[168:171], a[36:39], v[72:75]
    v_mul_f32 v51, s48, v51
    v_mul_f32 v52, s48, v52
    v_mul_f32 v53, s48, v53
    v_mfma_f32_16x16x32_bf16 v[72:75], a[200:203], a[40:43], v[72:75]
    v_mul_f32 v54, s48, v54
    v_mul_f32 v55, s48, v55
    v_mfma_f32_16x16x32_bf16 v[72:75], a[232:235], a[44:47], v[72:75]
    ds_read_b128 a[116:119], v221 offset:9216
    v_cvt_pk_bf16_f32 v24, v48, v49
    v_mfma_f32_16x16x32_bf16 v[76:79], a[140:143], a[32:35], v[76:79]
    v_cvt_pk_bf16_f32 v25, v50, v51
    v_cvt_pk_bf16_f32 v26, v52, v53
    v_mfma_f32_16x16x32_bf16 v[76:79], a[172:175], a[36:39], v[76:79]
    buffer_load_dwordx4 v233, s[16:19], s45 offen offset:3072 nt lds
    v_cvt_pk_bf16_f32 v27, v54, v55
    v_mfma_f32_16x16x32_bf16 v[76:79], a[204:207], a[40:43], v[76:79]
    ds_read_b128 a[120:123], v222 offset:9216
    v_mul_f32 v56, s48, v56
    v_mul_f32 v57, s48, v57
    v_mfma_f32_16x16x32_bf16 v[76:79], a[236:239], a[44:47], v[76:79]
    v_mul_f32 v58, s48, v58
    v_mul_f32 v59, s48, v59
    v_mfma_f32_16x16x32_bf16 v[80:83], a[144:147], a[32:35], v[80:83]
    v_mul_f32 v60, s48, v60
    v_mul_f32 v61, s48, v61
    v_mfma_f32_16x16x32_bf16 v[80:83], a[176:179], a[36:39], v[80:83]
    ds_read_b128 a[124:127], v223 offset:9216
    v_mul_f32 v62, s48, v62
    v_mfma_f32_16x16x32_bf16 v[80:83], a[208:211], a[40:43], v[80:83]
    v_mul_f32 v63, s48, v63
    v_cvt_pk_bf16_f32 v28, v56, v57
    v_mfma_f32_16x16x32_bf16 v[80:83], a[240:243], a[44:47], v[80:83]
    v_cvt_pk_bf16_f32 v29, v58, v59
    v_cvt_pk_bf16_f32 v30, v60, v61
    v_cvt_pk_bf16_f32 v31, v62, v63
    v_mfma_f32_16x16x32_bf16 v[84:87], a[148:151], a[32:35], v[84:87]
    v_exp_f32 v208, v128
    v_mfma_f32_16x16x32_bf16 v[84:87], a[180:183], a[36:39], v[84:87]
    v_exp_f32 v209, v129
    v_mfma_f32_16x16x32_bf16 v[84:87], a[212:215], a[40:43], v[84:87]
    v_exp_f32 v210, v130
    v_mfma_f32_16x16x32_bf16 v[84:87], a[244:247], a[44:47], v[84:87]
    v_cvt_pk_bf16_f32 v160, v208, v209
    v_mfma_f32_16x16x32_bf16 v[88:91], a[152:155], a[32:35], v[88:91]
    s_add_u32 s46, s46, 16384
    s_add_u32 m0, s41, 98304
    s_nop 0
    buffer_load_dwordx4 v234, s[20:23], s46 offen offset:0 nt lds
    v_exp_f32 v211, v131
    v_mfma_f32_16x16x32_bf16 v[88:91], a[184:187], a[36:39], v[88:91]
    v_exp_f32 v212, v132
    v_mfma_f32_16x16x32_bf16 v[88:91], a[216:219], a[40:43], v[88:91]
    v_cvt_pk_bf16_f32 v161, v210, v211
    v_mfma_f32_16x16x32_bf16 v[88:91], a[248:251], a[44:47], v[88:91]
    v_exp_f32 v213, v133
    v_mfma_f32_16x16x32_bf16 v[92:95], a[156:159], a[32:35], v[92:95]
    v_exp_f32 v214, v134
    v_cvt_pk_bf16_f32 v162, v212, v213
    v_mfma_f32_16x16x32_bf16 v[92:95], a[188:191], a[36:39], v[92:95]
    v_exp_f32 v215, v135
    v_mfma_f32_16x16x32_bf16 v[92:95], a[220:223], a[40:43], v[92:95]
    v_cvt_pk_bf16_f32 v163, v214, v215
    v_mfma_f32_16x16x32_bf16 v[92:95], a[252:255], a[44:47], v[92:95]
    v_mfma_f32_16x16x32_bf16 v[136:139], a[64:67], v[16:19], v[180:183]
    v_mfma_f32_16x16x32_bf16 v[136:139], a[68:71], v[20:23], v[136:139]
    v_mfma_f32_16x16x32_bf16 v[136:139], a[72:75], v[24:27], v[136:139]
    v_mul_f32 v64, s48, v64
    v_mul_f32 v65, s48, v65
    v_mul_f32 v66, s48, v66
    v_mfma_f32_16x16x32_bf16 v[136:139], a[76:79], v[28:31], v[136:139]
    buffer_load_dwordx4 v234, s[20:23], s46 offen offset:1024 nt lds
    v_mul_f32 v67, s48, v67
    v_mfma_f32_16x16x32_bf16 v[140:143], a[80:83], v[16:19], v[180:183]
    v_mul_f32 v68, s48, v68
    v_mul_f32 v69, s48, v69
    v_mfma_f32_16x16x32_bf16 v[140:143], a[84:87], v[20:23], v[140:143]
    v_mul_f32 v70, s48, v70
    v_mul_f32 v71, s48, v71
    v_cvt_pk_bf16_f32 v32, v64, v65
    v_mfma_f32_16x16x32_bf16 v[140:143], a[88:91], v[24:27], v[140:143]
    v_cvt_pk_bf16_f32 v33, v66, v67
    v_cvt_pk_bf16_f32 v34, v68, v69
    v_mfma_f32_16x16x32_bf16 v[140:143], a[92:95], v[28:31], v[140:143]
    v_cvt_pk_bf16_f32 v35, v70, v71
    v_mul_f32 v72, s48, v72
    v_mfma_f32_16x16x32_bf16 v[96:99], a[128:131], a[48:51], v[96:99]
    v_mul_f32 v73, s48, v73
    v_mul_f32 v74, s48, v74
    v_mfma_f32_16x16x32_bf16 v[96:99], a[160:163], a[52:55], v[96:99]
    v_mul_f32 v75, s48, v75
    v_mul_f32 v76, s48, v76
    v_mul_f32 v77, s48, v77
    v_mfma_f32_16x16x32_bf16 v[96:99], a[192:195], a[56:59], v[96:99]
    v_mul_f32 v78, s48, v78
    v_mul_f32 v79, s48, v79
    v_mfma_f32_16x16x32_bf16 v[96:99], a[224:227], a[60:63], v[96:99]
    v_cvt_pk_bf16_f32 v36, v72, v73
    v_cvt_pk_bf16_f32 v37, v74, v75
    v_mfma_f32_16x16x32_bf16 v[100:103], a[132:135], a[48:51], v[100:103]
    v_cvt_pk_bf16_f32 v38, v76, v77
    v_cvt_pk_bf16_f32 v39, v78, v79
    v_mul_f32 v80, s48, v80
    v_mfma_f32_16x16x32_bf16 v[100:103], a[164:167], a[52:55], v[100:103]
    ds_read_b64_tr_b16 a[128:129], v224 offset:0
    v_mul_f32 v81, s48, v81
    v_mfma_f32_16x16x32_bf16 v[100:103], a[196:199], a[56:59], v[100:103]
    buffer_load_dwordx4 v235, s[20:23], s46 offen offset:2048 nt lds
    v_mul_f32 v82, s48, v82
    v_mfma_f32_16x16x32_bf16 v[100:103], a[228:231], a[60:63], v[100:103]
    ds_read_b64_tr_b16 a[130:131], v224 offset:1024
    v_mul_f32 v83, s48, v83
    v_mfma_f32_16x16x32_bf16 v[104:107], a[136:139], a[48:51], v[104:107]
    v_mul_f32 v84, s48, v84
    v_mul_f32 v85, s48, v85
    v_mul_f32 v86, s48, v86
    v_mfma_f32_16x16x32_bf16 v[104:107], a[168:171], a[52:55], v[104:107]
    ds_read_b64_tr_b16 a[132:133], v225 offset:0
    v_mul_f32 v87, s48, v87
    v_mfma_f32_16x16x32_bf16 v[104:107], a[200:203], a[56:59], v[104:107]
    v_cvt_pk_bf16_f32 v40, v80, v81
    v_cvt_pk_bf16_f32 v41, v82, v83
    v_mfma_f32_16x16x32_bf16 v[104:107], a[232:235], a[60:63], v[104:107]
    ds_read_b64_tr_b16 a[134:135], v225 offset:1024
    v_cvt_pk_bf16_f32 v42, v84, v85
    v_mfma_f32_16x16x32_bf16 v[108:111], a[140:143], a[48:51], v[108:111]
    v_cvt_pk_bf16_f32 v43, v86, v87
    v_mul_f32 v88, s48, v88
    v_mul_f32 v89, s48, v89
    v_mfma_f32_16x16x32_bf16 v[108:111], a[172:175], a[52:55], v[108:111]
    ds_read_b64_tr_b16 a[136:137], v226 offset:0
    v_mul_f32 v90, s48, v90
    v_mfma_f32_16x16x32_bf16 v[108:111], a[204:207], a[56:59], v[108:111]
    v_mul_f32 v91, s48, v91
    v_mul_f32 v92, s48, v92
    v_mfma_f32_16x16x32_bf16 v[108:111], a[236:239], a[60:63], v[108:111]
    ds_read_b64_tr_b16 a[138:139], v226 offset:1024
    v_mul_f32 v93, s48, v93
    v_mul_f32 v94, s48, v94
    v_mfma_f32_16x16x32_bf16 v[112:115], a[144:147], a[48:51], v[112:115]
    v_mul_f32 v95, s48, v95
    v_cvt_pk_bf16_f32 v44, v88, v89
    v_mfma_f32_16x16x32_bf16 v[112:115], a[176:179], a[52:55], v[112:115]
    buffer_load_dwordx4 v235, s[20:23], s46 offen offset:3072 nt lds
    v_cvt_pk_bf16_f32 v45, v90, v91
    v_mfma_f32_16x16x32_bf16 v[112:115], a[208:211], a[56:59], v[112:115]
    ds_read_b64_tr_b16 a[140:141], v227 offset:0
    v_cvt_pk_bf16_f32 v46, v92, v93
    v_mfma_f32_16x16x32_bf16 v[112:115], a[240:243], a[60:63], v[112:115]
    ds_read_b64_tr_b16 a[142:143], v227 offset:1024
    v_cvt_pk_bf16_f32 v47, v94, v95
    v_mfma_f32_16x16x32_bf16 v[116:119], a[148:151], a[48:51], v[116:119]
    v_exp_f32 v208, v136
    v_mfma_f32_16x16x32_bf16 v[116:119], a[180:183], a[52:55], v[116:119]
    ds_read_b64_tr_b16 a[144:145], v228 offset:0
    v_exp_f32 v209, v137
    v_mfma_f32_16x16x32_bf16 v[116:119], a[212:215], a[56:59], v[116:119]
    v_exp_f32 v210, v138
    v_mfma_f32_16x16x32_bf16 v[116:119], a[244:247], a[60:63], v[116:119]
    ds_read_b64_tr_b16 a[146:147], v228 offset:1024
    v_cvt_pk_bf16_f32 v164, v208, v209
    v_mfma_f32_16x16x32_bf16 v[120:123], a[152:155], a[48:51], v[120:123]
    v_exp_f32 v211, v139
    v_mfma_f32_16x16x32_bf16 v[120:123], a[184:187], a[52:55], v[120:123]
    ds_read_b64_tr_b16 a[148:149], v229 offset:0
    v_exp_f32 v212, v140
    v_mfma_f32_16x16x32_bf16 v[120:123], a[216:219], a[56:59], v[120:123]
    v_cvt_pk_bf16_f32 v165, v210, v211
    v_mfma_f32_16x16x32_bf16 v[120:123], a[248:251], a[60:63], v[120:123]
    ds_read_b64_tr_b16 a[150:151], v229 offset:1024
    v_exp_f32 v213, v141
    v_mfma_f32_16x16x32_bf16 v[124:127], a[156:159], a[48:51], v[124:127]
    s_add_u32 s45, s45, 16384
    s_add_u32 m0, s41, 49152
    s_nop 0
    buffer_load_dwordx4 v232, s[16:19], s45 offen offset:0 nt lds
    v_mfma_f32_16x16x32_bf16 v[124:127], a[188:191], a[52:55], v[124:127]
    ds_read_b64_tr_b16 a[152:153], v230 offset:0
    v_exp_f32 v214, v142
    v_mfma_f32_16x16x32_bf16 v[124:127], a[220:223], a[56:59], v[124:127]
    v_cvt_pk_bf16_f32 v166, v212, v213
    v_mfma_f32_16x16x32_bf16 v[124:127], a[252:255], a[60:63], v[124:127]
    ds_read_b64_tr_b16 a[154:155], v230 offset:1024
    v_exp_f32 v215, v143
    v_mfma_f32_16x16x32_bf16 v[144:147], a[64:67], v[32:35], v[184:187]
    v_cvt_pk_bf16_f32 v167, v214, v215
    v_mfma_f32_16x16x32_bf16 v[144:147], a[68:71], v[36:39], v[144:147]
    ds_read_b64_tr_b16 a[156:157], v231 offset:0
    v_mfma_f32_16x16x32_bf16 v[144:147], a[72:75], v[40:43], v[144:147]
    v_mul_f32 v96, s48, v96
    v_mul_f32 v97, s48, v97
    v_mul_f32 v98, s48, v98
    v_mfma_f32_16x16x32_bf16 v[144:147], a[76:79], v[44:47], v[144:147]
    ds_read_b64_tr_b16 a[158:159], v231 offset:1024
    v_mul_f32 v99, s48, v99
    v_mfma_f32_16x16x32_bf16 v[148:151], a[80:83], v[32:35], v[184:187]
    v_mul_f32 v100, s48, v100
    v_mul_f32 v101, s48, v101
    v_mfma_f32_16x16x32_bf16 v[148:151], a[84:87], v[36:39], v[148:151]
    v_mul_f32 v102, s48, v102
    v_mul_f32 v103, s48, v103
    v_cvt_pk_bf16_f32 v48, v96, v97
    v_mfma_f32_16x16x32_bf16 v[148:151], a[88:91], v[40:43], v[148:151]
    v_cvt_pk_bf16_f32 v49, v98, v99
    v_cvt_pk_bf16_f32 v50, v100, v101
    v_mfma_f32_16x16x32_bf16 v[148:151], a[92:95], v[44:47], v[148:151]
    buffer_load_dwordx4 v232, s[16:19], s45 offen offset:1024 nt lds
    v_cvt_pk_bf16_f32 v51, v102, v103
    s_waitcnt lgkmcnt(15)
    v_mfma_f32_16x16x32_bf16 v[128:131], a[96:99], v[0:3], v[176:179]
    v_mul_f32 v104, s48, v104
    v_mul_f32 v105, s48, v105
    v_mul_f32 v106, s48, v106
    v_mfma_f32_16x16x32_bf16 v[128:131], a[100:103], v[4:7], v[128:131]
    v_mul_f32 v107, s48, v107
    v_mul_f32 v108, s48, v108
    v_mfma_f32_16x16x32_bf16 v[128:131], a[104:107], v[8:11], v[128:131]
    v_mul_f32 v109, s48, v109
    v_mul_f32 v110, s48, v110
    v_mfma_f32_16x16x32_bf16 v[128:131], a[108:111], v[12:15], v[128:131]
    v_mul_f32 v111, s48, v111
    v_cvt_pk_bf16_f32 v52, v104, v105
    v_cvt_pk_bf16_f32 v53, v106, v107
    v_mfma_f32_16x16x32_bf16 v[132:135], a[112:115], v[0:3], v[176:179]
    v_cvt_pk_bf16_f32 v54, v108, v109
    v_cvt_pk_bf16_f32 v55, v110, v111
    v_mfma_f32_16x16x32_bf16 v[132:135], a[116:119], v[4:7], v[132:135]
    v_mul_f32 v112, s48, v112
    v_mul_f32 v113, s48, v113
    v_mfma_f32_16x16x32_bf16 v[132:135], a[120:123], v[8:11], v[132:135]
    ds_read_b64_tr_b16 a[160:161], v224 offset:8192
    v_mul_f32 v114, s48, v114
    v_mul_f32 v115, s48, v115
    v_mfma_f32_16x16x32_bf16 v[132:135], a[124:127], v[12:15], v[132:135]
    v_mul_f32 v116, s48, v116
    v_mul_f32 v117, s48, v117
    s_waitcnt lgkmcnt(1)
    v_mfma_f32_16x16x32_bf16 a[0:3], a[128:131], v[160:163], 0
    v_mul_f32 v118, s48, v118
    v_mul_f32 v119, s48, v119
    v_mfma_f32_16x16x32_bf16 a[4:7], a[132:135], v[160:163], 0
    v_cvt_pk_bf16_f32 v56, v112, v113
    v_cvt_pk_bf16_f32 v57, v114, v115
    v_cvt_pk_bf16_f32 v58, v116, v117
    v_mfma_f32_16x16x32_bf16 a[8:11], a[136:139], v[160:163], 0
    buffer_load_dwordx4 v233, s[16:19], s45 offen offset:2048 nt lds
    v_cvt_pk_bf16_f32 v59, v118, v119
    v_mfma_f32_16x16x32_bf16 a[12:15], a[140:143], v[160:163], 0
    ds_read_b64_tr_b16 a[162:163], v224 offset:9216
    v_mul_f32 v120, s48, v120
    v_mfma_f32_16x16x32_bf16 a[16:19], a[144:147], v[160:163], 0
    v_mul_f32 v121, s48, v121
    v_mul_f32 v122, s48, v122
    v_mul_f32 v123, s48, v123
    v_mfma_f32_16x16x32_bf16 a[20:23], a[148:151], v[160:163], 0
    v_mul_f32 v124, s48, v124
    v_mul_f32 v125, s48, v125
    v_mfma_f32_16x16x32_bf16 a[24:27], a[152:155], v[160:163], 0
    ds_read_b64_tr_b16 a[164:165], v225 offset:8192
    v_mul_f32 v126, s48, v126
    v_mfma_f32_16x16x32_bf16 a[28:31], a[156:159], v[160:163], 0
    v_mul_f32 v127, s48, v127
    v_cvt_pk_bf16_f32 v60, v120, v121
    v_cvt_pk_bf16_f32 v61, v122, v123
    v_mfma_f32_16x16x32_bf16 v[192:195], v[216:219], v[160:163], 0
    v_cvt_pk_bf16_f32 v62, v124, v125
    v_cvt_pk_bf16_f32 v63, v126, v127
    v_mfma_f32_16x16x32_bf16 v[152:155], a[64:67], v[48:51], v[188:191]
    v_exp_f32 v208, v144
    v_mfma_f32_16x16x32_bf16 v[152:155], a[68:71], v[52:55], v[152:155]
    ds_read_b64_tr_b16 a[166:167], v225 offset:9216
    v_exp_f32 v209, v145
    v_mfma_f32_16x16x32_bf16 v[152:155], a[72:75], v[56:59], v[152:155]
    v_exp_f32 v210, v146
    v_mfma_f32_16x16x32_bf16 v[152:155], a[76:79], v[60:63], v[152:155]
    v_cvt_pk_bf16_f32 v168, v208, v209
    v_mfma_f32_16x16x32_bf16 v[156:159], a[80:83], v[48:51], v[188:191]
    buffer_load_dwordx4 v233, s[16:19], s45 offen offset:3072 nt lds
    v_exp_f32 v211, v147
    v_mfma_f32_16x16x32_bf16 v[156:159], a[84:87], v[52:55], v[156:159]
    ds_read_b64_tr_b16 a[168:169], v226 offset:8192
    v_mfma_f32_16x16x32_bf16 v[156:159], a[88:91], v[56:59], v[156:159]
    v_exp_f32 v212, v148
    v_cvt_pk_bf16_f32 v169, v210, v211
    v_mfma_f32_16x16x32_bf16 v[156:159], a[92:95], v[60:63], v[156:159]
    v_exp_f32 v213, v149
    v_mfma_f32_16x16x32_bf16 v[136:139], a[96:99], v[16:19], v[180:183]
    s_waitcnt vmcnt(12)
    s_barrier
    v_exp_f32 v214, v150
    v_mfma_f32_16x16x32_bf16 v[136:139], a[100:103], v[20:23], v[136:139]
    ds_read_b64_tr_b16 a[170:171], v226 offset:9216
    v_cvt_pk_bf16_f32 v170, v212, v213
    v_mfma_f32_16x16x32_bf16 v[136:139], a[104:107], v[24:27], v[136:139]
    s_cmp_eq_u32 s100, 1
    s_cbranch_scc1 L_max
    s_mov_b32 s8, s96
    s_mov_b32 s9, s97
    s_mov_b32 s10, 256
    s_lshl_b32 s38, s36, 5
    s_mov_b32 s47, 0
    s_mov_b32 s59, 0
    v_mfma_f32_16x16x32_bf16 v[136:139], a[108:111], v[28:31], v[136:139]
    s_xor_b32 s58, s29, 1
    s_min_u32 s58, s58, 8
    s_lshl_b32 s58, s58, 7
    s_add_u32 s12, s32, s58
    s_addc_u32 s13, s33, 0
    s_sub_u32 s14, 4718592, s58
    s_lshr_b32 s58, 0x2affffff, s57
    s_and_b32 s58, s58, 1
    s_cselect_b32 s14, s14, 0
    v_exp_f32 v215, v151
    v_mfma_f32_16x16x32_bf16 v[140:143], a[112:115], v[16:19], v[180:183]
    ds_read_b128 a[64:67], v220 offset:16384
    v_cvt_pk_bf16_f32 v171, v214, v215
    v_mfma_f32_16x16x32_bf16 v[140:143], a[116:119], v[20:23], v[140:143]
    ds_read_b64_tr_b16 a[172:173], v227 offset:8192
    v_exp_f32 v208, v152
    v_mfma_f32_16x16x32_bf16 v[140:143], a[120:123], v[24:27], v[140:143]
    s_xor_b32 s58, s30, 0
    s_mul_i32 s39, s58, 147456
    v_mfma_f32_16x16x32_bf16 v[140:143], a[124:127], v[28:31], v[140:143]
    ds_read_b128 a[68:71], v221 offset:16384
    v_exp_f32 v209, v153
    v_mfma_f32_16x16x32_bf16 a[32:35], a[128:131], v[164:167], 0
    s_add_u32 s46, s46, 16384
    s_add_u32 m0, s41, 114688
    s_nop 0
    buffer_load_dwordx4 v234, s[20:23], s46 offen offset:0 nt lds
    v_mfma_f32_16x16x32_bf16 a[36:39], a[132:135], v[164:167], 0
    ds_read_b64_tr_b16 a[174:175], v227 offset:9216
    v_exp_f32 v210, v154
    v_mfma_f32_16x16x32_bf16 a[40:43], a[136:139], v[164:167], 0
    s_xor_b32 s58, s30, 4
    s_mul_i32 s40, s58, 147456
    v_cvt_pk_bf16_f32 v172, v208, v209
    v_mfma_f32_16x16x32_bf16 a[44:47], a[140:143], v[164:167], 0
    ds_read_b128 a[72:75], v222 offset:16384
    v_exp_f32 v211, v155
    v_mfma_f32_16x16x32_bf16 a[48:51], a[144:147], v[164:167], 0
    v_exp_f32 v212, v156
    v_mfma_f32_16x16x32_bf16 a[52:55], a[148:151], v[164:167], 0
    s_xor_b32 s58, s30, 8
    s_mul_i32 s42, s58, 147456
    v_cvt_pk_bf16_f32 v173, v210, v211
    v_mfma_f32_16x16x32_bf16 a[56:59], a[152:155], v[164:167], 0
    ds_read_b128 a[76:79], v223 offset:16384
    v_exp_f32 v213, v157
    v_mfma_f32_16x16x32_bf16 a[60:63], a[156:159], v[164:167], 0
    ds_read_b64_tr_b16 a[176:177], v228 offset:8192
    v_mfma_f32_16x16x32_bf16 v[196:199], v[216:219], v[164:167], 0
    v_exp_f32 v214, v158
    v_cvt_pk_bf16_f32 v174, v212, v213
    v_mfma_f32_16x16x32_bf16 v[144:147], a[96:99], v[32:35], v[184:187]
    s_xor_b32 s58, s30, 12
    s_mul_i32 s43, s58, 147456
    v_mfma_f32_16x16x32_bf16 v[144:147], a[100:103], v[36:39], v[144:147]
    ds_read_b128 a[80:83], v220 offset:17408
    v_exp_f32 v215, v159
    v_mfma_f32_16x16x32_bf16 v[144:147], a[104:107], v[40:43], v[144:147]
    buffer_load_dwordx4 v234, s[20:23], s46 offen offset:1024 nt lds
    v_cvt_pk_bf16_f32 v175, v214, v215
    v_mfma_f32_16x16x32_bf16 v[144:147], a[108:111], v[44:47], v[144:147]
    ds_read_b64_tr_b16 a[178:179], v228 offset:9216
    v_exp_f32 v208, v128
    v_mfma_f32_16x16x32_bf16 v[148:151], a[112:115], v[32:35], v[184:187]
    ds_read_b128 a[84:87], v221 offset:17408
    v_mfma_f32_16x16x32_bf16 v[148:151], a[116:119], v[36:39], v[148:151]
    ds_read_b64_tr_b16 a[180:181], v229 offset:8192
    v_exp_f32 v209, v129
    v_mfma_f32_16x16x32_bf16 v[148:151], a[120:123], v[40:43], v[148:151]
    v_exp_f32 v210, v130
    v_mfma_f32_16x16x32_bf16 v[148:151], a[124:127], v[44:47], v[148:151]
    ds_read_b128 a[88:91], v222 offset:17408
    v_cvt_pk_bf16_f32 v160, v208, v209
    v_mfma_f32_16x16x32_bf16 v[64:67], a[128:131], v[168:171], 0
    v_exp_f32 v211, v131
    v_mfma_f32_16x16x32_bf16 v[68:71], a[132:135], v[168:171], 0
    ds_read_b64_tr_b16 a[182:183], v229 offset:9216
    v_exp_f32 v212, v132
    v_mfma_f32_16x16x32_bf16 v[72:75], a[136:139], v[168:171], 0
    ds_read_b128 a[92:95], v223 offset:17408
    v_cvt_pk_bf16_f32 v161, v210, v211
    v_mfma_f32_16x16x32_bf16 v[76:79], a[140:143], v[168:171], 0
    v_exp_f32 v213, v133
    v_mfma_f32_16x16x32_bf16 v[80:83], a[144:147], v[168:171], 0
    buffer_load_dwordx4 v235, s[20:23], s46 offen offset:2048 nt lds
    v_exp_f32 v214, v134
    v_mfma_f32_16x16x32_bf16 v[84:87], a[148:151], v[168:171], 0
    ds_read_b64_tr_b16 a[184:185], v230 offset:8192
    v_cvt_pk_bf16_f32 v162, v212, v213
    v_mfma_f32_16x16x32_bf16 v[88:91], a[152:155], v[168:171], 0
    v_exp_f32 v215, v135
    v_mfma_f32_16x16x32_bf16 v[92:95], a[156:159], v[168:171], 0
    v_exp_f32 v208, v136
    v_cvt_pk_bf16_f32 v163, v214, v215
    v_mfma_f32_16x16x32_bf16 v[200:203], v[216:219], v[168:171], 0
    v_exp_f32 v209, v137
    v_mfma_f32_16x16x32_bf16 v[152:155], a[96:99], v[48:51], v[188:191]
    ds_read_b64_tr_b16 a[186:187], v230 offset:9216
    v_exp_f32 v210, v138
    v_mfma_f32_16x16x32_bf16 v[152:155], a[100:103], v[52:55], v[152:155]
    v_cvt_pk_bf16_f32 v164, v208, v209
    v_exp_f32 v211, v139
    v_mfma_f32_16x16x32_bf16 v[152:155], a[104:107], v[56:59], v[152:155]
    v_exp_f32 v212, v140
    v_mfma_f32_16x16x32_bf16 v[152:155], a[108:111], v[60:63], v[152:155]
    v_cvt_pk_bf16_f32 v165, v210, v211
    v_exp_f32 v213, v141
    v_mfma_f32_16x16x32_bf16 v[156:159], a[112:115], v[48:51], v[188:191]
    ds_read_b64_tr_b16 a[188:189], v231 offset:8192
    v_mfma_f32_16x16x32_bf16 v[156:159], a[116:119], v[52:55], v[156:159]
    v_exp_f32 v214, v142
    v_cvt_pk_bf16_f32 v166, v212, v213
    v_mfma_f32_16x16x32_bf16 v[156:159], a[120:123], v[56:59], v[156:159]
    v_exp_f32 v215, v143
    v_mfma_f32_16x16x32_bf16 v[156:159], a[124:127], v[60:63], v[156:159]
    buffer_load_dwordx4 v235, s[20:23], s46 offen offset:3072 nt lds
    v_exp_f32 v208, v144
    v_mfma_f32_16x16x32_bf16 v[96:99], a[128:131], v[172:175], 0
    ds_read_b64_tr_b16 a[190:191], v231 offset:9216
    v_cvt_pk_bf16_f32 v167, v214, v215
    v_mfma_f32_16x16x32_bf16 v[100:103], a[132:135], v[172:175], 0
    v_exp_f32 v209, v145
    v_mfma_f32_16x16x32_bf16 v[104:107], a[136:139], v[172:175], 0
    v_exp_f32 v210, v146
    v_cvt_pk_bf16_f32 v168, v208, v209
    v_mfma_f32_16x16x32_bf16 v[108:111], a[140:143], v[172:175], 0
    v_exp_f32 v211, v147
    v_mfma_f32_16x16x32_bf16 v[112:115], a[144:147], v[172:175], 0
    v_exp_f32 v212, v148
    v_cvt_pk_bf16_f32 v169, v210, v211
    v_mfma_f32_16x16x32_bf16 v[116:119], a[148:151], v[172:175], 0
    v_exp_f32 v213, v149
    v_mfma_f32_16x16x32_bf16 v[120:123], a[152:155], v[172:175], 0
    v_exp_f32 v214, v150
    v_cvt_pk_bf16_f32 v170, v212, v213
    v_mfma_f32_16x16x32_bf16 v[124:127], a[156:159], v[172:175], 0
    v_exp_f32 v215, v151
    v_exp_f32 v208, v152
    v_mfma_f32_16x16x32_bf16 v[204:207], v[216:219], v[172:175], 0
    v_cvt_pk_bf16_f32 v171, v214, v215
    v_exp_f32 v209, v153
    s_waitcnt lgkmcnt(4)
L_loop:
    v_mfma_f32_16x16x32_bf16 v[128:131], a[64:67], v[0:3], v[176:179]
    ds_read_b128 a[96:99], v220 offset:24576
    v_cvt_pk_bf16_f32 v172, v208, v209
    v_mfma_f32_16x16x32_bf16 v[128:131], a[68:71], v[4:7], v[128:131]
    v_exp_f32 v210, v154
    v_mfma_f32_16x16x32_bf16 v[128:131], a[72:75], v[8:11], v[128:131]
    ds_read_b128 a[100:103], v221 offset:24576
    v_mfma_f32_16x16x32_bf16 v[128:131], a[76:79], v[12:15], v[128:131]
    v_exp_f32 v211, v155
    v_mfma_f32_16x16x32_bf16 v[132:135], a[80:83], v[0:3], v[176:179]
    ds_read_b128 a[104:107], v222 offset:24576
    v_cvt_pk_bf16_f32 v173, v210, v211
    v_mfma_f32_16x16x32_bf16 v[132:135], a[84:87], v[4:7], v[132:135]
    v_exp_f32 v212, v156
    v_mfma_f32_16x16x32_bf16 v[132:135], a[88:91], v[8:11], v[132:135]
    ds_read_b128 a[108:111], v223 offset:24576
    v_mfma_f32_16x16x32_bf16 v[132:135], a[92:95], v[12:15], v[132:135]
    s_waitcnt lgkmcnt(4)
    v_exp_f32 v213, v157
    v_mfma_f32_16x16x32_bf16 a[0:3], a[160:163], v[160:163], a[0:3]
    ds_read_b128 a[112:115], v220 offset:25600
    v_cvt_pk_bf16_f32 v174, v212, v213
    v_mfma_f32_16x16x32_bf16 a[4:7], a[164:167], v[160:163], a[4:7]
    s_add_u32 s45, s45, 16384
    v_exp_f32 v214, v158
    v_mfma_f32_16x16x32_bf16 a[8:11], a[168:171], v[160:163], a[8:11]
    ds_read_b128 a[116:119], v221 offset:25600
    v_mfma_f32_16x16x32_bf16 a[12:15], a[172:175], v[160:163], a[12:15]
    s_add_u32 m0, s41, 0
    v_exp_f32 v215, v159
    v_mfma_f32_16x16x32_bf16 a[16:19], a[176:179], v[160:163], a[16:19]
    ds_read_b128 a[120:123], v222 offset:25600
    v_cvt_pk_bf16_f32 v175, v214, v215
    v_mfma_f32_16x16x32_bf16 a[20:23], a[180:183], v[160:163], a[20:23]
    buffer_load_dwordx4 v232, s[16:19], s45 offen offset:0 nt lds
    v_mfma_f32_16x16x32_bf16 a[24:27], a[184:187], v[160:163], a[24:27]
    v_exp_f32 v208, v128
    v_mfma_f32_16x16x32_bf16 a[28:31], a[188:191], v[160:163], a[28:31]
    ds_read_b128 a[124:127], v223 offset:25600
    v_mfma_f32_16x16x32_bf16 v[192:195], v[216:219], v[160:163], v[192:195]
    v_exp_f32 v209, v129
    v_mfma_f32_16x16x32_bf16 v[136:139], a[64:67], v[16:19], v[180:183]
    ds_read_b64_tr_b16 a[128:129], v224 offset:16384
    v_cvt_pk_bf16_f32 v160, v208, v209
    v_mfma_f32_16x16x32_bf16 v[136:139], a[68:71], v[20:23], v[136:139]
    v_exp_f32 v210, v130
    v_mfma_f32_16x16x32_bf16 v[136:139], a[72:75], v[24:27], v[136:139]
    ds_read_b64_tr_b16 a[130:131], v224 offset:17408
    v_mfma_f32_16x16x32_bf16 v[136:139], a[76:79], v[28:31], v[136:139]
    v_exp_f32 v211, v131
    v_mfma_f32_16x16x32_bf16 v[140:143], a[80:83], v[16:19], v[180:183]
    ds_read_b64_tr_b16 a[132:133], v225 offset:16384
    v_cvt_pk_bf16_f32 v161, v210, v211
    v_mfma_f32_16x16x32_bf16 v[140:143], a[84:87], v[20:23], v[140:143]
    v_exp_f32 v212, v132
    v_mfma_f32_16x16x32_bf16 v[140:143], a[88:91], v[24:27], v[140:143]
    ds_read_b64_tr_b16 a[134:135], v225 offset:17408
    v_mfma_f32_16x16x32_bf16 v[140:143], a[92:95], v[28:31], v[140:143]
    v_exp_f32 v213, v133
    v_mfma_f32_16x16x32_bf16 a[32:35], a[160:163], v[164:167], a[32:35]
    buffer_load_dwordx4 v232, s[16:19], s45 offen offset:1024 nt lds
    v_cvt_pk_bf16_f32 v162, v212, v213
    v_mfma_f32_16x16x32_bf16 a[36:39], a[164:167], v[164:167], a[36:39]
    v_exp_f32 v214, v134
    v_mfma_f32_16x16x32_bf16 a[40:43], a[168:171], v[164:167], a[40:43]
    ds_read_b64_tr_b16 a[136:137], v226 offset:16384
    v_mfma_f32_16x16x32_bf16 a[44:47], a[172:175], v[164:167], a[44:47]
    v_exp_f32 v215, v135
    v_mfma_f32_16x16x32_bf16 a[48:51], a[176:179], v[164:167], a[48:51]
    ds_read_b64_tr_b16 a[138:139], v226 offset:17408
    v_cvt_pk_bf16_f32 v163, v214, v215
    v_mfma_f32_16x16x32_bf16 a[52:55], a[180:183], v[164:167], a[52:55]
    ds_read_b64_tr_b16 a[140:141], v227 offset:16384
    v_mfma_f32_16x16x32_bf16 a[56:59], a[184:187], v[164:167], a[56:59]
    v_exp_f32 v208, v136
    v_mfma_f32_16x16x32_bf16 a[60:63], a[188:191], v[164:167], a[60:63]
    ds_read_b64_tr_b16 a[142:143], v227 offset:17408
    v_mfma_f32_16x16x32_bf16 v[196:199], v[216:219], v[164:167], v[196:199]
    v_exp_f32 v209, v137
    v_mfma_f32_16x16x32_bf16 v[144:147], a[64:67], v[32:35], v[184:187]
    ds_read_b64_tr_b16 a[144:145], v228 offset:16384
    v_cvt_pk_bf16_f32 v164, v208, v209
    v_mfma_f32_16x16x32_bf16 v[144:147], a[68:71], v[36:39], v[144:147]
    v_exp_f32 v210, v138
    v_mfma_f32_16x16x32_bf16 v[144:147], a[72:75], v[40:43], v[144:147]
    ds_read_b64_tr_b16 a[146:147], v228 offset:17408
    v_mfma_f32_16x16x32_bf16 v[144:147], a[76:79], v[44:47], v[144:147]
    v_exp_f32 v211, v139
    v_mfma_f32_16x16x32_bf16 v[148:151], a[80:83], v[32:35], v[184:187]
    buffer_load_dwordx4 v233, s[16:19], s45 offen offset:2048 nt lds
    v_cvt_pk_bf16_f32 v165, v210, v211
    v_mfma_f32_16x16x32_bf16 v[148:151], a[84:87], v[36:39], v[148:151]
    v_exp_f32 v212, v140
    v_mfma_f32_16x16x32_bf16 v[148:151], a[88:91], v[40:43], v[148:151]
    ds_read_b64_tr_b16 a[148:149], v229 offset:16384
    v_mfma_f32_16x16x32_bf16 v[148:151], a[92:95], v[44:47], v[148:151]
    v_exp_f32 v213, v141
    v_mfma_f32_16x16x32_bf16 v[64:67], a[160:163], v[168:171], v[64:67]
    ds_read_b64_tr_b16 a[150:151], v229 offset:17408
    v_cvt_pk_bf16_f32 v166, v212, v213
    v_mfma_f32_16x16x32_bf16 v[68:71], a[164:167], v[168:171], v[68:71]
    v_exp_f32 v214, v142
    v_mfma_f32_16x16x32_bf16 v[72:75], a[168:171], v[168:171], v[72:75]
    ds_read_b64_tr_b16 a[152:153], v230 offset:16384
    v_mfma_f32_16x16x32_bf16 v[76:79], a[172:175], v[168:171], v[76:79]
    v_exp_f32 v215, v143
    v_mfma_f32_16x16x32_bf16 v[80:83], a[176:179], v[168:171], v[80:83]
    ds_read_b64_tr_b16 a[154:155], v230 offset:17408
    v_cvt_pk_bf16_f32 v167, v214, v215
    v_mfma_f32_16x16x32_bf16 v[84:87], a[180:183], v[168:171], v[84:87]
    ds_read_b64_tr_b16 a[156:157], v231 offset:16384
    v_mfma_f32_16x16x32_bf16 v[88:91], a[184:187], v[168:171], v[88:91]
    v_exp_f32 v208, v144
    v_mfma_f32_16x16x32_bf16 v[92:95], a[188:191], v[168:171], v[92:95]
    ds_read_b64_tr_b16 a[158:159], v231 offset:17408
    v_mfma_f32_16x16x32_bf16 v[200:203], v[216:219], v[168:171], v[200:203]
    v_exp_f32 v209, v145
    v_mfma_f32_16x16x32_bf16 v[152:155], a[64:67], v[48:51], v[188:191]
    buffer_load_dwordx4 v233, s[16:19], s45 offen offset:3072 nt lds
    v_cvt_pk_bf16_f32 v168, v208, v209
    v_mfma_f32_16x16x32_bf16 v[152:155], a[68:71], v[52:55], v[152:155]
    v_exp_f32 v210, v146
    v_mfma_f32_16x16x32_bf16 v[152:155], a[72:75], v[56:59], v[152:155]
    v_mfma_f32_16x16x32_bf16 v[152:155], a[76:79], v[60:63], v[152:155]
    v_exp_f32 v211, v147
    v_mfma_f32_16x16x32_bf16 v[156:159], a[80:83], v[48:51], v[188:191]
    v_cvt_pk_bf16_f32 v169, v210, v211
    v_mfma_f32_16x16x32_bf16 v[156:159], a[84:87], v[52:55], v[156:159]
    v_exp_f32 v212, v148
    v_mfma_f32_16x16x32_bf16 v[156:159], a[88:91], v[56:59], v[156:159]
    v_mfma_f32_16x16x32_bf16 v[156:159], a[92:95], v[60:63], v[156:159]
    v_exp_f32 v213, v149
    v_mfma_f32_16x16x32_bf16 v[96:99], a[160:163], v[172:175], v[96:99]
    v_cvt_pk_bf16_f32 v170, v212, v213
    v_mfma_f32_16x16x32_bf16 v[100:103], a[164:167], v[172:175], v[100:103]
    v_exp_f32 v214, v150
    v_mfma_f32_16x16x32_bf16 v[104:107], a[168:171], v[172:175], v[104:107]
    v_mfma_f32_16x16x32_bf16 v[108:111], a[172:175], v[172:175], v[108:111]
    v_exp_f32 v215, v151
    v_mfma_f32_16x16x32_bf16 v[112:115], a[176:179], v[172:175], v[112:115]
    v_cvt_pk_bf16_f32 v171, v214, v215
    v_mfma_f32_16x16x32_bf16 v[116:119], a[180:183], v[172:175], v[116:119]
    v_mfma_f32_16x16x32_bf16 v[120:123], a[184:187], v[172:175], v[120:123]
    v_exp_f32 v208, v152
    v_mfma_f32_16x16x32_bf16 v[124:127], a[188:191], v[172:175], v[124:127]
    v_mfma_f32_16x16x32_bf16 v[204:207], v[216:219], v[172:175], v[204:207]
    v_exp_f32 v209, v153
    s_waitcnt vmcnt(12) lgkmcnt(15)
    s_barrier
    v_mfma_f32_16x16x32_bf16 v[128:131], a[96:99], v[0:3], v[176:179]
    ds_read_b128 a[64:67], v220 offset:32768
    v_cvt_pk_bf16_f32 v172, v208, v209
    v_mfma_f32_16x16x32_bf16 v[128:131], a[100:103], v[4:7], v[128:131]
    v_exp_f32 v210, v154
    v_mfma_f32_16x16x32_bf16 v[128:131], a[104:107], v[8:11], v[128:131]
    ds_read_b128 a[68:71], v221 offset:32768
    v_mfma_f32_16x16x32_bf16 v[128:131], a[108:111], v[12:15], v[128:131]
    v_exp_f32 v211, v155
    v_mfma_f32_16x16x32_bf16 v[132:135], a[112:115], v[0:3], v[176:179]
    ds_read_b128 a[72:75], v222 offset:32768
    v_cvt_pk_bf16_f32 v173, v210, v211
    v_mfma_f32_16x16x32_bf16 v[132:135], a[116:119], v[4:7], v[132:135]
    v_exp_f32 v212, v156
    v_mfma_f32_16x16x32_bf16 v[132:135], a[120:123], v[8:11], v[132:135]
    ds_read_b128 a[76:79], v223 offset:32768
    v_mfma_f32_16x16x32_bf16 v[132:135], a[124:127], v[12:15], v[132:135]
    s_waitcnt lgkmcnt(4)
    v_exp_f32 v213, v157
    v_mfma_f32_16x16x32_bf16 a[0:3], a[128:131], v[160:163], a[0:3]
    ds_read_b128 a[80:83], v220 offset:33792
    v_cvt_pk_bf16_f32 v174, v212, v213
    v_mfma_f32_16x16x32_bf16 a[4:7], a[132:135], v[160:163], a[4:7]
    s_add_u32 s46, s46, 16384
    v_exp_f32 v214, v158
    v_mfma_f32_16x16x32_bf16 a[8:11], a[136:139], v[160:163], a[8:11]
    ds_read_b128 a[84:87], v221 offset:33792
    v_mfma_f32_16x16x32_bf16 a[12:15], a[140:143], v[160:163], a[12:15]
    s_add_u32 m0, s41, 65536
    v_exp_f32 v215, v159
    v_mfma_f32_16x16x32_bf16 a[16:19], a[144:147], v[160:163], a[16:19]
    ds_read_b128 a[88:91], v222 offset:33792
    v_cvt_pk_bf16_f32 v175, v214, v215
    v_mfma_f32_16x16x32_bf16 a[20:23], a[148:151], v[160:163], a[20:23]
    buffer_load_dwordx4 v234, s[20:23], s46 offen offset:0 nt lds
    v_mfma_f32_16x16x32_bf16 a[24:27], a[152:155], v[160:163], a[24:27]
    v_exp_f32 v208, v128
    v_mfma_f32_16x16x32_bf16 a[28:31], a[156:159], v[160:163], a[28:31]
    ds_read_b128 a[92:95], v223 offset:33792
    v_mfma_f32_16x16x32_bf16 v[192:195], v[216:219], v[160:163], v[192:195]
    v_exp_f32 v209, v129
    v_mfma_f32_16x16x32_bf16 v[136:139], a[96:99], v[16:19], v[180:183]
    ds_read_b64_tr_b16 a[160:161], v224 offset:24576
    v_cvt_pk_bf16_f32 v160, v208, v209
    v_mfma_f32_16x16x32_bf16 v[136:139], a[100:103], v[20:23], v[136:139]
    v_exp_f32 v210, v130
    v_mfma_f32_16x16x32_bf16 v[136:139], a[104:107], v[24:27], v[136:139]
    ds_read_b64_tr_b16 a[162:163], v224 offset:25600
    v_mfma_f32_16x16x32_bf16 v[136:139], a[108:111], v[28:31], v[136:139]
    v_exp_f32 v211, v131
    v_mfma_f32_16x16x32_bf16 v[140:143], a[112:115], v[16:19], v[180:183]
    ds_read_b64_tr_b16 a[164:165], v225 offset:24576
    v_cvt_pk_bf16_f32 v161, v210, v211
    v_mfma_f32_16x16x32_bf16 v[140:143], a[116:119], v[20:23], v[140:143]
    v_exp_f32 v212, v132
    v_mfma_f32_16x16x32_bf16 v[140:143], a[120:123], v[24:27], v[140:143]
    ds_read_b64_tr_b16 a[166:167], v225 offset:25600
    v_mfma_f32_16x16x32_bf16 v[140:143], a[124:127], v[28:31], v[140:143]
    v_exp_f32 v213, v133
    v_mfma_f32_16x16x32_bf16 a[32:35], a[128:131], v[164:167], a[32:35]
    buffer_load_dwordx4 v234, s[20:23], s46 offen offset:1024 nt lds
    v_cvt_pk_bf16_f32 v162, v212, v213
    v_mfma_f32_16x16x32_bf16 a[36:39], a[132:135], v[164:167], a[36:39]
    v_exp_f32 v214, v134
    v_mfma_f32_16x16x32_bf16 a[40:43], a[136:139], v[164:167], a[40:43]
    ds_read_b64_tr_b16 a[168:169], v226 offset:24576
    v_mfma_f32_16x16x32_bf16 a[44:47], a[140:143], v[164:167], a[44:47]
    v_exp_f32 v215, v135
    v_mfma_f32_16x16x32_bf16 a[48:51], a[144:147], v[164:167], a[48:51]
    ds_read_b64_tr_b16 a[170:171], v226 offset:25600
    v_cvt_pk_bf16_f32 v163, v214, v215
    v_mfma_f32_16x16x32_bf16 a[52:55], a[148:151], v[164:167], a[52:55]
    ds_read_b64_tr_b16 a[172:173], v227 offset:24576
    v_mfma_f32_16x16x32_bf16 a[56:59], a[152:155], v[164:167], a[56:59]
    v_exp_f32 v208, v136
    v_mfma_f32_16x16x32_bf16 a[60:63], a[156:159], v[164:167], a[60:63]
    ds_read_b64_tr_b16 a[174:175], v227 offset:25600
    v_mfma_f32_16x16x32_bf16 v[196:199], v[216:219], v[164:167], v[196:199]
    v_exp_f32 v209, v137
    v_mfma_f32_16x16x32_bf16 v[144:147], a[96:99], v[32:35], v[184:187]
    ds_read_b64_tr_b16 a[176:177], v228 offset:24576
    v_cvt_pk_bf16_f32 v164, v208, v209
    v_mfma_f32_16x16x32_bf16 v[144:147], a[100:103], v[36:39], v[144:147]
    v_exp_f32 v210, v138
    v_mfma_f32_16x16x32_bf16 v[144:147], a[104:107], v[40:43], v[144:147]
    ds_read_b64_tr_b16 a[178:179], v228 offset:25600
    v_mfma_f32_16x16x32_bf16 v[144:147], a[108:111], v[44:47], v[144:147]
    v_exp_f32 v211, v139
    v_mfma_f32_16x16x32_bf16 v[148:151], a[112:115], v[32:35], v[184:187]
    buffer_load_dwordx4 v235, s[20:23], s46 offen offset:2048 nt lds
    v_cvt_pk_bf16_f32 v165, v210, v211
    v_mfma_f32_16x16x32_bf16 v[148:151], a[116:119], v[36:39], v[148:151]
    v_exp_f32 v212, v140
    v_mfma_f32_16x16x32_bf16 v[148:151], a[120:123], v[40:43], v[148:151]
    ds_read_b64_tr_b16 a[180:181], v229 offset:24576
    v_mfma_f32_16x16x32_bf16 v[148:151], a[124:127], v[44:47], v[148:151]
    v_exp_f32 v213, v141
    v_mfma_f32_16x16x32_bf16 v[64:67], a[128:131], v[168:171], v[64:67]
    ds_read_b64_tr_b16 a[182:183], v229 offset:25600
    v_cvt_pk_bf16_f32 v166, v212, v213
    v_mfma_f32_16x16x32_bf16 v[68:71], a[132:135], v[168:171], v[68:71]
    v_exp_f32 v214, v142
    v_mfma_f32_16x16x32_bf16 v[72:75], a[136:139], v[168:171], v[72:75]
    ds_read_b64_tr_b16 a[184:185], v230 offset:24576
    v_mfma_f32_16x16x32_bf16 v[76:79], a[140:143], v[168:171], v[76:79]
    v_exp_f32 v215, v143
    v_mfma_f32_16x16x32_bf16 v[80:83], a[144:147], v[168:171], v[80:83]
    ds_read_b64_tr_b16 a[186:187], v230 offset:25600
    v_cvt_pk_bf16_f32 v167, v214, v215
    v_mfma_f32_16x16x32_bf16 v[84:87], a[148:151], v[168:171], v[84:87]
    ds_read_b64_tr_b16 a[188:189], v231 offset:24576
    v_mfma_f32_16x16x32_bf16 v[88:91], a[152:155], v[168:171], v[88:91]
    v_exp_f32 v208, v144
    v_mfma_f32_16x16x32_bf16 v[92:95], a[156:159], v[168:171], v[92:95]
    ds_read_b64_tr_b16 a[190:191], v231 offset:25600
    v_mfma_f32_16x16x32_bf16 v[200:203], v[216:219], v[168:171], v[200:203]
    v_exp_f32 v209, v145
    v_mfma_f32_16x16x32_bf16 v[152:155], a[96:99], v[48:51], v[188:191]
    buffer_load_dwordx4 v235, s[20:23], s46 offen offset:3072 nt lds
    v_cvt_pk_bf16_f32 v168, v208, v209
    v_mfma_f32_16x16x32_bf16 v[152:155], a[100:103], v[52:55], v[152:155]
    v_exp_f32 v210, v146
    v_mfma_f32_16x16x32_bf16 v[152:155], a[104:107], v[56:59], v[152:155]
    v_mfma_f32_16x16x32_bf16 v[152:155], a[108:111], v[60:63], v[152:155]
    v_exp_f32 v211, v147
    v_mfma_f32_16x16x32_bf16 v[156:159], a[112:115], v[48:51], v[188:191]
    v_cvt_pk_bf16_f32 v169, v210, v211
    v_mfma_f32_16x16x32_bf16 v[156:159], a[116:119], v[52:55], v[156:159]
    v_exp_f32 v212, v148
    v_mfma_f32_16x16x32_bf16 v[156:159], a[120:123], v[56:59], v[156:159]
    v_mfma_f32_16x16x32_bf16 v[156:159], a[124:127], v[60:63], v[156:159]
    v_exp_f32 v213, v149
    v_mfma_f32_16x16x32_bf16 v[96:99], a[128:131], v[172:175], v[96:99]
    v_cvt_pk_bf16_f32 v170, v212, v213
    v_mfma_f32_16x16x32_bf16 v[100:103], a[132:135], v[172:175], v[100:103]
    v_exp_f32 v214, v150
    v_mfma_f32_16x16x32_bf16 v[104:107], a[136:139], v[172:175], v[104:107]
    v_mfma_f32_16x16x32_bf16 v[108:111], a[140:143], v[172:175], v[108:111]
    v_exp_f32 v215, v151
    v_mfma_f32_16x16x32_bf16 v[112:115], a[144:147], v[172:175], v[112:115]
    v_cvt_pk_bf16_f32 v171, v214, v215
    v_mfma_f32_16x16x32_bf16 v[116:119], a[148:151], v[172:175], v[116:119]
    v_mfma_f32_16x16x32_bf16 v[120:123], a[152:155], v[172:175], v[120:123]
    v_exp_f32 v208, v152
    v_mfma_f32_16x16x32_bf16 v[124:127], a[156:159], v[172:175], v[124:127]
    v_mfma_f32_16x16x32_bf16 v[204:207], v[216:219], v[172:175], v[204:207]
    s_waitcnt lgkmcnt(15)
    v_exp_f32 v209, v153
    v_mfma_f32_16x16x32_bf16 v[128:131], a[64:67], v[0:3], v[176:179]
    ds_read_b128 a[96:99], v220 offset:40960
    v_cvt_pk_bf16_f32 v172, v208, v209
    v_mfma_f32_16x16x32_bf16 v[128:131], a[68:71], v[4:7], v[128:131]
    v_exp_f32 v210, v154
    v_mfma_f32_16x16x32_bf16 v[128:131], a[72:75], v[8:11], v[128:131]
    ds_read_b128 a[100:103], v221 offset:40960
    v_mfma_f32_16x16x32_bf16 v[128:131], a[76:79], v[12:15], v[128:131]
    v_exp_f32 v211, v155
    v_mfma_f32_16x16x32_bf16 v[132:135], a[80:83], v[0:3], v[176:179]
    ds_read_b128 a[104:107], v222 offset:40960
    v_cvt_pk_bf16_f32 v173, v210, v211
    v_mfma_f32_16x16x32_bf16 v[132:135], a[84:87], v[4:7], v[132:135]
    v_exp_f32 v212, v156
    v_mfma_f32_16x16x32_bf16 v[132:135], a[88:91], v[8:11], v[132:135]
    ds_read_b128 a[108:111], v223 offset:40960
    v_mfma_f32_16x16x32_bf16 v[132:135], a[92:95], v[12:15], v[132:135]
    s_waitcnt lgkmcnt(4)
    v_exp_f32 v213, v157
    v_mfma_f32_16x16x32_bf16 a[0:3], a[160:163], v[160:163], a[0:3]
    ds_read_b128 a[112:115], v220 offset:41984
    v_cvt_pk_bf16_f32 v174, v212, v213
    v_mfma_f32_16x16x32_bf16 a[4:7], a[164:167], v[160:163], a[4:7]
    s_add_u32 s45, s45, 16384
    v_exp_f32 v214, v158
    v_mfma_f32_16x16x32_bf16 a[8:11], a[168:171], v[160:163], a[8:11]
    ds_read_b128 a[116:119], v221 offset:41984
    v_mfma_f32_16x16x32_bf16 a[12:15], a[172:175], v[160:163], a[12:15]
    s_add_u32 m0, s41, 16384
    v_exp_f32 v215, v159
    v_mfma_f32_16x16x32_bf16 a[16:19], a[176:179], v[160:163], a[16:19]
    ds_read_b128 a[120:123], v222 offset:41984
    v_cvt_pk_bf16_f32 v175, v214, v215
    v_mfma_f32_16x16x32_bf16 a[20:23], a[180:183], v[160:163], a[20:23]
    buffer_load_dwordx4 v232, s[16:19], s45 offen offset:0 nt lds
    v_mfma_f32_16x16x32_bf16 a[24:27], a[184:187], v[160:163], a[24:27]
    v_exp_f32 v208, v128
    v_mfma_f32_16x16x32_bf16 a[28:31], a[188:191], v[160:163], a[28:31]
    ds_read_b128 a[124:127], v223 offset:41984
    v_mfma_f32_16x16x32_bf16 v[192:195], v[216:219], v[160:163], v[192:195]
    v_exp_f32 v209, v129
    v_mfma_f32_16x16x32_bf16 v[136:139], a[64:67], v[16:19], v[180:183]
    ds_read_b64_tr_b16 a[128:129], v224 offset:32768
    v_cvt_pk_bf16_f32 v160, v208, v209
    v_mfma_f32_16x16x32_bf16 v[136:139], a[68:71], v[20:23], v[136:139]
    v_exp_f32 v210, v130
    v_mfma_f32_16x16x32_bf16 v[136:139], a[72:75], v[24:27], v[136:139]
    ds_read_b64_tr_b16 a[130:131], v224 offset:33792
    v_mfma_f32_16x16x32_bf16 v[136:139], a[76:79], v[28:31], v[136:139]
    v_exp_f32 v211, v131
    v_mfma_f32_16x16x32_bf16 v[140:143], a[80:83], v[16:19], v[180:183]
    ds_read_b64_tr_b16 a[132:133], v225 offset:32768
    v_cvt_pk_bf16_f32 v161, v210, v211
    v_mfma_f32_16x16x32_bf16 v[140:143], a[84:87], v[20:23], v[140:143]
    v_exp_f32 v212, v132
    v_mfma_f32_16x16x32_bf16 v[140:143], a[88:91], v[24:27], v[140:143]
    ds_read_b64_tr_b16 a[134:135], v225 offset:33792
    v_mfma_f32_16x16x32_bf16 v[140:143], a[92:95], v[28:31], v[140:143]
    v_exp_f32 v213, v133
    v_mfma_f32_16x16x32_bf16 a[32:35], a[160:163], v[164:167], a[32:35]
    buffer_load_dwordx4 v232, s[16:19], s45 offen offset:1024 nt lds
    v_cvt_pk_bf16_f32 v162, v212, v213
    v_mfma_f32_16x16x32_bf16 a[36:39], a[164:167], v[164:167], a[36:39]
    v_exp_f32 v214, v134
    v_mfma_f32_16x16x32_bf16 a[40:43], a[168:171], v[164:167], a[40:43]
    ds_read_b64_tr_b16 a[136:137], v226 offset:32768
    v_mfma_f32_16x16x32_bf16 a[44:47], a[172:175], v[164:167], a[44:47]
    v_exp_f32 v215, v135
    v_mfma_f32_16x16x32_bf16 a[48:51], a[176:179], v[164:167], a[48:51]
    ds_read_b64_tr_b16 a[138:139], v226 offset:33792
    v_cvt_pk_bf16_f32 v163, v214, v215
    v_mfma_f32_16x16x32_bf16 a[52:55], a[180:183], v[164:167], a[52:55]
    ds_read_b64_tr_b16 a[140:141], v227 offset:32768
    v_mfma_f32_16x16x32_bf16 a[56:59], a[184:187], v[164:167], a[56:59]
    v_exp_f32 v208, v136
    v_mfma_f32_16x16x32_bf16 a[60:63], a[188:191], v[164:167], a[60:63]
    ds_read_b64_tr_b16 a[142:143], v227 offset:33792
    v_mfma_f32_16x16x32_bf16 v[196:199], v[216:219], v[164:167], v[196:199]
    v_exp_f32 v209, v137
    v_mfma_f32_16x16x32_bf16 v[144:147], a[64:67], v[32:35], v[184:187]
    ds_read_b64_tr_b16 a[144:145], v228 offset:32768
    v_cvt_pk_bf16_f32 v164, v208, v209
    v_mfma_f32_16x16x32_bf16 v[144:147], a[68:71], v[36:39], v[144:147]
    v_exp_f32 v210, v138
    v_mfma_f32_16x16x32_bf16 v[144:147], a[72:75], v[40:43], v[144:147]
    ds_read_b64_tr_b16 a[146:147], v228 offset:33792
    v_mfma_f32_16x16x32_bf16 v[144:147], a[76:79], v[44:47], v[144:147]
    v_exp_f32 v211, v139
    v_mfma_f32_16x16x32_bf16 v[148:151], a[80:83], v[32:35], v[184:187]
    buffer_load_dwordx4 v233, s[16:19], s45 offen offset:2048 nt lds
    v_cvt_pk_bf16_f32 v165, v210, v211
    v_mfma_f32_16x16x32_bf16 v[148:151], a[84:87], v[36:39], v[148:151]
    v_exp_f32 v212, v140
    v_mfma_f32_16x16x32_bf16 v[148:151], a[88:91], v[40:43], v[148:151]
    ds_read_b64_tr_b16 a[148:149], v229 offset:32768
    v_mfma_f32_16x16x32_bf16 v[148:151], a[92:95], v[44:47], v[148:151]
    v_exp_f32 v213, v141
    v_mfma_f32_16x16x32_bf16 v[64:67], a[160:163], v[168:171], v[64:67]
    ds_read_b64_tr_b16 a[150:151], v229 offset:33792
    v_cvt_pk_bf16_f32 v166, v212, v213
    v_mfma_f32_16x16x32_bf16 v[68:71], a[164:167], v[168:171], v[68:71]
    v_exp_f32 v214, v142
    v_mfma_f32_16x16x32_bf16 v[72:75], a[168:171], v[168:171], v[72:75]
    ds_read_b64_tr_b16 a[152:153], v230 offset:32768
    v_mfma_f32_16x16x32_bf16 v[76:79], a[172:175], v[168:171], v[76:79]
    v_exp_f32 v215, v143
    v_mfma_f32_16x16x32_bf16 v[80:83], a[176:179], v[168:171], v[80:83]
    ds_read_b64_tr_b16 a[154:155], v230 offset:33792
    v_cvt_pk_bf16_f32 v167, v214, v215
    v_mfma_f32_16x16x32_bf16 v[84:87], a[180:183], v[168:171], v[84:87]
    ds_read_b64_tr_b16 a[156:157], v231 offset:32768
    v_mfma_f32_16x16x32_bf16 v[88:91], a[184:187], v[168:171], v[88:91]
    v_exp_f32 v208, v144
    v_mfma_f32_16x16x32_bf16 v[92:95], a[188:191], v[168:171], v[92:95]
    ds_read_b64_tr_b16 a[158:159], v231 offset:33792
    v_mfma_f32_16x16x32_bf16 v[200:203], v[216:219], v[168:171], v[200:203]
    v_exp_f32 v209, v145
    v_mfma_f32_16x16x32_bf16 v[152:155], a[64:67], v[48:51], v[188:191]
    buffer_load_dwordx4 v233, s[16:19], s45 offen offset:3072 nt lds
    v_cvt_pk_bf16_f32 v168, v208, v209
    v_mfma_f32_16x16x32_bf16 v[152:155], a[68:71], v[52:55], v[152:155]
    v_exp_f32 v210, v146
    v_mfma_f32_16x16x32_bf16 v[152:155], a[72:75], v[56:59], v[152:155]
    v_mfma_f32_16x16x32_bf16 v[152:155], a[76:79], v[60:63], v[152:155]
    v_exp_f32 v211, v147
    v_mfma_f32_16x16x32_bf16 v[156:159], a[80:83], v[48:51], v[188:191]
    v_cvt_pk_bf16_f32 v169, v210, v211
    v_mfma_f32_16x16x32_bf16 v[156:159], a[84:87], v[52:55], v[156:159]
    v_exp_f32 v212, v148
    v_mfma_f32_16x16x32_bf16 v[156:159], a[88:91], v[56:59], v[156:159]
    v_mfma_f32_16x16x32_bf16 v[156:159], a[92:95], v[60:63], v[156:159]
    v_exp_f32 v213, v149
    v_mfma_f32_16x16x32_bf16 v[96:99], a[160:163], v[172:175], v[96:99]
    v_cvt_pk_bf16_f32 v170, v212, v213
    v_mfma_f32_16x16x32_bf16 v[100:103], a[164:167], v[172:175], v[100:103]
    v_exp_f32 v214, v150
    v_mfma_f32_16x16x32_bf16 v[104:107], a[168:171], v[172:175], v[104:107]
    v_mfma_f32_16x16x32_bf16 v[108:111], a[172:175], v[172:175], v[108:111]
    v_exp_f32 v215, v151
    v_mfma_f32_16x16x32_bf16 v[112:115], a[176:179], v[172:175], v[112:115]
    v_cvt_pk_bf16_f32 v171, v214, v215
    v_mfma_f32_16x16x32_bf16 v[116:119], a[180:183], v[172:175], v[116:119]
    v_mfma_f32_16x16x32_bf16 v[120:123], a[184:187], v[172:175], v[120:123]
    v_exp_f32 v208, v152
    v_mfma_f32_16x16x32_bf16 v[124:127], a[188:191], v[172:175], v[124:127]
    v_mfma_f32_16x16x32_bf16 v[204:207], v[216:219], v[172:175], v[204:207]
    v_exp_f32 v209, v153
    s_waitcnt vmcnt(12) lgkmcnt(15)
    s_barrier
    v_mfma_f32_16x16x32_bf16 v[128:131], a[96:99], v[0:3], v[176:179]
    ds_read_b128 a[64:67], v220 offset:49152
    v_cvt_pk_bf16_f32 v172, v208, v209
    v_mfma_f32_16x16x32_bf16 v[128:131], a[100:103], v[4:7], v[128:131]
    v_exp_f32 v210, v154
    v_mfma_f32_16x16x32_bf16 v[128:131], a[104:107], v[8:11], v[128:131]
    ds_read_b128 a[68:71], v221 offset:49152
    v_mfma_f32_16x16x32_bf16 v[128:131], a[108:111], v[12:15], v[128:131]
    v_exp_f32 v211, v155
    v_mfma_f32_16x16x32_bf16 v[132:135], a[112:115], v[0:3], v[176:179]
    ds_read_b128 a[72:75], v222 offset:49152
    v_cvt_pk_bf16_f32 v173, v210, v211
    v_mfma_f32_16x16x32_bf16 v[132:135], a[116:119], v[4:7], v[132:135]
    v_exp_f32 v212, v156
    v_mfma_f32_16x16x32_bf16 v[132:135], a[120:123], v[8:11], v[132:135]
    ds_read_b128 a[76:79], v223 offset:49152
    v_mfma_f32_16x16x32_bf16 v[132:135], a[124:127], v[12:15], v[132:135]
    s_waitcnt lgkmcnt(4)
    v_exp_f32 v213, v157
    v_mfma_f32_16x16x32_bf16 a[0:3], a[128:131], v[160:163], a[0:3]
    ds_read_b128 a[80:83], v220 offset:50176
    v_cvt_pk_bf16_f32 v174, v212, v213
    v_mfma_f32_16x16x32_bf16 a[4:7], a[132:135], v[160:163], a[4:7]
    s_add_u32 s46, s46, 16384
    v_exp_f32 v214, v158
    v_mfma_f32_16x16x32_bf16 a[8:11], a[136:139], v[160:163], a[8:11]
    ds_read_b128 a[84:87], v221 offset:50176
    v_mfma_f32_16x16x32_bf16 a[12:15], a[140:143], v[160:163], a[12:15]
    s_add_u32 m0, s41, 81920
    v_exp_f32 v215, v159
    v_mfma_f32_16x16x32_bf16 a[16:19], a[144:147], v[160:163], a[16:19]
    ds_read_b128 a[88:91], v222 offset:50176
    v_cvt_pk_bf16_f32 v175, v214, v215
    v_mfma_f32_16x16x32_bf16 a[20:23], a[148:151], v[160:163], a[20:23]
    buffer_load_dwordx4 v234, s[20:23], s46 offen offset:0 nt lds
    v_mfma_f32_16x16x32_bf16 a[24:27], a[152:155], v[160:163], a[24:27]
    v_exp_f32 v208, v128
    v_mfma_f32_16x16x32_bf16 a[28:31], a[156:159], v[160:163], a[28:31]
    ds_read_b128 a[92:95], v223 offset:50176
    v_mfma_f32_16x16x32_bf16 v[192:195], v[216:219], v[160:163], v[192:195]
    v_exp_f32 v209, v129
    v_mfma_f32_16x16x32_bf16 v[136:139], a[96:99], v[16:19], v[180:183]
    ds_read_b64_tr_b16 a[160:161], v224 offset:40960
    v_cvt_pk_bf16_f32 v160, v208, v209
    v_mfma_f32_16x16x32_bf16 v[136:139], a[100:103], v[20:23], v[136:139]
    v_exp_f32 v210, v130
    v_mfma_f32_16x16x32_bf16 v[136:139], a[104:107], v[24:27], v[136:139]
    ds_read_b64_tr_b16 a[162:163], v224 offset:41984
    v_mfma_f32_16x16x32_bf16 v[136:139], a[108:111], v[28:31], v[136:139]
    v_exp_f32 v211, v131
    v_mfma_f32_16x16x32_bf16 v[140:143], a[112:115], v[16:19], v[180:183]
    ds_read_b64_tr_b16 a[164:165], v225 offset:40960
    v_cvt_pk_bf16_f32 v161, v210, v211
    v_mfma_f32_16x16x32_bf16 v[140:143], a[116:119], v[20:23], v[140:143]
    v_exp_f32 v212, v132
    v_mfma_f32_16x16x32_bf16 v[140:143], a[120:123], v[24:27], v[140:143]
    ds_read_b64_tr_b16 a[166:167], v225 offset:41984
    v_mfma_f32_16x16x32_bf16 v[140:143], a[124:127], v[28:31], v[140:143]
    v_exp_f32 v213, v133
    v_mfma_f32_16x16x32_bf16 a[32:35], a[128:131], v[164:167], a[32:35]
    buffer_load_dwordx4 v234, s[20:23], s46 offen offset:1024 nt lds
    v_cvt_pk_bf16_f32 v162, v212, v213
    v_mfma_f32_16x16x32_bf16 a[36:39], a[132:135], v[164:167], a[36:39]
    v_exp_f32 v214, v134
    v_mfma_f32_16x16x32_bf16 a[40:43], a[136:139], v[164:167], a[40:43]
    ds_read_b64_tr_b16 a[168:169], v226 offset:40960
    v_mfma_f32_16x16x32_bf16 a[44:47], a[140:143], v[164:167], a[44:47]
    v_exp_f32 v215, v135
    v_mfma_f32_16x16x32_bf16 a[48:51], a[144:147], v[164:167], a[48:51]
    ds_read_b64_tr_b16 a[170:171], v226 offset:41984
    v_cvt_pk_bf16_f32 v163, v214, v215
    v_mfma_f32_16x16x32_bf16 a[52:55], a[148:151], v[164:167], a[52:55]
    ds_read_b64_tr_b16 a[172:173], v227 offset:40960
    v_mfma_f32_16x16x32_bf16 a[56:59], a[152:155], v[164:167], a[56:59]
    v_exp_f32 v208, v136
    v_mfma_f32_16x16x32_bf16 a[60:63], a[156:159], v[164:167], a[60:63]
    ds_read_b64_tr_b16 a[174:175], v227 offset:41984
    v_mfma_f32_16x16x32_bf16 v[196:199], v[216:219], v[164:167], v[196:199]
    v_exp_f32 v209, v137
    v_mfma_f32_16x16x32_bf16 v[144:147], a[96:99], v[32:35], v[184:187]
    ds_read_b64_tr_b16 a[176:177], v228 offset:40960
    v_cvt_pk_bf16_f32 v164, v208, v209
    v_mfma_f32_16x16x32_bf16 v[144:147], a[100:103], v[36:39], v[144:147]
    v_exp_f32 v210, v138
    v_mfma_f32_16x16x32_bf16 v[144:147], a[104:107], v[40:43], v[144:147]
    ds_read_b64_tr_b16 a[178:179], v228 offset:41984
    v_mfma_f32_16x16x32_bf16 v[144:147], a[108:111], v[44:47], v[144:147]
    v_exp_f32 v211, v139
    v_mfma_f32_16x16x32_bf16 v[148:151], a[112:115], v[32:35], v[184:187]
    buffer_load_dwordx4 v235, s[20:23], s46 offen offset:2048 nt lds
    v_cvt_pk_bf16_f32 v165, v210, v211
    v_mfma_f32_16x16x32_bf16 v[148:151], a[116:119], v[36:39], v[148:151]
    v_exp_f32 v212, v140
    v_mfma_f32_16x16x32_bf16 v[148:151], a[120:123], v[40:43], v[148:151]
    ds_read_b64_tr_b16 a[180:181], v229 offset:40960
    v_mfma_f32_16x16x32_bf16 v[148:151], a[124:127], v[44:47], v[148:151]
    v_exp_f32 v213, v141
    v_mfma_f32_16x16x32_bf16 v[64:67], a[128:131], v[168:171], v[64:67]
    ds_read_b64_tr_b16 a[182:183], v229 offset:41984
    v_cvt_pk_bf16_f32 v166, v212, v213
    v_mfma_f32_16x16x32_bf16 v[68:71], a[132:135], v[168:171], v[68:71]
    v_exp_f32 v214, v142
    v_mfma_f32_16x16x32_bf16 v[72:75], a[136:139], v[168:171], v[72:75]
    ds_read_b64_tr_b16 a[184:185], v230 offset:40960
    v_mfma_f32_16x16x32_bf16 v[76:79], a[140:143], v[168:171], v[76:79]
    v_exp_f32 v215, v143
    v_mfma_f32_16x16x32_bf16 v[80:83], a[144:147], v[168:171], v[80:83]
    ds_read_b64_tr_b16 a[186:187], v230 offset:41984
    v_cvt_pk_bf16_f32 v167, v214, v215
    v_mfma_f32_16x16x32_bf16 v[84:87], a[148:151], v[168:171], v[84:87]
    ds_read_b64_tr_b16 a[188:189], v231 offset:40960
    v_mfma_f32_16x16x32_bf16 v[88:91], a[152:155], v[168:171], v[88:91]
    v_exp_f32 v208, v144
    v_mfma_f32_16x16x32_bf16 v[92:95], a[156:159], v[168:171], v[92:95]
    ds_read_b64_tr_b16 a[190:191], v231 offset:41984
    v_mfma_f32_16x16x32_bf16 v[200:203], v[216:219], v[168:171], v[200:203]
    v_exp_f32 v209, v145
    v_mfma_f32_16x16x32_bf16 v[152:155], a[96:99], v[48:51], v[188:191]
    buffer_load_dwordx4 v235, s[20:23], s46 offen offset:3072 nt lds
    v_cvt_pk_bf16_f32 v168, v208, v209
    v_mfma_f32_16x16x32_bf16 v[152:155], a[100:103], v[52:55], v[152:155]
    v_exp_f32 v210, v146
    v_mfma_f32_16x16x32_bf16 v[152:155], a[104:107], v[56:59], v[152:155]
    v_mfma_f32_16x16x32_bf16 v[152:155], a[108:111], v[60:63], v[152:155]
    v_exp_f32 v211, v147
    v_mfma_f32_16x16x32_bf16 v[156:159], a[112:115], v[48:51], v[188:191]
    v_cvt_pk_bf16_f32 v169, v210, v211
    v_mfma_f32_16x16x32_bf16 v[156:159], a[116:119], v[52:55], v[156:159]
    v_exp_f32 v212, v148
    v_mfma_f32_16x16x32_bf16 v[156:159], a[120:123], v[56:59], v[156:159]
    v_mfma_f32_16x16x32_bf16 v[156:159], a[124:127], v[60:63], v[156:159]
    v_exp_f32 v213, v149
    v_mfma_f32_16x16x32_bf16 v[96:99], a[128:131], v[172:175], v[96:99]
    v_cvt_pk_bf16_f32 v170, v212, v213
    v_mfma_f32_16x16x32_bf16 v[100:103], a[132:135], v[172:175], v[100:103]
    v_exp_f32 v214, v150
    v_mfma_f32_16x16x32_bf16 v[104:107], a[136:139], v[172:175], v[104:107]
    v_mfma_f32_16x16x32_bf16 v[108:111], a[140:143], v[172:175], v[108:111]
    v_exp_f32 v215, v151
    v_mfma_f32_16x16x32_bf16 v[112:115], a[144:147], v[172:175], v[112:115]
    v_cvt_pk_bf16_f32 v171, v214, v215
    v_mfma_f32_16x16x32_bf16 v[116:119], a[148:151], v[172:175], v[116:119]
    v_mfma_f32_16x16x32_bf16 v[120:123], a[152:155], v[172:175], v[120:123]
    v_exp_f32 v208, v152
    v_mfma_f32_16x16x32_bf16 v[124:127], a[156:159], v[172:175], v[124:127]
    v_mfma_f32_16x16x32_bf16 v[204:207], v[216:219], v[172:175], v[204:207]
    s_waitcnt lgkmcnt(15)
    v_exp_f32 v209, v153
    v_mfma_f32_16x16x32_bf16 v[128:131], a[64:67], v[0:3], v[176:179]
    ds_read_b128 a[96:99], v220 offset:57344
    v_cvt_pk_bf16_f32 v172, v208, v209
    v_mfma_f32_16x16x32_bf16 v[128:131], a[68:71], v[4:7], v[128:131]
    v_exp_f32 v210, v154
    v_mfma_f32_16x16x32_bf16 v[128:131], a[72:75], v[8:11], v[128:131]
    ds_read_b128 a[100:103], v221 offset:57344
    v_mfma_f32_16x16x32_bf16 v[128:131], a[76:79], v[12:15], v[128:131]
    v_exp_f32 v211, v155
    v_mfma_f32_16x16x32_bf16 v[132:135], a[80:83], v[0:3], v[176:179]
    ds_read_b128 a[104:107], v222 offset:57344
    v_cvt_pk_bf16_f32 v173, v210, v211
    v_mfma_f32_16x16x32_bf16 v[132:135], a[84:87], v[4:7], v[132:135]
    v_exp_f32 v212, v156
    v_mfma_f32_16x16x32_bf16 v[132:135], a[88:91], v[8:11], v[132:135]
    ds_read_b128 a[108:111], v223 offset:57344
    v_mfma_f32_16x16x32_bf16 v[132:135], a[92:95], v[12:15], v[132:135]
    s_waitcnt lgkmcnt(4)
    v_exp_f32 v213, v157
    v_mfma_f32_16x16x32_bf16 a[0:3], a[160:163], v[160:163], a[0:3]
    ds_read_b128 a[112:115], v220 offset:58368
    v_cvt_pk_bf16_f32 v174, v212, v213
    v_mfma_f32_16x16x32_bf16 a[4:7], a[164:167], v[160:163], a[4:7]
    s_add_u32 s45, s45, 16384
    v_exp_f32 v214, v158
    v_mfma_f32_16x16x32_bf16 a[8:11], a[168:171], v[160:163], a[8:11]
    ds_read_b128 a[116:119], v221 offset:58368
    v_mfma_f32_16x16x32_bf16 a[12:15], a[172:175], v[160:163], a[12:15]
    s_add_u32 m0, s41, 32768
    v_exp_f32 v215, v159
    v_mfma_f32_16x16x32_bf16 a[16:19], a[176:179], v[160:163], a[16:19]
    ds_read_b128 a[120:123], v222 offset:58368
    v_cvt_pk_bf16_f32 v175, v214, v215
    v_mfma_f32_16x16x32_bf16 a[20:23], a[180:183], v[160:163], a[20:23]
    buffer_load_dwordx4 v232, s[16:19], s45 offen offset:0 nt lds
    v_mfma_f32_16x16x32_bf16 a[24:27], a[184:187], v[160:163], a[24:27]
    v_exp_f32 v208, v128
    v_mfma_f32_16x16x32_bf16 a[28:31], a[188:191], v[160:163], a[28:31]
    ds_read_b128 a[124:127], v223 offset:58368
    v_mfma_f32_16x16x32_bf16 v[192:195], v[216:219], v[160:163], v[192:195]
    v_exp_f32 v209, v129
    v_mfma_f32_16x16x32_bf16 v[136:139], a[64:67], v[16:19], v[180:183]
    ds_read_b64_tr_b16 a[128:129], v224 offset:49152
    v_cvt_pk_bf16_f32 v160, v208, v209
    v_mfma_f32_16x16x32_bf16 v[136:139], a[68:71], v[20:23], v[136:139]
    v_exp_f32 v210, v130
    v_mfma_f32_16x16x32_bf16 v[136:139], a[72:75], v[24:27], v[136:139]
    ds_read_b64_tr_b16 a[130:131], v224 offset:50176
    v_mfma_f32_16x16x32_bf16 v[136:139], a[76:79], v[28:31], v[136:139]
    v_exp_f32 v211, v131
    v_mfma_f32_16x16x32_bf16 v[140:143], a[80:83], v[16:19], v[180:183]
    ds_read_b64_tr_b16 a[132:133], v225 offset:49152
    v_cvt_pk_bf16_f32 v161, v210, v211
    v_mfma_f32_16x16x32_bf16 v[140:143], a[84:87], v[20:23], v[140:143]
    v_exp_f32 v212, v132
    v_mfma_f32_16x16x32_bf16 v[140:143], a[88:91], v[24:27], v[140:143]
    ds_read_b64_tr_b16 a[134:135], v225 offset:50176
    v_mfma_f32_16x16x32_bf16 v[140:143], a[92:95], v[28:31], v[140:143]
    v_exp_f32 v213, v133
    v_mfma_f32_16x16x32_bf16 a[32:35], a[160:163], v[164:167], a[32:35]
    buffer_load_dwordx4 v232, s[16:19], s45 offen offset:1024 nt lds
    v_cvt_pk_bf16_f32 v162, v212, v213
    v_mfma_f32_16x16x32_bf16 a[36:39], a[164:167], v[164:167], a[36:39]
    v_exp_f32 v214, v134
    v_mfma_f32_16x16x32_bf16 a[40:43], a[168:171], v[164:167], a[40:43]
    ds_read_b64_tr_b16 a[136:137], v226 offset:49152
    v_mfma_f32_16x16x32_bf16 a[44:47], a[172:175], v[164:167], a[44:47]
    v_exp_f32 v215, v135
    v_mfma_f32_16x16x32_bf16 a[48:51], a[176:179], v[164:167], a[48:51]
    ds_read_b64_tr_b16 a[138:139], v226 offset:50176
    v_cvt_pk_bf16_f32 v163, v214, v215
    v_mfma_f32_16x16x32_bf16 a[52:55], a[180:183], v[164:167], a[52:55]
    ds_read_b64_tr_b16 a[140:141], v227 offset:49152
    v_mfma_f32_16x16x32_bf16 a[56:59], a[184:187], v[164:167], a[56:59]
    v_exp_f32 v208, v136
    v_mfma_f32_16x16x32_bf16 a[60:63], a[188:191], v[164:167], a[60:63]
    ds_read_b64_tr_b16 a[142:143], v227 offset:50176
    v_mfma_f32_16x16x32_bf16 v[196:199], v[216:219], v[164:167], v[196:199]
    v_exp_f32 v209, v137
    v_mfma_f32_16x16x32_bf16 v[144:147], a[64:67], v[32:35], v[184:187]
    ds_read_b64_tr_b16 a[144:145], v228 offset:49152
    v_cvt_pk_bf16_f32 v164, v208, v209
    v_mfma_f32_16x16x32_bf16 v[144:147], a[68:71], v[36:39], v[144:147]
    v_exp_f32 v210, v138
    v_mfma_f32_16x16x32_bf16 v[144:147], a[72:75], v[40:43], v[144:147]
    ds_read_b64_tr_b16 a[146:147], v228 offset:50176
    v_mfma_f32_16x16x32_bf16 v[144:147], a[76:79], v[44:47], v[144:147]
    v_exp_f32 v211, v139
    v_mfma_f32_16x16x32_bf16 v[148:151], a[80:83], v[32:35], v[184:187]
    buffer_load_dwordx4 v233, s[16:19], s45 offen offset:2048 nt lds
    v_cvt_pk_bf16_f32 v165, v210, v211
    v_mfma_f32_16x16x32_bf16 v[148:151], a[84:87], v[36:39], v[148:151]
    v_exp_f32 v212, v140
    v_mfma_f32_16x16x32_bf16 v[148:151], a[88:91], v[40:43], v[148:151]
    ds_read_b64_tr_b16 a[148:149], v229 offset:49152
    v_mfma_f32_16x16x32_bf16 v[148:151], a[92:95], v[44:47], v[148:151]
    v_exp_f32 v213, v141
    v_mfma_f32_16x16x32_bf16 v[64:67], a[160:163], v[168:171], v[64:67]
    ds_read_b64_tr_b16 a[150:151], v229 offset:50176
    v_cvt_pk_bf16_f32 v166, v212, v213
    v_mfma_f32_16x16x32_bf16 v[68:71], a[164:167], v[168:171], v[68:71]
    v_exp_f32 v214, v142
    v_mfma_f32_16x16x32_bf16 v[72:75], a[168:171], v[168:171], v[72:75]
    ds_read_b64_tr_b16 a[152:153], v230 offset:49152
    v_mfma_f32_16x16x32_bf16 v[76:79], a[172:175], v[168:171], v[76:79]
    v_exp_f32 v215, v143
    v_mfma_f32_16x16x32_bf16 v[80:83], a[176:179], v[168:171], v[80:83]
    ds_read_b64_tr_b16 a[154:155], v230 offset:50176
    v_cvt_pk_bf16_f32 v167, v214, v215
    v_mfma_f32_16x16x32_bf16 v[84:87], a[180:183], v[168:171], v[84:87]
    ds_read_b64_tr_b16 a[156:157], v231 offset:49152
    v_mfma_f32_16x16x32_bf16 v[88:91], a[184:187], v[168:171], v[88:91]
    v_exp_f32 v208, v144
    v_mfma_f32_16x16x32_bf16 v[92:95], a[188:191], v[168:171], v[92:95]
    ds_read_b64_tr_b16 a[158:159], v231 offset:50176
    v_mfma_f32_16x16x32_bf16 v[200:203], v[216:219], v[168:171], v[200:203]
    v_exp_f32 v209, v145
    v_mfma_f32_16x16x32_bf16 v[152:155], a[64:67], v[48:51], v[188:191]
    buffer_load_dwordx4 v233, s[16:19], s45 offen offset:3072 nt lds
    v_cvt_pk_bf16_f32 v168, v208, v209
    v_mfma_f32_16x16x32_bf16 v[152:155], a[68:71], v[52:55], v[152:155]
    v_exp_f32 v210, v146
    v_mfma_f32_16x16x32_bf16 v[152:155], a[72:75], v[56:59], v[152:155]
    v_mfma_f32_16x16x32_bf16 v[152:155], a[76:79], v[60:63], v[152:155]
    v_exp_f32 v211, v147
    v_mfma_f32_16x16x32_bf16 v[156:159], a[80:83], v[48:51], v[188:191]
    v_cvt_pk_bf16_f32 v169, v210, v211
    v_mfma_f32_16x16x32_bf16 v[156:159], a[84:87], v[52:55], v[156:159]
    v_exp_f32 v212, v148
    v_mfma_f32_16x16x32_bf16 v[156:159], a[88:91], v[56:59], v[156:159]
    v_mfma_f32_16x16x32_bf16 v[156:159], a[92:95], v[60:63], v[156:159]
    v_exp_f32 v213, v149
    v_mfma_f32_16x16x32_bf16 v[96:99], a[160:163], v[172:175], v[96:99]
    v_cvt_pk_bf16_f32 v170, v212, v213
    v_mfma_f32_16x16x32_bf16 v[100:103], a[164:167], v[172:175], v[100:103]
    v_exp_f32 v214, v150
    v_mfma_f32_16x16x32_bf16 v[104:107], a[168:171], v[172:175], v[104:107]
    v_mfma_f32_16x16x32_bf16 v[108:111], a[172:175], v[172:175], v[108:111]
    v_exp_f32 v215, v151
    v_mfma_f32_16x16x32_bf16 v[112:115], a[176:179], v[172:175], v[112:115]
    v_cvt_pk_bf16_f32 v171, v214, v215
    v_mfma_f32_16x16x32_bf16 v[116:119], a[180:183], v[172:175], v[116:119]
    v_mfma_f32_16x16x32_bf16 v[120:123], a[184:187], v[172:175], v[120:123]
    v_exp_f32 v208, v152
    v_mfma_f32_16x16x32_bf16 v[124:127], a[188:191], v[172:175], v[124:127]
    v_mfma_f32_16x16x32_bf16 v[204:207], v[216:219], v[172:175], v[204:207]
    v_exp_f32 v209, v153
    s_waitcnt vmcnt(12) lgkmcnt(15)
    s_barrier
    v_mfma_f32_16x16x32_bf16 v[128:131], a[96:99], v[0:3], v[176:179]
    ds_read_b128 a[64:67], v220 offset:0
    v_cvt_pk_bf16_f32 v172, v208, v209
    v_mfma_f32_16x16x32_bf16 v[128:131], a[100:103], v[4:7], v[128:131]
    v_exp_f32 v210, v154
    v_mfma_f32_16x16x32_bf16 v[128:131], a[104:107], v[8:11], v[128:131]
    ds_read_b128 a[68:71], v221 offset:0
    v_mfma_f32_16x16x32_bf16 v[128:131], a[108:111], v[12:15], v[128:131]
    v_exp_f32 v211, v155
    v_mfma_f32_16x16x32_bf16 v[132:135], a[112:115], v[0:3], v[176:179]
    ds_read_b128 a[72:75], v222 offset:0
    v_cvt_pk_bf16_f32 v173, v210, v211
    v_mfma_f32_16x16x32_bf16 v[132:135], a[116:119], v[4:7], v[132:135]
    v_exp_f32 v212, v156
    v_mfma_f32_16x16x32_bf16 v[132:135], a[120:123], v[8:11], v[132:135]
    ds_read_b128 a[76:79], v223 offset:0
    v_mfma_f32_16x16x32_bf16 v[132:135], a[124:127], v[12:15], v[132:135]
    s_waitcnt lgkmcnt(4)
    v_exp_f32 v213, v157
    v_mfma_f32_16x16x32_bf16 a[0:3], a[128:131], v[160:163], a[0:3]
    ds_read_b128 a[80:83], v220 offset:1024
    v_cvt_pk_bf16_f32 v174, v212, v213
    v_mfma_f32_16x16x32_bf16 a[4:7], a[132:135], v[160:163], a[4:7]
    s_add_u32 s46, s46, 16384
    v_exp_f32 v214, v158
    v_mfma_f32_16x16x32_bf16 a[8:11], a[136:139], v[160:163], a[8:11]
    ds_read_b128 a[84:87], v221 offset:1024
    v_mfma_f32_16x16x32_bf16 a[12:15], a[140:143], v[160:163], a[12:15]
    s_add_u32 m0, s41, 98304
    v_exp_f32 v215, v159
    v_mfma_f32_16x16x32_bf16 a[16:19], a[144:147], v[160:163], a[16:19]
    ds_read_b128 a[88:91], v222 offset:1024
    v_cvt_pk_bf16_f32 v175, v214, v215
    v_mfma_f32_16x16x32_bf16 a[20:23], a[148:151], v[160:163], a[20:23]
    buffer_load_dwordx4 v234, s[20:23], s46 offen offset:0 nt lds
    v_mfma_f32_16x16x32_bf16 a[24:27], a[152:155], v[160:163], a[24:27]
    v_exp_f32 v208, v128
    v_mfma_f32_16x16x32_bf16 a[28:31], a[156:159], v[160:163], a[28:31]
    ds_read_b128 a[92:95], v223 offset:1024
    v_mfma_f32_16x16x32_bf16 v[192:195], v[216:219], v[160:163], v[192:195]
    v_exp_f32 v209, v129
    v_mfma_f32_16x16x32_bf16 v[136:139], a[96:99], v[16:19], v[180:183]
    ds_read_b64_tr_b16 a[160:161], v224 offset:57344
    v_cvt_pk_bf16_f32 v160, v208, v209
    v_mfma_f32_16x16x32_bf16 v[136:139], a[100:103], v[20:23], v[136:139]
    v_exp_f32 v210, v130
    v_mfma_f32_16x16x32_bf16 v[136:139], a[104:107], v[24:27], v[136:139]
    ds_read_b64_tr_b16 a[162:163], v224 offset:58368
    v_mfma_f32_16x16x32_bf16 v[136:139], a[108:111], v[28:31], v[136:139]
    v_exp_f32 v211, v131
    v_mfma_f32_16x16x32_bf16 v[140:143], a[112:115], v[16:19], v[180:183]
    ds_read_b64_tr_b16 a[164:165], v225 offset:57344
    v_cvt_pk_bf16_f32 v161, v210, v211
    v_mfma_f32_16x16x32_bf16 v[140:143], a[116:119], v[20:23], v[140:143]
    v_exp_f32 v212, v132
    v_mfma_f32_16x16x32_bf16 v[140:143], a[120:123], v[24:27], v[140:143]
    ds_read_b64_tr_b16 a[166:167], v225 offset:58368
    v_mfma_f32_16x16x32_bf16 v[140:143], a[124:127], v[28:31], v[140:143]
    v_exp_f32 v213, v133
    v_mfma_f32_16x16x32_bf16 a[32:35], a[128:131], v[164:167], a[32:35]
    buffer_load_dwordx4 v234, s[20:23], s46 offen offset:1024 nt lds
    v_cvt_pk_bf16_f32 v162, v212, v213
    v_mfma_f32_16x16x32_bf16 a[36:39], a[132:135], v[164:167], a[36:39]
    v_exp_f32 v214, v134
    v_mfma_f32_16x16x32_bf16 a[40:43], a[136:139], v[164:167], a[40:43]
    ds_read_b64_tr_b16 a[168:169], v226 offset:57344
    v_mfma_f32_16x16x32_bf16 a[44:47], a[140:143], v[164:167], a[44:47]
    v_exp_f32 v215, v135
    v_mfma_f32_16x16x32_bf16 a[48:51], a[144:147], v[164:167], a[48:51]
    ds_read_b64_tr_b16 a[170:171], v226 offset:58368
    v_cvt_pk_bf16_f32 v163, v214, v215
    v_mfma_f32_16x16x32_bf16 a[52:55], a[148:151], v[164:167], a[52:55]
    ds_read_b64_tr_b16 a[172:173], v227 offset:57344
    v_mfma_f32_16x16x32_bf16 a[56:59], a[152:155], v[164:167], a[56:59]
    v_exp_f32 v208, v136
    v_mfma_f32_16x16x32_bf16 a[60:63], a[156:159], v[164:167], a[60:63]
    ds_read_b64_tr_b16 a[174:175], v227 offset:58368
    v_mfma_f32_16x16x32_bf16 v[196:199], v[216:219], v[164:167], v[196:199]
    v_exp_f32 v209, v137
    v_mfma_f32_16x16x32_bf16 v[144:147], a[96:99], v[32:35], v[184:187]
    ds_read_b64_tr_b16 a[176:177], v228 offset:57344
    v_cvt_pk_bf16_f32 v164, v208, v209
    v_mfma_f32_16x16x32_bf16 v[144:147], a[100:103], v[36:39], v[144:147]
    v_exp_f32 v210, v138
    v_mfma_f32_16x16x32_bf16 v[144:147], a[104:107], v[40:43], v[144:147]
    ds_read_b64_tr_b16 a[178:179], v228 offset:58368
    v_mfma_f32_16x16x32_bf16 v[144:147], a[108:111], v[44:47], v[144:147]
    v_exp_f32 v211, v139
    v_mfma_f32_16x16x32_bf16 v[148:151], a[112:115], v[32:35], v[184:187]
    buffer_load_dwordx4 v235, s[20:23], s46 offen offset:2048 nt lds
    v_cvt_pk_bf16_f32 v165, v210, v211
    v_mfma_f32_16x16x32_bf16 v[148:151], a[116:119], v[36:39], v[148:151]
    v_exp_f32 v212, v140
    v_mfma_f32_16x16x32_bf16 v[148:151], a[120:123], v[40:43], v[148:151]
    ds_read_b64_tr_b16 a[180:181], v229 offset:57344
    v_mfma_f32_16x16x32_bf16 v[148:151], a[124:127], v[44:47], v[148:151]
    v_exp_f32 v213, v141
    v_mfma_f32_16x16x32_bf16 v[64:67], a[128:131], v[168:171], v[64:67]
    ds_read_b64_tr_b16 a[182:183], v229 offset:58368
    v_cvt_pk_bf16_f32 v166, v212, v213
    v_mfma_f32_16x16x32_bf16 v[68:71], a[132:135], v[168:171], v[68:71]
    v_exp_f32 v214, v142
    v_mfma_f32_16x16x32_bf16 v[72:75], a[136:139], v[168:171], v[72:75]
    ds_read_b64_tr_b16 a[184:185], v230 offset:57344
    v_mfma_f32_16x16x32_bf16 v[76:79], a[140:143], v[168:171], v[76:79]
    v_exp_f32 v215, v143
    v_mfma_f32_16x16x32_bf16 v[80:83], a[144:147], v[168:171], v[80:83]
    ds_read_b64_tr_b16 a[186:187], v230 offset:58368
    v_cvt_pk_bf16_f32 v167, v214, v215
    v_mfma_f32_16x16x32_bf16 v[84:87], a[148:151], v[168:171], v[84:87]
    ds_read_b64_tr_b16 a[188:189], v231 offset:57344
    v_mfma_f32_16x16x32_bf16 v[88:91], a[152:155], v[168:171], v[88:91]
    v_exp_f32 v208, v144
    v_mfma_f32_16x16x32_bf16 v[92:95], a[156:159], v[168:171], v[92:95]
    ds_read_b64_tr_b16 a[190:191], v231 offset:58368
    v_mfma_f32_16x16x32_bf16 v[200:203], v[216:219], v[168:171], v[200:203]
    v_exp_f32 v209, v145
    v_mfma_f32_16x16x32_bf16 v[152:155], a[96:99], v[48:51], v[188:191]
    buffer_load_dwordx4 v235, s[20:23], s46 offen offset:3072 nt lds
    v_cvt_pk_bf16_f32 v168, v208, v209
    v_mfma_f32_16x16x32_bf16 v[152:155], a[100:103], v[52:55], v[152:155]
    v_exp_f32 v210, v146
    v_mfma_f32_16x16x32_bf16 v[152:155], a[104:107], v[56:59], v[152:155]
    v_mfma_f32_16x16x32_bf16 v[152:155], a[108:111], v[60:63], v[152:155]
    v_exp_f32 v211, v147
    v_mfma_f32_16x16x32_bf16 v[156:159], a[112:115], v[48:51], v[188:191]
    v_cvt_pk_bf16_f32 v169, v210, v211
    v_mfma_f32_16x16x32_bf16 v[156:159], a[116:119], v[52:55], v[156:159]
    v_exp_f32 v212, v148
    v_mfma_f32_16x16x32_bf16 v[156:159], a[120:123], v[56:59], v[156:159]
    v_mfma_f32_16x16x32_bf16 v[156:159], a[124:127], v[60:63], v[156:159]
    v_exp_f32 v213, v149
    v_mfma_f32_16x16x32_bf16 v[96:99], a[128:131], v[172:175], v[96:99]
    v_cvt_pk_bf16_f32 v170, v212, v213
    v_mfma_f32_16x16x32_bf16 v[100:103], a[132:135], v[172:175], v[100:103]
    v_exp_f32 v214, v150
    v_mfma_f32_16x16x32_bf16 v[104:107], a[136:139], v[172:175], v[104:107]
    v_mfma_f32_16x16x32_bf16 v[108:111], a[140:143], v[172:175], v[108:111]
    v_exp_f32 v215, v151
    v_mfma_f32_16x16x32_bf16 v[112:115], a[144:147], v[172:175], v[112:115]
    v_cvt_pk_bf16_f32 v171, v214, v215
    v_mfma_f32_16x16x32_bf16 v[116:119], a[148:151], v[172:175], v[116:119]
    v_mfma_f32_16x16x32_bf16 v[120:123], a[152:155], v[172:175], v[120:123]
    v_exp_f32 v208, v152
    v_mfma_f32_16x16x32_bf16 v[124:127], a[156:159], v[172:175], v[124:127]
    v_mfma_f32_16x16x32_bf16 v[204:207], v[216:219], v[172:175], v[204:207]
    s_waitcnt lgkmcnt(15)
    v_exp_f32 v209, v153
    v_mfma_f32_16x16x32_bf16 v[128:131], a[64:67], v[0:3], v[176:179]
    ds_read_b128 a[96:99], v220 offset:8192
    v_cvt_pk_bf16_f32 v172, v208, v209
    v_mfma_f32_16x16x32_bf16 v[128:131], a[68:71], v[4:7], v[128:131]
    v_exp_f32 v210, v154
    v_mfma_f32_16x16x32_bf16 v[128:131], a[72:75], v[8:11], v[128:131]
    ds_read_b128 a[100:103], v221 offset:8192
    v_mfma_f32_16x16x32_bf16 v[128:131], a[76:79], v[12:15], v[128:131]
    v_exp_f32 v211, v155
    v_mfma_f32_16x16x32_bf16 v[132:135], a[80:83], v[0:3], v[176:179]
    ds_read_b128 a[104:107], v222 offset:8192
    v_cvt_pk_bf16_f32 v173, v210, v211
    v_mfma_f32_16x16x32_bf16 v[132:135], a[84:87], v[4:7], v[132:135]
    v_exp_f32 v212, v156
    v_mfma_f32_16x16x32_bf16 v[132:135], a[88:91], v[8:11], v[132:135]
    ds_read_b128 a[108:111], v223 offset:8192
    v_mfma_f32_16x16x32_bf16 v[132:135], a[92:95], v[12:15], v[132:135]
    s_waitcnt lgkmcnt(4)
    v_exp_f32 v213, v157
    v_mfma_f32_16x16x32_bf16 a[0:3], a[160:163], v[160:163], a[0:3]
    ds_read_b128 a[112:115], v220 offset:9216
    v_cvt_pk_bf16_f32 v174, v212, v213
    v_mfma_f32_16x16x32_bf16 a[4:7], a[164:167], v[160:163], a[4:7]
    s_add_u32 s45, s45, 16384
    v_exp_f32 v214, v158
    v_mfma_f32_16x16x32_bf16 a[8:11], a[168:171], v[160:163], a[8:11]
    ds_read_b128 a[116:119], v221 offset:9216
    v_mfma_f32_16x16x32_bf16 a[12:15], a[172:175], v[160:163], a[12:15]
    s_add_u32 m0, s41, 49152
    v_exp_f32 v215, v159
    v_mfma_f32_16x16x32_bf16 a[16:19], a[176:179], v[160:163], a[16:19]
    ds_read_b128 a[120:123], v222 offset:9216
    v_cvt_pk_bf16_f32 v175, v214, v215
    v_mfma_f32_16x16x32_bf16 a[20:23], a[180:183], v[160:163], a[20:23]
    buffer_load_dwordx4 v232, s[16:19], s45 offen offset:0 nt lds
    v_mfma_f32_16x16x32_bf16 a[24:27], a[184:187], v[160:163], a[24:27]
    v_exp_f32 v208, v128
    v_mfma_f32_16x16x32_bf16 a[28:31], a[188:191], v[160:163], a[28:31]
    ds_read_b128 a[124:127], v223 offset:9216
    v_mfma_f32_16x16x32_bf16 v[192:195], v[216:219], v[160:163], v[192:195]
    v_exp_f32 v209, v129
    v_mfma_f32_16x16x32_bf16 v[136:139], a[64:67], v[16:19], v[180:183]
    ds_read_b64_tr_b16 a[128:129], v224 offset:0
    v_cvt_pk_bf16_f32 v160, v208, v209
    v_mfma_f32_16x16x32_bf16 v[136:139], a[68:71], v[20:23], v[136:139]
    v_exp_f32 v210, v130
    v_mfma_f32_16x16x32_bf16 v[136:139], a[72:75], v[24:27], v[136:139]
    ds_read_b64_tr_b16 a[130:131], v224 offset:1024
    v_mfma_f32_16x16x32_bf16 v[136:139], a[76:79], v[28:31], v[136:139]
    v_exp_f32 v211, v131
    v_mfma_f32_16x16x32_bf16 v[140:143], a[80:83], v[16:19], v[180:183]
    ds_read_b64_tr_b16 a[132:133], v225 offset:0
    v_cvt_pk_bf16_f32 v161, v210, v211
    v_mfma_f32_16x16x32_bf16 v[140:143], a[84:87], v[20:23], v[140:143]
    v_exp_f32 v212, v132
    v_mfma_f32_16x16x32_bf16 v[140:143], a[88:91], v[24:27], v[140:143]
    ds_read_b64_tr_b16 a[134:135], v225 offset:1024
    v_mfma_f32_16x16x32_bf16 v[140:143], a[92:95], v[28:31], v[140:143]
    v_exp_f32 v213, v133
    v_mfma_f32_16x16x32_bf16 a[32:35], a[160:163], v[164:167], a[32:35]
    buffer_load_dwordx4 v232, s[16:19], s45 offen offset:1024 nt lds
    v_cvt_pk_bf16_f32 v162, v212, v213
    v_mfma_f32_16x16x32_bf16 a[36:39], a[164:167], v[164:167], a[36:39]
    v_exp_f32 v214, v134
    v_mfma_f32_16x16x32_bf16 a[40:43], a[168:171], v[164:167], a[40:43]
    ds_read_b64_tr_b16 a[136:137], v226 offset:0
    v_mfma_f32_16x16x32_bf16 a[44:47], a[172:175], v[164:167], a[44:47]
    v_exp_f32 v215, v135
    v_mfma_f32_16x16x32_bf16 a[48:51], a[176:179], v[164:167], a[48:51]
    ds_read_b64_tr_b16 a[138:139], v226 offset:1024
    v_cvt_pk_bf16_f32 v163, v214, v215
    v_mfma_f32_16x16x32_bf16 a[52:55], a[180:183], v[164:167], a[52:55]
    ds_read_b64_tr_b16 a[140:141], v227 offset:0
    v_mfma_f32_16x16x32_bf16 a[56:59], a[184:187], v[164:167], a[56:59]
    v_exp_f32 v208, v136
    v_mfma_f32_16x16x32_bf16 a[60:63], a[188:191], v[164:167], a[60:63]
    ds_read_b64_tr_b16 a[142:143], v227 offset:1024
    v_mfma_f32_16x16x32_bf16 v[196:199], v[216:219], v[164:167], v[196:199]
    v_exp_f32 v209, v137
    v_mfma_f32_16x16x32_bf16 v[144:147], a[64:67], v[32:35], v[184:187]
    ds_read_b64_tr_b16 a[144:145], v228 offset:0
    v_cvt_pk_bf16_f32 v164, v208, v209
    v_mfma_f32_16x16x32_bf16 v[144:147], a[68:71], v[36:39], v[144:147]
    v_exp_f32 v210, v138
    v_mfma_f32_16x16x32_bf16 v[144:147], a[72:75], v[40:43], v[144:147]
    ds_read_b64_tr_b16 a[146:147], v228 offset:1024
    v_mfma_f32_16x16x32_bf16 v[144:147], a[76:79], v[44:47], v[144:147]
    v_exp_f32 v211, v139
    v_mfma_f32_16x16x32_bf16 v[148:151], a[80:83], v[32:35], v[184:187]
    buffer_load_dwordx4 v233, s[16:19], s45 offen offset:2048 nt lds
    v_cvt_pk_bf16_f32 v165, v210, v211
    v_mfma_f32_16x16x32_bf16 v[148:151], a[84:87], v[36:39], v[148:151]
    v_exp_f32 v212, v140
    v_mfma_f32_16x16x32_bf16 v[148:151], a[88:91], v[40:43], v[148:151]
    ds_read_b64_tr_b16 a[148:149], v229 offset:0
    v_mfma_f32_16x16x32_bf16 v[148:151], a[92:95], v[44:47], v[148:151]
    v_exp_f32 v213, v141
    v_mfma_f32_16x16x32_bf16 v[64:67], a[160:163], v[168:171], v[64:67]
    ds_read_b64_tr_b16 a[150:151], v229 offset:1024
    v_cvt_pk_bf16_f32 v166, v212, v213
    v_mfma_f32_16x16x32_bf16 v[68:71], a[164:167], v[168:171], v[68:71]
    v_exp_f32 v214, v142
    v_mfma_f32_16x16x32_bf16 v[72:75], a[168:171], v[168:171], v[72:75]
    ds_read_b64_tr_b16 a[152:153], v230 offset:0
    v_mfma_f32_16x16x32_bf16 v[76:79], a[172:175], v[168:171], v[76:79]
    v_exp_f32 v215, v143
    v_mfma_f32_16x16x32_bf16 v[80:83], a[176:179], v[168:171], v[80:83]
    ds_read_b64_tr_b16 a[154:155], v230 offset:1024
    v_cvt_pk_bf16_f32 v167, v214, v215
    v_mfma_f32_16x16x32_bf16 v[84:87], a[180:183], v[168:171], v[84:87]
    ds_read_b64_tr_b16 a[156:157], v231 offset:0
    v_mfma_f32_16x16x32_bf16 v[88:91], a[184:187], v[168:171], v[88:91]
    v_exp_f32 v208, v144
    v_mfma_f32_16x16x32_bf16 v[92:95], a[188:191], v[168:171], v[92:95]
    ds_read_b64_tr_b16 a[158:159], v231 offset:1024
    v_mfma_f32_16x16x32_bf16 v[200:203], v[216:219], v[168:171], v[200:203]
    v_exp_f32 v209, v145
    v_mfma_f32_16x16x32_bf16 v[152:155], a[64:67], v[48:51], v[188:191]
    buffer_load_dwordx4 v233, s[16:19], s45 offen offset:3072 nt lds
    v_cvt_pk_bf16_f32 v168, v208, v209
    v_mfma_f32_16x16x32_bf16 v[152:155], a[68:71], v[52:55], v[152:155]
    v_exp_f32 v210, v146
    v_mfma_f32_16x16x32_bf16 v[152:155], a[72:75], v[56:59], v[152:155]
    v_mfma_f32_16x16x32_bf16 v[152:155], a[76:79], v[60:63], v[152:155]
    v_exp_f32 v211, v147
    v_mfma_f32_16x16x32_bf16 v[156:159], a[80:83], v[48:51], v[188:191]
    v_cvt_pk_bf16_f32 v169, v210, v211
    v_mfma_f32_16x16x32_bf16 v[156:159], a[84:87], v[52:55], v[156:159]
    v_exp_f32 v212, v148
    v_mfma_f32_16x16x32_bf16 v[156:159], a[88:91], v[56:59], v[156:159]
    v_mfma_f32_16x16x32_bf16 v[156:159], a[92:95], v[60:63], v[156:159]
    v_exp_f32 v213, v149
    v_mfma_f32_16x16x32_bf16 v[96:99], a[160:163], v[172:175], v[96:99]
    v_cvt_pk_bf16_f32 v170, v212, v213
    v_mfma_f32_16x16x32_bf16 v[100:103], a[164:167], v[172:175], v[100:103]
    v_exp_f32 v214, v150
    v_mfma_f32_16x16x32_bf16 v[104:107], a[168:171], v[172:175], v[104:107]
    v_mfma_f32_16x16x32_bf16 v[108:111], a[172:175], v[172:175], v[108:111]
    v_exp_f32 v215, v151
    v_mfma_f32_16x16x32_bf16 v[112:115], a[176:179], v[172:175], v[112:115]
    v_cvt_pk_bf16_f32 v171, v214, v215
    v_mfma_f32_16x16x32_bf16 v[116:119], a[180:183], v[172:175], v[116:119]
    v_mfma_f32_16x16x32_bf16 v[120:123], a[184:187], v[172:175], v[120:123]
    v_exp_f32 v208, v152
    v_mfma_f32_16x16x32_bf16 v[124:127], a[188:191], v[172:175], v[124:127]
    v_mfma_f32_16x16x32_bf16 v[204:207], v[216:219], v[172:175], v[204:207]
    v_exp_f32 v209, v153
    s_waitcnt vmcnt(12) lgkmcnt(15)
    s_barrier
    v_mfma_f32_16x16x32_bf16 v[128:131], a[96:99], v[0:3], v[176:179]
    ds_read_b128 a[64:67], v220 offset:16384
    v_cvt_pk_bf16_f32 v172, v208, v209
    v_mfma_f32_16x16x32_bf16 v[128:131], a[100:103], v[4:7], v[128:131]
    v_exp_f32 v210, v154
    v_mfma_f32_16x16x32_bf16 v[128:131], a[104:107], v[8:11], v[128:131]
    ds_read_b128 a[68:71], v221 offset:16384
    v_mfma_f32_16x16x32_bf16 v[128:131], a[108:111], v[12:15], v[128:131]
    v_exp_f32 v211, v155
    v_mfma_f32_16x16x32_bf16 v[132:135], a[112:115], v[0:3], v[176:179]
    ds_read_b128 a[72:75], v222 offset:16384
    v_cvt_pk_bf16_f32 v173, v210, v211
    v_mfma_f32_16x16x32_bf16 v[132:135], a[116:119], v[4:7], v[132:135]
    v_exp_f32 v212, v156
    v_mfma_f32_16x16x32_bf16 v[132:135], a[120:123], v[8:11], v[132:135]
    ds_read_b128 a[76:79], v223 offset:16384
    v_mfma_f32_16x16x32_bf16 v[132:135], a[124:127], v[12:15], v[132:135]
    s_waitcnt lgkmcnt(4)
    v_exp_f32 v213, v157
    v_mfma_f32_16x16x32_bf16 a[0:3], a[128:131], v[160:163], a[0:3]
    ds_read_b128 a[80:83], v220 offset:17408
    v_cvt_pk_bf16_f32 v174, v212, v213
    v_mfma_f32_16x16x32_bf16 a[4:7], a[132:135], v[160:163], a[4:7]
    s_add_u32 s46, s46, 16384
    v_exp_f32 v214, v158
    v_mfma_f32_16x16x32_bf16 a[8:11], a[136:139], v[160:163], a[8:11]
    ds_read_b128 a[84:87], v221 offset:17408
    v_mfma_f32_16x16x32_bf16 a[12:15], a[140:143], v[160:163], a[12:15]
    s_add_u32 m0, s41, 114688
    v_exp_f32 v215, v159
    v_mfma_f32_16x16x32_bf16 a[16:19], a[144:147], v[160:163], a[16:19]
    ds_read_b128 a[88:91], v222 offset:17408
    v_cvt_pk_bf16_f32 v175, v214, v215
    v_mfma_f32_16x16x32_bf16 a[20:23], a[148:151], v[160:163], a[20:23]
    buffer_load_dwordx4 v234, s[20:23], s46 offen offset:0 nt lds
    v_mfma_f32_16x16x32_bf16 a[24:27], a[152:155], v[160:163], a[24:27]
    v_exp_f32 v208, v128
    v_mfma_f32_16x16x32_bf16 a[28:31], a[156:159], v[160:163], a[28:31]
    ds_read_b128 a[92:95], v223 offset:17408
    v_mfma_f32_16x16x32_bf16 v[192:195], v[216:219], v[160:163], v[192:195]
    v_exp_f32 v209, v129
    v_mfma_f32_16x16x32_bf16 v[136:139], a[96:99], v[16:19], v[180:183]
    ds_read_b64_tr_b16 a[160:161], v224 offset:8192
    v_cvt_pk_bf16_f32 v160, v208, v209
    v_mfma_f32_16x16x32_bf16 v[136:139], a[100:103], v[20:23], v[136:139]
    v_exp_f32 v210, v130
    v_mfma_f32_16x16x32_bf16 v[136:139], a[104:107], v[24:27], v[136:139]
    ds_read_b64_tr_b16 a[162:163], v224 offset:9216
    v_mfma_f32_16x16x32_bf16 v[136:139], a[108:111], v[28:31], v[136:139]
    v_exp_f32 v211, v131
    v_mfma_f32_16x16x32_bf16 v[140:143], a[112:115], v[16:19], v[180:183]
    ds_read_b64_tr_b16 a[164:165], v225 offset:8192
    v_cvt_pk_bf16_f32 v161, v210, v211
    v_mfma_f32_16x16x32_bf16 v[140:143], a[116:119], v[20:23], v[140:143]
    v_exp_f32 v212, v132
    v_mfma_f32_16x16x32_bf16 v[140:143], a[120:123], v[24:27], v[140:143]
    ds_read_b64_tr_b16 a[166:167], v225 offset:9216
    v_mfma_f32_16x16x32_bf16 v[140:143], a[124:127], v[28:31], v[140:143]
    v_exp_f32 v213, v133
    v_mfma_f32_16x16x32_bf16 a[32:35], a[128:131], v[164:167], a[32:35]
    buffer_load_dwordx4 v234, s[20:23], s46 offen offset:1024 nt lds
    v_cvt_pk_bf16_f32 v162, v212, v213
    v_mfma_f32_16x16x32_bf16 a[36:39], a[132:135], v[164:167], a[36:39]
    v_exp_f32 v214, v134
    v_mfma_f32_16x16x32_bf16 a[40:43], a[136:139], v[164:167], a[40:43]
    ds_read_b64_tr_b16 a[168:169], v226 offset:8192
    v_mfma_f32_16x16x32_bf16 a[44:47], a[140:143], v[164:167], a[44:47]
    v_exp_f32 v215, v135
    v_mfma_f32_16x16x32_bf16 a[48:51], a[144:147], v[164:167], a[48:51]
    ds_read_b64_tr_b16 a[170:171], v226 offset:9216
    v_cvt_pk_bf16_f32 v163, v214, v215
    v_mfma_f32_16x16x32_bf16 a[52:55], a[148:151], v[164:167], a[52:55]
    ds_read_b64_tr_b16 a[172:173], v227 offset:8192
    v_mfma_f32_16x16x32_bf16 a[56:59], a[152:155], v[164:167], a[56:59]
    v_exp_f32 v208, v136
    v_mfma_f32_16x16x32_bf16 a[60:63], a[156:159], v[164:167], a[60:63]
    ds_read_b64_tr_b16 a[174:175], v227 offset:9216
    v_mfma_f32_16x16x32_bf16 v[196:199], v[216:219], v[164:167], v[196:199]
    v_exp_f32 v209, v137
    v_mfma_f32_16x16x32_bf16 v[144:147], a[96:99], v[32:35], v[184:187]
    ds_read_b64_tr_b16 a[176:177], v228 offset:8192
    v_cvt_pk_bf16_f32 v164, v208, v209
    v_mfma_f32_16x16x32_bf16 v[144:147], a[100:103], v[36:39], v[144:147]
    v_exp_f32 v210, v138
    v_mfma_f32_16x16x32_bf16 v[144:147], a[104:107], v[40:43], v[144:147]
    ds_read_b64_tr_b16 a[178:179], v228 offset:9216
    v_mfma_f32_16x16x32_bf16 v[144:147], a[108:111], v[44:47], v[144:147]
    v_exp_f32 v211, v139
    v_mfma_f32_16x16x32_bf16 v[148:151], a[112:115], v[32:35], v[184:187]
    buffer_load_dwordx4 v235, s[20:23], s46 offen offset:2048 nt lds
    v_cvt_pk_bf16_f32 v165, v210, v211
    v_mfma_f32_16x16x32_bf16 v[148:151], a[116:119], v[36:39], v[148:151]
    v_exp_f32 v212, v140
    v_mfma_f32_16x16x32_bf16 v[148:151], a[120:123], v[40:43], v[148:151]
    ds_read_b64_tr_b16 a[180:181], v229 offset:8192
    v_mfma_f32_16x16x32_bf16 v[148:151], a[124:127], v[44:47], v[148:151]
    v_exp_f32 v213, v141
    v_mfma_f32_16x16x32_bf16 v[64:67], a[128:131], v[168:171], v[64:67]
    ds_read_b64_tr_b16 a[182:183], v229 offset:9216
    v_cvt_pk_bf16_f32 v166, v212, v213
    v_mfma_f32_16x16x32_bf16 v[68:71], a[132:135], v[168:171], v[68:71]
    v_exp_f32 v214, v142
    v_mfma_f32_16x16x32_bf16 v[72:75], a[136:139], v[168:171], v[72:75]
    ds_read_b64_tr_b16 a[184:185], v230 offset:8192
    v_mfma_f32_16x16x32_bf16 v[76:79], a[140:143], v[168:171], v[76:79]
    v_exp_f32 v215, v143
    v_mfma_f32_16x16x32_bf16 v[80:83], a[144:147], v[168:171], v[80:83]
    ds_read_b64_tr_b16 a[186:187], v230 offset:9216
    v_cvt_pk_bf16_f32 v167, v214, v215
    v_mfma_f32_16x16x32_bf16 v[84:87], a[148:151], v[168:171], v[84:87]
    ds_read_b64_tr_b16 a[188:189], v231 offset:8192
    v_mfma_f32_16x16x32_bf16 v[88:91], a[152:155], v[168:171], v[88:91]
    v_exp_f32 v208, v144
    v_mfma_f32_16x16x32_bf16 v[92:95], a[156:159], v[168:171], v[92:95]
    ds_read_b64_tr_b16 a[190:191], v231 offset:9216
    v_mfma_f32_16x16x32_bf16 v[200:203], v[216:219], v[168:171], v[200:203]
    v_exp_f32 v209, v145
    v_mfma_f32_16x16x32_bf16 v[152:155], a[96:99], v[48:51], v[188:191]
    buffer_load_dwordx4 v235, s[20:23], s46 offen offset:3072 nt lds
    v_cvt_pk_bf16_f32 v168, v208, v209
    v_mfma_f32_16x16x32_bf16 v[152:155], a[100:103], v[52:55], v[152:155]
    v_exp_f32 v210, v146
    v_mfma_f32_16x16x32_bf16 v[152:155], a[104:107], v[56:59], v[152:155]
    v_mfma_f32_16x16x32_bf16 v[152:155], a[108:111], v[60:63], v[152:155]
    v_exp_f32 v211, v147
    v_mfma_f32_16x16x32_bf16 v[156:159], a[112:115], v[48:51], v[188:191]
    v_cvt_pk_bf16_f32 v169, v210, v211
    v_mfma_f32_16x16x32_bf16 v[156:159], a[116:119], v[52:55], v[156:159]
    v_exp_f32 v212, v148
    v_mfma_f32_16x16x32_bf16 v[156:159], a[120:123], v[56:59], v[156:159]
    v_mfma_f32_16x16x32_bf16 v[156:159], a[124:127], v[60:63], v[156:159]
    v_exp_f32 v213, v149
    v_mfma_f32_16x16x32_bf16 v[96:99], a[128:131], v[172:175], v[96:99]
    v_cvt_pk_bf16_f32 v170, v212, v213
    v_mfma_f32_16x16x32_bf16 v[100:103], a[132:135], v[172:175], v[100:103]
    v_exp_f32 v214, v150
    v_mfma_f32_16x16x32_bf16 v[104:107], a[136:139], v[172:175], v[104:107]
    v_mfma_f32_16x16x32_bf16 v[108:111], a[140:143], v[172:175], v[108:111]
    s_waitcnt lgkmcnt(15)
    v_exp_f32 v215, v151
    v_mfma_f32_16x16x32_bf16 v[112:115], a[144:147], v[172:175], v[112:115]
    v_cvt_pk_bf16_f32 v171, v214, v215
    v_mfma_f32_16x16x32_bf16 v[116:119], a[148:151], v[172:175], v[116:119]
    v_mfma_f32_16x16x32_bf16 v[120:123], a[152:155], v[172:175], v[120:123]
    s_add_u32 s47, s47, 1
    v_exp_f32 v208, v152
    v_mfma_f32_16x16x32_bf16 v[124:127], a[156:159], v[172:175], v[124:127]
    v_mfma_f32_16x16x32_bf16 v[204:207], v[216:219], v[172:175], v[204:207]
    s_cmp_eq_u32 s47, s63
    v_exp_f32 v209, v153
    s_cbranch_scc1 L_cnt
L_cnted:
    s_cmp_lg_u32 s47, 3
    s_cbranch_scc1 L_loop
    v_mfma_f32_16x16x32_bf16 v[128:131], a[64:67], v[0:3], v[176:179]
    ds_read_b128 a[96:99], v220 offset:24576
    v_cvt_pk_bf16_f32 v172, v208, v209
    v_mfma_f32_16x16x32_bf16 v[128:131], a[68:71], v[4:7], v[128:131]
    s_add_u32 s61, s39, 0
    s_add_u32 m0, s41, 131072
    v_exp_f32 v210, v154
    v_mfma_f32_16x16x32_bf16 v[128:131], a[72:75], v[8:11], v[128:131]
    buffer_load_dwordx4 v237, s[12:15], s61 offen offset:0  lds
    ds_read_b128 a[100:103], v221 offset:24576
    v_mfma_f32_16x16x32_bf16 v[128:131], a[76:79], v[12:15], v[128:131]
    v_exp_f32 v211, v155
    v_mfma_f32_16x16x32_bf16 v[132:135], a[80:83], v[0:3], v[176:179]
    ds_read_b128 a[104:107], v222 offset:24576
    v_cvt_pk_bf16_f32 v173, v210, v211
    v_mfma_f32_16x16x32_bf16 v[132:135], a[84:87], v[4:7], v[132:135]
    v_exp_f32 v212, v156
    v_mfma_f32_16x16x32_bf16 v[132:135], a[88:91], v[8:11], v[132:135]
    buffer_load_dwordx4 v238, s[12:15], s61 offen offset:1024  lds
    ds_read_b128 a[108:111], v223 offset:24576
    v_mfma_f32_16x16x32_bf16 v[132:135], a[92:95], v[12:15], v[132:135]
    s_waitcnt lgkmcnt(4)
    v_exp_f32 v213, v157
    v_mfma_f32_16x16x32_bf16 a[0:3], a[160:163], v[160:163], a[0:3]
    ds_read_b128 a[112:115], v220 offset:25600
    v_cvt_pk_bf16_f32 v174, v212, v213
    v_mfma_f32_16x16x32_bf16 a[4:7], a[164:167], v[160:163], a[4:7]
    v_exp_f32 v214, v158
    v_mfma_f32_16x16x32_bf16 a[8:11], a[168:171], v[160:163], a[8:11]
    buffer_load_dwordx4 v239, s[12:15], s61 offen offset:2048  lds
    ds_read_b128 a[116:119], v221 offset:25600
    v_mfma_f32_16x16x32_bf16 a[12:15], a[172:175], v[160:163], a[12:15]
    v_exp_f32 v215, v159
    v_mfma_f32_16x16x32_bf16 a[16:19], a[176:179], v[160:163], a[16:19]
    ds_read_b128 a[120:123], v222 offset:25600
    v_cvt_pk_bf16_f32 v175, v214, v215
    v_mfma_f32_16x16x32_bf16 a[20:23], a[180:183], v[160:163], a[20:23]
    buffer_load_dwordx4 v240, s[12:15], s61 offen offset:3072  lds
    ds_read_b128 a[124:127], v223 offset:25600
    v_mfma_f32_16x16x32_bf16 a[24:27], a[184:187], v[160:163], a[24:27]
    s_add_u32 s61, s39, 36864
    s_add_u32 m0, s41, 147456
    v_exp_f32 v208, v128
    v_mfma_f32_16x16x32_bf16 a[28:31], a[188:191], v[160:163], a[28:31]
    ds_read_b64_tr_b16 a[128:129], v224 offset:16384
    buffer_load_dwordx4 v237, s[12:15], s61 offen offset:0  lds
    v_mfma_f32_16x16x32_bf16 v[192:195], v[216:219], v[160:163], v[192:195]
    v_exp_f32 v209, v129
    v_mfma_f32_16x16x32_bf16 v[136:139], a[64:67], v[16:19], v[180:183]
    ds_read_b64_tr_b16 a[130:131], v224 offset:17408
    v_cvt_pk_bf16_f32 v160, v208, v209
    v_mfma_f32_16x16x32_bf16 v[136:139], a[68:71], v[20:23], v[136:139]
    v_exp_f32 v210, v130
    v_mfma_f32_16x16x32_bf16 v[136:139], a[72:75], v[24:27], v[136:139]
    ds_read_b64_tr_b16 a[132:133], v225 offset:16384
    buffer_load_dwordx4 v238, s[12:15], s61 offen offset:1024  lds
    v_mfma_f32_16x16x32_bf16 v[136:139], a[76:79], v[28:31], v[136:139]
    v_exp_f32 v211, v131
    v_mfma_f32_16x16x32_bf16 v[140:143], a[80:83], v[16:19], v[180:183]
    ds_read_b64_tr_b16 a[134:135], v225 offset:17408
    v_cvt_pk_bf16_f32 v161, v210, v211
    v_mfma_f32_16x16x32_bf16 v[140:143], a[84:87], v[20:23], v[140:143]
    v_exp_f32 v212, v132
    v_mfma_f32_16x16x32_bf16 v[140:143], a[88:91], v[24:27], v[140:143]
    ds_read_b64_tr_b16 a[136:137], v226 offset:16384
    buffer_load_dwordx4 v239, s[12:15], s61 offen offset:2048  lds
    v_mfma_f32_16x16x32_bf16 v[140:143], a[92:95], v[28:31], v[140:143]
    v_exp_f32 v213, v133
    v_mfma_f32_16x16x32_bf16 a[32:35], a[160:163], v[164:167], a[32:35]
    ds_read_b64_tr_b16 a[138:139], v226 offset:17408
    v_cvt_pk_bf16_f32 v162, v212, v213
    v_mfma_f32_16x16x32_bf16 a[36:39], a[164:167], v[164:167], a[36:39]
    v_exp_f32 v214, v134
    v_mfma_f32_16x16x32_bf16 a[40:43], a[168:171], v[164:167], a[40:43]
    ds_read_b64_tr_b16 a[140:141], v227 offset:16384
    buffer_load_dwordx4 v240, s[12:15], s61 offen offset:3072  lds
    v_mfma_f32_16x16x32_bf16 a[44:47], a[172:175], v[164:167], a[44:47]
    s_add_u32 s61, s39, 0
    v_exp_f32 v215, v135
    v_mfma_f32_16x16x32_bf16 a[48:51], a[176:179], v[164:167], a[48:51]
    ds_read_b64_tr_b16 a[142:143], v227 offset:17408
    v_cvt_pk_bf16_f32 v163, v214, v215
    v_mfma_f32_16x16x32_bf16 a[52:55], a[180:183], v[164:167], a[52:55]
    ds_read_b64_tr_b16 a[144:145], v228 offset:16384
    v_mfma_f32_16x16x32_bf16 a[56:59], a[184:187], v[164:167], a[56:59]
    s_add_u32 m0, s41, 0
    v_exp_f32 v208, v136
    v_mfma_f32_16x16x32_bf16 a[60:63], a[188:191], v[164:167], a[60:63]
    buffer_load_dwordx4 v237, s[52:55], s61 offen offset:0  lds
    v_mfma_f32_16x16x32_bf16 v[196:199], v[216:219], v[164:167], v[196:199]
    v_exp_f32 v209, v137
    v_mfma_f32_16x16x32_bf16 v[144:147], a[64:67], v[32:35], v[184:187]
    ds_read_b64_tr_b16 a[146:147], v228 offset:17408
    v_cvt_pk_bf16_f32 v164, v208, v209
    v_mfma_f32_16x16x32_bf16 v[144:147], a[68:71], v[36:39], v[144:147]
    v_exp_f32 v210, v138
    v_mfma_f32_16x16x32_bf16 v[144:147], a[72:75], v[40:43], v[144:147]
    ds_read_b64_tr_b16 a[148:149], v229 offset:16384
    v_mfma_f32_16x16x32_bf16 v[144:147], a[76:79], v[44:47], v[144:147]
    v_exp_f32 v211, v139
    v_mfma_f32_16x16x32_bf16 v[148:151], a[80:83], v[32:35], v[184:187]
    buffer_load_dwordx4 v238, s[52:55], s61 offen offset:1024  lds
    v_cvt_pk_bf16_f32 v165, v210, v211
    v_mfma_f32_16x16x32_bf16 v[148:151], a[84:87], v[36:39], v[148:151]
    v_exp_f32 v212, v140
    v_mfma_f32_16x16x32_bf16 v[148:151], a[88:91], v[40:43], v[148:151]
    ds_read_b64_tr_b16 a[150:151], v229 offset:17408
    v_mfma_f32_16x16x32_bf16 v[148:151], a[92:95], v[44:47], v[148:151]
    v_exp_f32 v213, v141
    v_mfma_f32_16x16x32_bf16 v[64:67], a[160:163], v[168:171], v[64:67]
    ds_read_b64_tr_b16 a[152:153], v230 offset:16384
    v_cvt_pk_bf16_f32 v166, v212, v213
    v_mfma_f32_16x16x32_bf16 v[68:71], a[164:167], v[168:171], v[68:71]
    v_exp_f32 v214, v142
    v_mfma_f32_16x16x32_bf16 v[72:75], a[168:171], v[168:171], v[72:75]
    buffer_load_dwordx4 v239, s[52:55], s61 offen offset:2048  lds
    v_mfma_f32_16x16x32_bf16 v[76:79], a[172:175], v[168:171], v[76:79]
    v_exp_f32 v215, v143
    v_mfma_f32_16x16x32_bf16 v[80:83], a[176:179], v[168:171], v[80:83]
    ds_read_b64_tr_b16 a[154:155], v230 offset:17408
    v_cvt_pk_bf16_f32 v167, v214, v215
    v_mfma_f32_16x16x32_bf16 v[84:87], a[180:183], v[168:171], v[84:87]
    ds_read_b64_tr_b16 a[156:157], v231 offset:16384
    v_mfma_f32_16x16x32_bf16 v[88:91], a[184:187], v[168:171], v[88:91]
    v_exp_f32 v208, v144
    v_mfma_f32_16x16x32_bf16 v[92:95], a[188:191], v[168:171], v[92:95]
    buffer_load_dwordx4 v240, s[52:55], s61 offen offset:3072  lds
    v_mfma_f32_16x16x32_bf16 v[200:203], v[216:219], v[168:171], v[200:203]
    v_exp_f32 v209, v145
    v_mfma_f32_16x16x32_bf16 v[152:155], a[64:67], v[48:51], v[188:191]
    ds_read_b64_tr_b16 a[158:159], v231 offset:17408
    v_cvt_pk_bf16_f32 v168, v208, v209
    v_mfma_f32_16x16x32_bf16 v[152:155], a[68:71], v[52:55], v[152:155]
    v_exp_f32 v210, v146
    v_mfma_f32_16x16x32_bf16 v[152:155], a[72:75], v[56:59], v[152:155]
    v_mfma_f32_16x16x32_bf16 v[152:155], a[76:79], v[60:63], v[152:155]
    v_exp_f32 v211, v147
    v_mfma_f32_16x16x32_bf16 v[156:159], a[80:83], v[48:51], v[188:191]
    v_cvt_pk_bf16_f32 v169, v210, v211
    v_mfma_f32_16x16x32_bf16 v[156:159], a[84:87], v[52:55], v[156:159]
    v_exp_f32 v212, v148
    v_mfma_f32_16x16x32_bf16 v[156:159], a[88:91], v[56:59], v[156:159]
    v_mfma_f32_16x16x32_bf16 v[156:159], a[92:95], v[60:63], v[156:159]
    v_exp_f32 v213, v149
    v_mfma_f32_16x16x32_bf16 v[96:99], a[160:163], v[172:175], v[96:99]
    v_cvt_pk_bf16_f32 v170, v212, v213
    v_mfma_f32_16x16x32_bf16 v[100:103], a[164:167], v[172:175], v[100:103]
    v_exp_f32 v214, v150
    v_mfma_f32_16x16x32_bf16 v[104:107], a[168:171], v[172:175], v[104:107]
    v_mfma_f32_16x16x32_bf16 v[108:111], a[172:175], v[172:175], v[108:111]
    v_exp_f32 v215, v151
    v_mfma_f32_16x16x32_bf16 v[112:115], a[176:179], v[172:175], v[112:115]
    v_cvt_pk_bf16_f32 v171, v214, v215
    v_mfma_f32_16x16x32_bf16 v[116:119], a[180:183], v[172:175], v[116:119]
    v_mfma_f32_16x16x32_bf16 v[120:123], a[184:187], v[172:175], v[120:123]
    v_exp_f32 v208, v152
    v_mfma_f32_16x16x32_bf16 v[124:127], a[188:191], v[172:175], v[124:127]
    v_mfma_f32_16x16x32_bf16 v[204:207], v[216:219], v[172:175], v[204:207]
    v_exp_f32 v209, v153
    s_waitcnt vmcnt(20) lgkmcnt(15)
    s_barrier
    v_mfma_f32_16x16x32_bf16 v[128:131], a[96:99], v[0:3], v[176:179]
    ds_read_b128 a[64:67], v220 offset:32768
    v_cvt_pk_bf16_f32 v172, v208, v209
    v_mfma_f32_16x16x32_bf16 v[128:131], a[100:103], v[4:7], v[128:131]
    s_add_u32 s61, s39, 36864
    s_add_u32 m0, s41, 16384
    v_exp_f32 v210, v154
    v_mfma_f32_16x16x32_bf16 v[128:131], a[104:107], v[8:11], v[128:131]
    ds_read_b128 a[68:71], v221 offset:32768
    buffer_load_dwordx4 v237, s[52:55], s61 offen offset:0  lds
    v_mfma_f32_16x16x32_bf16 v[128:131], a[108:111], v[12:15], v[128:131]
    v_exp_f32 v211, v155
    v_mfma_f32_16x16x32_bf16 v[132:135], a[112:115], v[0:3], v[176:179]
    ds_read_b128 a[72:75], v222 offset:32768
    v_cvt_pk_bf16_f32 v173, v210, v211
    v_mfma_f32_16x16x32_bf16 v[132:135], a[116:119], v[4:7], v[132:135]
    v_exp_f32 v212, v156
    v_mfma_f32_16x16x32_bf16 v[132:135], a[120:123], v[8:11], v[132:135]
    ds_read_b128 a[76:79], v223 offset:32768
    ds_read_b128 a[80:83], v220 offset:33792
    v_mfma_f32_16x16x32_bf16 v[132:135], a[124:127], v[12:15], v[132:135]
    s_waitcnt lgkmcnt(5)
    v_exp_f32 v213, v157
    v_mfma_f32_16x16x32_bf16 a[0:3], a[128:131], v[160:163], a[0:3]
    buffer_load_dwordx4 v238, s[52:55], s61 offen offset:1024  lds
    v_cvt_pk_bf16_f32 v174, v212, v213
    v_mfma_f32_16x16x32_bf16 a[4:7], a[132:135], v[160:163], a[4:7]
    v_exp_f32 v214, v158
    v_mfma_f32_16x16x32_bf16 a[8:11], a[136:139], v[160:163], a[8:11]
    ds_read_b128 a[84:87], v221 offset:33792
    ds_read_b128 a[88:91], v222 offset:33792
    v_mfma_f32_16x16x32_bf16 a[12:15], a[140:143], v[160:163], a[12:15]
    v_exp_f32 v215, v159
    v_mfma_f32_16x16x32_bf16 a[16:19], a[144:147], v[160:163], a[16:19]
    ds_read_b128 a[92:95], v223 offset:33792
    v_cvt_pk_bf16_f32 v175, v214, v215
    v_mfma_f32_16x16x32_bf16 a[20:23], a[148:151], v[160:163], a[20:23]
    buffer_load_dwordx4 v239, s[52:55], s61 offen offset:2048  lds
    ds_read_b64_tr_b16 a[160:161], v224 offset:24576
    v_mfma_f32_16x16x32_bf16 a[24:27], a[152:155], v[160:163], a[24:27]
    v_exp_f32 v208, v128
    v_mfma_f32_16x16x32_bf16 a[28:31], a[156:159], v[160:163], a[28:31]
    ds_read_b64_tr_b16 a[162:163], v224 offset:25600
    v_mfma_f32_16x16x32_bf16 v[192:195], v[216:219], v[160:163], v[192:195]
    v_exp_f32 v209, v129
    v_mfma_f32_16x16x32_bf16 v[136:139], a[96:99], v[16:19], v[180:183]
    ds_read_b64_tr_b16 a[164:165], v225 offset:24576
    v_cvt_pk_bf16_f32 v160, v208, v209
    v_mfma_f32_16x16x32_bf16 v[136:139], a[100:103], v[20:23], v[136:139]
    v_exp_f32 v210, v130
    v_mfma_f32_16x16x32_bf16 v[136:139], a[104:107], v[24:27], v[136:139]
    buffer_load_dwordx4 v240, s[52:55], s61 offen offset:3072  lds
    v_mfma_f32_16x16x32_bf16 v[136:139], a[108:111], v[28:31], v[136:139]
    v_exp_f32 v211, v131
    v_mfma_f32_16x16x32_bf16 v[140:143], a[112:115], v[16:19], v[180:183]
    ds_read_b64_tr_b16 a[166:167], v225 offset:25600
    v_cvt_pk_bf16_f32 v161, v210, v211
    v_mfma_f32_16x16x32_bf16 v[140:143], a[116:119], v[20:23], v[140:143]
    v_exp_f32 v212, v132
    v_mfma_f32_16x16x32_bf16 v[140:143], a[120:123], v[24:27], v[140:143]
    ds_read_b64_tr_b16 a[168:169], v226 offset:24576
    v_mfma_f32_16x16x32_bf16 v[140:143], a[124:127], v[28:31], v[140:143]
    s_add_u32 s61, s39, 73728
    v_exp_f32 v213, v133
    v_mfma_f32_16x16x32_bf16 a[32:35], a[128:131], v[164:167], a[32:35]
    ds_read_b64_tr_b16 a[170:171], v226 offset:25600
    v_cvt_pk_bf16_f32 v162, v212, v213
    v_mfma_f32_16x16x32_bf16 a[36:39], a[132:135], v[164:167], a[36:39]
    s_add_u32 m0, s41, 65536
    v_exp_f32 v214, v134
    v_mfma_f32_16x16x32_bf16 a[40:43], a[136:139], v[164:167], a[40:43]
    buffer_load_dwordx4 v237, s[12:15], s61 offen offset:0  lds
    v_mfma_f32_16x16x32_bf16 a[44:47], a[140:143], v[164:167], a[44:47]
    v_exp_f32 v215, v135
    v_mfma_f32_16x16x32_bf16 a[48:51], a[144:147], v[164:167], a[48:51]
    ds_read_b64_tr_b16 a[172:173], v227 offset:24576
    v_cvt_pk_bf16_f32 v163, v214, v215
    v_mfma_f32_16x16x32_bf16 a[52:55], a[148:151], v[164:167], a[52:55]
    ds_read_b64_tr_b16 a[174:175], v227 offset:25600
    v_mfma_f32_16x16x32_bf16 a[56:59], a[152:155], v[164:167], a[56:59]
    v_exp_f32 v208, v136
    v_mfma_f32_16x16x32_bf16 a[60:63], a[156:159], v[164:167], a[60:63]
    ds_read_b64_tr_b16 a[176:177], v228 offset:24576
    v_mfma_f32_16x16x32_bf16 v[196:199], v[216:219], v[164:167], v[196:199]
    v_exp_f32 v209, v137
    v_mfma_f32_16x16x32_bf16 v[144:147], a[96:99], v[32:35], v[184:187]
    buffer_load_dwordx4 v238, s[12:15], s61 offen offset:1024  lds
    v_cvt_pk_bf16_f32 v164, v208, v209
    v_mfma_f32_16x16x32_bf16 v[144:147], a[100:103], v[36:39], v[144:147]
    v_exp_f32 v210, v138
    v_mfma_f32_16x16x32_bf16 v[144:147], a[104:107], v[40:43], v[144:147]
    ds_read_b64_tr_b16 a[178:179], v228 offset:25600
    v_mfma_f32_16x16x32_bf16 v[144:147], a[108:111], v[44:47], v[144:147]
    v_exp_f32 v211, v139
    v_mfma_f32_16x16x32_bf16 v[148:151], a[112:115], v[32:35], v[184:187]
    ds_read_b64_tr_b16 a[180:181], v229 offset:24576
    v_cvt_pk_bf16_f32 v165, v210, v211
    v_mfma_f32_16x16x32_bf16 v[148:151], a[116:119], v[36:39], v[148:151]
    v_exp_f32 v212, v140
    v_mfma_f32_16x16x32_bf16 v[148:151], a[120:123], v[40:43], v[148:151]
    ds_read_b64_tr_b16 a[182:183], v229 offset:25600
    v_mfma_f32_16x16x32_bf16 v[148:151], a[124:127], v[44:47], v[148:151]
    v_exp_f32 v213, v141
    v_mfma_f32_16x16x32_bf16 v[64:67], a[128:131], v[168:171], v[64:67]
    buffer_load_dwordx4 v239, s[12:15], s61 offen offset:2048  lds
    v_cvt_pk_bf16_f32 v166, v212, v213
    v_mfma_f32_16x16x32_bf16 v[68:71], a[132:135], v[168:171], v[68:71]
    v_exp_f32 v214, v142
    v_mfma_f32_16x16x32_bf16 v[72:75], a[136:139], v[168:171], v[72:75]
    ds_read_b64_tr_b16 a[184:185], v230 offset:24576
    v_mfma_f32_16x16x32_bf16 v[76:79], a[140:143], v[168:171], v[76:79]
    v_exp_f32 v215, v143
    v_mfma_f32_16x16x32_bf16 v[80:83], a[144:147], v[168:171], v[80:83]
    ds_read_b64_tr_b16 a[186:187], v230 offset:25600
    v_cvt_pk_bf16_f32 v167, v214, v215
    v_mfma_f32_16x16x32_bf16 v[84:87], a[148:151], v[168:171], v[84:87]
    ds_read_b64_tr_b16 a[188:189], v231 offset:24576
    v_mfma_f32_16x16x32_bf16 v[88:91], a[152:155], v[168:171], v[88:91]
    v_exp_f32 v208, v144
    v_mfma_f32_16x16x32_bf16 v[92:95], a[156:159], v[168:171], v[92:95]
    buffer_load_dwordx4 v240, s[12:15], s61 offen offset:3072  lds
    v_mfma_f32_16x16x32_bf16 v[200:203], v[216:219], v[168:171], v[200:203]
    v_exp_f32 v209, v145
    v_mfma_f32_16x16x32_bf16 v[152:155], a[96:99], v[48:51], v[188:191]
    ds_read_b64_tr_b16 a[190:191], v231 offset:25600
    v_cvt_pk_bf16_f32 v168, v208, v209
    v_mfma_f32_16x16x32_bf16 v[152:155], a[100:103], v[52:55], v[152:155]
    v_exp_f32 v210, v146
    v_mfma_f32_16x16x32_bf16 v[152:155], a[104:107], v[56:59], v[152:155]
    v_mfma_f32_16x16x32_bf16 v[152:155], a[108:111], v[60:63], v[152:155]
    v_exp_f32 v211, v147
    v_mfma_f32_16x16x32_bf16 v[156:159], a[112:115], v[48:51], v[188:191]
    v_cvt_pk_bf16_f32 v169, v210, v211
    v_mfma_f32_16x16x32_bf16 v[156:159], a[116:119], v[52:55], v[156:159]
    v_exp_f32 v212, v148
    v_mfma_f32_16x16x32_bf16 v[156:159], a[120:123], v[56:59], v[156:159]
    v_mfma_f32_16x16x32_bf16 v[156:159], a[124:127], v[60:63], v[156:159]
    v_exp_f32 v213, v149
    v_mfma_f32_16x16x32_bf16 v[96:99], a[128:131], v[172:175], v[96:99]
    v_cvt_pk_bf16_f32 v170, v212, v213
    v_mfma_f32_16x16x32_bf16 v[100:103], a[132:135], v[172:175], v[100:103]
    v_exp_f32 v214, v150
    v_mfma_f32_16x16x32_bf16 v[104:107], a[136:139], v[172:175], v[104:107]
    v_mfma_f32_16x16x32_bf16 v[108:111], a[140:143], v[172:175], v[108:111]
    v_exp_f32 v215, v151
    v_mfma_f32_16x16x32_bf16 v[112:115], a[144:147], v[172:175], v[112:115]
    v_cvt_pk_bf16_f32 v171, v214, v215
    v_mfma_f32_16x16x32_bf16 v[116:119], a[148:151], v[172:175], v[116:119]
    v_mfma_f32_16x16x32_bf16 v[120:123], a[152:155], v[172:175], v[120:123]
    v_exp_f32 v208, v152
    v_mfma_f32_16x16x32_bf16 v[124:127], a[156:159], v[172:175], v[124:127]
    v_mfma_f32_16x16x32_bf16 v[204:207], v[216:219], v[172:175], v[204:207]
    v_exp_f32 v209, v153
    s_waitcnt lgkmcnt(15)
    v_mfma_f32_16x16x32_bf16 v[128:131], a[64:67], v[0:3], v[176:179]
    ds_read_b128 a[96:99], v220 offset:40960
    v_cvt_pk_bf16_f32 v172, v208, v209
    v_mfma_f32_16x16x32_bf16 v[128:131], a[68:71], v[4:7], v[128:131]
    s_waitcnt vmcnt(16)
    v_exp_f32 v210, v154
    v_mfma_f32_16x16x32_bf16 v[128:131], a[72:75], v[8:11], v[128:131]
    ds_read_b64_tr_b16 a[192:193], v249 offset:0
    ds_read_b128 a[100:103], v221 offset:40960
    v_mfma_f32_16x16x32_bf16 v[128:131], a[76:79], v[12:15], v[128:131]
    v_exp_f32 v211, v155
    v_mfma_f32_16x16x32_bf16 v[132:135], a[80:83], v[0:3], v[176:179]
    ds_read_b64_tr_b16 a[194:195], v249 offset:2048
    v_cvt_pk_bf16_f32 v173, v210, v211
    v_mfma_f32_16x16x32_bf16 v[132:135], a[84:87], v[4:7], v[132:135]
    v_exp_f32 v212, v156
    v_mfma_f32_16x16x32_bf16 v[132:135], a[88:91], v[8:11], v[132:135]
    ds_read_b128 a[104:107], v222 offset:40960
    ds_read_b64_tr_b16 a[196:197], v250 offset:0
    v_mfma_f32_16x16x32_bf16 v[132:135], a[92:95], v[12:15], v[132:135]
    s_waitcnt lgkmcnt(6)
    v_exp_f32 v213, v157
    v_mfma_f32_16x16x32_bf16 a[0:3], a[160:163], v[160:163], a[0:3]
    ds_read_b128 a[108:111], v223 offset:40960
    v_cvt_pk_bf16_f32 v174, v212, v213
    v_mfma_f32_16x16x32_bf16 a[4:7], a[164:167], v[160:163], a[4:7]
    v_exp_f32 v214, v158
    v_mfma_f32_16x16x32_bf16 a[8:11], a[168:171], v[160:163], a[8:11]
    ds_read_b64_tr_b16 a[198:199], v250 offset:2048
    ds_read_b128 a[112:115], v220 offset:41984
    v_mfma_f32_16x16x32_bf16 a[12:15], a[172:175], v[160:163], a[12:15]
    v_exp_f32 v215, v159
    v_mfma_f32_16x16x32_bf16 a[16:19], a[176:179], v[160:163], a[16:19]
    ds_read_b64_tr_b16 a[200:201], v251 offset:0
    v_cvt_pk_bf16_f32 v175, v214, v215
    v_mfma_f32_16x16x32_bf16 a[20:23], a[180:183], v[160:163], a[20:23]
    ds_read_b128 a[116:119], v221 offset:41984
    ds_read_b64_tr_b16 a[202:203], v251 offset:2048
    v_mfma_f32_16x16x32_bf16 a[24:27], a[184:187], v[160:163], a[24:27]
    v_exp_f32 v208, v128
    v_mfma_f32_16x16x32_bf16 a[28:31], a[188:191], v[160:163], a[28:31]
    ds_read_b128 a[120:123], v222 offset:41984
    ds_read_b64_tr_b16 a[204:205], v252 offset:0
    v_mfma_f32_16x16x32_bf16 v[192:195], v[216:219], v[160:163], v[192:195]
    v_exp_f32 v209, v129
    v_mfma_f32_16x16x32_bf16 v[136:139], a[64:67], v[16:19], v[180:183]
    ds_read_b128 a[124:127], v223 offset:41984
    v_cvt_pk_bf16_f32 v160, v208, v209
    v_mfma_f32_16x16x32_bf16 v[136:139], a[68:71], v[20:23], v[136:139]
    v_exp_f32 v210, v130
    v_mfma_f32_16x16x32_bf16 v[136:139], a[72:75], v[24:27], v[136:139]
    ds_read_b64_tr_b16 a[206:207], v252 offset:2048
    ds_read_b64_tr_b16 a[128:129], v224 offset:32768
    v_mfma_f32_16x16x32_bf16 v[136:139], a[76:79], v[28:31], v[136:139]
    s_waitcnt vmcnt(12)
    v_exp_f32 v211, v131
    v_mfma_f32_16x16x32_bf16 v[140:143], a[80:83], v[16:19], v[180:183]
    ds_read_b64_tr_b16 a[208:209], v249 offset:16384
    v_cvt_pk_bf16_f32 v161, v210, v211
    v_mfma_f32_16x16x32_bf16 v[140:143], a[84:87], v[20:23], v[140:143]
    v_exp_f32 v212, v132
    v_mfma_f32_16x16x32_bf16 v[140:143], a[88:91], v[24:27], v[140:143]
    ds_read_b64_tr_b16 a[130:131], v224 offset:33792
    ds_read_b64_tr_b16 a[210:211], v249 offset:18432
    v_mfma_f32_16x16x32_bf16 v[140:143], a[92:95], v[28:31], v[140:143]
    v_exp_f32 v213, v133
    v_mfma_f32_16x16x32_bf16 a[32:35], a[160:163], v[164:167], a[32:35]
    ds_read_b64_tr_b16 a[132:133], v225 offset:32768
    v_cvt_pk_bf16_f32 v162, v212, v213
    v_mfma_f32_16x16x32_bf16 a[36:39], a[164:167], v[164:167], a[36:39]
    v_exp_f32 v214, v134
    v_mfma_f32_16x16x32_bf16 a[40:43], a[168:171], v[164:167], a[40:43]
    ds_read_b64_tr_b16 a[212:213], v250 offset:16384
    ds_read_b64_tr_b16 a[134:135], v225 offset:33792
    v_mfma_f32_16x16x32_bf16 a[44:47], a[172:175], v[164:167], a[44:47]
    v_exp_f32 v215, v135
    v_mfma_f32_16x16x32_bf16 a[48:51], a[176:179], v[164:167], a[48:51]
    ds_read_b64_tr_b16 a[214:215], v250 offset:18432
    v_cvt_pk_bf16_f32 v163, v214, v215
    v_mfma_f32_16x16x32_bf16 a[52:55], a[180:183], v[164:167], a[52:55]
    ds_read_b64_tr_b16 a[136:137], v226 offset:32768
    ds_read_b64_tr_b16 a[216:217], v251 offset:16384
    v_mfma_f32_16x16x32_bf16 a[56:59], a[184:187], v[164:167], a[56:59]
    v_exp_f32 v208, v136
    v_mfma_f32_16x16x32_bf16 a[60:63], a[188:191], v[164:167], a[60:63]
    ds_read_b64_tr_b16 a[138:139], v226 offset:33792
    ds_read_b64_tr_b16 a[218:219], v251 offset:18432
    v_mfma_f32_16x16x32_bf16 v[196:199], v[216:219], v[164:167], v[196:199]
    v_exp_f32 v209, v137
    v_mfma_f32_16x16x32_bf16 v[144:147], a[64:67], v[32:35], v[184:187]
    ds_read_b64_tr_b16 a[140:141], v227 offset:32768
    v_cvt_pk_bf16_f32 v164, v208, v209
    v_mfma_f32_16x16x32_bf16 v[144:147], a[68:71], v[36:39], v[144:147]
    v_exp_f32 v210, v138
    v_mfma_f32_16x16x32_bf16 v[144:147], a[72:75], v[40:43], v[144:147]
    ds_read_b64_tr_b16 a[220:221], v252 offset:16384
    ds_read_b64_tr_b16 a[142:143], v227 offset:33792
    v_mfma_f32_16x16x32_bf16 v[144:147], a[76:79], v[44:47], v[144:147]
    v_exp_f32 v211, v139
    v_mfma_f32_16x16x32_bf16 v[148:151], a[80:83], v[32:35], v[184:187]
    ds_read_b64_tr_b16 a[222:223], v252 offset:18432
    v_cvt_pk_bf16_f32 v165, v210, v211
    v_mfma_f32_16x16x32_bf16 v[148:151], a[84:87], v[36:39], v[148:151]
    s_add_u32 s61, s39, 110592
    s_add_u32 m0, s41, 131072
    s_waitcnt lgkmcnt(15)
    v_exp_f32 v212, v140
    v_mfma_f32_16x16x32_bf16 v[148:151], a[88:91], v[40:43], v[148:151]
    ds_read_b64_tr_b16 a[144:145], v228 offset:32768
    buffer_load_dwordx4 v237, s[12:15], s61 offen offset:0  lds
    v_mfma_f32_16x16x32_bf16 v[148:151], a[92:95], v[44:47], v[148:151]
    v_exp_f32 v213, v141
    v_mfma_f32_16x16x32_bf16 v[64:67], a[160:163], v[168:171], v[64:67]
    ds_read_b64_tr_b16 a[146:147], v228 offset:33792
    v_cvt_pk_bf16_f32 v166, v212, v213
    v_mfma_f32_16x16x32_bf16 v[68:71], a[164:167], v[168:171], v[68:71]
    v_exp_f32 v214, v142
    v_mfma_f32_16x16x32_bf16 v[72:75], a[168:171], v[168:171], v[72:75]
    buffer_load_dwordx4 v238, s[12:15], s61 offen offset:1024  lds
    ds_read_b64_tr_b16 a[148:149], v229 offset:32768
    v_mfma_f32_16x16x32_bf16 v[76:79], a[172:175], v[168:171], v[76:79]
    v_exp_f32 v215, v143
    v_mfma_f32_16x16x32_bf16 v[80:83], a[176:179], v[168:171], v[80:83]
    buffer_load_dwordx4 v239, s[12:15], s61 offen offset:2048  lds
    v_cvt_pk_bf16_f32 v167, v214, v215
    v_mfma_f32_16x16x32_bf16 v[84:87], a[180:183], v[168:171], v[84:87]
    ds_read_b64_tr_b16 a[150:151], v229 offset:33792
    buffer_load_dwordx4 v240, s[12:15], s61 offen offset:3072  lds
    v_mfma_f32_16x16x32_bf16 v[88:91], a[184:187], v[168:171], v[88:91]
    s_add_u32 s61, s39, 73728
    s_add_u32 m0, s41, 147456
    s_waitcnt lgkmcnt(4)
    v_exp_f32 v208, v144
    v_mfma_f32_16x16x32_bf16 v[92:95], a[188:191], v[168:171], v[92:95]
    ds_read_b64_tr_b16 a[152:153], v230 offset:32768
    buffer_load_dwordx4 v237, s[52:55], s61 offen offset:0  lds
    v_mfma_f32_16x16x32_bf16 v[200:203], v[216:219], v[168:171], v[200:203]
    v_exp_f32 v209, v145
    v_mfma_f32_16x16x32_bf16 v[152:155], a[64:67], v[48:51], v[188:191]
    ds_read_b64_tr_b16 a[154:155], v230 offset:33792
    v_cvt_pk_bf16_f32 v168, v208, v209
    v_mfma_f32_16x16x32_bf16 v[152:155], a[68:71], v[52:55], v[152:155]
    v_exp_f32 v210, v146
    v_mfma_f32_16x16x32_bf16 v[152:155], a[72:75], v[56:59], v[152:155]
    buffer_load_dwordx4 v238, s[52:55], s61 offen offset:1024  lds
    v_mfma_f32_16x16x32_bf16 v[152:155], a[76:79], v[60:63], v[152:155]
    v_exp_f32 v211, v147
    v_mfma_f32_16x16x32_bf16 v[156:159], a[80:83], v[48:51], v[188:191]
    ds_read_b64_tr_b16 a[156:157], v231 offset:32768
    v_cvt_pk_bf16_f32 v169, v210, v211
    v_mfma_f32_16x16x32_bf16 v[156:159], a[84:87], v[52:55], v[156:159]
    v_exp_f32 v212, v148
    v_mfma_f32_16x16x32_bf16 v[156:159], a[88:91], v[56:59], v[156:159]
    buffer_load_dwordx4 v239, s[52:55], s61 offen offset:2048  lds
    v_mfma_f32_16x16x32_bf16 v[156:159], a[92:95], v[60:63], v[156:159]
    v_exp_f32 v213, v149
    v_mfma_f32_16x16x32_bf16 v[96:99], a[160:163], v[172:175], v[96:99]
    ds_read_b64_tr_b16 a[158:159], v231 offset:33792
    v_cvt_pk_bf16_f32 v170, v212, v213
    v_mfma_f32_16x16x32_bf16 v[100:103], a[164:167], v[172:175], v[100:103]
    v_exp_f32 v214, v150
    v_mfma_f32_16x16x32_bf16 v[104:107], a[168:171], v[172:175], v[104:107]
    buffer_load_dwordx4 v240, s[52:55], s61 offen offset:3072  lds
    v_mfma_f32_16x16x32_bf16 v[108:111], a[172:175], v[172:175], v[108:111]
    v_exp_f32 v215, v151
    v_mfma_f32_16x16x32_bf16 v[112:115], a[176:179], v[172:175], v[112:115]
    v_cvt_pk_bf16_f32 v171, v214, v215
    v_mfma_f32_16x16x32_bf16 v[116:119], a[180:183], v[172:175], v[116:119]
    v_mfma_f32_16x16x32_bf16 v[120:123], a[184:187], v[172:175], v[120:123]
    v_exp_f32 v208, v152
    v_mfma_f32_16x16x32_bf16 v[124:127], a[188:191], v[172:175], v[124:127]
    v_mfma_f32_16x16x32_bf16 v[204:207], v[216:219], v[172:175], v[204:207]
    v_exp_f32 v209, v153
    s_barrier
    v_mfma_f32_16x16x32_bf16 v[128:131], a[96:99], v[0:3], v[176:179]
    ds_read_b128 a[64:67], v220 offset:49152
    v_cvt_pk_bf16_f32 v172, v208, v209
    v_mfma_f32_16x16x32_bf16 v[128:131], a[100:103], v[4:7], v[128:131]
    s_waitcnt vmcnt(16)
    v_exp_f32 v210, v154
    v_mfma_f32_16x16x32_bf16 v[128:131], a[104:107], v[8:11], v[128:131]
    ds_read_b64_tr_b16 a[224:225], v241 offset:0
    ds_read_b128 a[68:71], v221 offset:49152
    v_mfma_f32_16x16x32_bf16 v[128:131], a[108:111], v[12:15], v[128:131]
    v_exp_f32 v211, v155
    v_mfma_f32_16x16x32_bf16 v[132:135], a[112:115], v[0:3], v[176:179]
    ds_read_b64_tr_b16 a[226:227], v241 offset:2048
    v_cvt_pk_bf16_f32 v173, v210, v211
    v_mfma_f32_16x16x32_bf16 v[132:135], a[116:119], v[4:7], v[132:135]
    v_exp_f32 v212, v156
    v_mfma_f32_16x16x32_bf16 v[132:135], a[120:123], v[8:11], v[132:135]
    ds_read_b128 a[72:75], v222 offset:49152
    ds_read_b64_tr_b16 a[228:229], v242 offset:0
    v_mfma_f32_16x16x32_bf16 v[132:135], a[124:127], v[12:15], v[132:135]
    s_waitcnt lgkmcnt(6)
    v_exp_f32 v213, v157
    v_mfma_f32_16x16x32_bf16 a[0:3], a[128:131], v[160:163], a[0:3]
    ds_read_b128 a[76:79], v223 offset:49152
    v_cvt_pk_bf16_f32 v174, v212, v213
    v_mfma_f32_16x16x32_bf16 a[4:7], a[132:135], v[160:163], a[4:7]
    v_exp_f32 v214, v158
    v_mfma_f32_16x16x32_bf16 a[8:11], a[136:139], v[160:163], a[8:11]
    ds_read_b64_tr_b16 a[230:231], v242 offset:2048
    ds_read_b128 a[80:83], v220 offset:50176
    v_mfma_f32_16x16x32_bf16 a[12:15], a[140:143], v[160:163], a[12:15]
    v_exp_f32 v215, v159
    v_mfma_f32_16x16x32_bf16 a[16:19], a[144:147], v[160:163], a[16:19]
    ds_read_b64_tr_b16 a[232:233], v243 offset:0
    v_cvt_pk_bf16_f32 v175, v214, v215
    v_mfma_f32_16x16x32_bf16 a[20:23], a[148:151], v[160:163], a[20:23]
    ds_read_b128 a[84:87], v221 offset:50176
    ds_read_b64_tr_b16 a[234:235], v243 offset:2048
    v_mfma_f32_16x16x32_bf16 a[24:27], a[152:155], v[160:163], a[24:27]
    v_exp_f32 v208, v128
    v_mfma_f32_16x16x32_bf16 a[28:31], a[156:159], v[160:163], a[28:31]
    ds_read_b128 a[88:91], v222 offset:50176
    ds_read_b64_tr_b16 a[236:237], v244 offset:0
    v_mfma_f32_16x16x32_bf16 v[192:195], v[216:219], v[160:163], v[192:195]
    v_exp_f32 v209, v129
    v_mfma_f32_16x16x32_bf16 v[136:139], a[96:99], v[16:19], v[180:183]
    ds_read_b128 a[92:95], v223 offset:50176
    v_cvt_pk_bf16_f32 v160, v208, v209
    v_mfma_f32_16x16x32_bf16 v[136:139], a[100:103], v[20:23], v[136:139]
    v_exp_f32 v210, v130
    v_mfma_f32_16x16x32_bf16 v[136:139], a[104:107], v[24:27], v[136:139]
    ds_read_b64_tr_b16 a[238:239], v244 offset:2048
    ds_read_b64_tr_b16 a[160:161], v224 offset:40960
    v_mfma_f32_16x16x32_bf16 v[136:139], a[108:111], v[28:31], v[136:139]
    s_waitcnt vmcnt(12)
    v_exp_f32 v211, v131
    v_mfma_f32_16x16x32_bf16 v[140:143], a[112:115], v[16:19], v[180:183]
    ds_read_b64_tr_b16 a[240:241], v241 offset:16384
    v_cvt_pk_bf16_f32 v161, v210, v211
    v_mfma_f32_16x16x32_bf16 v[140:143], a[116:119], v[20:23], v[140:143]
    v_exp_f32 v212, v132
    v_mfma_f32_16x16x32_bf16 v[140:143], a[120:123], v[24:27], v[140:143]
    ds_read_b64_tr_b16 a[162:163], v224 offset:41984
    ds_read_b64_tr_b16 a[242:243], v241 offset:18432
    v_mfma_f32_16x16x32_bf16 v[140:143], a[124:127], v[28:31], v[140:143]
    v_exp_f32 v213, v133
    v_mfma_f32_16x16x32_bf16 a[32:35], a[128:131], v[164:167], a[32:35]
    ds_read_b64_tr_b16 a[164:165], v225 offset:40960
    v_cvt_pk_bf16_f32 v162, v212, v213
    v_mfma_f32_16x16x32_bf16 a[36:39], a[132:135], v[164:167], a[36:39]
    v_exp_f32 v214, v134
    v_mfma_f32_16x16x32_bf16 a[40:43], a[136:139], v[164:167], a[40:43]
    ds_read_b64_tr_b16 a[244:245], v242 offset:16384
    ds_read_b64_tr_b16 a[166:167], v225 offset:41984
    v_mfma_f32_16x16x32_bf16 a[44:47], a[140:143], v[164:167], a[44:47]
    v_exp_f32 v215, v135
    v_mfma_f32_16x16x32_bf16 a[48:51], a[144:147], v[164:167], a[48:51]
    ds_read_b64_tr_b16 a[246:247], v242 offset:18432
    v_cvt_pk_bf16_f32 v163, v214, v215
    v_mfma_f32_16x16x32_bf16 a[52:55], a[148:151], v[164:167], a[52:55]
    ds_read_b64_tr_b16 a[168:169], v226 offset:40960
    ds_read_b64_tr_b16 a[248:249], v243 offset:16384
    v_mfma_f32_16x16x32_bf16 a[56:59], a[152:155], v[164:167], a[56:59]
    v_exp_f32 v208, v136
    v_mfma_f32_16x16x32_bf16 a[60:63], a[156:159], v[164:167], a[60:63]
    ds_read_b64_tr_b16 a[170:171], v226 offset:41984
    ds_read_b64_tr_b16 a[250:251], v243 offset:18432
    v_mfma_f32_16x16x32_bf16 v[196:199], v[216:219], v[164:167], v[196:199]
    v_exp_f32 v209, v137
    v_mfma_f32_16x16x32_bf16 v[144:147], a[96:99], v[32:35], v[184:187]
    ds_read_b64_tr_b16 a[172:173], v227 offset:40960
    v_cvt_pk_bf16_f32 v164, v208, v209
    v_mfma_f32_16x16x32_bf16 v[144:147], a[100:103], v[36:39], v[144:147]
    v_exp_f32 v210, v138
    v_mfma_f32_16x16x32_bf16 v[144:147], a[104:107], v[40:43], v[144:147]
    ds_read_b64_tr_b16 a[252:253], v244 offset:16384
    ds_read_b64_tr_b16 a[174:175], v227 offset:41984
    v_mfma_f32_16x16x32_bf16 v[144:147], a[108:111], v[44:47], v[144:147]
    v_exp_f32 v211, v139
    v_mfma_f32_16x16x32_bf16 v[148:151], a[112:115], v[32:35], v[184:187]
    ds_read_b64_tr_b16 a[254:255], v244 offset:18432
    v_cvt_pk_bf16_f32 v165, v210, v211
    v_mfma_f32_16x16x32_bf16 v[148:151], a[116:119], v[36:39], v[148:151]
    s_add_u32 s61, s39, 110592
    s_add_u32 m0, s41, 32768
    v_exp_f32 v212, v140
    v_mfma_f32_16x16x32_bf16 v[148:151], a[120:123], v[40:43], v[148:151]
    ds_read_b64_tr_b16 a[176:177], v228 offset:40960
    buffer_load_dwordx4 v237, s[52:55], s61 offen offset:0  lds
    v_mfma_f32_16x16x32_bf16 v[148:151], a[124:127], v[44:47], v[148:151]
    v_exp_f32 v213, v141
    v_mfma_f32_16x16x32_bf16 v[64:67], a[128:131], v[168:171], v[64:67]
    ds_read_b64_tr_b16 a[178:179], v228 offset:41984
    v_cvt_pk_bf16_f32 v166, v212, v213
    v_mfma_f32_16x16x32_bf16 v[68:71], a[132:135], v[168:171], v[68:71]
    v_exp_f32 v214, v142
    v_mfma_f32_16x16x32_bf16 v[72:75], a[136:139], v[168:171], v[72:75]
    buffer_load_dwordx4 v238, s[52:55], s61 offen offset:1024  lds
    ds_read_b64_tr_b16 a[180:181], v229 offset:40960
    v_mfma_f32_16x16x32_bf16 v[76:79], a[140:143], v[168:171], v[76:79]
    v_exp_f32 v215, v143
    v_mfma_f32_16x16x32_bf16 v[80:83], a[144:147], v[168:171], v[80:83]
    buffer_load_dwordx4 v239, s[52:55], s61 offen offset:2048  lds
    v_cvt_pk_bf16_f32 v167, v214, v215
    v_mfma_f32_16x16x32_bf16 v[84:87], a[148:151], v[168:171], v[84:87]
    ds_read_b64_tr_b16 a[182:183], v229 offset:41984
    buffer_load_dwordx4 v240, s[52:55], s61 offen offset:3072  lds
    v_mfma_f32_16x16x32_bf16 v[88:91], a[152:155], v[168:171], v[88:91]
    s_add_u32 s61, s40, 0
    s_add_u32 m0, s41, 81920
    v_exp_f32 v208, v144
    v_mfma_f32_16x16x32_bf16 v[92:95], a[156:159], v[168:171], v[92:95]
    ds_read_b64_tr_b16 a[184:185], v230 offset:40960
    buffer_load_dwordx4 v237, s[12:15], s61 offen offset:0  lds
    v_mfma_f32_16x16x32_bf16 v[200:203], v[216:219], v[168:171], v[200:203]
    v_exp_f32 v209, v145
    v_mfma_f32_16x16x32_bf16 v[152:155], a[96:99], v[48:51], v[188:191]
    ds_read_b64_tr_b16 a[186:187], v230 offset:41984
    v_cvt_pk_bf16_f32 v168, v208, v209
    v_mfma_f32_16x16x32_bf16 v[152:155], a[100:103], v[52:55], v[152:155]
    v_exp_f32 v210, v146
    v_mfma_f32_16x16x32_bf16 v[152:155], a[104:107], v[56:59], v[152:155]
    buffer_load_dwordx4 v238, s[12:15], s61 offen offset:1024  lds
    v_mfma_f32_16x16x32_bf16 v[152:155], a[108:111], v[60:63], v[152:155]
    v_exp_f32 v211, v147
    v_mfma_f32_16x16x32_bf16 v[156:159], a[112:115], v[48:51], v[188:191]
    ds_read_b64_tr_b16 a[188:189], v231 offset:40960
    v_cvt_pk_bf16_f32 v169, v210, v211
    v_mfma_f32_16x16x32_bf16 v[156:159], a[116:119], v[52:55], v[156:159]
    v_exp_f32 v212, v148
    v_mfma_f32_16x16x32_bf16 v[156:159], a[120:123], v[56:59], v[156:159]
    buffer_load_dwordx4 v239, s[12:15], s61 offen offset:2048  lds
    v_mfma_f32_16x16x32_bf16 v[156:159], a[124:127], v[60:63], v[156:159]
    v_exp_f32 v213, v149
    v_mfma_f32_16x16x32_bf16 v[96:99], a[128:131], v[172:175], v[96:99]
    ds_read_b64_tr_b16 a[190:191], v231 offset:41984
    v_cvt_pk_bf16_f32 v170, v212, v213
    v_mfma_f32_16x16x32_bf16 v[100:103], a[132:135], v[172:175], v[100:103]
    v_exp_f32 v214, v150
    v_mfma_f32_16x16x32_bf16 v[104:107], a[136:139], v[172:175], v[104:107]
    buffer_load_dwordx4 v240, s[12:15], s61 offen offset:3072  lds
    v_mfma_f32_16x16x32_bf16 v[108:111], a[140:143], v[172:175], v[108:111]
    v_exp_f32 v215, v151
    v_mfma_f32_16x16x32_bf16 v[112:115], a[144:147], v[172:175], v[112:115]
    v_cvt_pk_bf16_f32 v171, v214, v215
    v_mfma_f32_16x16x32_bf16 v[116:119], a[148:151], v[172:175], v[116:119]
    v_mfma_f32_16x16x32_bf16 v[120:123], a[152:155], v[172:175], v[120:123]
    v_exp_f32 v208, v152
    v_mfma_f32_16x16x32_bf16 v[124:127], a[156:159], v[172:175], v[124:127]
    v_mfma_f32_16x16x32_bf16 v[204:207], v[216:219], v[172:175], v[204:207]
    v_exp_f32 v209, v153
    s_waitcnt lgkmcnt(15)
    v_mfma_f32_16x16x32_bf16 v[128:131], a[64:67], v[0:3], v[176:179]
    ds_read_b128 a[96:99], v220 offset:57344
    v_cvt_pk_bf16_f32 v172, v208, v209
    v_mfma_f32_16x16x32_bf16 v[128:131], a[68:71], v[4:7], v[128:131]
    s_add_u32 s61, s40, 36864
    s_add_u32 m0, s41, 0
    v_exp_f32 v210, v154
    v_mfma_f32_16x16x32_bf16 v[128:131], a[72:75], v[8:11], v[128:131]
    ds_read_b128 a[100:103], v221 offset:57344
    buffer_load_dwordx4 v237, s[12:15], s61 offen offset:0  lds
    v_mfma_f32_16x16x32_bf16 v[128:131], a[76:79], v[12:15], v[128:131]
    v_exp_f32 v211, v155
    v_mfma_f32_16x16x32_bf16 v[132:135], a[80:83], v[0:3], v[176:179]
    ds_read_b128 a[104:107], v222 offset:57344
    v_cvt_pk_bf16_f32 v173, v210, v211
    v_mfma_f32_16x16x32_bf16 v[132:135], a[84:87], v[4:7], v[132:135]
    v_exp_f32 v212, v156
    v_mfma_f32_16x16x32_bf16 v[132:135], a[88:91], v[8:11], v[132:135]
    ds_read_b128 a[108:111], v223 offset:57344
    ds_read_b128 a[112:115], v220 offset:58368
    v_mfma_f32_16x16x32_bf16 v[132:135], a[92:95], v[12:15], v[132:135]
    s_waitcnt lgkmcnt(5)
    v_exp_f32 v213, v157
    v_mfma_f32_16x16x32_bf16 a[0:3], a[160:163], v[160:163], a[0:3]
    buffer_load_dwordx4 v238, s[12:15], s61 offen offset:1024  lds
    v_cvt_pk_bf16_f32 v174, v212, v213
    v_mfma_f32_16x16x32_bf16 a[4:7], a[164:167], v[160:163], a[4:7]
    v_exp_f32 v214, v158
    v_mfma_f32_16x16x32_bf16 a[8:11], a[168:171], v[160:163], a[8:11]
    ds_read_b128 a[116:119], v221 offset:58368
    ds_read_b128 a[120:123], v222 offset:58368
    v_mfma_f32_16x16x32_bf16 a[12:15], a[172:175], v[160:163], a[12:15]
    v_exp_f32 v215, v159
    v_mfma_f32_16x16x32_bf16 a[16:19], a[176:179], v[160:163], a[16:19]
    ds_read_b128 a[124:127], v223 offset:58368
    v_cvt_pk_bf16_f32 v175, v214, v215
    v_mfma_f32_16x16x32_bf16 a[20:23], a[180:183], v[160:163], a[20:23]
    buffer_load_dwordx4 v239, s[12:15], s61 offen offset:2048  lds
    ds_read_b64_tr_b16 a[128:129], v224 offset:49152
    v_mfma_f32_16x16x32_bf16 a[24:27], a[184:187], v[160:163], a[24:27]
    v_exp_f32 v208, v128
    v_mfma_f32_16x16x32_bf16 a[28:31], a[188:191], v[160:163], a[28:31]
    ds_read_b64_tr_b16 a[130:131], v224 offset:50176
    v_mfma_f32_16x16x32_bf16 v[192:195], v[216:219], v[160:163], v[192:195]
    v_exp_f32 v209, v129
    v_mfma_f32_16x16x32_bf16 v[136:139], a[64:67], v[16:19], v[180:183]
    ds_read_b64_tr_b16 a[132:133], v225 offset:49152
    v_cvt_pk_bf16_f32 v160, v208, v209
    v_mfma_f32_16x16x32_bf16 v[136:139], a[68:71], v[20:23], v[136:139]
    v_exp_f32 v210, v130
    v_mfma_f32_16x16x32_bf16 v[136:139], a[72:75], v[24:27], v[136:139]
    buffer_load_dwordx4 v240, s[12:15], s61 offen offset:3072  lds
    v_mfma_f32_16x16x32_bf16 v[136:139], a[76:79], v[28:31], v[136:139]
    v_exp_f32 v211, v131
    v_mfma_f32_16x16x32_bf16 v[140:143], a[80:83], v[16:19], v[180:183]
    ds_read_b64_tr_b16 a[134:135], v225 offset:50176
    v_cvt_pk_bf16_f32 v161, v210, v211
    v_mfma_f32_16x16x32_bf16 v[140:143], a[84:87], v[20:23], v[140:143]
    s_add_u32 s61, s40, 0
    v_exp_f32 v212, v132
    v_mfma_f32_16x16x32_bf16 v[140:143], a[88:91], v[24:27], v[140:143]
    ds_read_b64_tr_b16 a[136:137], v226 offset:49152
    v_mfma_f32_16x16x32_bf16 v[140:143], a[92:95], v[28:31], v[140:143]
    s_add_u32 m0, s41, 16384
    v_exp_f32 v213, v133
    v_mfma_f32_16x16x32_bf16 a[32:35], a[160:163], v[164:167], a[32:35]
    ds_read_b64_tr_b16 a[138:139], v226 offset:50176
    v_cvt_pk_bf16_f32 v162, v212, v213
    v_mfma_f32_16x16x32_bf16 a[36:39], a[164:167], v[164:167], a[36:39]
    v_exp_f32 v214, v134
    v_mfma_f32_16x16x32_bf16 a[40:43], a[168:171], v[164:167], a[40:43]
    buffer_load_dwordx4 v237, s[52:55], s61 offen offset:0  lds
    v_mfma_f32_16x16x32_bf16 a[44:47], a[172:175], v[164:167], a[44:47]
    v_exp_f32 v215, v135
    v_mfma_f32_16x16x32_bf16 a[48:51], a[176:179], v[164:167], a[48:51]
    ds_read_b64_tr_b16 a[140:141], v227 offset:49152
    v_cvt_pk_bf16_f32 v163, v214, v215
    v_mfma_f32_16x16x32_bf16 a[52:55], a[180:183], v[164:167], a[52:55]
    ds_read_b64_tr_b16 a[142:143], v227 offset:50176
    v_mfma_f32_16x16x32_bf16 a[56:59], a[184:187], v[164:167], a[56:59]
    v_exp_f32 v208, v136
    v_mfma_f32_16x16x32_bf16 a[60:63], a[188:191], v[164:167], a[60:63]
    ds_read_b64_tr_b16 a[144:145], v228 offset:49152
    v_mfma_f32_16x16x32_bf16 v[196:199], v[216:219], v[164:167], v[196:199]
    v_exp_f32 v209, v137
    v_mfma_f32_16x16x32_bf16 v[144:147], a[64:67], v[32:35], v[184:187]
    buffer_load_dwordx4 v238, s[52:55], s61 offen offset:1024  lds
    v_cvt_pk_bf16_f32 v164, v208, v209
    v_mfma_f32_16x16x32_bf16 v[144:147], a[68:71], v[36:39], v[144:147]
    v_exp_f32 v210, v138
    v_mfma_f32_16x16x32_bf16 v[144:147], a[72:75], v[40:43], v[144:147]
    ds_read_b64_tr_b16 a[146:147], v228 offset:50176
    v_mfma_f32_16x16x32_bf16 v[144:147], a[76:79], v[44:47], v[144:147]
    v_exp_f32 v211, v139
    v_mfma_f32_16x16x32_bf16 v[148:151], a[80:83], v[32:35], v[184:187]
    ds_read_b64_tr_b16 a[148:149], v229 offset:49152
    v_cvt_pk_bf16_f32 v165, v210, v211
    v_mfma_f32_16x16x32_bf16 v[148:151], a[84:87], v[36:39], v[148:151]
    v_exp_f32 v212, v140
    v_mfma_f32_16x16x32_bf16 v[148:151], a[88:91], v[40:43], v[148:151]
    ds_read_b64_tr_b16 a[150:151], v229 offset:50176
    v_mfma_f32_16x16x32_bf16 v[148:151], a[92:95], v[44:47], v[148:151]
    v_exp_f32 v213, v141
    v_mfma_f32_16x16x32_bf16 v[64:67], a[160:163], v[168:171], v[64:67]
    buffer_load_dwordx4 v239, s[52:55], s61 offen offset:2048  lds
    v_cvt_pk_bf16_f32 v166, v212, v213
    v_mfma_f32_16x16x32_bf16 v[68:71], a[164:167], v[168:171], v[68:71]
    v_exp_f32 v214, v142
    v_mfma_f32_16x16x32_bf16 v[72:75], a[168:171], v[168:171], v[72:75]
    ds_read_b64_tr_b16 a[152:153], v230 offset:49152
    v_mfma_f32_16x16x32_bf16 v[76:79], a[172:175], v[168:171], v[76:79]
    v_exp_f32 v215, v143
    v_mfma_f32_16x16x32_bf16 v[80:83], a[176:179], v[168:171], v[80:83]
    ds_read_b64_tr_b16 a[154:155], v230 offset:50176
    v_cvt_pk_bf16_f32 v167, v214, v215
    v_mfma_f32_16x16x32_bf16 v[84:87], a[180:183], v[168:171], v[84:87]
    ds_read_b64_tr_b16 a[156:157], v231 offset:49152
    v_mfma_f32_16x16x32_bf16 v[88:91], a[184:187], v[168:171], v[88:91]
    v_exp_f32 v208, v144
    v_mfma_f32_16x16x32_bf16 v[92:95], a[188:191], v[168:171], v[92:95]
    buffer_load_dwordx4 v240, s[52:55], s61 offen offset:3072  lds
    v_mfma_f32_16x16x32_bf16 v[200:203], v[216:219], v[168:171], v[200:203]
    v_exp_f32 v209, v145
    v_mfma_f32_16x16x32_bf16 v[152:155], a[64:67], v[48:51], v[188:191]
    ds_read_b64_tr_b16 a[158:159], v231 offset:50176
    v_cvt_pk_bf16_f32 v168, v208, v209
    v_mfma_f32_16x16x32_bf16 v[152:155], a[68:71], v[52:55], v[152:155]
    v_exp_f32 v210, v146
    v_mfma_f32_16x16x32_bf16 v[152:155], a[72:75], v[56:59], v[152:155]
    v_mfma_f32_16x16x32_bf16 v[152:155], a[76:79], v[60:63], v[152:155]
    v_exp_f32 v211, v147
    v_mfma_f32_16x16x32_bf16 v[156:159], a[80:83], v[48:51], v[188:191]
    v_cvt_pk_bf16_f32 v169, v210, v211
    v_mfma_f32_16x16x32_bf16 v[156:159], a[84:87], v[52:55], v[156:159]
    v_exp_f32 v212, v148
    v_mfma_f32_16x16x32_bf16 v[156:159], a[88:91], v[56:59], v[156:159]
    v_mfma_f32_16x16x32_bf16 v[156:159], a[92:95], v[60:63], v[156:159]
    v_exp_f32 v213, v149
    v_mfma_f32_16x16x32_bf16 v[96:99], a[160:163], v[172:175], v[96:99]
    v_cvt_pk_bf16_f32 v170, v212, v213
    v_mfma_f32_16x16x32_bf16 v[100:103], a[164:167], v[172:175], v[100:103]
    v_exp_f32 v214, v150
    v_mfma_f32_16x16x32_bf16 v[104:107], a[168:171], v[172:175], v[104:107]
    v_mfma_f32_16x16x32_bf16 v[108:111], a[172:175], v[172:175], v[108:111]
    v_exp_f32 v215, v151
    v_mfma_f32_16x16x32_bf16 v[112:115], a[176:179], v[172:175], v[112:115]
    v_cvt_pk_bf16_f32 v171, v214, v215
    v_mfma_f32_16x16x32_bf16 v[116:119], a[180:183], v[172:175], v[116:119]
    v_mfma_f32_16x16x32_bf16 v[120:123], a[184:187], v[172:175], v[120:123]
    v_exp_f32 v208, v152
    v_mfma_f32_16x16x32_bf16 v[124:127], a[188:191], v[172:175], v[124:127]
    v_mfma_f32_16x16x32_bf16 v[204:207], v[216:219], v[172:175], v[204:207]
    v_exp_f32 v209, v153
    s_waitcnt lgkmcnt(0)
    s_barrier
    s_lshl_b32 s47, s3, 19
    s_lshl_b32 s50, s37, 12
    s_add_u32 s47, s47, s50
    v_lshlrev_b32 v254, 1, v236
    v_and_b32 v254, 0xe0, v254
    s_cmp_lg_u32 s3, 0
    s_cbranch_scc1 L_nochk
    buffer_load_dword v255, v254, s[8:11], 0 offen sc1
L_nochk:
    v_mfma_f32_16x16x32_bf16 v[128:131], a[96:99], v[0:3], v[176:179]
    ds_read_b64_tr_b16 a[160:161], v224 offset:57344
    v_exp_f32 v210, v154
    v_cvt_pk_bf16_f32 v172, v208, v209
    v_mfma_f32_16x16x32_bf16 v[128:131], a[100:103], v[4:7], v[128:131]
    s_add_u32 s61, s40, 36864
    s_add_u32 m0, s41, 49152
    s_nop 0
    buffer_load_dwordx4 v237, s[52:55], s61 offen offset:0  lds
    ds_read_b64_tr_b16 a[162:163], v224 offset:58368
    v_mfma_f32_16x16x32_bf16 v[128:131], a[104:107], v[8:11], v[128:131]
    v_exp_f32 v211, v155
    v_exp_f32 v212, v156
    v_mfma_f32_16x16x32_bf16 v[128:131], a[108:111], v[12:15], v[128:131]
    ds_read_b64_tr_b16 a[164:165], v225 offset:57344
    v_cvt_pk_bf16_f32 v173, v210, v211
    v_exp_f32 v213, v157
    v_mfma_f32_16x16x32_bf16 v[132:135], a[112:115], v[0:3], v[176:179]
    v_exp_f32 v214, v158
    v_cvt_pk_bf16_f32 v174, v212, v213
    v_mfma_f32_16x16x32_bf16 v[132:135], a[116:119], v[4:7], v[132:135]
    buffer_load_dwordx4 v238, s[52:55], s61 offen offset:1024  lds
    ds_read_b64_tr_b16 a[166:167], v225 offset:58368
    v_mfma_f32_16x16x32_bf16 v[132:135], a[120:123], v[8:11], v[132:135]
    ds_read_b64_tr_b16 a[168:169], v226 offset:57344
    v_exp_f32 v215, v159
    s_nop 0
    v_cvt_pk_bf16_f32 v175, v214, v215
    v_mfma_f32_16x16x32_bf16 v[132:135], a[124:127], v[12:15], v[132:135]
    v_mfma_f32_16x16x32_bf16 a[0:3], a[128:131], v[160:163], a[0:3]
    ds_read_b64_tr_b16 a[170:171], v226 offset:58368
    v_mfma_f32_16x16x32_bf16 a[4:7], a[132:135], v[160:163], a[4:7]
    buffer_load_dwordx4 v239, s[52:55], s61 offen offset:2048  lds
    v_mfma_f32_16x16x32_bf16 a[8:11], a[136:139], v[160:163], a[8:11]
    ds_read_b64_tr_b16 a[172:173], v227 offset:57344
    v_exp_f32 v208, v128
    v_mfma_f32_16x16x32_bf16 a[12:15], a[140:143], v[160:163], a[12:15]
    ds_read_b64_tr_b16 a[174:175], v227 offset:58368
    v_exp_f32 v209, v129
    v_mfma_f32_16x16x32_bf16 a[16:19], a[144:147], v[160:163], a[16:19]
    v_exp_f32 v210, v130
    v_mfma_f32_16x16x32_bf16 a[20:23], a[148:151], v[160:163], a[20:23]
    buffer_load_dwordx4 v240, s[52:55], s61 offen offset:3072  lds
    ds_read_b64_tr_b16 a[176:177], v228 offset:57344
    v_mfma_f32_16x16x32_bf16 a[24:27], a[152:155], v[160:163], a[24:27]
    v_mfma_f32_16x16x32_bf16 a[28:31], a[156:159], v[160:163], a[28:31]
    ds_read_b64_tr_b16 a[178:179], v228 offset:58368
    v_mfma_f32_16x16x32_bf16 v[192:195], v[216:219], v[160:163], v[192:195]
    v_mfma_f32_16x16x32_bf16 v[136:139], a[96:99], v[16:19], v[180:183]
    s_add_u32 s61, s40, 73728
    s_add_u32 m0, s41, 98304
    s_nop 0
    buffer_load_dwordx4 v237, s[12:15], s61 offen offset:0  lds
    ds_read_b64_tr_b16 a[180:181], v229 offset:57344
    v_cvt_pk_bf16_f32 v160, v208, v209
    v_mfma_f32_16x16x32_bf16 v[136:139], a[100:103], v[20:23], v[136:139]
    ds_read_b64_tr_b16 a[182:183], v229 offset:58368
    v_exp_f32 v211, v131
    v_mfma_f32_16x16x32_bf16 v[136:139], a[104:107], v[24:27], v[136:139]
    v_exp_f32 v212, v132
    v_cvt_pk_bf16_f32 v161, v210, v211
    v_mfma_f32_16x16x32_bf16 v[136:139], a[108:111], v[28:31], v[136:139]
    ds_read_b64_tr_b16 a[184:185], v230 offset:57344
    v_exp_f32 v213, v133
    v_mfma_f32_16x16x32_bf16 v[140:143], a[112:115], v[16:19], v[180:183]
    buffer_load_dwordx4 v238, s[12:15], s61 offen offset:1024  lds
    v_exp_f32 v214, v134
    v_cvt_pk_bf16_f32 v162, v212, v213
    v_mfma_f32_16x16x32_bf16 v[140:143], a[116:119], v[20:23], v[140:143]
    ds_read_b64_tr_b16 a[186:187], v230 offset:58368
    v_exp_f32 v215, v135
    s_nop 0
    v_cvt_pk_bf16_f32 v163, v214, v215
    v_mfma_f32_16x16x32_bf16 v[140:143], a[120:123], v[24:27], v[140:143]
    ds_read_b64_tr_b16 a[188:189], v231 offset:57344
    v_mfma_f32_16x16x32_bf16 v[140:143], a[124:127], v[28:31], v[140:143]
    v_mfma_f32_16x16x32_bf16 a[32:35], a[128:131], v[164:167], a[32:35]
    buffer_load_dwordx4 v239, s[12:15], s61 offen offset:2048  lds
    ds_read_b64_tr_b16 a[190:191], v231 offset:58368
    v_mfma_f32_16x16x32_bf16 a[36:39], a[132:135], v[164:167], a[36:39]
    v_mfma_f32_16x16x32_bf16 a[40:43], a[136:139], v[164:167], a[40:43]
    v_exp_f32 v208, v136
    v_exp_f32 v209, v137
    v_mfma_f32_16x16x32_bf16 a[44:47], a[140:143], v[164:167], a[44:47]
    v_exp_f32 v210, v138
    v_mfma_f32_16x16x32_bf16 a[48:51], a[144:147], v[164:167], a[48:51]
    buffer_load_dwordx4 v240, s[12:15], s61 offen offset:3072  lds
    v_mfma_f32_16x16x32_bf16 a[52:55], a[148:151], v[164:167], a[52:55]
    v_mfma_f32_16x16x32_bf16 a[56:59], a[152:155], v[164:167], a[56:59]
    v_mfma_f32_16x16x32_bf16 a[60:63], a[156:159], v[164:167], a[60:63]
    v_mfma_f32_16x16x32_bf16 v[196:199], v[216:219], v[164:167], v[196:199]
    s_waitcnt vmcnt(32)
    ds_read_b64_tr_b16 a[64:65], v245 offset:0
    s_waitcnt lgkmcnt(1)
    v_mfma_f32_16x16x32_bf16 a[0:3], a[160:163], v[160:163], a[0:3]
    ds_read_b64_tr_b16 a[66:67], v245 offset:2048
    v_cvt_pk_bf16_f32 v164, v208, v209
    v_exp_f32 v211, v139
    v_mfma_f32_16x16x32_bf16 a[4:7], a[164:167], v[160:163], a[4:7]
    ds_read_b64_tr_b16 a[68:69], v246 offset:0
    v_exp_f32 v212, v140
    v_cvt_pk_bf16_f32 v165, v210, v211
    v_mfma_f32_16x16x32_bf16 a[8:11], a[168:171], v[160:163], a[8:11]
    ds_read_b64_tr_b16 a[70:71], v246 offset:2048
    v_exp_f32 v213, v141
    v_mfma_f32_16x16x32_bf16 a[12:15], a[172:175], v[160:163], a[12:15]
    ds_read_b64_tr_b16 a[72:73], v247 offset:0
    v_exp_f32 v214, v142
    v_cvt_pk_bf16_f32 v166, v212, v213
    v_mfma_f32_16x16x32_bf16 a[16:19], a[176:179], v[160:163], a[16:19]
    ds_read_b64_tr_b16 a[74:75], v247 offset:2048
    v_exp_f32 v215, v143
    s_nop 0
    v_cvt_pk_bf16_f32 v167, v214, v215
    v_mfma_f32_16x16x32_bf16 a[20:23], a[180:183], v[160:163], a[20:23]
    ds_read_b64_tr_b16 a[76:77], v248 offset:0
    v_mfma_f32_16x16x32_bf16 a[24:27], a[184:187], v[160:163], a[24:27]
    ds_read_b64_tr_b16 a[78:79], v248 offset:2048
    v_mfma_f32_16x16x32_bf16 a[28:31], a[188:191], v[160:163], a[28:31]
    s_add_u32 s61, s40, 110592
    s_add_u32 m0, s41, 65536
    s_waitcnt lgkmcnt(0)
    buffer_load_dwordx4 v237, s[12:15], s61 offen offset:0  lds
    v_mfma_f32_16x16x32_bf16 v[192:195], v[216:219], v[160:163], v[192:195]
    v_mfma_f32_16x16x32_bf16 a[32:35], a[160:163], v[164:167], a[32:35]
    v_mfma_f32_16x16x32_bf16 a[36:39], a[164:167], v[164:167], a[36:39]
    buffer_load_dwordx4 v238, s[12:15], s61 offen offset:1024  lds
    v_mfma_f32_16x16x32_bf16 a[40:43], a[168:171], v[164:167], a[40:43]
    s_nop 3
    v_rcp_f32 v193, v192
    s_add_u32 s50, s47, 0
    v_accvgpr_read_b32 v176, a0
    v_accvgpr_read_b32 v177, a1
    v_mfma_f32_16x16x32_bf16 a[44:47], a[172:175], v[164:167], a[44:47]
    v_accvgpr_read_b32 v178, a2
    v_accvgpr_read_b32 v179, a3
    v_accvgpr_read_b32 v180, a4
    v_accvgpr_read_b32 v181, a5
    v_mfma_f32_16x16x32_bf16 a[48:51], a[176:179], v[164:167], a[48:51]
    buffer_load_dwordx4 v239, s[12:15], s61 offen offset:2048  lds
    v_accvgpr_read_b32 v182, a6
    v_accvgpr_read_b32 v183, a7
    v_mul_f32 v176, v193, v176
    v_mfma_f32_16x16x32_bf16 a[52:55], a[180:183], v[164:167], a[52:55]
    v_mul_f32 v177, v193, v177
    v_mul_f32 v178, v193, v178
    v_mul_f32 v179, v193, v179
    v_mul_f32 v180, v193, v180
    v_mfma_f32_16x16x32_bf16 a[56:59], a[184:187], v[164:167], a[56:59]
    v_mul_f32 v181, v193, v181
    v_mul_f32 v182, v193, v182
    v_mul_f32 v183, v193, v183
    v_cvt_pk_bf16_f32 v128, v176, v177
    v_mfma_f32_16x16x32_bf16 a[60:63], a[188:191], v[164:167], a[60:63]
    buffer_load_dwordx4 v240, s[12:15], s61 offen offset:3072  lds
    v_cvt_pk_bf16_f32 v129, v178, v179
    v_cvt_pk_bf16_f32 v130, v180, v181
    v_cvt_pk_bf16_f32 v131, v182, v183
    v_mfma_f32_16x16x32_bf16 v[196:199], v[216:219], v[164:167], v[196:199]
    buffer_store_dwordx4 v[128:131], v236, s[24:27], s50 offen offset:0 sc1
    v_accvgpr_read_b32 v176, a8
    v_accvgpr_read_b32 v177, a9
    v_accvgpr_read_b32 v178, a10
    v_mfma_f32_16x16x32_bf16 v[144:147], a[96:99], v[32:35], v[184:187]
    v_accvgpr_read_b32 v179, a11
    v_accvgpr_read_b32 v180, a12
    v_accvgpr_read_b32 v181, a13
    v_accvgpr_read_b32 v182, a14
    v_mfma_f32_16x16x32_bf16 v[144:147], a[100:103], v[36:39], v[144:147]
    s_waitcnt vmcnt(33)
    ds_read_b64_tr_b16 a[80:81], v249 offset:0
    v_accvgpr_read_b32 v183, a15
    v_mul_f32 v176, v193, v176
    v_mul_f32 v177, v193, v177
    v_mfma_f32_16x16x32_bf16 v[144:147], a[104:107], v[40:43], v[144:147]
    ds_read_b64_tr_b16 a[82:83], v249 offset:2048
    v_mul_f32 v178, v193, v178
    v_mul_f32 v179, v193, v179
    v_mul_f32 v180, v193, v180
    v_mfma_f32_16x16x32_bf16 v[144:147], a[108:111], v[44:47], v[144:147]
    ds_read_b64_tr_b16 a[84:85], v250 offset:0
    v_mul_f32 v181, v193, v181
    v_mul_f32 v182, v193, v182
    v_mul_f32 v183, v193, v183
    v_mfma_f32_16x16x32_bf16 v[148:151], a[112:115], v[32:35], v[184:187]
    ds_read_b64_tr_b16 a[86:87], v250 offset:2048
    v_cvt_pk_bf16_f32 v132, v176, v177
    v_cvt_pk_bf16_f32 v133, v178, v179
    v_cvt_pk_bf16_f32 v134, v180, v181
    v_mfma_f32_16x16x32_bf16 v[148:151], a[116:119], v[36:39], v[148:151]
    ds_read_b64_tr_b16 a[88:89], v251 offset:0
    v_cvt_pk_bf16_f32 v135, v182, v183
    buffer_store_dwordx4 v[132:135], v236, s[24:27], s50 offen offset:1024 sc1
    v_accvgpr_read_b32 v176, a16
    v_mfma_f32_16x16x32_bf16 v[148:151], a[120:123], v[40:43], v[148:151]
    ds_read_b64_tr_b16 a[90:91], v251 offset:2048
    v_accvgpr_read_b32 v177, a17
    v_accvgpr_read_b32 v178, a18
    v_accvgpr_read_b32 v179, a19
    v_mfma_f32_16x16x32_bf16 v[148:151], a[124:127], v[44:47], v[148:151]
    ds_read_b64_tr_b16 a[92:93], v252 offset:0
    v_accvgpr_read_b32 v180, a20
    v_accvgpr_read_b32 v181, a21
    v_accvgpr_read_b32 v182, a22
    v_mfma_f32_16x16x32_bf16 v[64:67], a[128:131], v[168:171], v[64:67]
    ds_read_b64_tr_b16 a[94:95], v252 offset:2048
    v_accvgpr_read_b32 v183, a23
    v_mul_f32 v176, v193, v176
    v_mul_f32 v177, v193, v177
    v_mfma_f32_16x16x32_bf16 v[68:71], a[132:135], v[168:171], v[68:71]
    s_waitcnt vmcnt(30)
    ds_read_b64_tr_b16 v[0:1], v249 offset:16384
    v_mul_f32 v178, v193, v178
    v_mul_f32 v179, v193, v179
    v_mul_f32 v180, v193, v180
    v_mfma_f32_16x16x32_bf16 v[72:75], a[136:139], v[168:171], v[72:75]
    ds_read_b64_tr_b16 v[2:3], v249 offset:18432
    v_mul_f32 v181, v193, v181
    v_mul_f32 v182, v193, v182
    v_mul_f32 v183, v193, v183
    v_mfma_f32_16x16x32_bf16 v[76:79], a[140:143], v[168:171], v[76:79]
    ds_read_b64_tr_b16 v[4:5], v250 offset:16384
    v_cvt_pk_bf16_f32 v128, v176, v177
    v_cvt_pk_bf16_f32 v129, v178, v179
    v_cvt_pk_bf16_f32 v130, v180, v181
    v_mfma_f32_16x16x32_bf16 v[80:83], a[144:147], v[168:171], v[80:83]
    ds_read_b64_tr_b16 v[6:7], v250 offset:18432
    v_cvt_pk_bf16_f32 v131, v182, v183
    buffer_store_dwordx4 v[128:131], v236, s[24:27], s50 offen offset:2048 sc1
    v_accvgpr_read_b32 v176, a24
    v_mfma_f32_16x16x32_bf16 v[84:87], a[148:151], v[168:171], v[84:87]
    ds_read_b64_tr_b16 v[8:9], v251 offset:16384
    v_accvgpr_read_b32 v177, a25
    v_accvgpr_read_b32 v178, a26
    v_accvgpr_read_b32 v179, a27
    v_mfma_f32_16x16x32_bf16 v[88:91], a[152:155], v[168:171], v[88:91]
    ds_read_b64_tr_b16 v[10:11], v251 offset:18432
    v_accvgpr_read_b32 v180, a28
    v_accvgpr_read_b32 v181, a29
    v_accvgpr_read_b32 v182, a30
    v_mfma_f32_16x16x32_bf16 v[92:95], a[156:159], v[168:171], v[92:95]
    ds_read_b64_tr_b16 v[12:13], v252 offset:16384
    v_accvgpr_read_b32 v183, a31
    v_mul_f32 v176, v193, v176
    v_mul_f32 v177, v193, v177
    v_mfma_f32_16x16x32_bf16 v[200:203], v[216:219], v[168:171], v[200:203]
    ds_read_b64_tr_b16 v[14:15], v252 offset:18432
    v_mul_f32 v178, v193, v178
    v_mul_f32 v179, v193, v179
    v_mul_f32 v180, v193, v180
    v_mfma_f32_16x16x32_bf16 v[152:155], a[96:99], v[48:51], v[188:191]
    s_waitcnt vmcnt(27)
    ds_read_b64_tr_b16 v[16:17], v241 offset:32768
    v_mul_f32 v181, v193, v181
    v_mul_f32 v182, v193, v182
    v_mul_f32 v183, v193, v183
    v_mfma_f32_16x16x32_bf16 v[152:155], a[100:103], v[52:55], v[152:155]
    ds_read_b64_tr_b16 v[18:19], v241 offset:34816
    v_cvt_pk_bf16_f32 v132, v176, v177
    v_cvt_pk_bf16_f32 v133, v178, v179
    v_cvt_pk_bf16_f32 v134, v180, v181
    v_mfma_f32_16x16x32_bf16 v[152:155], a[104:107], v[56:59], v[152:155]
    ds_read_b64_tr_b16 v[20:21], v242 offset:32768
    v_cvt_pk_bf16_f32 v135, v182, v183
    buffer_store_dwordx4 v[132:135], v236, s[24:27], s50 offen offset:3072 sc1
    v_rcp_f32 v197, v196
    v_mfma_f32_16x16x32_bf16 v[152:155], a[108:111], v[60:63], v[152:155]
    ds_read_b64_tr_b16 v[22:23], v242 offset:34816
    s_add_u32 s50, s47, 131072
    v_accvgpr_read_b32 v176, a32
    v_accvgpr_read_b32 v177, a33
    v_mfma_f32_16x16x32_bf16 v[156:159], a[112:115], v[48:51], v[188:191]
    ds_read_b64_tr_b16 v[24:25], v243 offset:32768
    v_accvgpr_read_b32 v178, a34
    v_accvgpr_read_b32 v179, a35
    v_accvgpr_read_b32 v180, a36
    v_mfma_f32_16x16x32_bf16 v[156:159], a[116:119], v[52:55], v[156:159]
    ds_read_b64_tr_b16 v[26:27], v243 offset:34816
    v_accvgpr_read_b32 v181, a37
    v_accvgpr_read_b32 v182, a38
    v_accvgpr_read_b32 v183, a39
    v_mfma_f32_16x16x32_bf16 v[156:159], a[120:123], v[56:59], v[156:159]
    ds_read_b64_tr_b16 v[28:29], v244 offset:32768
    v_mul_f32 v176, v197, v176
    v_mul_f32 v177, v197, v177
    v_mul_f32 v178, v197, v178
    v_mfma_f32_16x16x32_bf16 v[156:159], a[124:127], v[60:63], v[156:159]
    ds_read_b64_tr_b16 v[30:31], v244 offset:34816
    v_mul_f32 v179, v197, v179
    v_mul_f32 v180, v197, v180
    v_mul_f32 v181, v197, v181
    v_mfma_f32_16x16x32_bf16 v[96:99], a[128:131], v[172:175], v[96:99]
    s_waitcnt vmcnt(24)
    ds_read_b64_tr_b16 v[32:33], v245 offset:16384
    v_mul_f32 v182, v197, v182
    v_mul_f32 v183, v197, v183
    v_cvt_pk_bf16_f32 v128, v176, v177
    v_mfma_f32_16x16x32_bf16 v[100:103], a[132:135], v[172:175], v[100:103]
    ds_read_b64_tr_b16 v[34:35], v245 offset:18432
    v_cvt_pk_bf16_f32 v129, v178, v179
    v_cvt_pk_bf16_f32 v130, v180, v181
    v_cvt_pk_bf16_f32 v131, v182, v183
    v_mfma_f32_16x16x32_bf16 v[104:107], a[136:139], v[172:175], v[104:107]
    ds_read_b64_tr_b16 v[36:37], v246 offset:16384
    buffer_store_dwordx4 v[128:131], v236, s[24:27], s50 offen offset:0 sc1
    v_accvgpr_read_b32 v176, a40
    v_accvgpr_read_b32 v177, a41
    v_mfma_f32_16x16x32_bf16 v[108:111], a[140:143], v[172:175], v[108:111]
    ds_read_b64_tr_b16 v[38:39], v246 offset:18432
    v_accvgpr_read_b32 v178, a42
    v_accvgpr_read_b32 v179, a43
    v_accvgpr_read_b32 v180, a44
    v_mfma_f32_16x16x32_bf16 v[112:115], a[144:147], v[172:175], v[112:115]
    ds_read_b64_tr_b16 v[40:41], v247 offset:16384
    v_accvgpr_read_b32 v181, a45
    v_accvgpr_read_b32 v182, a46
    v_accvgpr_read_b32 v183, a47
    v_mfma_f32_16x16x32_bf16 v[116:119], a[148:151], v[172:175], v[116:119]
    ds_read_b64_tr_b16 v[42:43], v247 offset:18432
    v_mul_f32 v176, v197, v176
    v_mul_f32 v177, v197, v177
    v_mul_f32 v178, v197, v178
    v_mfma_f32_16x16x32_bf16 v[120:123], a[152:155], v[172:175], v[120:123]
    ds_read_b64_tr_b16 v[44:45], v248 offset:16384
    v_mul_f32 v179, v197, v179
    v_mul_f32 v180, v197, v180
    v_mul_f32 v181, v197, v181
    v_mfma_f32_16x16x32_bf16 v[124:127], a[156:159], v[172:175], v[124:127]
    ds_read_b64_tr_b16 v[46:47], v248 offset:18432
    v_mul_f32 v182, v197, v182
    v_mul_f32 v183, v197, v183
    v_cvt_pk_bf16_f32 v132, v176, v177
    v_mfma_f32_16x16x32_bf16 v[204:207], v[216:219], v[172:175], v[204:207]
    s_waitcnt vmcnt(21)
    ds_read_b64_tr_b16 v[48:49], v241 offset:0
    v_cvt_pk_bf16_f32 v133, v178, v179
    v_cvt_pk_bf16_f32 v134, v180, v181
    v_cvt_pk_bf16_f32 v135, v182, v183
    buffer_store_dwordx4 v[132:135], v236, s[24:27], s50 offen offset:1024 sc1
    v_accvgpr_read_b32 v176, a48
    v_accvgpr_read_b32 v177, a49
    v_accvgpr_read_b32 v178, a50
    v_accvgpr_read_b32 v179, a51
    v_accvgpr_read_b32 v180, a52
    v_accvgpr_read_b32 v181, a53
    v_accvgpr_read_b32 v182, a54
    v_accvgpr_read_b32 v183, a55
    v_mul_f32 v176, v197, v176
    v_mul_f32 v177, v197, v177
    v_mul_f32 v178, v197, v178
    v_mul_f32 v179, v197, v179
    v_mul_f32 v180, v197, v180
    v_mul_f32 v181, v197, v181
    v_mul_f32 v182, v197, v182
    v_mul_f32 v183, v197, v183
    v_cvt_pk_bf16_f32 v128, v176, v177
    v_cvt_pk_bf16_f32 v129, v178, v179
    v_cvt_pk_bf16_f32 v130, v180, v181
    v_cvt_pk_bf16_f32 v131, v182, v183
    buffer_store_dwordx4 v[128:131], v236, s[24:27], s50 offen offset:2048 sc1
    v_accvgpr_read_b32 v176, a56
    v_accvgpr_read_b32 v177, a57
    v_accvgpr_read_b32 v178, a58
    v_accvgpr_read_b32 v179, a59
    v_accvgpr_read_b32 v180, a60
    v_accvgpr_read_b32 v181, a61
    v_accvgpr_read_b32 v182, a62
    v_accvgpr_read_b32 v183, a63
    v_mul_f32 v176, v197, v176
    v_mul_f32 v177, v197, v177
    v_mul_f32 v178, v197, v178
    v_mul_f32 v179, v197, v179
    v_mul_f32 v180, v197, v180
    v_mul_f32 v181, v197, v181
    v_mul_f32 v182, v197, v182
    v_mul_f32 v183, v197, v183
    v_cvt_pk_bf16_f32 v132, v176, v177
    v_cvt_pk_bf16_f32 v133, v178, v179
    v_cvt_pk_bf16_f32 v134, v180, v181
    v_cvt_pk_bf16_f32 v135, v182, v183
    buffer_store_dwordx4 v[132:135], v236, s[24:27], s50 offen offset:3072 sc1
    v_exp_f32 v208, v144
    v_exp_f32 v209, v145
    v_exp_f32 v210, v146
    v_cvt_pk_bf16_f32 v168, v208, v209
    v_exp_f32 v211, v147
    v_exp_f32 v212, v148
    v_cvt_pk_bf16_f32 v169, v210, v211
    v_exp_f32 v213, v149
    v_exp_f32 v214, v150
    v_cvt_pk_bf16_f32 v170, v212, v213
    v_exp_f32 v215, v151
    s_nop 0
    v_cvt_pk_bf16_f32 v171, v214, v215
    s_nop 1
    v_mfma_f32_16x16x32_bf16 v[64:67], a[160:163], v[168:171], v[64:67]
    ds_read_b64_tr_b16 v[50:51], v241 offset:2048
    v_exp_f32 v208, v152
    v_mfma_f32_16x16x32_bf16 v[68:71], a[164:167], v[168:171], v[68:71]
    ds_read_b64_tr_b16 v[52:53], v242 offset:0
    v_exp_f32 v209, v153
    v_mfma_f32_16x16x32_bf16 v[72:75], a[168:171], v[168:171], v[72:75]
    ds_read_b64_tr_b16 v[54:55], v242 offset:2048
    v_exp_f32 v210, v154
    v_cvt_pk_bf16_f32 v172, v208, v209
    v_mfma_f32_16x16x32_bf16 v[76:79], a[172:175], v[168:171], v[76:79]
    ds_read_b64_tr_b16 v[56:57], v243 offset:0
    v_exp_f32 v211, v155
    v_mfma_f32_16x16x32_bf16 v[80:83], a[176:179], v[168:171], v[80:83]
    ds_read_b64_tr_b16 v[58:59], v243 offset:2048
    v_exp_f32 v212, v156
    v_cvt_pk_bf16_f32 v173, v210, v211
    v_mfma_f32_16x16x32_bf16 v[84:87], a[180:183], v[168:171], v[84:87]
    ds_read_b64_tr_b16 v[60:61], v244 offset:0
    v_exp_f32 v213, v157
    v_mfma_f32_16x16x32_bf16 v[88:91], a[184:187], v[168:171], v[88:91]
    ds_read_b64_tr_b16 v[62:63], v244 offset:2048
    v_exp_f32 v214, v158
    v_cvt_pk_bf16_f32 v174, v212, v213
    v_mfma_f32_16x16x32_bf16 v[92:95], a[188:191], v[168:171], v[92:95]
    s_waitcnt vmcnt(20)
    ds_read_b64_tr_b16 a[96:97], v241 offset:16384
    v_exp_f32 v215, v159
    s_nop 0
    v_cvt_pk_bf16_f32 v175, v214, v215
    v_mfma_f32_16x16x32_bf16 v[200:203], v[216:219], v[168:171], v[200:203]
    ds_read_b64_tr_b16 a[98:99], v241 offset:18432
    v_mfma_f32_16x16x32_bf16 v[96:99], a[160:163], v[172:175], v[96:99]
    ds_read_b64_tr_b16 a[100:101], v242 offset:16384
    v_mfma_f32_16x16x32_bf16 v[100:103], a[164:167], v[172:175], v[100:103]
    ds_read_b64_tr_b16 a[102:103], v242 offset:18432
    v_mfma_f32_16x16x32_bf16 v[104:107], a[168:171], v[172:175], v[104:107]
    ds_read_b64_tr_b16 a[104:105], v243 offset:16384
    s_nop 0
    v_rcp_f32 v201, v200
    s_add_u32 s50, s47, 262144
    v_mul_f32 v64, v201, v64
    v_mfma_f32_16x16x32_bf16 v[108:111], a[172:175], v[172:175], v[108:111]
    ds_read_b64_tr_b16 a[106:107], v243 offset:18432
    v_mul_f32 v65, v201, v65
    v_mul_f32 v66, v201, v66
    v_mul_f32 v67, v201, v67
    v_mfma_f32_16x16x32_bf16 v[112:115], a[176:179], v[172:175], v[112:115]
    ds_read_b64_tr_b16 a[108:109], v244 offset:16384
    v_mul_f32 v68, v201, v68
    v_mul_f32 v69, v201, v69
    v_mul_f32 v70, v201, v70
    v_mfma_f32_16x16x32_bf16 v[116:119], a[180:183], v[172:175], v[116:119]
    ds_read_b64_tr_b16 a[110:111], v244 offset:18432
    v_mul_f32 v71, v201, v71
    v_cvt_pk_bf16_f32 v128, v64, v65
    v_cvt_pk_bf16_f32 v129, v66, v67
    v_mfma_f32_16x16x32_bf16 v[120:123], a[184:187], v[172:175], v[120:123]
    s_waitcnt vmcnt(16)
    ds_read_b64_tr_b16 a[112:113], v241 offset:49152
    v_cvt_pk_bf16_f32 v130, v68, v69
    v_cvt_pk_bf16_f32 v131, v70, v71
    buffer_store_dwordx4 v[128:131], v236, s[24:27], s50 offen offset:0 sc1
    v_mfma_f32_16x16x32_bf16 v[124:127], a[188:191], v[172:175], v[124:127]
    ds_read_b64_tr_b16 a[114:115], v241 offset:51200
    v_mul_f32 v72, v201, v72
    v_mul_f32 v73, v201, v73
    v_mul_f32 v74, v201, v74
    v_mfma_f32_16x16x32_bf16 v[204:207], v[216:219], v[172:175], v[204:207]
    ds_read_b64_tr_b16 a[116:117], v242 offset:49152
    v_mul_f32 v75, v201, v75
    v_mul_f32 v76, v201, v76
    v_mul_f32 v77, v201, v77
    v_mul_f32 v78, v201, v78
    v_mul_f32 v79, v201, v79
    v_cvt_pk_bf16_f32 v132, v72, v73
    v_cvt_pk_bf16_f32 v133, v74, v75
    v_cvt_pk_bf16_f32 v134, v76, v77
    v_cvt_pk_bf16_f32 v135, v78, v79
    buffer_store_dwordx4 v[132:135], v236, s[24:27], s50 offen offset:1024 sc1
    v_mul_f32 v80, v201, v80
    v_mul_f32 v81, v201, v81
    v_mul_f32 v82, v201, v82
    v_mul_f32 v83, v201, v83
    v_mul_f32 v84, v201, v84
    v_mul_f32 v85, v201, v85
    v_mul_f32 v86, v201, v86
    v_mul_f32 v87, v201, v87
    v_cvt_pk_bf16_f32 v128, v80, v81
    v_cvt_pk_bf16_f32 v129, v82, v83
    v_cvt_pk_bf16_f32 v130, v84, v85
    v_cvt_pk_bf16_f32 v131, v86, v87
    buffer_store_dwordx4 v[128:131], v236, s[24:27], s50 offen offset:2048 sc1
    v_mul_f32 v88, v201, v88
    v_mul_f32 v89, v201, v89
    v_mul_f32 v90, v201, v90
    v_mul_f32 v91, v201, v91
    v_mul_f32 v92, v201, v92
    v_mul_f32 v93, v201, v93
    v_mul_f32 v94, v201, v94
    v_mul_f32 v95, v201, v95
    v_cvt_pk_bf16_f32 v132, v88, v89
    v_cvt_pk_bf16_f32 v133, v90, v91
    v_cvt_pk_bf16_f32 v134, v92, v93
    v_cvt_pk_bf16_f32 v135, v94, v95
    buffer_store_dwordx4 v[132:135], v236, s[24:27], s50 offen offset:3072 sc1
    v_rcp_f32 v205, v204
    v_subrev_u32 v194, 0x3a800000, v192
    v_subrev_u32 v198, 0x3a800000, v196
    v_subrev_u32 v202, 0x3a800000, v200
    v_subrev_u32 v206, 0x3a800000, v204
    v_max3_u32 v194, v194, v198, v202
    v_max_u32 v194, v194, v206
    v_cmp_lt_u32 vcc, 0x15000000, v194
    s_lshl_b32 s58, s3, 2
    s_add_u32 s58, s58, 114688
    v_mov_b32 v195, s58
    s_cmp_lg_u64 vcc, 0
    s_cselect_b32 s58, 1, 0
    v_mov_b32 v194, s58
    ds_write_b32 v195, v194
    v_mov_b32 v199, 114688
    s_add_u32 s50, s47, 393216
    v_mul_f32 v96, v205, v96
    v_mul_f32 v97, v205, v97
    v_mul_f32 v98, v205, v98
    v_mul_f32 v99, v205, v99
    v_mul_f32 v100, v205, v100
    v_mul_f32 v101, v205, v101
    v_mul_f32 v102, v205, v102
    v_mul_f32 v103, v205, v103
    v_cvt_pk_bf16_f32 v128, v96, v97
    v_cvt_pk_bf16_f32 v129, v98, v99
    v_cvt_pk_bf16_f32 v130, v100, v101
    v_cvt_pk_bf16_f32 v131, v102, v103
    buffer_store_dwordx4 v[128:131], v236, s[24:27], s50 offen offset:0 sc1
    v_mul_f32 v104, v205, v104
    v_mul_f32 v105, v205, v105
    v_mul_f32 v106, v205, v106
    v_mul_f32 v107, v205, v107
    v_mul_f32 v108, v205, v108
    v_mul_f32 v109, v205, v109
    v_mul_f32 v110, v205, v110
    v_mul_f32 v111, v205, v111
    v_cvt_pk_bf16_f32 v132, v104, v105
    v_cvt_pk_bf16_f32 v133, v106, v107
    v_cvt_pk_bf16_f32 v134, v108, v109
    v_cvt_pk_bf16_f32 v135, v110, v111
    s_waitcnt lgkmcnt(0)
    s_barrier
    ds_read_b128 v[208:211], v199
    buffer_store_dwordx4 v[132:135], v236, s[24:27], s50 offen offset:1024 sc1
    v_mul_f32 v112, v205, v112
    v_mul_f32 v113, v205, v113
    v_mul_f32 v114, v205, v114
    v_mul_f32 v115, v205, v115
    v_mul_f32 v116, v205, v116
    v_mul_f32 v117, v205, v117
    v_mul_f32 v118, v205, v118
    v_mul_f32 v119, v205, v119
    v_cvt_pk_bf16_f32 v128, v112, v113
    v_cvt_pk_bf16_f32 v129, v114, v115
    v_cvt_pk_bf16_f32 v130, v116, v117
    v_cvt_pk_bf16_f32 v131, v118, v119
    buffer_store_dwordx4 v[128:131], v236, s[24:27], s50 offen offset:2048 sc1
    v_mul_f32 v120, v205, v120
    v_mul_f32 v121, v205, v121
    v_mul_f32 v122, v205, v122
    v_mul_f32 v123, v205, v123
    v_mul_f32 v124, v205, v124
    v_mul_f32 v125, v205, v125
    v_mul_f32 v126, v205, v126
    v_mul_f32 v127, v205, v127
    v_cvt_pk_bf16_f32 v132, v120, v121
    v_cvt_pk_bf16_f32 v133, v122, v123
    v_cvt_pk_bf16_f32 v134, v124, v125
    v_cvt_pk_bf16_f32 v135, v126, v127
    buffer_store_dwordx4 v[132:135], v236, s[24:27], s50 offen offset:3072 sc1
    s_waitcnt lgkmcnt(0)
    v_or3_b32 v208, v208, v209, v210
    v_or_b32 v208, v208, v211
    s_nop 0
    v_readfirstlane_b32 s49, v208
    ds_read_b64_tr_b16 a[118:119], v242 offset:51200
    ds_read_b64_tr_b16 a[120:121], v243 offset:49152
    ds_read_b64_tr_b16 a[122:123], v243 offset:51200
    ds_read_b64_tr_b16 a[124:125], v244 offset:49152
    ds_read_b64_tr_b16 a[126:127], v244 offset:51200
    s_waitcnt vmcnt(20)
    ds_read_b64_tr_b16 a[128:129], v245 offset:32768
    ds_read_b64_tr_b16 a[130:131], v245 offset:34816
    ds_read_b64_tr_b16 a[132:133], v246 offset:32768
    ds_read_b64_tr_b16 a[134:135], v246 offset:34816
    ds_read_b64_tr_b16 a[136:137], v247 offset:32768
    ds_read_b64_tr_b16 a[138:139], v247 offset:34816
    ds_read_b64_tr_b16 a[140:141], v248 offset:32768
    ds_read_b64_tr_b16 a[142:143], v248 offset:34816
    s_waitcnt vmcnt(16)
    ds_read_b64_tr_b16 a[144:145], v245 offset:0
    ds_read_b64_tr_b16 a[146:147], v245 offset:2048
    ds_read_b64_tr_b16 a[148:149], v246 offset:0
    ds_read_b64_tr_b16 a[150:151], v246 offset:2048
    ds_read_b64_tr_b16 a[152:153], v247 offset:0
    ds_read_b64_tr_b16 a[154:155], v247 offset:2048
    ds_read_b64_tr_b16 a[156:157], v248 offset:0
    ds_read_b64_tr_b16 a[158:159], v248 offset:2048
L_join:
    s_mul_i32 s58, s56, 15
    s_mul_i32 s59, s28, 5
    s_add_u32 s58, s58, s59
    s_lshl_b32 s58, s58, 17
    s_add_u32 s16, s98, s58
    s_addc_u32 s17, s99, 0
    s_mov_b32 s18, 655360
    s_mul_i32 s58, s56, 240
    s_mul_i32 s59, s28, 80
    s_add_u32 s58, s58, s59
    s_mul_i32 s58, s58, 1152
    s_lshl_b32 s59, s29, 7
    s_add_u32 s58, s58, s59
    s_add_u32 s20, s34, s58
    s_addc_u32 s21, s35, 0
    s_sub_u32 s22, 2211840, s58
    s_cmp_lg_u32 s54, 0
    s_cselect_b32 s22, s22, 0
    s_xor_b32 s58, s30, 0
    s_lshl_b32 s44, s58, 12
    s_xor_b32 s58, s30, 4
    s_lshl_b32 s45, s58, 12
    s_xor_b32 s58, s30, 8
    s_lshl_b32 s46, s58, 12
    s_xor_b32 s58, s30, 12
    s_lshl_b32 s48, s58, 12
    s_add_u32 s63, s60, 163840
    s_sub_u32 s58, s60, 163840
    s_bitcmp1_b32 s57, 0
    s_cselect_b32 s63, s58, s63
    s_xor_b32 s38, s62, 512
    s_mul_i32 s59, s56, 0x1100
    s_and_b32 s58, s57, 1
    s_lshl_b32 s58, s58, 6
    s_add_u32 s59, s59, s58
    v_lshrrev_b32 v229, 2, v236
    v_and_b32 v229, 0x3c, v229
    v_add_u32 v229, s59, v229
    s_lshl_b32 s58, s3, 10
    v_add_u32 v224, s58, v236
    v_add_u32 v225, 0x10000, v224
    v_lshrrev_b32 v144, 8, v236
    v_lshrrev_b32 v145, 4, v236
    v_and_b32 v146, 12, v145
    v_add_u32 v144, v144, v146
    v_mul_u32_u24 v144, 1152, v144
    v_and_b32 v145, 3, v145
    v_lshl_add_u32 v226, v145, 3, v144
    s_cmp_gt_u32 s49, s100
    s_cbranch_scc1 L_redo
    s_waitcnt vmcnt(0) lgkmcnt(0)
    s_barrier
    s_cmp_lg_u32 s3, 0
    s_cbranch_scc1 L_nosig
    s_mov_b64 exec, 1
    buffer_store_dword v253, off, s[4:7], s31 sc1
    s_mov_b64 exec, -1
L_nosig:
    s_cmp_ge_u32 s57, 30
    s_cbranch_scc1 L_done
    s_add_u32 s61, s40, 73728
    s_add_u32 m0, s41, 131072
    s_nop 0
    buffer_load_dwordx4 v237, s[52:55], s61 offen offset:0  lds
    buffer_load_dwordx4 v238, s[52:55], s61 offen offset:1024  lds
    buffer_load_dwordx4 v239, s[52:55], s61 offen offset:2048  lds
    buffer_load_dwordx4 v240, s[52:55], s61 offen offset:3072  lds
    s_add_u32 s61, s40, 110592
    s_add_u32 m0, s41, 147456
    s_nop 0
    buffer_load_dwordx4 v237, s[52:55], s61 offen offset:0  lds
    buffer_load_dwordx4 v238, s[52:55], s61 offen offset:1024  lds
    buffer_load_dwordx4 v239, s[52:55], s61 offen offset:2048  lds
    buffer_load_dwordx4 v240, s[52:55], s61 offen offset:3072  lds
    s_add_u32 s61, s42, 0
    s_add_u32 m0, s41, 32768
    s_nop 0
    buffer_load_dwordx4 v237, s[12:15], s61 offen offset:0  lds
    buffer_load_dwordx4 v238, s[12:15], s61 offen offset:1024  lds
    buffer_load_dwordx4 v239, s[12:15], s61 offen offset:2048  lds
    buffer_load_dwordx4 v240, s[12:15], s61 offen offset:3072  lds
    s_add_u32 s61, s42, 36864
    s_add_u32 m0, s41, 81920
    s_nop 0
    buffer_load_dwordx4 v237, s[12:15], s61 offen offset:0  lds
    buffer_load_dwordx4 v238, s[12:15], s61 offen offset:1024  lds
    buffer_load_dwordx4 v239, s[12:15], s61 offen offset:2048  lds
    buffer_load_dwordx4 v240, s[12:15], s61 offen offset:3072  lds
    s_add_u32 s61, s42, 73728
    s_add_u32 m0, s41, 0
    s_nop 0
    buffer_load_dwordx4 v237, s[12:15], s61 offen offset:0  lds
    buffer_load_dwordx4 v238, s[12:15], s61 offen offset:1024  lds
    buffer_load_dwordx4 v239, s[12:15], s61 offen offset:2048  lds
    buffer_load_dwordx4 v240, s[12:15], s61 offen offset:3072  lds
    s_add_u32 s61, s42, 110592
    s_add_u32 m0, s41, 16384
    s_nop 0
    buffer_load_dwordx4 v237, s[12:15], s61 offen offset:0  lds
    buffer_load_dwordx4 v238, s[12:15], s61 offen offset:1024  lds
    buffer_load_dwordx4 v239, s[12:15], s61 offen offset:2048  lds
    buffer_load_dwordx4 v240, s[12:15], s61 offen offset:3072  lds
    s_mov_b32 s50, 0
    s_cmp_lg_u32 s3, 0
    s_cbranch_scc1 L_nopoll
L_poll0:
    v_cmp_gt_u32 vcc, 32, v255
    s_add_u32 s50, s50, 1
    s_cbranch_vccz L_poll1
    s_cmp_ge_u32 s50, 0x20000
    s_cbranch_scc1 L_poll1
    s_sleep 16
    buffer_load_dword v255, v254, s[8:11], 0 offen sc1
    s_waitcnt vmcnt(0)
    s_branch L_poll0
L_poll1:
    buffer_load_dword v231, v229, s[4:7], 0 offen sc1
L_nopoll:
    s_add_u32 s61, s43, 0
    s_add_u32 m0, s41, 49152
    s_nop 0
    buffer_load_dwordx4 v237, s[12:15], s61 offen offset:0  lds
    buffer_load_dwordx4 v238, s[12:15], s61 offen offset:1024  lds
    buffer_load_dwordx4 v239, s[12:15], s61 offen offset:2048  lds
    buffer_load_dwordx4 v240, s[12:15], s61 offen offset:3072  lds
    s_add_u32 s61, s43, 36864
    s_add_u32 m0, s41, 98304
    s_nop 0
    buffer_load_dwordx4 v237, s[12:15], s61 offen offset:0  lds
    buffer_load_dwordx4 v238, s[12:15], s61 offen offset:1024  lds
    buffer_load_dwordx4 v239, s[12:15], s61 offen offset:2048  lds
    buffer_load_dwordx4 v240, s[12:15], s61 offen offset:3072  lds
    s_cmp_lg_u32 s3, 0
    s_cbranch_scc1 L_ready
    s_waitcnt vmcnt(8)
L_poll:
    v_cmp_ne_u32 vcc, 1, v231
    s_add_u32 s50, s50, 1
    s_cbranch_vccz L_ready
    s_cmp_ge_u32 s50, 0x20000
    s_cbranch_scc1 L_ready
    s_sleep 4
    buffer_load_dword v231, v229, s[4:7], 0 offen sc1
    s_waitcnt vmcnt(0)
    s_branch L_poll
L_ready:
    s_barrier
    s_cmp_ge_u32 s57, 30
    s_cbranch_scc1 L_help
    s_add_u32 s51, s44, 0
    buffer_load_dwordx4 a[48:51], v236, s[16:19], s51 offen offset:0 sc1
    buffer_load_dwordx4 a[52:55], v236, s[16:19], s51 offen offset:1024 sc1
    s_add_u32 s51, s44, 131072
    buffer_load_dwordx4 a[56:59], v236, s[16:19], s51 offen offset:0 sc1
    buffer_load_dwordx4 a[60:63], v236, s[16:19], s51 offen offset:1024 sc1
    s_add_u32 s51, s44, 262144
    buffer_load_dwordx4 a[32:35], v236, s[16:19], s51 offen offset:0 sc1
    buffer_load_dwordx4 a[36:39], v236, s[16:19], s51 offen offset:1024 sc1
    s_waitcnt vmcnt(4)
    v_mfma_f32_16x16x32_bf16 v[64:67], a[48:51], a[192:195], 0
    v_mfma_f32_16x16x32_bf16 v[64:67], a[52:55], a[208:211], v[64:67]
    s_add_u32 s51, s44, 393216
    buffer_load_dwordx4 a[40:43], v236, s[16:19], s51 offen offset:0 sc1
    v_mfma_f32_16x16x32_bf16 v[68:71], a[48:51], a[196:199], 0
    v_mfma_f32_16x16x32_bf16 v[68:71], a[52:55], a[212:215], v[68:71]
    v_mfma_f32_16x16x32_bf16 v[72:75], a[48:51], a[200:203], 0
    v_mfma_f32_16x16x32_bf16 v[72:75], a[52:55], a[216:219], v[72:75]
    buffer_load_dwordx4 a[44:47], v236, s[16:19], s51 offen offset:1024 sc1
    v_mfma_f32_16x16x32_bf16 v[76:79], a[48:51], a[204:207], 0
    v_mfma_f32_16x16x32_bf16 v[76:79], a[52:55], a[220:223], v[76:79]
    v_mfma_f32_16x16x32_bf16 v[144:147], a[48:51], a[224:227], 0
    v_mfma_f32_16x16x32_bf16 v[144:147], a[52:55], a[240:243], v[144:147]
    s_add_u32 s51, s44, 524288
    buffer_load_dwordx4 a[16:19], v236, s[16:19], s51 offen offset:0 sc1
    v_mfma_f32_16x16x32_bf16 v[148:151], a[48:51], a[228:231], 0
    v_mfma_f32_16x16x32_bf16 v[148:151], a[52:55], a[244:247], v[148:151]
    v_mfma_f32_16x16x32_bf16 v[152:155], a[48:51], a[232:235], 0
    v_mfma_f32_16x16x32_bf16 v[152:155], a[52:55], a[248:251], v[152:155]
    buffer_load_dwordx4 a[20:23], v236, s[16:19], s51 offen offset:1024 sc1
    v_mfma_f32_16x16x32_bf16 v[156:159], a[48:51], a[236:239], 0
    v_mfma_f32_16x16x32_bf16 v[156:159], a[52:55], a[252:255], v[156:159]
    s_waitcnt vmcnt(6)
    v_mfma_f32_16x16x32_bf16 v[80:83], a[56:59], a[192:195], 0
    v_mfma_f32_16x16x32_bf16 v[80:83], a[60:63], a[208:211], v[80:83]
    s_add_u32 s51, s44, 0
    buffer_load_dwordx4 a[24:27], v236, s[16:19], s51 offen offset:2048 sc1
    v_mfma_f32_16x16x32_bf16 v[84:87], a[56:59], a[196:199], 0
    v_mfma_f32_16x16x32_bf16 v[84:87], a[60:63], a[212:215], v[84:87]
    v_mfma_f32_16x16x32_bf16 v[88:91], a[56:59], a[200:203], 0
    v_mfma_f32_16x16x32_bf16 v[88:91], a[60:63], a[216:219], v[88:91]
    buffer_load_dwordx4 a[28:31], v236, s[16:19], s51 offen offset:3072 sc1
    v_mfma_f32_16x16x32_bf16 v[92:95], a[56:59], a[204:207], 0
    v_mfma_f32_16x16x32_bf16 v[92:95], a[60:63], a[220:223], v[92:95]
    v_mfma_f32_16x16x32_bf16 v[160:163], a[56:59], a[224:227], 0
    v_mfma_f32_16x16x32_bf16 v[160:163], a[60:63], a[240:243], v[160:163]
    s_add_u32 s51, s44, 131072
    buffer_load_dwordx4 a[48:51], v236, s[16:19], s51 offen offset:2048 sc1
    v_mfma_f32_16x16x32_bf16 v[164:167], a[56:59], a[228:231], 0
    v_mfma_f32_16x16x32_bf16 v[164:167], a[60:63], a[244:247], v[164:167]
    v_mfma_f32_16x16x32_bf16 v[168:171], a[56:59], a[232:235], 0
    v_mfma_f32_16x16x32_bf16 v[168:171], a[60:63], a[248:251], v[168:171]
    buffer_load_dwordx4 a[52:55], v236, s[16:19], s51 offen offset:3072 sc1
    v_mfma_f32_16x16x32_bf16 v[172:175], a[56:59], a[236:239], 0
    v_mfma_f32_16x16x32_bf16 v[172:175], a[60:63], a[252:255], v[172:175]
    s_waitcnt vmcnt(8)
    v_mfma_f32_16x16x32_bf16 v[96:99], a[32:35], a[192:195], 0
    v_mfma_f32_16x16x32_bf16 v[96:99], a[36:39], a[208:211], v[96:99]
    s_add_u32 s51, s44, 262144
    buffer_load_dwordx4 a[56:59], v236, s[16:19], s51 offen offset:2048 sc1
    v_mfma_f32_16x16x32_bf16 v[100:103], a[32:35], a[196:199], 0
    v_mfma_f32_16x16x32_bf16 v[100:103], a[36:39], a[212:215], v[100:103]
    v_mfma_f32_16x16x32_bf16 v[104:107], a[32:35], a[200:203], 0
    v_mfma_f32_16x16x32_bf16 v[104:107], a[36:39], a[216:219], v[104:107]
    buffer_load_dwordx4 a[60:63], v236, s[16:19], s51 offen offset:3072 sc1
    v_mfma_f32_16x16x32_bf16 v[108:111], a[32:35], a[204:207], 0
    v_mfma_f32_16x16x32_bf16 v[108:111], a[36:39], a[220:223], v[108:111]
    v_mfma_f32_16x16x32_bf16 v[176:179], a[32:35], a[224:227], 0
    s_add_u32 s51, s44, 393216
    buffer_load_dwordx4 a[0:3], v236, s[16:19], s51 offen offset:2048 sc1
    v_mfma_f32_16x16x32_bf16 v[176:179], a[36:39], a[240:243], v[176:179]
    v_mfma_f32_16x16x32_bf16 v[180:183], a[32:35], a[228:231], 0
    v_mfma_f32_16x16x32_bf16 v[180:183], a[36:39], a[244:247], v[180:183]
    v_mfma_f32_16x16x32_bf16 v[184:187], a[32:35], a[232:235], 0
    buffer_load_dwordx4 a[4:7], v236, s[16:19], s51 offen offset:3072 sc1
    v_mfma_f32_16x16x32_bf16 v[184:187], a[36:39], a[248:251], v[184:187]
    v_mfma_f32_16x16x32_bf16 v[188:191], a[32:35], a[236:239], 0
    v_mfma_f32_16x16x32_bf16 v[188:191], a[36:39], a[252:255], v[188:191]
    s_waitcnt vmcnt(10)
    v_mfma_f32_16x16x32_bf16 v[112:115], a[40:43], a[192:195], 0
    s_add_u32 s51, s44, 524288
    buffer_load_dwordx4 a[8:11], v236, s[16:19], s51 offen offset:2048 sc1
    v_mfma_f32_16x16x32_bf16 v[112:115], a[44:47], a[208:211], v[112:115]
    v_mfma_f32_16x16x32_bf16 v[116:119], a[40:43], a[196:199], 0
    v_mfma_f32_16x16x32_bf16 v[116:119], a[44:47], a[212:215], v[116:119]
    v_mfma_f32_16x16x32_bf16 v[120:123], a[40:43], a[200:203], 0
    buffer_load_dwordx4 a[12:15], v236, s[16:19], s51 offen offset:3072 sc1
    v_mfma_f32_16x16x32_bf16 v[120:123], a[44:47], a[216:219], v[120:123]
    v_mfma_f32_16x16x32_bf16 v[124:127], a[40:43], a[204:207], 0
    v_mfma_f32_16x16x32_bf16 v[124:127], a[44:47], a[220:223], v[124:127]
    v_mfma_f32_16x16x32_bf16 v[192:195], a[40:43], a[224:227], 0
    s_add_u32 s51, s45, 0
    buffer_load_dwordx4 a[32:35], v236, s[16:19], s51 offen offset:0 sc1
    v_mfma_f32_16x16x32_bf16 v[192:195], a[44:47], a[240:243], v[192:195]
    v_mfma_f32_16x16x32_bf16 v[196:199], a[40:43], a[228:231], 0
    v_mfma_f32_16x16x32_bf16 v[196:199], a[44:47], a[244:247], v[196:199]
    v_mfma_f32_16x16x32_bf16 v[200:203], a[40:43], a[232:235], 0
    buffer_load_dwordx4 a[36:39], v236, s[16:19], s51 offen offset:1024 sc1
    v_mfma_f32_16x16x32_bf16 v[200:203], a[44:47], a[248:251], v[200:203]
    v_mfma_f32_16x16x32_bf16 v[204:207], a[40:43], a[236:239], 0
    v_mfma_f32_16x16x32_bf16 v[204:207], a[44:47], a[252:255], v[204:207]
    s_waitcnt vmcnt(12)
    v_mfma_f32_16x16x32_bf16 v[128:131], a[16:19], a[192:195], 0
    s_add_u32 s51, s45, 131072
    buffer_load_dwordx4 a[40:43], v236, s[16:19], s51 offen offset:0 sc1
    v_mfma_f32_16x16x32_bf16 v[128:131], a[20:23], a[208:211], v[128:131]
    v_mfma_f32_16x16x32_bf16 v[132:135], a[16:19], a[196:199], 0
    v_mfma_f32_16x16x32_bf16 v[132:135], a[20:23], a[212:215], v[132:135]
    v_mfma_f32_16x16x32_bf16 v[136:139], a[16:19], a[200:203], 0
    buffer_load_dwordx4 a[44:47], v236, s[16:19], s51 offen offset:1024 sc1
    v_mfma_f32_16x16x32_bf16 v[136:139], a[20:23], a[216:219], v[136:139]
    v_mfma_f32_16x16x32_bf16 v[140:143], a[16:19], a[204:207], 0
    v_mfma_f32_16x16x32_bf16 v[140:143], a[20:23], a[220:223], v[140:143]
    v_mfma_f32_16x16x32_bf16 v[208:211], a[16:19], a[224:227], 0
    s_add_u32 s51, s45, 262144
    buffer_load_dwordx4 a[176:179], v236, s[16:19], s51 offen offset:0 sc1
    v_mfma_f32_16x16x32_bf16 v[208:211], a[20:23], a[240:243], v[208:211]
    v_mfma_f32_16x16x32_bf16 v[212:215], a[16:19], a[228:231], 0
    v_mfma_f32_16x16x32_bf16 v[212:215], a[20:23], a[244:247], v[212:215]
    v_mfma_f32_16x16x32_bf16 v[216:219], a[16:19], a[232:235], 0
    buffer_load_dwordx4 a[180:183], v236, s[16:19], s51 offen offset:1024 sc1
    v_mfma_f32_16x16x32_bf16 v[216:219], a[20:23], a[248:251], v[216:219]
    v_mfma_f32_16x16x32_bf16 v[220:223], a[16:19], a[236:239], 0
    v_mfma_f32_16x16x32_bf16 v[220:223], a[20:23], a[252:255], v[220:223]
    s_add_u32 s51, s45, 393216
    buffer_load_dwordx4 a[184:187], v236, s[16:19], s51 offen offset:0 sc1
    s_waitcnt vmcnt(15)
    v_mfma_f32_16x16x32_bf16 v[64:67], a[24:27], a[64:67], v[64:67]
    v_mfma_f32_16x16x32_bf16 v[64:67], a[28:31], a[80:83], v[64:67]
    v_mfma_f32_16x16x32_bf16 v[68:71], a[24:27], a[68:71], v[68:71]
    v_mfma_f32_16x16x32_bf16 v[68:71], a[28:31], a[84:87], v[68:71]
    buffer_load_dwordx4 a[188:191], v236, s[16:19], s51 offen offset:1024 sc1
    v_mfma_f32_16x16x32_bf16 v[72:75], a[24:27], a[72:75], v[72:75]
    v_mfma_f32_16x16x32_bf16 v[72:75], a[28:31], a[88:91], v[72:75]
    v_mfma_f32_16x16x32_bf16 v[76:79], a[24:27], a[76:79], v[76:79]
    v_mfma_f32_16x16x32_bf16 v[76:79], a[28:31], a[92:95], v[76:79]
    s_add_u32 s51, s45, 524288
    buffer_load_dwordx4 a[16:19], v236, s[16:19], s51 offen offset:0 sc1
    v_mfma_f32_16x16x32_bf16 v[144:147], a[24:27], v[0:3], v[144:147]
    v_mfma_f32_16x16x32_bf16 v[144:147], a[28:31], v[16:19], v[144:147]
    v_mfma_f32_16x16x32_bf16 v[148:151], a[24:27], v[4:7], v[148:151]
    v_mfma_f32_16x16x32_bf16 v[148:151], a[28:31], v[20:23], v[148:151]
    buffer_load_dwordx4 a[20:23], v236, s[16:19], s51 offen offset:1024 sc1
    v_mfma_f32_16x16x32_bf16 v[152:155], a[24:27], v[8:11], v[152:155]
    v_mfma_f32_16x16x32_bf16 v[152:155], a[28:31], v[24:27], v[152:155]
    v_mfma_f32_16x16x32_bf16 v[156:159], a[24:27], v[12:15], v[156:159]
    v_mfma_f32_16x16x32_bf16 v[156:159], a[28:31], v[28:31], v[156:159]
    s_add_u32 s51, s45, 0
    buffer_load_dwordx4 a[160:163], v236, s[16:19], s51 offen offset:2048 sc1
    s_waitcnt vmcnt(17)
    v_mfma_f32_16x16x32_bf16 v[80:83], a[48:51], a[64:67], v[80:83]
    v_mfma_f32_16x16x32_bf16 v[80:83], a[52:55], a[80:83], v[80:83]
    v_mfma_f32_16x16x32_bf16 v[84:87], a[48:51], a[68:71], v[84:87]
    v_mfma_f32_16x16x32_bf16 v[84:87], a[52:55], a[84:87], v[84:87]
    buffer_load_dwordx4 a[164:167], v236, s[16:19], s51 offen offset:3072 sc1
    v_mfma_f32_16x16x32_bf16 v[88:91], a[48:51], a[72:75], v[88:91]
    v_mfma_f32_16x16x32_bf16 v[88:91], a[52:55], a[88:91], v[88:91]
    v_mfma_f32_16x16x32_bf16 v[92:95], a[48:51], a[76:79], v[92:95]
    v_mfma_f32_16x16x32_bf16 v[92:95], a[52:55], a[92:95], v[92:95]
    s_add_u32 s61, s43, 73728
    s_add_u32 m0, s41, 65536
    s_nop 0
    buffer_load_dwordx4 v237, s[12:15], s61 offen offset:0  lds
    v_mfma_f32_16x16x32_bf16 v[160:163], a[48:51], v[0:3], v[160:163]
    v_mfma_f32_16x16x32_bf16 v[160:163], a[52:55], v[16:19], v[160:163]
    v_mfma_f32_16x16x32_bf16 v[164:167], a[48:51], v[4:7], v[164:167]
    v_mfma_f32_16x16x32_bf16 v[164:167], a[52:55], v[20:23], v[164:167]
    buffer_load_dwordx4 v238, s[12:15], s61 offen offset:1024  lds
    v_mfma_f32_16x16x32_bf16 v[168:171], a[48:51], v[8:11], v[168:171]
    ds_read_b64_tr_b16 a[240:241], v249 offset:0
    v_mfma_f32_16x16x32_bf16 v[168:171], a[52:55], v[24:27], v[168:171]
    ds_read_b64_tr_b16 a[242:243], v249 offset:2048
    v_mfma_f32_16x16x32_bf16 v[172:175], a[48:51], v[12:15], v[172:175]
    ds_read_b64_tr_b16 a[244:245], v250 offset:0
    v_mfma_f32_16x16x32_bf16 v[172:175], a[52:55], v[28:31], v[172:175]
    buffer_load_dwordx4 v239, s[12:15], s61 offen offset:2048  lds
    s_waitcnt vmcnt(19)
    v_mfma_f32_16x16x32_bf16 v[96:99], a[56:59], a[64:67], v[96:99]
    ds_read_b64_tr_b16 a[246:247], v250 offset:2048
    v_mfma_f32_16x16x32_bf16 v[96:99], a[60:63], a[80:83], v[96:99]
    ds_read_b64_tr_b16 a[248:249], v251 offset:0
    v_mfma_f32_16x16x32_bf16 v[100:103], a[56:59], a[68:71], v[100:103]
    ds_read_b64_tr_b16 a[250:251], v251 offset:2048
    v_mfma_f32_16x16x32_bf16 v[100:103], a[60:63], a[84:87], v[100:103]
    buffer_load_dwordx4 v240, s[12:15], s61 offen offset:3072  lds
    v_mfma_f32_16x16x32_bf16 v[104:107], a[56:59], a[72:75], v[104:107]
    ds_read_b64_tr_b16 a[252:253], v252 offset:0
    v_mfma_f32_16x16x32_bf16 v[104:107], a[60:63], a[88:91], v[104:107]
    ds_read_b64_tr_b16 a[254:255], v252 offset:2048
    v_mfma_f32_16x16x32_bf16 v[108:111], a[56:59], a[76:79], v[108:111]
    ds_read_b64_tr_b16 a[224:225], v249 offset:16384
    v_mfma_f32_16x16x32_bf16 v[108:111], a[60:63], a[92:95], v[108:111]
    s_add_u32 s61, s43, 110592
    s_add_u32 m0, s41, 114688
    s_nop 0
    buffer_load_dwordx4 v237, s[12:15], s61 offen offset:0  lds
    v_mfma_f32_16x16x32_bf16 v[176:179], a[56:59], v[0:3], v[176:179]
    ds_read_b64_tr_b16 a[226:227], v249 offset:18432
    v_mfma_f32_16x16x32_bf16 v[176:179], a[60:63], v[16:19], v[176:179]
    ds_read_b64_tr_b16 a[228:229], v250 offset:16384
    v_mfma_f32_16x16x32_bf16 v[180:183], a[56:59], v[4:7], v[180:183]
    buffer_load_dwordx4 v238, s[12:15], s61 offen offset:1024  lds
    v_mfma_f32_16x16x32_bf16 v[180:183], a[60:63], v[20:23], v[180:183]
    ds_read_b64_tr_b16 a[230:231], v250 offset:18432
    v_mfma_f32_16x16x32_bf16 v[184:187], a[56:59], v[8:11], v[184:187]
    ds_read_b64_tr_b16 a[232:233], v251 offset:16384
    v_mfma_f32_16x16x32_bf16 v[184:187], a[60:63], v[24:27], v[184:187]
    ds_read_b64_tr_b16 a[234:235], v251 offset:18432
    v_mfma_f32_16x16x32_bf16 v[188:191], a[56:59], v[12:15], v[188:191]
    buffer_load_dwordx4 v239, s[12:15], s61 offen offset:2048  lds
    v_mfma_f32_16x16x32_bf16 v[188:191], a[60:63], v[28:31], v[188:191]
    ds_read_b64_tr_b16 a[236:237], v252 offset:16384
    s_waitcnt vmcnt(21)
    v_mfma_f32_16x16x32_bf16 v[112:115], a[0:3], a[64:67], v[112:115]
    ds_read_b64_tr_b16 a[238:239], v252 offset:18432
    v_mfma_f32_16x16x32_bf16 v[112:115], a[4:7], a[80:83], v[112:115]
    v_mfma_f32_16x16x32_bf16 v[116:119], a[0:3], a[68:71], v[116:119]
    buffer_load_dwordx4 v240, s[12:15], s61 offen offset:3072  lds
    v_mfma_f32_16x16x32_bf16 v[116:119], a[4:7], a[84:87], v[116:119]
    v_mfma_f32_16x16x32_bf16 v[120:123], a[0:3], a[72:75], v[120:123]
    v_mfma_f32_16x16x32_bf16 v[120:123], a[4:7], a[88:91], v[120:123]
    v_mfma_f32_16x16x32_bf16 v[124:127], a[0:3], a[76:79], v[124:127]
    s_add_u32 s51, s45, 131072
    buffer_load_dwordx4 a[168:171], v236, s[16:19], s51 offen offset:2048 sc1
    v_mfma_f32_16x16x32_bf16 v[124:127], a[4:7], a[92:95], v[124:127]
    v_mfma_f32_16x16x32_bf16 v[192:195], a[0:3], v[0:3], v[192:195]
    v_mfma_f32_16x16x32_bf16 v[192:195], a[4:7], v[16:19], v[192:195]
    v_mfma_f32_16x16x32_bf16 v[196:199], a[0:3], v[4:7], v[196:199]
    buffer_load_dwordx4 a[172:175], v236, s[16:19], s51 offen offset:3072 sc1
    v_mfma_f32_16x16x32_bf16 v[196:199], a[4:7], v[20:23], v[196:199]
    v_mfma_f32_16x16x32_bf16 v[200:203], a[0:3], v[8:11], v[200:203]
    v_mfma_f32_16x16x32_bf16 v[200:203], a[4:7], v[24:27], v[200:203]
    v_mfma_f32_16x16x32_bf16 v[204:207], a[0:3], v[12:15], v[204:207]
    s_add_u32 s51, s45, 262144
    buffer_load_dwordx4 a[24:27], v236, s[16:19], s51 offen offset:2048 sc1
    v_mfma_f32_16x16x32_bf16 v[204:207], a[4:7], v[28:31], v[204:207]
    s_waitcnt vmcnt(23)
    v_mfma_f32_16x16x32_bf16 v[128:131], a[8:11], a[64:67], v[128:131]
    v_mfma_f32_16x16x32_bf16 v[128:131], a[12:15], a[80:83], v[128:131]
    v_mfma_f32_16x16x32_bf16 v[132:135], a[8:11], a[68:71], v[132:135]
    buffer_load_dwordx4 a[28:31], v236, s[16:19], s51 offen offset:3072 sc1
    v_mfma_f32_16x16x32_bf16 v[132:135], a[12:15], a[84:87], v[132:135]
    v_mfma_f32_16x16x32_bf16 v[136:139], a[8:11], a[72:75], v[136:139]
    v_mfma_f32_16x16x32_bf16 v[136:139], a[12:15], a[88:91], v[136:139]
    v_mfma_f32_16x16x32_bf16 v[140:143], a[8:11], a[76:79], v[140:143]
    s_add_u32 s51, s45, 393216
    buffer_load_dwordx4 a[48:51], v236, s[16:19], s51 offen offset:2048 sc1
    v_mfma_f32_16x16x32_bf16 v[140:143], a[12:15], a[92:95], v[140:143]
    v_mfma_f32_16x16x32_bf16 v[208:211], a[8:11], v[0:3], v[208:211]
    v_mfma_f32_16x16x32_bf16 v[208:211], a[12:15], v[16:19], v[208:211]
    v_mfma_f32_16x16x32_bf16 v[212:215], a[8:11], v[4:7], v[212:215]
    buffer_load_dwordx4 a[52:55], v236, s[16:19], s51 offen offset:3072 sc1
    v_mfma_f32_16x16x32_bf16 v[212:215], a[12:15], v[20:23], v[212:215]
    v_mfma_f32_16x16x32_bf16 v[216:219], a[8:11], v[8:11], v[216:219]
    v_mfma_f32_16x16x32_bf16 v[216:219], a[12:15], v[24:27], v[216:219]
    v_mfma_f32_16x16x32_bf16 v[220:223], a[8:11], v[12:15], v[220:223]
    s_add_u32 s51, s45, 524288
    buffer_load_dwordx4 a[56:59], v236, s[16:19], s51 offen offset:2048 sc1
    v_mfma_f32_16x16x32_bf16 v[220:223], a[12:15], v[28:31], v[220:223]
    s_waitcnt vmcnt(25)
    v_mfma_f32_16x16x32_bf16 v[64:67], a[32:35], v[32:35], v[64:67]
    v_mfma_f32_16x16x32_bf16 v[64:67], a[36:39], v[48:51], v[64:67]
    buffer_load_dwordx4 a[60:63], v236, s[16:19], s51 offen offset:3072 sc1
    v_mfma_f32_16x16x32_bf16 v[68:71], a[32:35], v[36:39], v[68:71]
    v_mfma_f32_16x16x32_bf16 v[68:71], a[36:39], v[52:55], v[68:71]
    v_mfma_f32_16x16x32_bf16 v[72:75], a[32:35], v[40:43], v[72:75]
    v_mfma_f32_16x16x32_bf16 v[72:75], a[36:39], v[56:59], v[72:75]
    s_add_u32 s51, s46, 0
    buffer_load_dwordx4 a[0:3], v236, s[16:19], s51 offen offset:0 sc1
    v_mfma_f32_16x16x32_bf16 v[76:79], a[32:35], v[44:47], v[76:79]
    v_mfma_f32_16x16x32_bf16 v[76:79], a[36:39], v[60:63], v[76:79]
    v_mfma_f32_16x16x32_bf16 v[144:147], a[32:35], a[96:99], v[144:147]
    v_mfma_f32_16x16x32_bf16 v[144:147], a[36:39], a[112:115], v[144:147]
    buffer_load_dwordx4 a[4:7], v236, s[16:19], s51 offen offset:1024 sc1
    v_mfma_f32_16x16x32_bf16 v[148:151], a[32:35], a[100:103], v[148:151]
    v_mfma_f32_16x16x32_bf16 v[148:151], a[36:39], a[116:119], v[148:151]
    v_mfma_f32_16x16x32_bf16 v[152:155], a[32:35], a[104:107], v[152:155]
    v_mfma_f32_16x16x32_bf16 v[152:155], a[36:39], a[120:123], v[152:155]
    s_add_u32 s61, s42, 0
    s_waitcnt lgkmcnt(8)
    s_add_u32 m0, s41, 131072
    s_nop 0
    buffer_load_dwordx4 v237, s[52:55], s61 offen offset:0  lds
    v_mfma_f32_16x16x32_bf16 v[156:159], a[32:35], a[108:111], v[156:159]
    v_mfma_f32_16x16x32_bf16 v[156:159], a[36:39], a[124:127], v[156:159]
    s_waitcnt vmcnt(27)
    v_mfma_f32_16x16x32_bf16 v[80:83], a[40:43], v[32:35], v[80:83]
    v_mfma_f32_16x16x32_bf16 v[80:83], a[44:47], v[48:51], v[80:83]
    buffer_load_dwordx4 v238, s[52:55], s61 offen offset:1024  lds
    v_mfma_f32_16x16x32_bf16 v[84:87], a[40:43], v[36:39], v[84:87]
    v_mfma_f32_16x16x32_bf16 v[84:87], a[44:47], v[52:55], v[84:87]
    v_mfma_f32_16x16x32_bf16 v[88:91], a[40:43], v[40:43], v[88:91]
    ds_read_b64_tr_b16 a[80:81], v241 offset:32768
    v_mfma_f32_16x16x32_bf16 v[88:91], a[44:47], v[56:59], v[88:91]
    buffer_load_dwordx4 v239, s[52:55], s61 offen offset:2048  lds
    v_mfma_f32_16x16x32_bf16 v[92:95], a[40:43], v[44:47], v[92:95]
    ds_read_b64_tr_b16 a[82:83], v241 offset:34816
    v_mfma_f32_16x16x32_bf16 v[92:95], a[44:47], v[60:63], v[92:95]
    ds_read_b64_tr_b16 a[84:85], v242 offset:32768
    v_mfma_f32_16x16x32_bf16 v[160:163], a[40:43], a[96:99], v[160:163]
    ds_read_b64_tr_b16 a[86:87], v242 offset:34816
    v_mfma_f32_16x16x32_bf16 v[160:163], a[44:47], a[112:115], v[160:163]
    buffer_load_dwordx4 v240, s[52:55], s61 offen offset:3072  lds
    v_mfma_f32_16x16x32_bf16 v[164:167], a[40:43], a[100:103], v[164:167]
    ds_read_b64_tr_b16 a[88:89], v243 offset:32768
    v_mfma_f32_16x16x32_bf16 v[164:167], a[44:47], a[116:119], v[164:167]
    ds_read_b64_tr_b16 a[90:91], v243 offset:34816
    v_mfma_f32_16x16x32_bf16 v[168:171], a[40:43], a[104:107], v[168:171]
    ds_read_b64_tr_b16 a[92:93], v244 offset:32768
    v_mfma_f32_16x16x32_bf16 v[168:171], a[44:47], a[120:123], v[168:171]
    s_add_u32 s61, s42, 36864
    s_waitcnt lgkmcnt(7)
    s_add_u32 m0, s41, 147456
    s_nop 0
    buffer_load_dwordx4 v237, s[52:55], s61 offen offset:0  lds
    v_mfma_f32_16x16x32_bf16 v[172:175], a[40:43], a[108:111], v[172:175]
    ds_read_b64_tr_b16 a[94:95], v244 offset:34816
    v_mfma_f32_16x16x32_bf16 v[172:175], a[44:47], a[124:127], v[172:175]
    ds_read_b64_tr_b16 a[64:65], v245 offset:16384
    s_waitcnt vmcnt(29)
    v_mfma_f32_16x16x32_bf16 v[96:99], a[176:179], v[32:35], v[96:99]
    ds_read_b64_tr_b16 a[66:67], v245 offset:18432
    v_mfma_f32_16x16x32_bf16 v[96:99], a[180:183], v[48:51], v[96:99]
    buffer_load_dwordx4 v238, s[52:55], s61 offen offset:1024  lds
    v_mfma_f32_16x16x32_bf16 v[100:103], a[176:179], v[36:39], v[100:103]
    ds_read_b64_tr_b16 a[68:69], v246 offset:16384
    v_mfma_f32_16x16x32_bf16 v[100:103], a[180:183], v[52:55], v[100:103]
    ds_read_b64_tr_b16 a[70:71], v246 offset:18432
    v_mfma_f32_16x16x32_bf16 v[104:107], a[176:179], v[40:43], v[104:107]
    ds_read_b64_tr_b16 a[72:73], v247 offset:16384
    v_mfma_f32_16x16x32_bf16 v[104:107], a[180:183], v[56:59], v[104:107]
    buffer_load_dwordx4 v239, s[52:55], s61 offen offset:2048  lds
    v_mfma_f32_16x16x32_bf16 v[108:111], a[176:179], v[44:47], v[108:111]
    ds_read_b64_tr_b16 a[74:75], v247 offset:18432
    v_mfma_f32_16x16x32_bf16 v[108:111], a[180:183], v[60:63], v[108:111]
    ds_read_b64_tr_b16 a[76:77], v248 offset:16384
    v_mfma_f32_16x16x32_bf16 v[176:179], a[176:179], a[96:99], v[176:179]
    buffer_load_dwordx4 v240, s[52:55], s61 offen offset:3072  lds
    v_mfma_f32_16x16x32_bf16 v[176:179], a[180:183], a[112:115], v[176:179]
    ds_read_b64_tr_b16 a[78:79], v248 offset:18432
    v_mfma_f32_16x16x32_bf16 v[180:183], a[176:179], a[100:103], v[180:183]
    v_mfma_f32_16x16x32_bf16 v[180:183], a[180:183], a[116:119], v[180:183]
    v_mfma_f32_16x16x32_bf16 v[184:187], a[176:179], a[104:107], v[184:187]
    s_add_u32 s51, s46, 131072
    buffer_load_dwordx4 a[8:11], v236, s[16:19], s51 offen offset:0 sc1
    v_mfma_f32_16x16x32_bf16 v[184:187], a[180:183], a[120:123], v[184:187]
    v_mfma_f32_16x16x32_bf16 v[188:191], a[176:179], a[108:111], v[188:191]
    v_mfma_f32_16x16x32_bf16 v[188:191], a[180:183], a[124:127], v[188:191]
    s_waitcnt vmcnt(31)
    v_mfma_f32_16x16x32_bf16 v[112:115], a[184:187], v[32:35], v[112:115]
    buffer_load_dwordx4 a[12:15], v236, s[16:19], s51 offen offset:1024 sc1
    v_mfma_f32_16x16x32_bf16 v[112:115], a[188:191], v[48:51], v[112:115]
    v_mfma_f32_16x16x32_bf16 v[116:119], a[184:187], v[36:39], v[116:119]
    v_mfma_f32_16x16x32_bf16 v[116:119], a[188:191], v[52:55], v[116:119]
    v_mfma_f32_16x16x32_bf16 v[120:123], a[184:187], v[40:43], v[120:123]
    s_add_u32 s51, s46, 262144
    buffer_load_dwordx4 a[32:35], v236, s[16:19], s51 offen offset:0 sc1
    v_mfma_f32_16x16x32_bf16 v[120:123], a[188:191], v[56:59], v[120:123]
    v_mfma_f32_16x16x32_bf16 v[124:127], a[184:187], v[44:47], v[124:127]
    v_mfma_f32_16x16x32_bf16 v[124:127], a[188:191], v[60:63], v[124:127]
    v_mfma_f32_16x16x32_bf16 v[192:195], a[184:187], a[96:99], v[192:195]
    buffer_load_dwordx4 a[36:39], v236, s[16:19], s51 offen offset:1024 sc1
    v_mfma_f32_16x16x32_bf16 v[192:195], a[188:191], a[112:115], v[192:195]
    v_mfma_f32_16x16x32_bf16 v[196:199], a[184:187], a[100:103], v[196:199]
    v_mfma_f32_16x16x32_bf16 v[196:199], a[188:191], a[116:119], v[196:199]
    v_mfma_f32_16x16x32_bf16 v[200:203], a[184:187], a[104:107], v[200:203]
    s_add_u32 s51, s46, 393216
    buffer_load_dwordx4 a[40:43], v236, s[16:19], s51 offen offset:0 sc1
    v_mfma_f32_16x16x32_bf16 v[200:203], a[188:191], a[120:123], v[200:203]
    ds_read_b64_tr_b16 a[208:209], v241 offset:0
    v_mfma_f32_16x16x32_bf16 v[204:207], a[184:187], a[108:111], v[204:207]
    ds_read_b64_tr_b16 a[210:211], v241 offset:2048
    v_mfma_f32_16x16x32_bf16 v[204:207], a[188:191], a[124:127], v[204:207]
    ds_read_b64_tr_b16 a[212:213], v242 offset:0
    s_waitcnt vmcnt(33)
    v_mfma_f32_16x16x32_bf16 v[128:131], a[16:19], v[32:35], v[128:131]
    buffer_load_dwordx4 a[44:47], v236, s[16:19], s51 offen offset:1024 sc1
    v_mfma_f32_16x16x32_bf16 v[128:131], a[20:23], v[48:51], v[128:131]
    ds_read_b64_tr_b16 a[214:215], v242 offset:2048
    v_mfma_f32_16x16x32_bf16 v[132:135], a[16:19], v[36:39], v[132:135]
    ds_read_b64_tr_b16 a[216:217], v243 offset:0
    v_mfma_f32_16x16x32_bf16 v[132:135], a[20:23], v[52:55], v[132:135]
    ds_read_b64_tr_b16 a[218:219], v243 offset:2048
    v_mfma_f32_16x16x32_bf16 v[136:139], a[16:19], v[40:43], v[136:139]
    s_add_u32 s51, s46, 524288
    buffer_load_dwordx4 a[176:179], v236, s[16:19], s51 offen offset:0 sc1
    v_mfma_f32_16x16x32_bf16 v[136:139], a[20:23], v[56:59], v[136:139]
    ds_read_b64_tr_b16 a[220:221], v244 offset:0
    v_mfma_f32_16x16x32_bf16 v[140:143], a[16:19], v[44:47], v[140:143]
    ds_read_b64_tr_b16 a[222:223], v244 offset:2048
    v_mfma_f32_16x16x32_bf16 v[140:143], a[20:23], v[60:63], v[140:143]
    ds_read_b64_tr_b16 v[32:33], v241 offset:16384
    v_mfma_f32_16x16x32_bf16 v[208:211], a[16:19], a[96:99], v[208:211]
    buffer_load_dwordx4 a[180:183], v236, s[16:19], s51 offen offset:1024 sc1
    v_mfma_f32_16x16x32_bf16 v[208:211], a[20:23], a[112:115], v[208:211]
    ds_read_b64_tr_b16 v[34:35], v241 offset:18432
    v_mfma_f32_16x16x32_bf16 v[212:215], a[16:19], a[100:103], v[212:215]
    ds_read_b64_tr_b16 v[36:37], v242 offset:16384
    v_mfma_f32_16x16x32_bf16 v[212:215], a[20:23], a[116:119], v[212:215]
    ds_read_b64_tr_b16 v[38:39], v242 offset:18432
    v_mfma_f32_16x16x32_bf16 v[216:219], a[16:19], a[104:107], v[216:219]
    s_add_u32 s51, s46, 0
    buffer_load_dwordx4 a[184:187], v236, s[16:19], s51 offen offset:2048 sc1
    v_mfma_f32_16x16x32_bf16 v[216:219], a[20:23], a[120:123], v[216:219]
    ds_read_b64_tr_b16 v[40:41], v243 offset:16384
    v_mfma_f32_16x16x32_bf16 v[220:223], a[16:19], a[108:111], v[220:223]
    ds_read_b64_tr_b16 v[42:43], v243 offset:18432
    v_mfma_f32_16x16x32_bf16 v[220:223], a[20:23], a[124:127], v[220:223]
    buffer_load_dwordx4 a[188:191], v236, s[16:19], s51 offen offset:3072 sc1
    s_waitcnt vmcnt(36)
    v_mfma_f32_16x16x32_bf16 v[64:67], a[160:163], a[128:131], v[64:67]
    ds_read_b64_tr_b16 v[44:45], v244 offset:16384
    v_mfma_f32_16x16x32_bf16 v[64:67], a[164:167], a[144:147], v[64:67]
    ds_read_b64_tr_b16 v[46:47], v244 offset:18432
    v_mfma_f32_16x16x32_bf16 v[68:71], a[160:163], a[132:135], v[68:71]
    v_mfma_f32_16x16x32_bf16 v[68:71], a[164:167], a[148:151], v[68:71]
    s_add_u32 s61, s42, 73728
    s_waitcnt lgkmcnt(15)
    s_add_u32 m0, s41, 81920
    s_nop 0
    buffer_load_dwordx4 v237, s[52:55], s61 offen offset:0  lds
    v_mfma_f32_16x16x32_bf16 v[72:75], a[160:163], a[136:139], v[72:75]
    v_mfma_f32_16x16x32_bf16 v[72:75], a[164:167], a[152:155], v[72:75]
    v_mfma_f32_16x16x32_bf16 v[76:79], a[160:163], a[140:143], v[76:79]
    v_mfma_f32_16x16x32_bf16 v[76:79], a[164:167], a[156:159], v[76:79]
    buffer_load_dwordx4 v238, s[52:55], s61 offen offset:1024  lds
    v_mfma_f32_16x16x32_bf16 v[144:147], a[160:163], a[240:243], v[144:147]
    v_mfma_f32_16x16x32_bf16 v[144:147], a[164:167], a[224:227], v[144:147]
    v_mfma_f32_16x16x32_bf16 v[148:151], a[160:163], a[244:247], v[148:151]
    v_mfma_f32_16x16x32_bf16 v[148:151], a[164:167], a[228:231], v[148:151]
    buffer_load_dwordx4 v239, s[52:55], s61 offen offset:2048  lds
    v_mfma_f32_16x16x32_bf16 v[152:155], a[160:163], a[248:251], v[152:155]
    v_mfma_f32_16x16x32_bf16 v[152:155], a[164:167], a[232:235], v[152:155]
    v_mfma_f32_16x16x32_bf16 v[156:159], a[160:163], a[252:255], v[156:159]
    v_mfma_f32_16x16x32_bf16 v[156:159], a[164:167], a[236:239], v[156:159]
    buffer_load_dwordx4 v240, s[52:55], s61 offen offset:3072  lds
    s_waitcnt vmcnt(30)
    v_mfma_f32_16x16x32_bf16 v[80:83], a[168:171], a[128:131], v[80:83]
    v_mfma_f32_16x16x32_bf16 v[80:83], a[172:175], a[144:147], v[80:83]
    v_mfma_f32_16x16x32_bf16 v[84:87], a[168:171], a[132:135], v[84:87]
    v_mfma_f32_16x16x32_bf16 v[84:87], a[172:175], a[148:151], v[84:87]
    s_add_u32 s51, s46, 131072
    buffer_load_dwordx4 a[16:19], v236, s[16:19], s51 offen offset:2048 sc1
    v_mfma_f32_16x16x32_bf16 v[88:91], a[168:171], a[136:139], v[88:91]
    ds_read_b64_tr_b16 a[112:113], v241 offset:49152
    v_mfma_f32_16x16x32_bf16 v[88:91], a[172:175], a[152:155], v[88:91]
    ds_read_b64_tr_b16 a[114:115], v241 offset:51200
    v_mfma_f32_16x16x32_bf16 v[92:95], a[168:171], a[140:143], v[92:95]
    ds_read_b64_tr_b16 a[116:117], v242 offset:49152
    v_mfma_f32_16x16x32_bf16 v[92:95], a[172:175], a[156:159], v[92:95]
    buffer_load_dwordx4 a[20:23], v236, s[16:19], s51 offen offset:3072 sc1
    v_mfma_f32_16x16x32_bf16 v[160:163], a[168:171], a[240:243], v[160:163]
    ds_read_b64_tr_b16 a[118:119], v242 offset:51200
    v_mfma_f32_16x16x32_bf16 v[160:163], a[172:175], a[224:227], v[160:163]
    ds_read_b64_tr_b16 a[120:121], v243 offset:49152
    v_mfma_f32_16x16x32_bf16 v[164:167], a[168:171], a[244:247], v[164:167]
    ds_read_b64_tr_b16 a[122:123], v243 offset:51200
    v_mfma_f32_16x16x32_bf16 v[164:167], a[172:175], a[228:231], v[164:167]
    s_add_u32 s51, s46, 262144
    buffer_load_dwordx4 a[160:163], v236, s[16:19], s51 offen offset:2048 sc1
    v_mfma_f32_16x16x32_bf16 v[168:171], a[168:171], a[248:251], v[168:171]
    ds_read_b64_tr_b16 a[124:125], v244 offset:49152
    v_mfma_f32_16x16x32_bf16 v[168:171], a[172:175], a[232:235], v[168:171]
    ds_read_b64_tr_b16 a[126:127], v244 offset:51200
    v_mfma_f32_16x16x32_bf16 v[172:175], a[168:171], a[252:255], v[172:175]
    ds_read_b64_tr_b16 a[96:97], v245 offset:32768
    v_mfma_f32_16x16x32_bf16 v[172:175], a[172:175], a[236:239], v[172:175]
    buffer_load_dwordx4 a[164:167], v236, s[16:19], s51 offen offset:3072 sc1
    s_waitcnt vmcnt(32)
    v_mfma_f32_16x16x32_bf16 v[96:99], a[24:27], a[128:131], v[96:99]
    ds_read_b64_tr_b16 a[98:99], v245 offset:34816
    v_mfma_f32_16x16x32_bf16 v[96:99], a[28:31], a[144:147], v[96:99]
    ds_read_b64_tr_b16 a[100:101], v246 offset:32768
    v_mfma_f32_16x16x32_bf16 v[100:103], a[24:27], a[132:135], v[100:103]
    ds_read_b64_tr_b16 a[102:103], v246 offset:34816
    v_mfma_f32_16x16x32_bf16 v[100:103], a[28:31], a[148:151], v[100:103]
    s_add_u32 s51, s46, 393216
    buffer_load_dwordx4 a[168:171], v236, s[16:19], s51 offen offset:2048 sc1
    v_mfma_f32_16x16x32_bf16 v[104:107], a[24:27], a[136:139], v[104:107]
    ds_read_b64_tr_b16 a[104:105], v247 offset:32768
    v_mfma_f32_16x16x32_bf16 v[104:107], a[28:31], a[152:155], v[104:107]
    ds_read_b64_tr_b16 a[106:107], v247 offset:34816
    v_mfma_f32_16x16x32_bf16 v[108:111], a[24:27], a[140:143], v[108:111]
    buffer_load_dwordx4 a[172:175], v236, s[16:19], s51 offen offset:3072 sc1
    v_mfma_f32_16x16x32_bf16 v[108:111], a[28:31], a[156:159], v[108:111]
    ds_read_b64_tr_b16 a[108:109], v248 offset:32768
    v_mfma_f32_16x16x32_bf16 v[176:179], a[24:27], a[240:243], v[176:179]
    ds_read_b64_tr_b16 a[110:111], v248 offset:34816
    v_mfma_f32_16x16x32_bf16 v[176:179], a[28:31], a[224:227], v[176:179]
    ds_read_b64_tr_b16 v[48:49], v245 offset:0
    v_mfma_f32_16x16x32_bf16 v[180:183], a[24:27], a[244:247], v[180:183]
    s_add_u32 s51, s46, 524288
    buffer_load_dwordx4 a[192:195], v236, s[16:19], s51 offen offset:2048 sc1
    v_mfma_f32_16x16x32_bf16 v[180:183], a[28:31], a[228:231], v[180:183]
    ds_read_b64_tr_b16 v[50:51], v245 offset:2048
    v_mfma_f32_16x16x32_bf16 v[184:187], a[24:27], a[248:251], v[184:187]
    ds_read_b64_tr_b16 v[52:53], v246 offset:0
    v_mfma_f32_16x16x32_bf16 v[184:187], a[28:31], a[232:235], v[184:187]
    ds_read_b64_tr_b16 v[54:55], v246 offset:2048
    v_mfma_f32_16x16x32_bf16 v[188:191], a[24:27], a[252:255], v[188:191]
    buffer_load_dwordx4 a[196:199], v236, s[16:19], s51 offen offset:3072 sc1
    v_mfma_f32_16x16x32_bf16 v[188:191], a[28:31], a[236:239], v[188:191]
    ds_read_b64_tr_b16 v[56:57], v247 offset:0
    s_waitcnt vmcnt(34)
    v_mfma_f32_16x16x32_bf16 v[112:115], a[48:51], a[128:131], v[112:115]
    ds_read_b64_tr_b16 v[58:59], v247 offset:2048
    v_mfma_f32_16x16x32_bf16 v[112:115], a[52:55], a[144:147], v[112:115]
    ds_read_b64_tr_b16 v[60:61], v248 offset:0
    v_mfma_f32_16x16x32_bf16 v[116:119], a[48:51], a[132:135], v[116:119]
    s_add_u32 s61, s42, 110592
    s_waitcnt lgkmcnt(7)
    s_add_u32 m0, s41, 98304
    s_nop 0
    buffer_load_dwordx4 v237, s[52:55], s61 offen offset:0  lds
    v_mfma_f32_16x16x32_bf16 v[116:119], a[52:55], a[148:151], v[116:119]
    ds_read_b64_tr_b16 v[62:63], v248 offset:2048
    v_mfma_f32_16x16x32_bf16 v[120:123], a[48:51], a[136:139], v[120:123]
    v_mfma_f32_16x16x32_bf16 v[120:123], a[52:55], a[152:155], v[120:123]
    v_mfma_f32_16x16x32_bf16 v[124:127], a[48:51], a[140:143], v[124:127]
    buffer_load_dwordx4 v238, s[52:55], s61 offen offset:1024  lds
    v_mfma_f32_16x16x32_bf16 v[124:127], a[52:55], a[156:159], v[124:127]
    v_mfma_f32_16x16x32_bf16 v[192:195], a[48:51], a[240:243], v[192:195]
    v_mfma_f32_16x16x32_bf16 v[192:195], a[52:55], a[224:227], v[192:195]
    v_mfma_f32_16x16x32_bf16 v[196:199], a[48:51], a[244:247], v[196:199]
    buffer_load_dwordx4 v239, s[52:55], s61 offen offset:2048  lds
    v_mfma_f32_16x16x32_bf16 v[196:199], a[52:55], a[228:231], v[196:199]
    v_mfma_f32_16x16x32_bf16 v[200:203], a[48:51], a[248:251], v[200:203]
    v_mfma_f32_16x16x32_bf16 v[200:203], a[52:55], a[232:235], v[200:203]
    v_mfma_f32_16x16x32_bf16 v[204:207], a[48:51], a[252:255], v[204:207]
    buffer_load_dwordx4 v240, s[52:55], s61 offen offset:3072  lds
    v_mfma_f32_16x16x32_bf16 v[204:207], a[52:55], a[236:239], v[204:207]
    s_waitcnt vmcnt(36)
    v_mfma_f32_16x16x32_bf16 v[128:131], a[56:59], a[128:131], v[128:131]
    v_mfma_f32_16x16x32_bf16 v[128:131], a[60:63], a[144:147], v[128:131]
    v_mfma_f32_16x16x32_bf16 v[132:135], a[56:59], a[132:135], v[132:135]
    s_add_u32 s51, s48, 0
    buffer_load_dwordx4 a[200:203], v236, s[16:19], s51 offen offset:0 sc1
    v_mfma_f32_16x16x32_bf16 v[132:135], a[60:63], a[148:151], v[132:135]
    v_mfma_f32_16x16x32_bf16 v[136:139], a[56:59], a[136:139], v[136:139]
    v_mfma_f32_16x16x32_bf16 v[136:139], a[60:63], a[152:155], v[136:139]
    v_mfma_f32_16x16x32_bf16 v[140:143], a[56:59], a[140:143], v[140:143]
    buffer_load_dwordx4 a[204:207], v236, s[16:19], s51 offen offset:1024 sc1
    v_mfma_f32_16x16x32_bf16 v[140:143], a[60:63], a[156:159], v[140:143]
    ds_read_b64_tr_b16 a[128:129], v245 offset:49152
    v_mfma_f32_16x16x32_bf16 v[208:211], a[56:59], a[240:243], v[208:211]
    ds_read_b64_tr_b16 a[130:131], v245 offset:51200
    v_mfma_f32_16x16x32_bf16 v[208:211], a[60:63], a[224:227], v[208:211]
    s_add_u32 s51, s48, 0
    buffer_load_dwordx4 a[24:27], v236, s[16:19], s51 offen offset:2048 sc1
    v_mfma_f32_16x16x32_bf16 v[212:215], a[56:59], a[244:247], v[212:215]
    ds_read_b64_tr_b16 a[132:133], v246 offset:49152
    v_mfma_f32_16x16x32_bf16 v[212:215], a[60:63], a[228:231], v[212:215]
    ds_read_b64_tr_b16 a[134:135], v246 offset:51200
    v_mfma_f32_16x16x32_bf16 v[216:219], a[56:59], a[248:251], v[216:219]
    ds_read_b64_tr_b16 a[136:137], v247 offset:49152
    v_mfma_f32_16x16x32_bf16 v[216:219], a[60:63], a[232:235], v[216:219]
    buffer_load_dwordx4 a[28:31], v236, s[16:19], s51 offen offset:3072 sc1
    v_mfma_f32_16x16x32_bf16 v[220:223], a[56:59], a[252:255], v[220:223]
    ds_read_b64_tr_b16 a[138:139], v247 offset:51200
    v_mfma_f32_16x16x32_bf16 v[220:223], a[60:63], a[236:239], v[220:223]
    ds_read_b64_tr_b16 a[140:141], v248 offset:49152
    s_waitcnt vmcnt(38)
    v_mfma_f32_16x16x32_bf16 v[64:67], a[0:3], a[80:83], v[64:67]
    ds_read_b64_tr_b16 a[142:143], v248 offset:51200
    v_mfma_f32_16x16x32_bf16 v[64:67], a[4:7], a[64:67], v[64:67]
    s_add_u32 s51, s48, 131072
    buffer_load_dwordx4 a[48:51], v236, s[16:19], s51 offen offset:0 sc1
    v_mfma_f32_16x16x32_bf16 v[68:71], a[0:3], a[84:87], v[68:71]
    v_mfma_f32_16x16x32_bf16 v[68:71], a[4:7], a[68:71], v[68:71]
    v_mfma_f32_16x16x32_bf16 v[72:75], a[0:3], a[88:91], v[72:75]
    v_mfma_f32_16x16x32_bf16 v[72:75], a[4:7], a[72:75], v[72:75]
    buffer_load_dwordx4 a[52:55], v236, s[16:19], s51 offen offset:1024 sc1
    v_mfma_f32_16x16x32_bf16 v[76:79], a[0:3], a[92:95], v[76:79]
    v_mfma_f32_16x16x32_bf16 v[76:79], a[4:7], a[76:79], v[76:79]
    s_waitcnt vmcnt(30)
    v_mfma_f32_16x16x32_bf16 v[80:83], a[8:11], a[80:83], v[80:83]
    v_mfma_f32_16x16x32_bf16 v[80:83], a[12:15], a[64:67], v[80:83]
    s_add_u32 s61, s43, 0
    s_waitcnt lgkmcnt(0)
    s_add_u32 m0, s41, 114688
    s_nop 0
    buffer_load_dwordx4 v237, s[52:55], s61 offen offset:0  lds
    v_mfma_f32_16x16x32_bf16 v[84:87], a[8:11], a[84:87], v[84:87]
    v_mfma_f32_16x16x32_bf16 v[84:87], a[12:15], a[68:71], v[84:87]
    v_mfma_f32_16x16x32_bf16 v[88:91], a[8:11], a[88:91], v[88:91]
    v_mfma_f32_16x16x32_bf16 v[88:91], a[12:15], a[72:75], v[88:91]
    buffer_load_dwordx4 v238, s[52:55], s61 offen offset:1024  lds
    v_mfma_f32_16x16x32_bf16 v[92:95], a[8:11], a[92:95], v[92:95]
    v_mfma_f32_16x16x32_bf16 v[92:95], a[12:15], a[76:79], v[92:95]
    s_waitcnt vmcnt(30)
    v_mfma_f32_16x16x32_bf16 v[96:99], a[32:35], a[80:83], v[96:99]
    v_mfma_f32_16x16x32_bf16 v[96:99], a[36:39], a[64:67], v[96:99]
    buffer_load_dwordx4 v239, s[52:55], s61 offen offset:2048  lds
    v_mfma_f32_16x16x32_bf16 v[100:103], a[32:35], a[84:87], v[100:103]
    v_mfma_f32_16x16x32_bf16 v[100:103], a[36:39], a[68:71], v[100:103]
    v_mfma_f32_16x16x32_bf16 v[104:107], a[32:35], a[88:91], v[104:107]
    ds_read_b64_tr_b16 a[224:225], v249 offset:0
    v_mfma_f32_16x16x32_bf16 v[104:107], a[36:39], a[72:75], v[104:107]
    buffer_load_dwordx4 v240, s[52:55], s61 offen offset:3072  lds
    v_mfma_f32_16x16x32_bf16 v[108:111], a[32:35], a[92:95], v[108:111]
    ds_read_b64_tr_b16 a[226:227], v249 offset:2048
    v_mfma_f32_16x16x32_bf16 v[108:111], a[36:39], a[76:79], v[108:111]
    ds_read_b64_tr_b16 a[228:229], v250 offset:0
    s_waitcnt vmcnt(30)
    v_mfma_f32_16x16x32_bf16 v[112:115], a[40:43], a[80:83], v[112:115]
    ds_read_b64_tr_b16 a[230:231], v250 offset:2048
    v_mfma_f32_16x16x32_bf16 v[112:115], a[44:47], a[64:67], v[112:115]
    s_add_u32 s51, s48, 131072
    buffer_load_dwordx4 a[56:59], v236, s[16:19], s51 offen offset:2048 sc1
    v_mfma_f32_16x16x32_bf16 v[116:119], a[40:43], a[84:87], v[116:119]
    ds_read_b64_tr_b16 a[232:233], v251 offset:0
    v_mfma_f32_16x16x32_bf16 v[116:119], a[44:47], a[68:71], v[116:119]
    ds_read_b64_tr_b16 a[234:235], v251 offset:2048
    v_mfma_f32_16x16x32_bf16 v[120:123], a[40:43], a[88:91], v[120:123]
    ds_read_b64_tr_b16 a[236:237], v252 offset:0
    v_mfma_f32_16x16x32_bf16 v[120:123], a[44:47], a[72:75], v[120:123]
    buffer_load_dwordx4 a[60:63], v236, s[16:19], s51 offen offset:3072 sc1
    v_mfma_f32_16x16x32_bf16 v[124:127], a[40:43], a[92:95], v[124:127]
    ds_read_b64_tr_b16 a[238:239], v252 offset:2048
    v_mfma_f32_16x16x32_bf16 v[124:127], a[44:47], a[76:79], v[124:127]
    ds_read_b64_tr_b16 a[240:241], v249 offset:16384
    s_waitcnt vmcnt(30)
    v_mfma_f32_16x16x32_bf16 v[128:131], a[176:179], a[80:83], v[128:131]
    s_add_u32 s51, s48, 262144
    buffer_load_dwordx4 a[144:147], v236, s[16:19], s51 offen offset:0 sc1
    v_mfma_f32_16x16x32_bf16 v[128:131], a[180:183], a[64:67], v[128:131]
    ds_read_b64_tr_b16 a[242:243], v249 offset:18432
    v_mfma_f32_16x16x32_bf16 v[132:135], a[176:179], a[84:87], v[132:135]
    ds_read_b64_tr_b16 a[244:245], v250 offset:16384
    v_mfma_f32_16x16x32_bf16 v[132:135], a[180:183], a[68:71], v[132:135]
    ds_read_b64_tr_b16 a[246:247], v250 offset:18432
    v_mfma_f32_16x16x32_bf16 v[136:139], a[176:179], a[88:91], v[136:139]
    buffer_load_dwordx4 a[148:151], v236, s[16:19], s51 offen offset:1024 sc1
    v_mfma_f32_16x16x32_bf16 v[136:139], a[180:183], a[72:75], v[136:139]
    ds_read_b64_tr_b16 a[248:249], v251 offset:16384
    v_mfma_f32_16x16x32_bf16 v[140:143], a[176:179], a[92:95], v[140:143]
    ds_read_b64_tr_b16 a[250:251], v251 offset:18432
    v_mfma_f32_16x16x32_bf16 v[140:143], a[180:183], a[76:79], v[140:143]
    ds_read_b64_tr_b16 a[252:253], v252 offset:16384
    s_waitcnt vmcnt(30)
    v_mfma_f32_16x16x32_bf16 v[64:67], a[184:187], a[208:211], v[64:67]
    s_add_u32 s61, s43, 36864
    s_waitcnt lgkmcnt(7)
    s_add_u32 m0, s41, 131072
    s_nop 0
    buffer_load_dwordx4 v237, s[52:55], s61 offen offset:0  lds
    v_mfma_f32_16x16x32_bf16 v[64:67], a[188:191], v[32:35], v[64:67]
    ds_read_b64_tr_b16 a[254:255], v252 offset:18432
    v_mfma_f32_16x16x32_bf16 v[68:71], a[184:187], a[212:215], v[68:71]
    v_mfma_f32_16x16x32_bf16 v[68:71], a[188:191], v[36:39], v[68:71]
    v_mfma_f32_16x16x32_bf16 v[72:75], a[184:187], a[216:219], v[72:75]
    buffer_load_dwordx4 v238, s[52:55], s61 offen offset:1024  lds
    v_mfma_f32_16x16x32_bf16 v[72:75], a[188:191], v[40:43], v[72:75]
    v_mfma_f32_16x16x32_bf16 v[76:79], a[184:187], a[220:223], v[76:79]
    v_mfma_f32_16x16x32_bf16 v[76:79], a[188:191], v[44:47], v[76:79]
    s_waitcnt vmcnt(26)
    v_mfma_f32_16x16x32_bf16 v[80:83], a[16:19], a[208:211], v[80:83]
    buffer_load_dwordx4 v239, s[52:55], s61 offen offset:2048  lds
    v_mfma_f32_16x16x32_bf16 v[80:83], a[20:23], v[32:35], v[80:83]
    v_mfma_f32_16x16x32_bf16 v[84:87], a[16:19], a[212:215], v[84:87]
    v_mfma_f32_16x16x32_bf16 v[84:87], a[20:23], v[36:39], v[84:87]
    v_mfma_f32_16x16x32_bf16 v[88:91], a[16:19], a[216:219], v[88:91]
    buffer_load_dwordx4 v240, s[52:55], s61 offen offset:3072  lds
    v_mfma_f32_16x16x32_bf16 v[88:91], a[20:23], v[40:43], v[88:91]
    v_mfma_f32_16x16x32_bf16 v[92:95], a[16:19], a[220:223], v[92:95]
    v_mfma_f32_16x16x32_bf16 v[92:95], a[20:23], v[44:47], v[92:95]
    s_waitcnt vmcnt(26)
    v_mfma_f32_16x16x32_bf16 v[96:99], a[160:163], a[208:211], v[96:99]
    s_add_u32 s51, s48, 262144
    buffer_load_dwordx4 a[152:155], v236, s[16:19], s51 offen offset:2048 sc1
    v_mfma_f32_16x16x32_bf16 v[96:99], a[164:167], v[32:35], v[96:99]
    v_mfma_f32_16x16x32_bf16 v[100:103], a[160:163], a[212:215], v[100:103]
    v_mfma_f32_16x16x32_bf16 v[100:103], a[164:167], v[36:39], v[100:103]
    v_mfma_f32_16x16x32_bf16 v[104:107], a[160:163], a[216:219], v[104:107]
    buffer_load_dwordx4 a[156:159], v236, s[16:19], s51 offen offset:3072 sc1
    v_mfma_f32_16x16x32_bf16 v[104:107], a[164:167], v[40:43], v[104:107]
    ds_read_b64_tr_b16 a[64:65], v245 offset:16384
    v_mfma_f32_16x16x32_bf16 v[108:111], a[160:163], a[220:223], v[108:111]
    ds_read_b64_tr_b16 a[66:67], v245 offset:18432
    v_mfma_f32_16x16x32_bf16 v[108:111], a[164:167], v[44:47], v[108:111]
    ds_read_b64_tr_b16 a[68:69], v246 offset:16384
    s_waitcnt vmcnt(26)
    v_mfma_f32_16x16x32_bf16 v[112:115], a[168:171], a[208:211], v[112:115]
    s_add_u32 s51, s48, 393216
    buffer_load_dwordx4 a[80:83], v236, s[16:19], s51 offen offset:0 sc1
    v_mfma_f32_16x16x32_bf16 v[112:115], a[172:175], v[32:35], v[112:115]
    ds_read_b64_tr_b16 a[70:71], v246 offset:18432
    v_mfma_f32_16x16x32_bf16 v[116:119], a[168:171], a[212:215], v[116:119]
    ds_read_b64_tr_b16 a[72:73], v247 offset:16384
    v_mfma_f32_16x16x32_bf16 v[116:119], a[172:175], v[36:39], v[116:119]
    ds_read_b64_tr_b16 a[74:75], v247 offset:18432
    v_mfma_f32_16x16x32_bf16 v[120:123], a[168:171], a[216:219], v[120:123]
    buffer_load_dwordx4 a[84:87], v236, s[16:19], s51 offen offset:1024 sc1
    v_mfma_f32_16x16x32_bf16 v[120:123], a[172:175], v[40:43], v[120:123]
    ds_read_b64_tr_b16 a[76:77], v248 offset:16384
    v_mfma_f32_16x16x32_bf16 v[124:127], a[168:171], a[220:223], v[124:127]
    ds_read_b64_tr_b16 a[78:79], v248 offset:18432
    v_mfma_f32_16x16x32_bf16 v[124:127], a[172:175], v[44:47], v[124:127]
    s_add_u32 s51, s48, 393216
    buffer_load_dwordx4 a[88:91], v236, s[16:19], s51 offen offset:2048 sc1
    s_waitcnt vmcnt(27)
    v_mfma_f32_16x16x32_bf16 v[128:131], a[192:195], a[208:211], v[128:131]
    v_mfma_f32_16x16x32_bf16 v[128:131], a[196:199], v[32:35], v[128:131]
    v_mfma_f32_16x16x32_bf16 v[132:135], a[192:195], a[212:215], v[132:135]
    v_mfma_f32_16x16x32_bf16 v[132:135], a[196:199], v[36:39], v[132:135]
    buffer_load_dwordx4 a[92:95], v236, s[16:19], s51 offen offset:3072 sc1
    v_mfma_f32_16x16x32_bf16 v[136:139], a[192:195], a[216:219], v[136:139]
    v_mfma_f32_16x16x32_bf16 v[136:139], a[196:199], v[40:43], v[136:139]
    v_mfma_f32_16x16x32_bf16 v[140:143], a[192:195], a[220:223], v[140:143]
    v_mfma_f32_16x16x32_bf16 v[140:143], a[196:199], v[44:47], v[140:143]
    s_add_u32 s51, s48, 524288
    buffer_load_dwordx4 a[208:211], v236, s[16:19], s51 offen offset:0 sc1
    s_waitcnt vmcnt(23)
    v_mfma_f32_16x16x32_bf16 v[64:67], a[200:203], a[112:115], v[64:67]
    ds_read_b64_tr_b16 v[32:33], v245 offset:32768
    v_mfma_f32_16x16x32_bf16 v[64:67], a[204:207], a[96:99], v[64:67]
    ds_read_b64_tr_b16 v[34:35], v245 offset:34816
    s_waitcnt vmcnt(21)
    v_mfma_f32_16x16x32_bf16 v[64:67], a[24:27], v[48:51], v[64:67]
    ds_read_b64_tr_b16 v[36:37], v246 offset:32768
    v_mfma_f32_16x16x32_bf16 v[64:67], a[28:31], a[128:131], v[64:67]
    buffer_load_dwordx4 a[212:215], v236, s[16:19], s51 offen offset:1024 sc1
    v_mfma_f32_16x16x32_bf16 v[68:71], a[200:203], a[116:119], v[68:71]
    ds_read_b64_tr_b16 v[38:39], v246 offset:34816
    v_mfma_f32_16x16x32_bf16 v[68:71], a[204:207], a[100:103], v[68:71]
    ds_read_b64_tr_b16 v[40:41], v247 offset:32768
    v_mfma_f32_16x16x32_bf16 v[68:71], a[24:27], v[52:55], v[68:71]
    ds_read_b64_tr_b16 v[42:43], v247 offset:34816
    v_mfma_f32_16x16x32_bf16 v[68:71], a[28:31], a[132:135], v[68:71]
    s_add_u32 s51, s48, 524288
    buffer_load_dwordx4 a[216:219], v236, s[16:19], s51 offen offset:2048 sc1
    v_mfma_f32_16x16x32_bf16 v[72:75], a[200:203], a[120:123], v[72:75]
    ds_read_b64_tr_b16 v[44:45], v248 offset:32768
    s_add_u32 m0, s41, 0
    s_nop 0
    ds_write_addtid_b32 v64 offset:0
    v_mfma_f32_16x16x32_bf16 v[72:75], a[204:207], a[104:107], v[72:75]
    ds_read_b64_tr_b16 v[46:47], v248 offset:34816
    v_mfma_f32_16x16x32_bf16 v[72:75], a[24:27], v[56:59], v[72:75]
    ds_write_addtid_b32 v65 offset:256
    v_mfma_f32_16x16x32_bf16 v[72:75], a[28:31], a[136:139], v[72:75]
    buffer_load_dwordx4 a[220:223], v236, s[16:19], s51 offen offset:3072 sc1
    v_mfma_f32_16x16x32_bf16 v[76:79], a[200:203], a[124:127], v[76:79]
    ds_write_addtid_b32 v66 offset:512
    ds_write_addtid_b32 v67 offset:768
    v_mfma_f32_16x16x32_bf16 v[76:79], a[204:207], a[108:111], v[76:79]
    ds_write_addtid_b32 v68 offset:1024
    v_mfma_f32_16x16x32_bf16 v[76:79], a[24:27], v[60:63], v[76:79]
    ds_write_addtid_b32 v69 offset:1280
    v_mfma_f32_16x16x32_bf16 v[76:79], a[28:31], a[140:143], v[76:79]
    ds_write_addtid_b32 v70 offset:1536
    s_waitcnt vmcnt(22)
    v_mfma_f32_16x16x32_bf16 v[80:83], a[48:51], a[112:115], v[80:83]
    ds_write_addtid_b32 v71 offset:1792
    v_mfma_f32_16x16x32_bf16 v[80:83], a[52:55], a[96:99], v[80:83]
    ds_write_addtid_b32 v72 offset:2048
    s_waitcnt vmcnt(16)
    v_mfma_f32_16x16x32_bf16 v[80:83], a[56:59], v[48:51], v[80:83]
    ds_write_addtid_b32 v73 offset:2304
    v_mfma_f32_16x16x32_bf16 v[80:83], a[60:63], a[128:131], v[80:83]
    ds_write_addtid_b32 v74 offset:2560
    v_mfma_f32_16x16x32_bf16 v[84:87], a[48:51], a[116:119], v[84:87]
    ds_write_addtid_b32 v75 offset:2816
    v_mfma_f32_16x16x32_bf16 v[84:87], a[52:55], a[100:103], v[84:87]
    ds_write_addtid_b32 v76 offset:3072
    v_mfma_f32_16x16x32_bf16 v[84:87], a[56:59], v[52:55], v[84:87]
    ds_write_addtid_b32 v77 offset:3328
    v_mfma_f32_16x16x32_bf16 v[84:87], a[60:63], a[132:135], v[84:87]
    ds_write_addtid_b32 v78 offset:3584
    v_mfma_f32_16x16x32_bf16 v[88:91], a[48:51], a[120:123], v[88:91]
    ds_write_addtid_b32 v79 offset:3840
    v_mfma_f32_16x16x32_bf16 v[88:91], a[52:55], a[104:107], v[88:91]
    ds_write_addtid_b32 v80 offset:16384
    v_mfma_f32_16x16x32_bf16 v[88:91], a[56:59], v[56:59], v[88:91]
    ds_write_addtid_b32 v81 offset:16640
    v_mfma_f32_16x16x32_bf16 v[88:91], a[60:63], a[136:139], v[88:91]
    ds_write_addtid_b32 v82 offset:16896
    v_mfma_f32_16x16x32_bf16 v[92:95], a[48:51], a[124:127], v[92:95]
    ds_write_addtid_b32 v83 offset:17152
    v_mfma_f32_16x16x32_bf16 v[92:95], a[52:55], a[108:111], v[92:95]
    ds_write_addtid_b32 v84 offset:17408
    v_mfma_f32_16x16x32_bf16 v[92:95], a[56:59], v[60:63], v[92:95]
    ds_write_addtid_b32 v85 offset:17664
    v_mfma_f32_16x16x32_bf16 v[92:95], a[60:63], a[140:143], v[92:95]
    ds_write_addtid_b32 v86 offset:17920
    s_waitcnt vmcnt(14)
    v_mfma_f32_16x16x32_bf16 v[96:99], a[144:147], a[112:115], v[96:99]
    ds_write_addtid_b32 v87 offset:18176
    v_mfma_f32_16x16x32_bf16 v[96:99], a[148:151], a[96:99], v[96:99]
    ds_write_addtid_b32 v88 offset:18432
    s_waitcnt vmcnt(8)
    v_mfma_f32_16x16x32_bf16 v[96:99], a[152:155], v[48:51], v[96:99]
    ds_write_addtid_b32 v89 offset:18688
    v_mfma_f32_16x16x32_bf16 v[96:99], a[156:159], a[128:131], v[96:99]
    ds_write_addtid_b32 v90 offset:18944
    v_mfma_f32_16x16x32_bf16 v[100:103], a[144:147], a[116:119], v[100:103]
    ds_write_addtid_b32 v91 offset:19200
    v_mfma_f32_16x16x32_bf16 v[100:103], a[148:151], a[100:103], v[100:103]
    ds_write_addtid_b32 v92 offset:19456
    v_mfma_f32_16x16x32_bf16 v[100:103], a[152:155], v[52:55], v[100:103]
    ds_write_addtid_b32 v93 offset:19712
    v_mfma_f32_16x16x32_bf16 v[100:103], a[156:159], a[132:135], v[100:103]
    ds_write_addtid_b32 v94 offset:19968
    v_mfma_f32_16x16x32_bf16 v[104:107], a[144:147], a[120:123], v[104:107]
    ds_write_addtid_b32 v95 offset:20224
    v_mfma_f32_16x16x32_bf16 v[104:107], a[148:151], a[104:107], v[104:107]
    ds_write_addtid_b32 v96 offset:32768
    v_mfma_f32_16x16x32_bf16 v[104:107], a[152:155], v[56:59], v[104:107]
    ds_write_addtid_b32 v97 offset:33024
    v_mfma_f32_16x16x32_bf16 v[104:107], a[156:159], a[136:139], v[104:107]
    ds_write_addtid_b32 v98 offset:33280
    v_mfma_f32_16x16x32_bf16 v[108:111], a[144:147], a[124:127], v[108:111]
    ds_write_addtid_b32 v99 offset:33536
    v_mfma_f32_16x16x32_bf16 v[108:111], a[148:151], a[108:111], v[108:111]
    ds_write_addtid_b32 v100 offset:33792
    v_mfma_f32_16x16x32_bf16 v[108:111], a[152:155], v[60:63], v[108:111]
    ds_write_addtid_b32 v101 offset:34048
    v_mfma_f32_16x16x32_bf16 v[108:111], a[156:159], a[140:143], v[108:111]
    ds_write_addtid_b32 v102 offset:34304
    s_waitcnt vmcnt(6)
    v_mfma_f32_16x16x32_bf16 v[112:115], a[80:83], a[112:115], v[112:115]
    ds_write_addtid_b32 v103 offset:34560
    v_mfma_f32_16x16x32_bf16 v[112:115], a[84:87], a[96:99], v[112:115]
    ds_write_addtid_b32 v104 offset:34816
    s_waitcnt vmcnt(4)
    v_mfma_f32_16x16x32_bf16 v[112:115], a[88:91], v[48:51], v[112:115]
    ds_write_addtid_b32 v105 offset:35072
    v_mfma_f32_16x16x32_bf16 v[112:115], a[92:95], a[128:131], v[112:115]
    ds_write_addtid_b32 v106 offset:35328
    v_mfma_f32_16x16x32_bf16 v[116:119], a[80:83], a[116:119], v[116:119]
    ds_write_addtid_b32 v107 offset:35584
    v_mfma_f32_16x16x32_bf16 v[116:119], a[84:87], a[100:103], v[116:119]
    ds_write_addtid_b32 v108 offset:35840
    v_mfma_f32_16x16x32_bf16 v[116:119], a[88:91], v[52:55], v[116:119]
    ds_write_addtid_b32 v109 offset:36096
    v_mfma_f32_16x16x32_bf16 v[116:119], a[92:95], a[132:135], v[116:119]
    ds_write_addtid_b32 v110 offset:36352
    v_mfma_f32_16x16x32_bf16 v[120:123], a[80:83], a[120:123], v[120:123]
    ds_write_addtid_b32 v111 offset:36608
    v_mfma_f32_16x16x32_bf16 v[120:123], a[84:87], a[104:107], v[120:123]
    v_mfma_f32_16x16x32_bf16 v[120:123], a[88:91], v[56:59], v[120:123]
    v_mfma_f32_16x16x32_bf16 v[120:123], a[92:95], a[136:139], v[120:123]
    v_mfma_f32_16x16x32_bf16 v[124:127], a[80:83], a[124:127], v[124:127]
    s_waitcnt lgkmcnt(0)
    s_barrier
    v_mfma_f32_16x16x32_bf16 v[124:127], a[84:87], a[108:111], v[124:127]
    ds_write_addtid_b32 v112 offset:49152
    ds_read_b128 v[64:67], v224 offset:0
    v_mfma_f32_16x16x32_bf16 v[124:127], a[88:91], v[60:63], v[124:127]
    ds_write_addtid_b32 v113 offset:49408
    ds_read_b128 v[68:71], v224 offset:4096
    v_mfma_f32_16x16x32_bf16 v[124:127], a[92:95], a[140:143], v[124:127]
    ds_write_addtid_b32 v114 offset:49664
    ds_read_b128 v[72:75], v224 offset:8192
    s_waitcnt vmcnt(2)
    v_mfma_f32_16x16x32_bf16 v[128:131], a[208:211], a[112:115], v[128:131]
    ds_write_addtid_b32 v115 offset:49920
    ds_read_b128 v[76:79], v224 offset:12288
    v_mfma_f32_16x16x32_bf16 v[128:131], a[212:215], a[96:99], v[128:131]
    ds_write_addtid_b32 v116 offset:50176
    ds_read_b128 v[80:83], v224 offset:16384
    s_waitcnt vmcnt(0)
    v_mfma_f32_16x16x32_bf16 v[128:131], a[216:219], v[48:51], v[128:131]
    ds_write_addtid_b32 v117 offset:50432
    ds_read_b128 v[84:87], v224 offset:20480
    v_mfma_f32_16x16x32_bf16 v[128:131], a[220:223], a[128:131], v[128:131]
    ds_write_addtid_b32 v118 offset:50688
    ds_read_b128 v[88:91], v224 offset:24576
    v_mfma_f32_16x16x32_bf16 v[132:135], a[208:211], a[116:119], v[132:135]
    ds_write_addtid_b32 v119 offset:50944
    ds_read_b128 v[92:95], v224 offset:28672
    v_mfma_f32_16x16x32_bf16 v[132:135], a[212:215], a[100:103], v[132:135]
    ds_write_addtid_b32 v120 offset:51200
    ds_read_b128 v[96:99], v224 offset:32768
    v_mfma_f32_16x16x32_bf16 v[132:135], a[216:219], v[52:55], v[132:135]
    ds_write_addtid_b32 v121 offset:51456
    ds_read_b128 v[100:103], v224 offset:36864
    v_mfma_f32_16x16x32_bf16 v[132:135], a[220:223], a[132:135], v[132:135]
    ds_write_addtid_b32 v122 offset:51712
    ds_read_b128 v[104:107], v224 offset:40960
    v_mfma_f32_16x16x32_bf16 v[136:139], a[208:211], a[120:123], v[136:139]
    ds_write_addtid_b32 v123 offset:51968
    ds_read_b128 v[108:111], v224 offset:45056
    v_mfma_f32_16x16x32_bf16 v[136:139], a[212:215], a[104:107], v[136:139]
    ds_write_addtid_b32 v124 offset:52224
    ds_write_addtid_b32 v125 offset:52480
    s_waitcnt lgkmcnt(15)
    v_add_f32 v64, v64, v68
    v_add_f32 v72, v72, v76
    v_mfma_f32_16x16x32_bf16 v[136:139], a[216:219], v[56:59], v[136:139]
    ds_write_addtid_b32 v126 offset:52736
    ds_write_addtid_b32 v127 offset:52992
    v_add_f32 v65, v65, v69
    v_add_f32 v73, v73, v77
    s_add_u32 m0, s41, 16384
    v_mfma_f32_16x16x32_bf16 v[136:139], a[220:223], a[136:139], v[136:139]
    ds_write_addtid_b32 v128 offset:49152
    v_add_f32 v66, v66, v70
    v_add_f32 v74, v74, v78
    v_mfma_f32_16x16x32_bf16 v[140:143], a[208:211], a[124:127], v[140:143]
    ds_write_addtid_b32 v129 offset:49408
    ds_write_addtid_b32 v130 offset:49664
    v_add_f32 v67, v67, v71
    v_add_f32 v75, v75, v79
    v_mfma_f32_16x16x32_bf16 v[140:143], a[212:215], a[108:111], v[140:143]
    ds_read_b64_tr_b16 a[112:113], v245 offset:49152
    ds_write_addtid_b32 v131 offset:49920
    v_add_f32 v64, v64, v72
    v_add_f32 v65, v65, v73
    v_mfma_f32_16x16x32_bf16 v[140:143], a[216:219], v[60:63], v[140:143]
    ds_read_b64_tr_b16 a[114:115], v245 offset:51200
    ds_write_addtid_b32 v132 offset:50176
    v_add_f32 v66, v66, v74
    v_add_f32 v67, v67, v75
    v_mfma_f32_16x16x32_bf16 v[140:143], a[220:223], a[140:143], v[140:143]
    ds_write_addtid_b32 v133 offset:50432
    buffer_store_dwordx4 v[64:67], v236, s[4:7], s63 offen offset:0 sc1
    v_mfma_f32_16x16x32_bf16 v[144:147], a[0:3], a[224:227], v[144:147]
    ds_read_b64_tr_b16 a[116:117], v246 offset:49152
    ds_write_addtid_b32 v134 offset:50688
    s_waitcnt lgkmcnt(15)
    v_add_f32 v80, v80, v84
    v_add_f32 v88, v88, v92
    v_mfma_f32_16x16x32_bf16 v[144:147], a[4:7], a[240:243], v[144:147]
    ds_read_b64_tr_b16 a[118:119], v246 offset:51200
    ds_write_addtid_b32 v135 offset:50944
    v_add_f32 v81, v81, v85
    v_add_f32 v89, v89, v93
    v_mfma_f32_16x16x32_bf16 v[148:151], a[0:3], a[228:231], v[148:151]
    ds_read_b64_tr_b16 a[120:121], v247 offset:49152
    ds_write_addtid_b32 v136 offset:51200
    v_add_f32 v82, v82, v86
    v_add_f32 v90, v90, v94
    v_mfma_f32_16x16x32_bf16 v[148:151], a[4:7], a[244:247], v[148:151]
    ds_read_b64_tr_b16 a[122:123], v247 offset:51200
    ds_write_addtid_b32 v137 offset:51456
    v_add_f32 v83, v83, v87
    v_add_f32 v91, v91, v95
    v_mfma_f32_16x16x32_bf16 v[152:155], a[0:3], a[232:235], v[152:155]
    ds_read_b64_tr_b16 a[124:125], v248 offset:49152
    ds_write_addtid_b32 v138 offset:51712
    v_add_f32 v80, v80, v88
    v_add_f32 v81, v81, v89
    v_mfma_f32_16x16x32_bf16 v[152:155], a[4:7], a[248:251], v[152:155]
    ds_read_b64_tr_b16 a[126:127], v248 offset:51200
    ds_write_addtid_b32 v139 offset:51968
    v_add_f32 v82, v82, v90
    v_add_f32 v83, v83, v91
    v_mfma_f32_16x16x32_bf16 v[156:159], a[0:3], a[236:239], v[156:159]
    ds_write_addtid_b32 v140 offset:52224
    buffer_store_dwordx4 v[80:83], v236, s[4:7], s63 offen offset:1024 sc1
    v_mfma_f32_16x16x32_bf16 v[156:159], a[4:7], a[252:255], v[156:159]
    ds_read_b64_tr_b16 a[128:129], v249 offset:0
    ds_write_addtid_b32 v141 offset:52480
    s_waitcnt lgkmcnt(15)
    v_add_f32 v96, v96, v100
    v_add_f32 v104, v104, v108
    v_mfma_f32_16x16x32_bf16 v[160:163], a[8:11], a[224:227], v[160:163]
    ds_read_b64_tr_b16 a[130:131], v249 offset:2048
    ds_write_addtid_b32 v142 offset:52736
    v_add_f32 v97, v97, v101
    v_add_f32 v105, v105, v109
    v_mfma_f32_16x16x32_bf16 v[160:163], a[12:15], a[240:243], v[160:163]
    ds_read_b64_tr_b16 a[132:133], v250 offset:0
    ds_write_addtid_b32 v143 offset:52992
    v_add_f32 v98, v98, v102
    v_add_f32 v106, v106, v110
    v_mfma_f32_16x16x32_bf16 v[164:167], a[8:11], a[228:231], v[164:167]
    s_add_u32 s61, s43, 73728
    s_add_u32 m0, s41, 81920
    s_nop 0
    buffer_load_dwordx4 v237, s[52:55], s61 offen offset:0  lds
    v_add_f32 v99, v99, v103
    v_add_f32 v107, v107, v111
    v_mfma_f32_16x16x32_bf16 v[164:167], a[12:15], a[244:247], v[164:167]
    buffer_load_dwordx4 v238, s[52:55], s61 offen offset:1024  lds
    v_add_f32 v96, v96, v104
    v_add_f32 v97, v97, v105
    v_mfma_f32_16x16x32_bf16 v[168:171], a[8:11], a[232:235], v[168:171]
    buffer_load_dwordx4 v239, s[52:55], s61 offen offset:2048  lds
    v_add_f32 v98, v98, v106
    v_add_f32 v99, v99, v107
    v_mfma_f32_16x16x32_bf16 v[168:171], a[12:15], a[248:251], v[168:171]
    buffer_store_dwordx4 v[96:99], v236, s[4:7], s63 offen offset:2048 sc1
    v_mfma_f32_16x16x32_bf16 v[172:175], a[8:11], a[236:239], v[172:175]
    buffer_load_dwordx4 v240, s[52:55], s61 offen offset:3072  lds
    s_waitcnt lgkmcnt(0)
    s_barrier
    v_mfma_f32_16x16x32_bf16 v[172:175], a[12:15], a[252:255], v[172:175]
    ds_read_b128 v[112:115], v224 offset:49152
    v_mfma_f32_16x16x32_bf16 v[176:179], a[32:35], a[224:227], v[176:179]
    ds_read_b128 v[116:119], v224 offset:53248
    v_mfma_f32_16x16x32_bf16 v[176:179], a[36:39], a[240:243], v[176:179]
    ds_read_b128 v[120:123], v224 offset:57344
    v_mfma_f32_16x16x32_bf16 v[180:183], a[32:35], a[228:231], v[180:183]
    ds_read_b128 v[124:127], v224 offset:61440
    v_mfma_f32_16x16x32_bf16 v[180:183], a[36:39], a[244:247], v[180:183]
    ds_read_b128 v[128:131], v225 offset:0
    v_mfma_f32_16x16x32_bf16 v[184:187], a[32:35], a[232:235], v[184:187]
    ds_read_b128 v[132:135], v225 offset:4096
    v_mfma_f32_16x16x32_bf16 v[184:187], a[36:39], a[248:251], v[184:187]
    ds_read_b128 v[136:139], v225 offset:8192
    v_mfma_f32_16x16x32_bf16 v[188:191], a[32:35], a[236:239], v[188:191]
    ds_read_b128 v[140:143], v225 offset:12288
    v_mfma_f32_16x16x32_bf16 v[188:191], a[36:39], a[252:255], v[188:191]
    s_add_u32 s61, s43, 110592
    s_add_u32 m0, s41, 98304
    s_nop 0
    buffer_load_dwordx4 v237, s[52:55], s61 offen offset:0  lds
    s_waitcnt lgkmcnt(4)
    v_add_f32 v112, v112, v116
    v_add_f32 v120, v120, v124
    v_mfma_f32_16x16x32_bf16 v[192:195], a[40:43], a[224:227], v[192:195]
    buffer_load_dwordx4 v238, s[52:55], s61 offen offset:1024  lds
    v_add_f32 v113, v113, v117
    v_add_f32 v121, v121, v125
    v_mfma_f32_16x16x32_bf16 v[192:195], a[44:47], a[240:243], v[192:195]
    buffer_load_dwordx4 v239, s[52:55], s61 offen offset:2048  lds
    v_add_f32 v114, v114, v118
    v_add_f32 v122, v122, v126
    v_mfma_f32_16x16x32_bf16 v[196:199], a[40:43], a[228:231], v[196:199]
    ds_read_b64_tr_b16 a[134:135], v250 offset:2048
    v_add_f32 v115, v115, v119
    v_add_f32 v123, v123, v127
    v_mfma_f32_16x16x32_bf16 v[196:199], a[44:47], a[244:247], v[196:199]
    buffer_load_dwordx4 v240, s[52:55], s61 offen offset:3072  lds
    v_add_f32 v112, v112, v120
    v_add_f32 v113, v113, v121
    v_mfma_f32_16x16x32_bf16 v[200:203], a[40:43], a[232:235], v[200:203]
    ds_read_b64_tr_b16 a[136:137], v251 offset:0
    v_add_f32 v114, v114, v122
    v_add_f32 v115, v115, v123
    v_mfma_f32_16x16x32_bf16 v[200:203], a[44:47], a[248:251], v[200:203]
    buffer_store_dwordx4 v[112:115], v236, s[4:7], s63 offen offset:3072 sc1
    v_mfma_f32_16x16x32_bf16 v[204:207], a[40:43], a[236:239], v[204:207]
    ds_read_b64_tr_b16 a[138:139], v251 offset:2048
    s_waitcnt lgkmcnt(3)
    v_add_f32 v128, v128, v132
    v_add_f32 v136, v136, v140
    v_mfma_f32_16x16x32_bf16 v[204:207], a[44:47], a[252:255], v[204:207]
    ds_read_b64_tr_b16 a[140:141], v252 offset:0
    v_add_f32 v129, v129, v133
    v_add_f32 v137, v137, v141
    v_mfma_f32_16x16x32_bf16 v[208:211], a[176:179], a[224:227], v[208:211]
    ds_read_b64_tr_b16 a[142:143], v252 offset:2048
    v_add_f32 v130, v130, v134
    v_add_f32 v138, v138, v142
    v_mfma_f32_16x16x32_bf16 v[208:211], a[180:183], a[240:243], v[208:211]
    v_add_f32 v131, v131, v135
    v_add_f32 v139, v139, v143
    v_mfma_f32_16x16x32_bf16 v[212:215], a[176:179], a[228:231], v[212:215]
    v_add_f32 v128, v128, v136
    v_add_f32 v129, v129, v137
    v_mfma_f32_16x16x32_bf16 v[212:215], a[180:183], a[244:247], v[212:215]
    v_add_f32 v130, v130, v138
    v_add_f32 v131, v131, v139
    v_mfma_f32_16x16x32_bf16 v[216:219], a[176:179], a[232:235], v[216:219]
    s_add_u32 s63, s63, 4096
    buffer_store_dwordx4 v[128:131], v236, s[4:7], s63 offen offset:0 sc1
    v_mfma_f32_16x16x32_bf16 v[216:219], a[180:183], a[248:251], v[216:219]
    v_mfma_f32_16x16x32_bf16 v[220:223], a[176:179], a[236:239], v[220:223]
    v_mfma_f32_16x16x32_bf16 v[220:223], a[180:183], a[252:255], v[220:223]
    v_mfma_f32_16x16x32_bf16 v[144:147], a[184:187], a[64:67], v[144:147]
    v_mfma_f32_16x16x32_bf16 v[144:147], a[188:191], v[32:35], v[144:147]
    v_mfma_f32_16x16x32_bf16 v[148:151], a[184:187], a[68:71], v[148:151]
    v_mfma_f32_16x16x32_bf16 v[148:151], a[188:191], v[36:39], v[148:151]
    v_mfma_f32_16x16x32_bf16 v[152:155], a[184:187], a[72:75], v[152:155]
    v_mfma_f32_16x16x32_bf16 v[152:155], a[188:191], v[40:43], v[152:155]
    v_mfma_f32_16x16x32_bf16 v[156:159], a[184:187], a[76:79], v[156:159]
    v_mfma_f32_16x16x32_bf16 v[156:159], a[188:191], v[44:47], v[156:159]
    v_mfma_f32_16x16x32_bf16 v[160:163], a[16:19], a[64:67], v[160:163]
    v_mfma_f32_16x16x32_bf16 v[160:163], a[20:23], v[32:35], v[160:163]
    v_mfma_f32_16x16x32_bf16 v[164:167], a[16:19], a[68:71], v[164:167]
    v_mfma_f32_16x16x32_bf16 v[164:167], a[20:23], v[36:39], v[164:167]
    v_mfma_f32_16x16x32_bf16 v[168:171], a[16:19], a[72:75], v[168:171]
    v_mfma_f32_16x16x32_bf16 v[168:171], a[20:23], v[40:43], v[168:171]
    v_mfma_f32_16x16x32_bf16 v[172:175], a[16:19], a[76:79], v[172:175]
    v_mfma_f32_16x16x32_bf16 v[172:175], a[20:23], v[44:47], v[172:175]
    v_mfma_f32_16x16x32_bf16 v[176:179], a[160:163], a[64:67], v[176:179]
    v_mfma_f32_16x16x32_bf16 v[176:179], a[164:167], v[32:35], v[176:179]
    v_mfma_f32_16x16x32_bf16 v[180:183], a[160:163], a[68:71], v[180:183]
    v_mfma_f32_16x16x32_bf16 v[180:183], a[164:167], v[36:39], v[180:183]
    v_mfma_f32_16x16x32_bf16 v[184:187], a[160:163], a[72:75], v[184:187]
    v_mfma_f32_16x16x32_bf16 v[184:187], a[164:167], v[40:43], v[184:187]
    v_mfma_f32_16x16x32_bf16 v[188:191], a[160:163], a[76:79], v[188:191]
    s_waitcnt vmcnt(6)
    ds_read_b64_tr_b16 a[240:241], v245 offset:16384
    v_mfma_f32_16x16x32_bf16 v[188:191], a[164:167], v[44:47], v[188:191]
    ds_read_b64_tr_b16 a[242:243], v245 offset:18432
    v_mfma_f32_16x16x32_bf16 v[192:195], a[168:171], a[64:67], v[192:195]
    ds_read_b64_tr_b16 a[244:245], v246 offset:16384
    v_mfma_f32_16x16x32_bf16 v[192:195], a[172:175], v[32:35], v[192:195]
    ds_read_b64_tr_b16 a[246:247], v246 offset:18432
    v_mfma_f32_16x16x32_bf16 v[196:199], a[168:171], a[68:71], v[196:199]
    ds_read_b64_tr_b16 a[248:249], v247 offset:16384
    s_waitcnt vmcnt(0)
    s_mov_b64 exec, 1
    buffer_store_dword v253, off, s[4:7], s38 sc1
    s_mov_b64 exec, -1
    v_mfma_f32_16x16x32_bf16 v[196:199], a[172:175], v[36:39], v[196:199]
    ds_read_b64_tr_b16 a[250:251], v247 offset:18432
    v_mfma_f32_16x16x32_bf16 v[200:203], a[168:171], a[72:75], v[200:203]
    ds_read_b64_tr_b16 a[252:253], v248 offset:16384
    v_mfma_f32_16x16x32_bf16 v[200:203], a[172:175], v[40:43], v[200:203]
    ds_read_b64_tr_b16 a[254:255], v248 offset:18432
    v_mfma_f32_16x16x32_bf16 v[204:207], a[168:171], a[76:79], v[204:207]
    ds_read_b64_tr_b16 a[224:225], v245 offset:32768
    v_mfma_f32_16x16x32_bf16 v[204:207], a[172:175], v[44:47], v[204:207]
    ds_read_b64_tr_b16 a[226:227], v245 offset:34816
    v_mfma_f32_16x16x32_bf16 v[208:211], a[192:195], a[64:67], v[208:211]
    ds_read_b64_tr_b16 a[228:229], v246 offset:32768
    v_mfma_f32_16x16x32_bf16 v[208:211], a[196:199], v[32:35], v[208:211]
    ds_read_b64_tr_b16 a[230:231], v246 offset:34816
    v_mfma_f32_16x16x32_bf16 v[212:215], a[192:195], a[68:71], v[212:215]
    ds_read_b64_tr_b16 a[232:233], v247 offset:32768
    v_mfma_f32_16x16x32_bf16 v[212:215], a[196:199], v[36:39], v[212:215]
    ds_read_b64_tr_b16 a[234:235], v247 offset:34816
    v_mfma_f32_16x16x32_bf16 v[216:219], a[192:195], a[72:75], v[216:219]
    ds_read_b64_tr_b16 a[236:237], v248 offset:32768
    v_mfma_f32_16x16x32_bf16 v[216:219], a[196:199], v[40:43], v[216:219]
    ds_read_b64_tr_b16 a[238:239], v248 offset:34816
    v_mfma_f32_16x16x32_bf16 v[220:223], a[192:195], a[76:79], v[220:223]
    v_mfma_f32_16x16x32_bf16 v[220:223], a[196:199], v[44:47], v[220:223]
    s_waitcnt lgkmcnt(15)
    v_mfma_f32_16x16x32_bf16 v[144:147], a[200:203], a[112:115], v[144:147]
    v_mfma_f32_16x16x32_bf16 v[144:147], a[204:207], a[128:131], v[144:147]
    s_waitcnt lgkmcnt(0)
    v_mfma_f32_16x16x32_bf16 v[144:147], a[24:27], a[240:243], v[144:147]
    v_mfma_f32_16x16x32_bf16 v[144:147], a[28:31], a[224:227], v[144:147]
    v_mfma_f32_16x16x32_bf16 v[148:151], a[200:203], a[116:119], v[148:151]
    v_mfma_f32_16x16x32_bf16 v[148:151], a[204:207], a[132:135], v[148:151]
    v_mfma_f32_16x16x32_bf16 v[148:151], a[24:27], a[244:247], v[148:151]
    v_mfma_f32_16x16x32_bf16 v[148:151], a[28:31], a[228:231], v[148:151]
    s_add_u32 m0, s41, 0
    v_mfma_f32_16x16x32_bf16 v[152:155], a[200:203], a[120:123], v[152:155]
    s_nop 1
    ds_write_addtid_b32 v144 offset:0
    v_mfma_f32_16x16x32_bf16 v[152:155], a[204:207], a[136:139], v[152:155]
    ds_write_addtid_b32 v145 offset:256
    v_mfma_f32_16x16x32_bf16 v[152:155], a[24:27], a[248:251], v[152:155]
    ds_write_addtid_b32 v146 offset:512
    v_mfma_f32_16x16x32_bf16 v[152:155], a[28:31], a[232:235], v[152:155]
    ds_write_addtid_b32 v147 offset:768
    v_mfma_f32_16x16x32_bf16 v[156:159], a[200:203], a[124:127], v[156:159]
    ds_write_addtid_b32 v148 offset:1024
    v_mfma_f32_16x16x32_bf16 v[156:159], a[204:207], a[140:143], v[156:159]
    ds_write_addtid_b32 v149 offset:1280
    v_mfma_f32_16x16x32_bf16 v[156:159], a[24:27], a[252:255], v[156:159]
    ds_write_addtid_b32 v150 offset:1536
    v_mfma_f32_16x16x32_bf16 v[156:159], a[28:31], a[236:239], v[156:159]
    ds_write_addtid_b32 v151 offset:1792
    v_mfma_f32_16x16x32_bf16 v[160:163], a[48:51], a[112:115], v[160:163]
    ds_write_addtid_b32 v152 offset:2048
    v_mfma_f32_16x16x32_bf16 v[160:163], a[52:55], a[128:131], v[160:163]
    ds_write_addtid_b32 v153 offset:2304
    v_mfma_f32_16x16x32_bf16 v[160:163], a[56:59], a[240:243], v[160:163]
    ds_write_addtid_b32 v154 offset:2560
    v_mfma_f32_16x16x32_bf16 v[160:163], a[60:63], a[224:227], v[160:163]
    ds_write_addtid_b32 v155 offset:2816
    v_mfma_f32_16x16x32_bf16 v[164:167], a[48:51], a[116:119], v[164:167]
    buffer_load_dword v231, off, s[4:7], s62 sc1
    v_mfma_f32_16x16x32_bf16 v[164:167], a[52:55], a[132:135], v[164:167]
    ds_write_addtid_b32 v156 offset:3072
    v_mfma_f32_16x16x32_bf16 v[164:167], a[56:59], a[244:247], v[164:167]
    ds_write_addtid_b32 v157 offset:3328
    v_mfma_f32_16x16x32_bf16 v[164:167], a[60:63], a[228:231], v[164:167]
    ds_write_addtid_b32 v158 offset:3584
    v_mfma_f32_16x16x32_bf16 v[168:171], a[48:51], a[120:123], v[168:171]
    ds_write_addtid_b32 v159 offset:3840
    v_mfma_f32_16x16x32_bf16 v[168:171], a[52:55], a[136:139], v[168:171]
    ds_write_addtid_b32 v160 offset:16384
    v_mfma_f32_16x16x32_bf16 v[168:171], a[56:59], a[248:251], v[168:171]
    ds_write_addtid_b32 v161 offset:16640
    v_mfma_f32_16x16x32_bf16 v[168:171], a[60:63], a[232:235], v[168:171]
    ds_write_addtid_b32 v162 offset:16896
    v_mfma_f32_16x16x32_bf16 v[172:175], a[48:51], a[124:127], v[172:175]
    ds_write_addtid_b32 v163 offset:17152
    v_mfma_f32_16x16x32_bf16 v[172:175], a[52:55], a[140:143], v[172:175]
    ds_write_addtid_b32 v164 offset:17408
    v_mfma_f32_16x16x32_bf16 v[172:175], a[56:59], a[252:255], v[172:175]
    ds_write_addtid_b32 v165 offset:17664
    v_mfma_f32_16x16x32_bf16 v[172:175], a[60:63], a[236:239], v[172:175]
    ds_write_addtid_b32 v166 offset:17920
    v_mfma_f32_16x16x32_bf16 v[176:179], a[144:147], a[112:115], v[176:179]
    ds_write_addtid_b32 v167 offset:18176
    v_mfma_f32_16x16x32_bf16 v[176:179], a[148:151], a[128:131], v[176:179]
    ds_write_addtid_b32 v168 offset:18432
    v_mfma_f32_16x16x32_bf16 v[176:179], a[152:155], a[240:243], v[176:179]
    ds_write_addtid_b32 v169 offset:18688
    v_mfma_f32_16x16x32_bf16 v[176:179], a[156:159], a[224:227], v[176:179]
    ds_write_addtid_b32 v170 offset:18944
    v_mfma_f32_16x16x32_bf16 v[180:183], a[144:147], a[116:119], v[180:183]
    ds_write_addtid_b32 v171 offset:19200
    v_mfma_f32_16x16x32_bf16 v[180:183], a[148:151], a[132:135], v[180:183]
    ds_write_addtid_b32 v172 offset:19456
    v_mfma_f32_16x16x32_bf16 v[180:183], a[152:155], a[244:247], v[180:183]
    ds_write_addtid_b32 v173 offset:19712
    v_mfma_f32_16x16x32_bf16 v[180:183], a[156:159], a[228:231], v[180:183]
    ds_write_addtid_b32 v174 offset:19968
    v_mfma_f32_16x16x32_bf16 v[184:187], a[144:147], a[120:123], v[184:187]
    ds_write_addtid_b32 v175 offset:20224
    v_mfma_f32_16x16x32_bf16 v[184:187], a[148:151], a[136:139], v[184:187]
    v_mfma_f32_16x16x32_bf16 v[184:187], a[152:155], a[248:251], v[184:187]
    v_mfma_f32_16x16x32_bf16 v[184:187], a[156:159], a[232:235], v[184:187]
    v_mfma_f32_16x16x32_bf16 v[188:191], a[144:147], a[124:127], v[188:191]
    s_waitcnt lgkmcnt(0)
    s_barrier
    v_mfma_f32_16x16x32_bf16 v[188:191], a[148:151], a[140:143], v[188:191]
    ds_write_addtid_b32 v176 offset:32768
    ds_read_b128 v[64:67], v224 offset:0
    v_mfma_f32_16x16x32_bf16 v[188:191], a[152:155], a[252:255], v[188:191]
    ds_write_addtid_b32 v177 offset:33024
    ds_read_b128 v[68:71], v224 offset:4096
    v_mfma_f32_16x16x32_bf16 v[188:191], a[156:159], a[236:239], v[188:191]
    ds_write_addtid_b32 v178 offset:33280
    ds_read_b128 v[72:75], v224 offset:8192
    s_waitcnt vmcnt(0)
    v_cmp_ne_u32 vcc, 1, v231
    v_mfma_f32_16x16x32_bf16 v[192:195], a[80:83], a[112:115], v[192:195]
    ds_write_addtid_b32 v179 offset:33536
    ds_read_b128 v[76:79], v224 offset:12288
    v_mfma_f32_16x16x32_bf16 v[192:195], a[84:87], a[128:131], v[192:195]
    ds_write_addtid_b32 v180 offset:33792
    ds_read_b128 v[80:83], v224 offset:16384
    s_cbranch_vccnz L_late
L_intime:
    v_mfma_f32_16x16x32_bf16 v[192:195], a[88:91], a[240:243], v[192:195]
    buffer_load_dwordx4 v[0:3], v236, s[4:7], s60 offen offset:0 sc1
    ds_read_b128 v[84:87], v224 offset:20480
    v_mfma_f32_16x16x32_bf16 v[192:195], a[92:95], a[224:227], v[192:195]
    buffer_load_dwordx4 v[4:7], v236, s[4:7], s60 offen offset:1024 sc1
    ds_read_b128 v[88:91], v224 offset:24576
    v_mfma_f32_16x16x32_bf16 v[196:199], a[80:83], a[116:119], v[196:199]
    buffer_load_dwordx4 v[8:11], v236, s[4:7], s60 offen offset:2048 sc1
    ds_read_b128 v[92:95], v224 offset:28672
    v_mfma_f32_16x16x32_bf16 v[196:199], a[84:87], a[132:135], v[196:199]
    buffer_load_dwordx4 v[12:15], v236, s[4:7], s60 offen offset:3072 sc1
    s_waitcnt lgkmcnt(5)
    v_add_f32 v64, v64, v68
    v_add_f32 v72, v72, v76
    v_mfma_f32_16x16x32_bf16 v[196:199], a[88:91], a[244:247], v[196:199]
    s_add_u32 s58, s60, 4096
    buffer_load_dwordx4 v[16:19], v236, s[4:7], s58 offen offset:0 sc1
    v_add_f32 v65, v65, v69
    v_add_f32 v73, v73, v77
    v_mfma_f32_16x16x32_bf16 v[196:199], a[92:95], a[228:231], v[196:199]
    ds_write_addtid_b32 v181 offset:34048
    ds_write_addtid_b32 v182 offset:34304
    v_add_f32 v66, v66, v70
    v_add_f32 v74, v74, v78
    v_mfma_f32_16x16x32_bf16 v[200:203], a[80:83], a[120:123], v[200:203]
    ds_write_addtid_b32 v183 offset:34560
    ds_write_addtid_b32 v184 offset:34816
    v_add_f32 v67, v67, v71
    v_add_f32 v75, v75, v79
    v_mfma_f32_16x16x32_bf16 v[200:203], a[84:87], a[136:139], v[200:203]
    ds_write_addtid_b32 v185 offset:35072
    ds_write_addtid_b32 v186 offset:35328
    v_add_f32 v64, v64, v72
    v_add_f32 v65, v65, v73
    v_mfma_f32_16x16x32_bf16 v[200:203], a[88:91], a[248:251], v[200:203]
    ds_write_addtid_b32 v187 offset:35584
    ds_write_addtid_b32 v188 offset:35840
    v_add_f32 v66, v66, v74
    v_add_f32 v67, v67, v75
    v_mfma_f32_16x16x32_bf16 v[200:203], a[92:95], a[232:235], v[200:203]
    ds_write_addtid_b32 v189 offset:36096
    ds_write_addtid_b32 v190 offset:36352
    s_waitcnt lgkmcnt(10)
    v_add_f32 v80, v80, v84
    v_add_f32 v88, v88, v92
    v_mfma_f32_16x16x32_bf16 v[204:207], a[80:83], a[124:127], v[204:207]
    ds_write_addtid_b32 v191 offset:36608
    ds_write_addtid_b32 v192 offset:49152
    v_add_f32 v81, v81, v85
    v_add_f32 v89, v89, v93
    v_mfma_f32_16x16x32_bf16 v[204:207], a[84:87], a[140:143], v[204:207]
    ds_write_addtid_b32 v193 offset:49408
    ds_write_addtid_b32 v194 offset:49664
    v_add_f32 v82, v82, v86
    v_add_f32 v90, v90, v94
    v_mfma_f32_16x16x32_bf16 v[204:207], a[88:91], a[252:255], v[204:207]
    ds_write_addtid_b32 v195 offset:49920
    v_add_f32 v83, v83, v87
    v_add_f32 v91, v91, v95
    v_mfma_f32_16x16x32_bf16 v[204:207], a[92:95], a[236:239], v[204:207]
    ds_write_addtid_b32 v196 offset:50176
    v_add_f32 v80, v80, v88
    v_add_f32 v81, v81, v89
    v_mfma_f32_16x16x32_bf16 v[208:211], a[208:211], a[112:115], v[208:211]
    ds_write_addtid_b32 v197 offset:50432
    ds_write_addtid_b32 v198 offset:50688
    v_add_f32 v82, v82, v90
    v_add_f32 v83, v83, v91
    v_mfma_f32_16x16x32_bf16 v[208:211], a[212:215], a[128:131], v[208:211]
    ds_write_addtid_b32 v199 offset:50944
    v_mfma_f32_16x16x32_bf16 v[208:211], a[216:219], a[240:243], v[208:211]
    ds_write_addtid_b32 v200 offset:51200
    v_mfma_f32_16x16x32_bf16 v[208:211], a[220:223], a[224:227], v[208:211]
    ds_write_addtid_b32 v201 offset:51456
    v_mfma_f32_16x16x32_bf16 v[212:215], a[208:211], a[116:119], v[212:215]
    ds_write_addtid_b32 v202 offset:51712
    ds_write_addtid_b32 v203 offset:51968
    v_mfma_f32_16x16x32_bf16 v[212:215], a[212:215], a[132:135], v[212:215]
    ds_write_addtid_b32 v204 offset:52224
    v_mfma_f32_16x16x32_bf16 v[212:215], a[216:219], a[244:247], v[212:215]
    ds_write_addtid_b32 v205 offset:52480
    v_mfma_f32_16x16x32_bf16 v[212:215], a[220:223], a[228:231], v[212:215]
    ds_write_addtid_b32 v206 offset:52736
    v_mfma_f32_16x16x32_bf16 v[216:219], a[208:211], a[120:123], v[216:219]
    ds_write_addtid_b32 v207 offset:52992
    s_add_u32 m0, s41, 16384
    v_mfma_f32_16x16x32_bf16 v[216:219], a[212:215], a[136:139], v[216:219]
    ds_write_addtid_b32 v208 offset:49152
    v_mfma_f32_16x16x32_bf16 v[216:219], a[216:219], a[248:251], v[216:219]
    ds_write_addtid_b32 v209 offset:49408
    v_mfma_f32_16x16x32_bf16 v[216:219], a[220:223], a[232:235], v[216:219]
    ds_write_addtid_b32 v210 offset:49664
    v_mfma_f32_16x16x32_bf16 v[220:223], a[208:211], a[124:127], v[220:223]
    ds_write_addtid_b32 v211 offset:49920
    v_mfma_f32_16x16x32_bf16 v[220:223], a[212:215], a[140:143], v[220:223]
    ds_write_addtid_b32 v212 offset:50176
    v_mfma_f32_16x16x32_bf16 v[220:223], a[216:219], a[252:255], v[220:223]
    ds_write_addtid_b32 v213 offset:50432
    v_mfma_f32_16x16x32_bf16 v[220:223], a[220:223], a[236:239], v[220:223]
    ds_write_addtid_b32 v214 offset:50688
    ds_write_addtid_b32 v215 offset:50944
    ds_write_addtid_b32 v216 offset:51200
    ds_write_addtid_b32 v217 offset:51456
    ds_write_addtid_b32 v218 offset:51712
    ds_write_addtid_b32 v219 offset:51968
    s_nop 1
    ds_write_addtid_b32 v220 offset:52224
    ds_write_addtid_b32 v221 offset:52480
    ds_write_addtid_b32 v222 offset:52736
    ds_write_addtid_b32 v223 offset:52992
    s_waitcnt lgkmcnt(0)
    s_barrier
    ds_read_b128 v[96:99], v224 offset:32768
    ds_read_b128 v[100:103], v224 offset:36864
    ds_read_b128 v[104:107], v224 offset:40960
    ds_read_b128 v[108:111], v224 offset:45056
    ds_read_b128 v[112:115], v224 offset:49152
    ds_read_b128 v[116:119], v224 offset:53248
    ds_read_b128 v[120:123], v224 offset:57344
    ds_read_b128 v[124:127], v224 offset:61440
    ds_read_b128 v[128:131], v225 offset:0
    ds_read_b128 v[132:135], v225 offset:4096
    ds_read_b128 v[136:139], v225 offset:8192
    ds_read_b128 v[140:143], v225 offset:12288
    s_waitcnt vmcnt(0)
    s_lshl_b32 s58, s3, 5
    v_add_f32 v64, v64, v0
    v_add_f32 v65, v65, v1
    v_add_f32 v66, v66, v2
    v_add_f32 v67, v67, v3
    v_cvt_pk_bf16_f32 v68, v64, v65
    v_cvt_pk_bf16_f32 v69, v66, v67
    buffer_store_dwordx2 v[68:69], v226, s[20:23], s58 offen
    s_add_u32 s58, s58, 18432
    v_add_f32 v80, v80, v4
    v_add_f32 v81, v81, v5
    v_add_f32 v82, v82, v6
    v_add_f32 v83, v83, v7
    v_cvt_pk_bf16_f32 v84, v80, v81
    v_cvt_pk_bf16_f32 v85, v82, v83
    buffer_store_dwordx2 v[84:85], v226, s[20:23], s58 offen
    s_add_u32 s58, s58, 18432
    s_waitcnt lgkmcnt(8)
    v_add_f32 v96, v96, v100
    v_add_f32 v104, v104, v108
    v_add_f32 v97, v97, v101
    v_add_f32 v105, v105, v109
    v_add_f32 v98, v98, v102
    v_add_f32 v106, v106, v110
    v_add_f32 v99, v99, v103
    v_add_f32 v107, v107, v111
    v_add_f32 v96, v96, v104
    v_add_f32 v97, v97, v105
    v_add_f32 v98, v98, v106
    v_add_f32 v99, v99, v107
    v_add_f32 v96, v96, v8
    v_add_f32 v97, v97, v9
    v_add_f32 v98, v98, v10
    v_add_f32 v99, v99, v11
    v_cvt_pk_bf16_f32 v100, v96, v97
    v_cvt_pk_bf16_f32 v101, v98, v99
    buffer_store_dwordx2 v[100:101], v226, s[20:23], s58 offen
    s_add_u32 s58, s58, 18432
    s_waitcnt lgkmcnt(4)
    v_add_f32 v112, v112, v116
    v_add_f32 v120, v120, v124
    v_add_f32 v113, v113, v117
    v_add_f32 v121, v121, v125
    v_add_f32 v114, v114, v118
    v_add_f32 v122, v122, v126
    v_add_f32 v115, v115, v119
    v_add_f32 v123, v123, v127
    v_add_f32 v112, v112, v120
    v_add_f32 v113, v113, v121
    v_add_f32 v114, v114, v122
    v_add_f32 v115, v115, v123
    v_add_f32 v112, v112, v12
    v_add_f32 v113, v113, v13
    v_add_f32 v114, v114, v14
    v_add_f32 v115, v115, v15
    v_cvt_pk_bf16_f32 v116, v112, v113
    v_cvt_pk_bf16_f32 v117, v114, v115
    buffer_store_dwordx2 v[116:117], v226, s[20:23], s58 offen
    s_add_u32 s58, s58, 18432
    s_waitcnt lgkmcnt(0)
    v_add_f32 v128, v128, v132
    v_add_f32 v136, v136, v140
    v_add_f32 v129, v129, v133
    v_add_f32 v137, v137, v141
    v_add_f32 v130, v130, v134
    v_add_f32 v138, v138, v142
    v_add_f32 v131, v131, v135
    v_add_f32 v139, v139, v143
    v_add_f32 v128, v128, v136
    v_add_f32 v129, v129, v137
    v_add_f32 v130, v130, v138
    v_add_f32 v131, v131, v139
    v_add_f32 v128, v128, v16
    v_add_f32 v129, v129, v17
    v_add_f32 v130, v130, v18
    v_add_f32 v131, v131, v19
    v_cvt_pk_bf16_f32 v132, v128, v129
    v_cvt_pk_bf16_f32 v133, v130, v131
    buffer_store_dwordx2 v[132:133], v226, s[20:23], s58 offen
    s_add_u32 s58, s58, 18432
L_done:
L_end:
    s_endpgm
L_cnt:
    s_mov_b64 exec, 1
    buffer_atomic_add v253, off, s[8:11], s38 sc1
    s_mov_b64 exec, -1
    s_branch L_cnted
L_late:
    s_mov_b32 s50, 0
L_late1:
    buffer_load_dword v231, off, s[4:7], s62 sc1
    s_add_u32 s50, s50, 1
    s_waitcnt vmcnt(0)
    v_cmp_ne_u32 vcc, 1, v231
    s_cbranch_vccz L_intime
    s_cmp_ge_u32 s50, 0x20000
    s_cbranch_scc1 L_intime
    s_sleep 1
    s_branch L_late1
L_help:
    s_mul_i32 s58, s56, 1966080
    s_add_u32 s16, s98, s58
    s_addc_u32 s17, s99, 0
    s_mov_b32 s18, 1966080
    v_lshrrev_b32 v0, 8, v236
    v_lshlrev_b32 v0, 17, v0
    v_and_b32 v1, 0xf0, v236
    v_lshl_add_u32 v0, v1, 3, v0
    s_add_u32 s51, s46, 0
    buffer_load_dword v2, v0, s[16:19], s51 offen offset:2048 sc1
    s_add_u32 s51, s46, 524288
    buffer_load_dword v2, v0, s[16:19], s51 offen offset:2048 sc1
    s_add_u32 s51, s46, 1048576
    buffer_load_dword v2, v0, s[16:19], s51 offen offset:2048 sc1
    s_add_u32 s51, s46, 1572864
    buffer_load_dword v2, v0, s[16:19], s51 offen offset:2048 sc1
    s_add_u32 s51, s48, 0
    buffer_load_dword v2, v0, s[16:19], s51 offen offset:0 sc1
    s_add_u32 s51, s48, 524288
    buffer_load_dword v2, v0, s[16:19], s51 offen offset:0 sc1
    s_add_u32 s51, s48, 1048576
    buffer_load_dword v2, v0, s[16:19], s51 offen offset:0 sc1
    s_add_u32 s51, s48, 1572864
    buffer_load_dword v2, v0, s[16:19], s51 offen offset:0 sc1
    s_add_u32 s51, s48, 0
    buffer_load_dword v2, v0, s[16:19], s51 offen offset:2048 sc1
    s_add_u32 s51, s48, 524288
    buffer_load_dword v2, v0, s[16:19], s51 offen offset:2048 sc1
    s_add_u32 s51, s48, 1048576
    buffer_load_dword v2, v0, s[16:19], s51 offen offset:2048 sc1
    s_add_u32 s51, s48, 1572864
    buffer_load_dword v2, v0, s[16:19], s51 offen offset:2048 sc1
    s_branch L_done
L_w3:
    v_mov_b32 v204, 1.0
    ds_read_b128 a[64:67], v140 offset:0
    ds_read_b128 a[68:71], v141 offset:0
    ds_read_b64_tr_b16 a[192:193], v160 offset:16384
    ds_read_b64_tr_b16 a[194:195], v160 offset:17408
    ds_read_b64_tr_b16 a[224:225], v160 offset:24576
    ds_read_b64_tr_b16 a[226:227], v160 offset:25600
    ds_read_b64_tr_b16 a[196:197], v160 offset:16392
    ds_read_b64_tr_b16 a[198:199], v160 offset:17416
    ds_read_b64_tr_b16 a[228:229], v160 offset:24584
    ds_read_b64_tr_b16 a[230:231], v160 offset:25608
    s_waitcnt lgkmcnt(4)
    v_mfma_f32_16x16x32_bf16 v[0:3], a[192:195], a[64:67], 0
    ds_read_b64_tr_b16 a[200:201], v161 offset:16384
    ds_read_b64_tr_b16 a[202:203], v161 offset:17408
    v_mfma_f32_16x16x32_bf16 v[0:3], a[224:227], a[68:71], v[0:3]
    ds_read_b64_tr_b16 a[232:233], v161 offset:24576
    ds_read_b64_tr_b16 a[234:235], v161 offset:25600
    s_mov_b32 m0, s43
    s_waitcnt lgkmcnt(4)
    v_mfma_f32_16x16x32_bf16 v[4:7], a[196:199], a[64:67], 0
    ds_read_b64_tr_b16 a[204:205], v161 offset:16392
    buffer_load_dwordx4 v128, s[8:11], s39 offen offset:0  lds
    v_mfma_f32_16x16x32_bf16 v[4:7], a[228:231], a[68:71], v[4:7]
    ds_read_b64_tr_b16 a[206:207], v161 offset:17416
    ds_read_b64_tr_b16 a[236:237], v161 offset:24584
    s_waitcnt lgkmcnt(3)
    v_mfma_f32_16x16x32_bf16 v[8:11], a[200:203], a[64:67], 0
    ds_read_b64_tr_b16 a[238:239], v161 offset:25608
    ds_read_b64_tr_b16 a[208:209], v162 offset:16384
    v_mfma_f32_16x16x32_bf16 v[8:11], a[232:235], a[68:71], v[8:11]
    ds_read_b64_tr_b16 a[210:211], v162 offset:17408
    buffer_load_dwordx4 v129, s[8:11], s39 offen offset:1024  lds
    s_waitcnt lgkmcnt(2)
    v_mfma_f32_16x16x32_bf16 v[12:15], a[204:207], a[64:67], 0
    ds_read_b64_tr_b16 a[240:241], v162 offset:24576
    ds_read_b64_tr_b16 a[242:243], v162 offset:25600
    v_mfma_f32_16x16x32_bf16 v[12:15], a[236:239], a[68:71], v[12:15]
    ds_read_b64_tr_b16 a[212:213], v162 offset:16392
    ds_read_b64_tr_b16 a[214:215], v162 offset:17416
    s_waitcnt lgkmcnt(2)
    v_mfma_f32_16x16x32_bf16 v[16:19], a[208:211], a[64:67], 0
    ds_read_b64_tr_b16 a[244:245], v162 offset:24584
    ds_read_b64_tr_b16 a[246:247], v162 offset:25608
    v_mfma_f32_16x16x32_bf16 v[16:19], a[240:243], a[68:71], v[16:19]
    ds_read_b64_tr_b16 a[216:217], v163 offset:16384
    buffer_load_dwordx4 v130, s[8:11], s39 offen offset:2048  lds
    s_waitcnt lgkmcnt(1)
    v_mfma_f32_16x16x32_bf16 v[20:23], a[212:215], a[64:67], 0
    ds_read_b64_tr_b16 a[218:219], v163 offset:17408
    ds_read_b64_tr_b16 a[248:249], v163 offset:24576
    v_mfma_f32_16x16x32_bf16 v[20:23], a[244:247], a[68:71], v[20:23]
    ds_read_b64_tr_b16 a[250:251], v163 offset:25600
    ds_read_b64_tr_b16 a[220:221], v163 offset:16392
    s_waitcnt lgkmcnt(1)
    v_mfma_f32_16x16x32_bf16 v[24:27], a[216:219], a[64:67], 0
    ds_read_b64_tr_b16 a[222:223], v163 offset:17416
    buffer_load_dwordx4 v131, s[8:11], s39 offen offset:3072  lds
    v_mfma_f32_16x16x32_bf16 v[24:27], a[248:251], a[68:71], v[24:27]
    ds_read_b64_tr_b16 a[252:253], v163 offset:24584
    ds_read_b64_tr_b16 a[254:255], v163 offset:25608
    s_waitcnt lgkmcnt(0)
    v_mfma_f32_16x16x32_bf16 v[28:31], a[220:223], a[64:67], 0
    ds_read_b128 a[72:75], v140 offset:2048
    ds_read_b128 a[76:79], v141 offset:2048
    v_mfma_f32_16x16x32_bf16 v[28:31], a[252:255], a[68:71], v[28:31]
    s_add_u32 m0, s43, 4096
    s_waitcnt lgkmcnt(0)
    v_mfma_f32_16x16x32_bf16 v[32:35], a[192:195], a[72:75], 0
    buffer_load_dwordx4 v132, s[8:11], s39 offen offset:0  lds
    v_mfma_f32_16x16x32_bf16 v[32:35], a[224:227], a[76:79], v[32:35]
    v_mfma_f32_16x16x32_bf16 v[36:39], a[196:199], a[72:75], 0
    v_mfma_f32_16x16x32_bf16 v[36:39], a[228:231], a[76:79], v[36:39]
    buffer_load_dwordx4 v133, s[8:11], s39 offen offset:1024  lds
    v_mfma_f32_16x16x32_bf16 v[40:43], a[200:203], a[72:75], 0
    s_waitcnt vmcnt(10)
    ds_read_b128 a[80:83], v140 offset:4096
    v_mfma_f32_16x16x32_bf16 v[40:43], a[232:235], a[76:79], v[40:43]
    ds_read_b128 a[84:87], v141 offset:4096
    v_mfma_f32_16x16x32_bf16 v[44:47], a[204:207], a[72:75], 0
    v_mfma_f32_16x16x32_bf16 v[44:47], a[236:239], a[76:79], v[44:47]
    buffer_load_dwordx4 v134, s[8:11], s39 offen offset:2048  lds
    v_mfma_f32_16x16x32_bf16 v[48:51], a[208:211], a[72:75], 0
    v_mfma_f32_16x16x32_bf16 v[48:51], a[240:243], a[76:79], v[48:51]
    v_mfma_f32_16x16x32_bf16 v[52:55], a[212:215], a[72:75], 0
    buffer_load_dwordx4 v135, s[8:11], s39 offen offset:3072  lds
    v_mfma_f32_16x16x32_bf16 v[52:55], a[244:247], a[76:79], v[52:55]
    v_mfma_f32_16x16x32_bf16 v[56:59], a[216:219], a[72:75], 0
    s_lshl_b32 s39, s38, 7
    v_mfma_f32_16x16x32_bf16 v[56:59], a[248:251], a[76:79], v[56:59]
    s_lshl_b32 s40, s38, 19
    s_add_u32 m0, s41, 98304
    v_mfma_f32_16x16x32_bf16 v[60:63], a[220:223], a[72:75], 0
    s_waitcnt vmcnt(8)
    s_barrier
    buffer_load_dwordx4 v136, s[12:15], s40 offen offset:0  lds
    v_mfma_f32_16x16x32_bf16 v[60:63], a[252:255], a[76:79], v[60:63]
    ds_read_b64_tr_b16 a[128:129], v160 offset:32768
    s_add_u32 s38, s38, 1
    s_waitcnt lgkmcnt(1)
    v_mfma_f32_16x16x32_bf16 v[64:67], a[192:195], a[80:83], 0
    ds_read_b64_tr_b16 a[130:131], v160 offset:33792
    s_cmp_eq_u32 s38, 9
    s_cselect_b32 s38, 0, s38
    v_mfma_f32_16x16x32_bf16 v[64:67], a[224:227], a[84:87], v[64:67]
    buffer_load_dwordx4 v137, s[12:15], s40 offen offset:1024  lds
    v_mfma_f32_16x16x32_bf16 v[68:71], a[196:199], a[80:83], 0
    ds_read_b64_tr_b16 a[160:161], v160 offset:40960
    v_mfma_f32_16x16x32_bf16 v[68:71], a[228:231], a[84:87], v[68:71]
    ds_read_b64_tr_b16 a[162:163], v160 offset:41984
    v_mfma_f32_16x16x32_bf16 v[72:75], a[200:203], a[80:83], 0
    ds_read_b64_tr_b16 a[132:133], v160 offset:32776
    v_mfma_f32_16x16x32_bf16 v[72:75], a[232:235], a[84:87], v[72:75]
    ds_read_b128 a[88:91], v140 offset:6144
    buffer_load_dwordx4 v138, s[12:15], s40 offen offset:2048  lds
    v_mfma_f32_16x16x32_bf16 v[76:79], a[204:207], a[80:83], 0
    ds_read_b64_tr_b16 a[134:135], v160 offset:33800
    ds_read_b128 a[92:95], v141 offset:6144
    v_mfma_f32_16x16x32_bf16 v[76:79], a[236:239], a[84:87], v[76:79]
    ds_read_b64_tr_b16 a[164:165], v160 offset:40968
    v_mfma_f32_16x16x32_bf16 v[80:83], a[208:211], a[80:83], 0
    ds_read_b64_tr_b16 a[166:167], v160 offset:41992
    buffer_load_dwordx4 v139, s[12:15], s40 offen offset:3072  lds
    v_mfma_f32_16x16x32_bf16 v[80:83], a[240:243], a[84:87], v[80:83]
    ds_read_b64_tr_b16 a[136:137], v161 offset:32768
    ds_read_b64_tr_b16 a[138:139], v161 offset:33792
    v_mfma_f32_16x16x32_bf16 v[84:87], a[212:215], a[80:83], 0
    ds_read_b64_tr_b16 a[168:169], v161 offset:40960
    v_mfma_f32_16x16x32_bf16 v[84:87], a[244:247], a[84:87], v[84:87]
    ds_read_b64_tr_b16 a[170:171], v161 offset:41984
    s_mov_b32 m0, s44
    v_mfma_f32_16x16x32_bf16 v[88:91], a[216:219], a[80:83], 0
    ds_read_b64_tr_b16 a[140:141], v161 offset:32776
    buffer_load_dwordx4 v128, s[8:11], s39 offen offset:0  lds
    v_mfma_f32_16x16x32_bf16 v[88:91], a[248:251], a[84:87], v[88:91]
    ds_read_b64_tr_b16 a[142:143], v161 offset:33800
    v_mfma_f32_16x16x32_bf16 v[92:95], a[220:223], a[80:83], 0
    ds_read_b64_tr_b16 a[172:173], v161 offset:40968
    v_mfma_f32_16x16x32_bf16 v[92:95], a[252:255], a[84:87], v[92:95]
    ds_read_b64_tr_b16 a[174:175], v161 offset:41992
    buffer_load_dwordx4 v129, s[8:11], s39 offen offset:1024  lds
    s_waitcnt lgkmcnt(10)
    ds_read_b64_tr_b16 a[144:145], v162 offset:32768
    ds_read_b64_tr_b16 a[146:147], v162 offset:33792
    ds_read_b64_tr_b16 a[176:177], v162 offset:40960
    ds_read_b64_tr_b16 a[178:179], v162 offset:41984
    ds_read_b64_tr_b16 a[148:149], v162 offset:32776
    buffer_load_dwordx4 v130, s[8:11], s39 offen offset:2048  lds
    ds_read_b64_tr_b16 a[150:151], v162 offset:33800
    ds_read_b64_tr_b16 a[180:181], v162 offset:40968
    s_waitcnt vmcnt(11)
    ds_read_b128 a[96:99], v142 offset:0
    ds_read_b64_tr_b16 a[182:183], v162 offset:41992
    buffer_load_dwordx4 v131, s[8:11], s39 offen offset:3072  lds
    ds_read_b128 a[100:103], v143 offset:0
    ds_read_b64_tr_b16 a[152:153], v163 offset:32768
    ds_read_b64_tr_b16 a[154:155], v163 offset:33792
    ds_read_b64_tr_b16 a[184:185], v163 offset:40960
    ds_read_b64_tr_b16 a[186:187], v163 offset:41984
    s_add_u32 m0, s44, 4096
    ds_read_b64_tr_b16 a[156:157], v163 offset:32776
    buffer_load_dwordx4 v132, s[8:11], s39 offen offset:0  lds
    ds_read_b64_tr_b16 a[158:159], v163 offset:33800
    ds_read_b64_tr_b16 a[188:189], v163 offset:40968
    ds_read_b64_tr_b16 a[190:191], v163 offset:41992
    buffer_load_dwordx4 v133, s[8:11], s39 offen offset:1024  lds
    s_waitcnt lgkmcnt(0)
    v_mfma_f32_16x16x32_bf16 v[0:3], a[128:131], a[96:99], v[0:3]
    v_mfma_f32_16x16x32_bf16 v[0:3], a[160:163], a[100:103], v[0:3]
    buffer_load_dwordx4 v134, s[8:11], s39 offen offset:2048  lds
    v_mfma_f32_16x16x32_bf16 v[4:7], a[132:135], a[96:99], v[4:7]
    v_mfma_f32_16x16x32_bf16 v[4:7], a[164:167], a[100:103], v[4:7]
    ds_read_b128 a[104:107], v142 offset:2048
    v_mfma_f32_16x16x32_bf16 v[8:11], a[136:139], a[96:99], v[8:11]
    buffer_load_dwordx4 v135, s[8:11], s39 offen offset:3072  lds
    v_mfma_f32_16x16x32_bf16 v[8:11], a[168:171], a[100:103], v[8:11]
    ds_read_b128 a[108:111], v143 offset:2048
    v_mfma_f32_16x16x32_bf16 v[12:15], a[140:143], a[96:99], v[12:15]
    v_mfma_f32_16x16x32_bf16 v[12:15], a[172:175], a[100:103], v[12:15]
    s_mov_b32 m0, s41
    v_mfma_f32_16x16x32_bf16 v[16:19], a[144:147], a[96:99], v[16:19]
    buffer_load_dwordx4 v128, s[8:11], s49 offen offset:0  lds
    v_mfma_f32_16x16x32_bf16 v[16:19], a[176:179], a[100:103], v[16:19]
    v_mfma_f32_16x16x32_bf16 v[20:23], a[148:151], a[96:99], v[20:23]
    v_mfma_f32_16x16x32_bf16 v[20:23], a[180:183], a[100:103], v[20:23]
    buffer_load_dwordx4 v129, s[8:11], s49 offen offset:1024  lds
    v_mfma_f32_16x16x32_bf16 v[24:27], a[152:155], a[96:99], v[24:27]
    v_mfma_f32_16x16x32_bf16 v[24:27], a[184:187], a[100:103], v[24:27]
    v_mfma_f32_16x16x32_bf16 v[28:31], a[156:159], a[96:99], v[28:31]
    v_mfma_f32_16x16x32_bf16 v[28:31], a[188:191], a[100:103], v[28:31]
    buffer_load_dwordx4 v130, s[8:11], s49 offen offset:2048  lds
    s_waitcnt lgkmcnt(0)
    v_mfma_f32_16x16x32_bf16 v[32:35], a[128:131], a[104:107], v[32:35]
    v_mfma_f32_16x16x32_bf16 v[32:35], a[160:163], a[108:111], v[32:35]
    v_mfma_f32_16x16x32_bf16 v[36:39], a[132:135], a[104:107], v[36:39]
    buffer_load_dwordx4 v131, s[8:11], s49 offen offset:3072  lds
    v_mfma_f32_16x16x32_bf16 v[36:39], a[164:167], a[108:111], v[36:39]
    s_waitcnt vmcnt(16)
    ds_read_b128 a[112:115], v142 offset:4096
    v_mfma_f32_16x16x32_bf16 v[40:43], a[136:139], a[104:107], v[40:43]
    ds_read_b128 a[116:119], v143 offset:4096
    s_lshl_b32 s39, s38, 7
    v_mfma_f32_16x16x32_bf16 v[40:43], a[168:171], a[108:111], v[40:43]
    s_lshl_b32 s40, s38, 19
    s_add_u32 m0, s41, 114688
    v_mfma_f32_16x16x32_bf16 v[44:47], a[140:143], a[104:107], v[44:47]
    buffer_load_dwordx4 v136, s[12:15], s40 offen offset:0  lds
    v_mfma_f32_16x16x32_bf16 v[44:47], a[172:175], a[108:111], v[44:47]
    s_add_u32 s38, s38, 1
    v_mfma_f32_16x16x32_bf16 v[48:51], a[144:147], a[104:107], v[48:51]
    s_waitcnt vmcnt(13)
    s_barrier
    s_cmp_eq_u32 s38, 9
    s_cselect_b32 s38, 0, s38
    v_mfma_f32_16x16x32_bf16 v[48:51], a[176:179], a[108:111], v[48:51]
    buffer_load_dwordx4 v137, s[12:15], s40 offen offset:1024  lds
    v_mfma_f32_16x16x32_bf16 v[52:55], a[148:151], a[104:107], v[52:55]
    ds_read_b64_tr_b16 a[192:193], v160 offset:0
    v_mfma_f32_16x16x32_bf16 v[52:55], a[180:183], a[108:111], v[52:55]
    ds_read_b64_tr_b16 a[194:195], v160 offset:1024
    v_mfma_f32_16x16x32_bf16 v[56:59], a[152:155], a[104:107], v[56:59]
    ds_read_b64_tr_b16 a[224:225], v160 offset:8192
    v_mfma_f32_16x16x32_bf16 v[56:59], a[184:187], a[108:111], v[56:59]
    buffer_load_dwordx4 v138, s[12:15], s40 offen offset:2048  lds
    v_mfma_f32_16x16x32_bf16 v[60:63], a[156:159], a[104:107], v[60:63]
    ds_read_b64_tr_b16 a[226:227], v160 offset:9216
    v_mfma_f32_16x16x32_bf16 v[60:63], a[188:191], a[108:111], v[60:63]
    ds_read_b64_tr_b16 a[196:197], v160 offset:8
    s_waitcnt lgkmcnt(5)
    v_mfma_f32_16x16x32_bf16 v[64:67], a[128:131], a[112:115], v[64:67]
    buffer_load_dwordx4 v139, s[12:15], s40 offen offset:3072  lds
    v_mfma_f32_16x16x32_bf16 v[64:67], a[160:163], a[116:119], v[64:67]
    ds_read_b64_tr_b16 a[198:199], v160 offset:1032
    v_mfma_f32_16x16x32_bf16 v[68:71], a[132:135], a[112:115], v[68:71]
    ds_read_b64_tr_b16 a[228:229], v160 offset:8200
    v_mfma_f32_16x16x32_bf16 v[68:71], a[164:167], a[116:119], v[68:71]
    ds_read_b64_tr_b16 a[230:231], v160 offset:9224
    s_mov_b32 m0, s42
    v_mfma_f32_16x16x32_bf16 v[72:75], a[136:139], a[112:115], v[72:75]
    ds_read_b64_tr_b16 a[200:201], v161 offset:0
    buffer_load_dwordx4 v128, s[8:11], s39 offen offset:0  lds
    v_mfma_f32_16x16x32_bf16 v[72:75], a[168:171], a[116:119], v[72:75]
    ds_read_b64_tr_b16 a[202:203], v161 offset:1024
    ds_read_b128 a[120:123], v142 offset:6144
    v_mfma_f32_16x16x32_bf16 v[76:79], a[140:143], a[112:115], v[76:79]
    ds_read_b64_tr_b16 a[232:233], v161 offset:8192
    ds_read_b128 a[124:127], v143 offset:6144
    v_mfma_f32_16x16x32_bf16 v[76:79], a[172:175], a[116:119], v[76:79]
    ds_read_b64_tr_b16 a[234:235], v161 offset:9216
    buffer_load_dwordx4 v129, s[8:11], s39 offen offset:1024  lds
    v_mfma_f32_16x16x32_bf16 v[80:83], a[144:147], a[112:115], v[80:83]
    ds_read_b64_tr_b16 a[204:205], v161 offset:8
    v_mfma_f32_16x16x32_bf16 v[80:83], a[176:179], a[116:119], v[80:83]
    ds_read_b64_tr_b16 a[206:207], v161 offset:1032
    v_mfma_f32_16x16x32_bf16 v[84:87], a[148:151], a[112:115], v[84:87]
    ds_read_b64_tr_b16 a[236:237], v161 offset:8200
    v_mfma_f32_16x16x32_bf16 v[84:87], a[180:183], a[116:119], v[84:87]
    ds_read_b64_tr_b16 a[238:239], v161 offset:9224
    buffer_load_dwordx4 v130, s[8:11], s39 offen offset:2048  lds
    v_mfma_f32_16x16x32_bf16 v[88:91], a[152:155], a[112:115], v[88:91]
    ds_read_b64_tr_b16 a[208:209], v162 offset:0
    v_mfma_f32_16x16x32_bf16 v[88:91], a[184:187], a[116:119], v[88:91]
    ds_read_b64_tr_b16 a[210:211], v162 offset:1024
    v_mfma_f32_16x16x32_bf16 v[92:95], a[156:159], a[112:115], v[92:95]
    buffer_load_dwordx4 v131, s[8:11], s39 offen offset:3072  lds
    v_mfma_f32_16x16x32_bf16 v[92:95], a[188:191], a[116:119], v[92:95]
    ds_read_b64_tr_b16 a[240:241], v162 offset:8192
    s_waitcnt lgkmcnt(8)
    ds_read_b64_tr_b16 a[242:243], v162 offset:9216
    ds_read_b64_tr_b16 a[212:213], v162 offset:8
    s_add_u32 m0, s42, 4096
    ds_read_b64_tr_b16 a[214:215], v162 offset:1032
    buffer_load_dwordx4 v132, s[8:11], s39 offen offset:0  lds
    ds_read_b64_tr_b16 a[244:245], v162 offset:8200
    ds_read_b64_tr_b16 a[246:247], v162 offset:9224
    s_waitcnt vmcnt(9)
    ds_read_b128 a[0:3], v146 offset:0
    ds_read_b64_tr_b16 a[216:217], v163 offset:0
    buffer_load_dwordx4 v133, s[8:11], s39 offen offset:1024  lds
    ds_read_b128 a[64:67], v144 offset:0
    ds_read_b128 a[4:7], v147 offset:0
    ds_read_b64_tr_b16 a[218:219], v163 offset:1024
    ds_read_b128 a[68:71], v145 offset:0
    ds_read_b128 a[16:19], v146 offset:2048
    ds_read_b64_tr_b16 a[248:249], v163 offset:8192
    ds_read_b128 a[20:23], v147 offset:2048
    buffer_load_dwordx4 v134, s[8:11], s39 offen offset:2048  lds
    ds_read_b64_tr_b16 a[250:251], v163 offset:9216
    ds_read_b64_tr_b16 a[220:221], v163 offset:8
    ds_read_b64_tr_b16 a[222:223], v163 offset:1032
    ds_read_b64_tr_b16 a[252:253], v163 offset:8200
    ds_read_b64_tr_b16 a[254:255], v163 offset:9224
    buffer_load_dwordx4 v135, s[8:11], s39 offen offset:3072  lds
    s_waitcnt lgkmcnt(5)
    s_mov_b32 m0, s41
    s_waitcnt lgkmcnt(0)
    v_mfma_f32_16x16x32_bf16 v[0:3], a[192:195], a[64:67], v[0:3]
    buffer_load_dwordx4 v132, s[8:11], s49 offen offset:0  lds
    v_mfma_f32_16x16x32_bf16 v[0:3], a[224:227], a[68:71], v[0:3]
    v_mfma_f32_16x16x32_bf16 v[4:7], a[196:199], a[64:67], v[4:7]
    v_mfma_f32_16x16x32_bf16 v[4:7], a[228:231], a[68:71], v[4:7]
    buffer_load_dwordx4 v133, s[8:11], s49 offen offset:1024  lds
    v_mfma_f32_16x16x32_bf16 v[8:11], a[200:203], a[64:67], v[8:11]
    ds_read_b128 a[72:75], v144 offset:2048
    v_mfma_f32_16x16x32_bf16 v[8:11], a[232:235], a[68:71], v[8:11]
    ds_read_b128 a[76:79], v145 offset:2048
    v_mfma_f32_16x16x32_bf16 v[12:15], a[204:207], a[64:67], v[12:15]
    v_mfma_f32_16x16x32_bf16 v[12:15], a[236:239], a[68:71], v[12:15]
    buffer_load_dwordx4 v134, s[8:11], s49 offen offset:2048  lds
    v_mfma_f32_16x16x32_bf16 v[16:19], a[208:211], a[64:67], v[16:19]
    v_mfma_f32_16x16x32_bf16 v[16:19], a[240:243], a[68:71], v[16:19]
    v_mfma_f32_16x16x32_bf16 v[20:23], a[212:215], a[64:67], v[20:23]
    buffer_load_dwordx4 v135, s[8:11], s49 offen offset:3072  lds
    v_mfma_f32_16x16x32_bf16 v[20:23], a[244:247], a[68:71], v[20:23]
    v_mfma_f32_16x16x32_bf16 v[24:27], a[216:219], a[64:67], v[24:27]
    s_lshl_b32 s39, s38, 7
    v_mfma_f32_16x16x32_bf16 v[24:27], a[248:251], a[68:71], v[24:27]
    s_lshl_b32 s40, s38, 19
    s_add_u32 m0, s41, 131072
    v_mfma_f32_16x16x32_bf16 v[28:31], a[220:223], a[64:67], v[28:31]
    buffer_load_dwordx4 v136, s[12:15], s40 offen offset:0  lds
    v_mfma_f32_16x16x32_bf16 v[28:31], a[252:255], a[68:71], v[28:31]
    s_add_u32 s38, s38, 1
    s_waitcnt lgkmcnt(0)
    v_mfma_f32_16x16x32_bf16 v[32:35], a[192:195], a[72:75], v[32:35]
    s_cmp_eq_u32 s38, 9
    s_cselect_b32 s38, 0, s38
    v_mfma_f32_16x16x32_bf16 v[32:35], a[224:227], a[76:79], v[32:35]
    buffer_load_dwordx4 v137, s[12:15], s40 offen offset:1024  lds
    v_mfma_f32_16x16x32_bf16 v[36:39], a[196:199], a[72:75], v[36:39]
    v_mfma_f32_16x16x32_bf16 v[36:39], a[228:231], a[76:79], v[36:39]
    ds_read_b128 a[80:83], v144 offset:4096
    v_mfma_f32_16x16x32_bf16 v[40:43], a[200:203], a[72:75], v[40:43]
    s_waitcnt vmcnt(14)
    s_barrier
    v_mfma_f32_16x16x32_bf16 v[40:43], a[232:235], a[76:79], v[40:43]
    buffer_load_dwordx4 v138, s[12:15], s40 offen offset:2048  lds
    v_mfma_f32_16x16x32_bf16 v[44:47], a[204:207], a[72:75], v[44:47]
    ds_read_b128 a[84:87], v145 offset:4096
    v_mfma_f32_16x16x32_bf16 v[44:47], a[236:239], a[76:79], v[44:47]
    ds_read_b64_tr_b16 a[128:129], v160 offset:16384
    v_mfma_f32_16x16x32_bf16 v[48:51], a[208:211], a[72:75], v[48:51]
    buffer_load_dwordx4 v139, s[12:15], s40 offen offset:3072  lds
    v_mfma_f32_16x16x32_bf16 v[48:51], a[240:243], a[76:79], v[48:51]
    ds_read_b64_tr_b16 a[130:131], v160 offset:17408
    v_mfma_f32_16x16x32_bf16 v[52:55], a[212:215], a[72:75], v[52:55]
    ds_read_b64_tr_b16 a[160:161], v160 offset:24576
    v_mfma_f32_16x16x32_bf16 v[52:55], a[244:247], a[76:79], v[52:55]
    ds_read_b64_tr_b16 a[162:163], v160 offset:25600
    s_mov_b32 m0, s43
    v_mfma_f32_16x16x32_bf16 v[56:59], a[216:219], a[72:75], v[56:59]
    ds_read_b64_tr_b16 a[132:133], v160 offset:16392
    buffer_load_dwordx4 v128, s[8:11], s39 offen offset:0  lds
    v_mfma_f32_16x16x32_bf16 v[56:59], a[248:251], a[76:79], v[56:59]
    ds_read_b64_tr_b16 a[134:135], v160 offset:17416
    v_mfma_f32_16x16x32_bf16 v[60:63], a[220:223], a[72:75], v[60:63]
    ds_read_b64_tr_b16 a[164:165], v160 offset:24584
    v_mfma_f32_16x16x32_bf16 v[60:63], a[252:255], a[76:79], v[60:63]
    buffer_load_dwordx4 v129, s[8:11], s39 offen offset:1024  lds
    s_waitcnt lgkmcnt(7)
    v_mfma_f32_16x16x32_bf16 v[64:67], a[192:195], a[80:83], v[64:67]
    ds_read_b64_tr_b16 a[166:167], v160 offset:25608
    v_mfma_f32_16x16x32_bf16 v[64:67], a[224:227], a[84:87], v[64:67]
    ds_read_b64_tr_b16 a[136:137], v161 offset:16384
    v_mfma_f32_16x16x32_bf16 v[68:71], a[196:199], a[80:83], v[68:71]
    ds_read_b64_tr_b16 a[138:139], v161 offset:17408
    v_mfma_f32_16x16x32_bf16 v[68:71], a[228:231], a[84:87], v[68:71]
    ds_read_b64_tr_b16 a[168:169], v161 offset:24576
    buffer_load_dwordx4 v130, s[8:11], s39 offen offset:2048  lds
    v_mfma_f32_16x16x32_bf16 v[72:75], a[200:203], a[80:83], v[72:75]
    ds_read_b64_tr_b16 a[170:171], v161 offset:25600
    v_mfma_f32_16x16x32_bf16 v[72:75], a[232:235], a[84:87], v[72:75]
    ds_read_b128 a[88:91], v144 offset:6144
    v_mfma_f32_16x16x32_bf16 v[76:79], a[204:207], a[80:83], v[76:79]
    ds_read_b64_tr_b16 a[140:141], v161 offset:16392
    buffer_load_dwordx4 v131, s[8:11], s39 offen offset:3072  lds
    v_mfma_f32_16x16x32_bf16 v[76:79], a[236:239], a[84:87], v[76:79]
    ds_read_b128 a[92:95], v145 offset:6144
    ds_read_b64_tr_b16 a[142:143], v161 offset:17416
    v_mfma_f32_16x16x32_bf16 v[80:83], a[208:211], a[80:83], v[80:83]
    ds_read_b64_tr_b16 a[172:173], v161 offset:24584
    v_mfma_f32_16x16x32_bf16 v[80:83], a[240:243], a[84:87], v[80:83]
    ds_read_b64_tr_b16 a[174:175], v161 offset:25608
    s_add_u32 m0, s43, 4096
    v_mfma_f32_16x16x32_bf16 v[84:87], a[212:215], a[80:83], v[84:87]
    ds_read_b64_tr_b16 a[144:145], v162 offset:16384
    buffer_load_dwordx4 v132, s[8:11], s39 offen offset:0  lds
    v_mfma_f32_16x16x32_bf16 v[84:87], a[244:247], a[84:87], v[84:87]
    ds_read_b64_tr_b16 a[146:147], v162 offset:17408
    v_mfma_f32_16x16x32_bf16 v[88:91], a[216:219], a[80:83], v[88:91]
    s_waitcnt vmcnt(9)
    ds_read_b128 a[32:35], v146 offset:0
    v_mfma_f32_16x16x32_bf16 v[88:91], a[248:251], a[84:87], v[88:91]
    ds_read_b64_tr_b16 a[176:177], v162 offset:24576
    buffer_load_dwordx4 v133, s[8:11], s39 offen offset:1024  lds
    v_mfma_f32_16x16x32_bf16 v[92:95], a[220:223], a[80:83], v[92:95]
    ds_read_b128 a[36:39], v147 offset:0
    ds_read_b64_tr_b16 a[178:179], v162 offset:25600
    v_mfma_f32_16x16x32_bf16 v[92:95], a[252:255], a[84:87], v[92:95]
    ds_read_b128 a[48:51], v146 offset:2048
    ds_read_b64_tr_b16 a[148:149], v162 offset:16392
    s_waitcnt lgkmcnt(11)
    ds_read_b128 a[52:55], v147 offset:2048
    ds_read_b64_tr_b16 a[150:151], v162 offset:17416
    ds_read_b128 a[96:99], v140 offset:0
    buffer_load_dwordx4 v134, s[8:11], s39 offen offset:2048  lds
    ds_read_b128 a[100:103], v141 offset:0
    ds_read_b64_tr_b16 a[180:181], v162 offset:24584
    ds_read_b64_tr_b16 a[182:183], v162 offset:25608
    ds_read_b128 a[104:107], v140 offset:2048
    ds_read_b64_tr_b16 a[152:153], v163 offset:16384
    buffer_load_dwordx4 v135, s[8:11], s39 offen offset:3072  lds
    ds_read_b128 a[108:111], v141 offset:2048
    ds_read_b64_tr_b16 a[154:155], v163 offset:17408
    ds_read_b64_tr_b16 a[184:185], v163 offset:24576
    ds_read_b128 a[112:115], v140 offset:4096
    ds_read_b128 a[116:119], v141 offset:4096
    s_waitcnt lgkmcnt(12)
    s_mov_b32 m0, s41
    ds_read_b64_tr_b16 a[186:187], v163 offset:25600
    buffer_load_dwordx4 v128, s[8:11], s50 offen offset:0  lds
    ds_read_b64_tr_b16 a[156:157], v163 offset:16392
    ds_read_b128 a[120:123], v140 offset:6144
    ds_read_b64_tr_b16 a[158:159], v163 offset:17416
    ds_read_b128 a[124:127], v141 offset:6144
    ds_read_b64_tr_b16 a[188:189], v163 offset:24584
    buffer_load_dwordx4 v129, s[8:11], s50 offen offset:1024  lds
    ds_read_b64_tr_b16 a[190:191], v163 offset:25608
    buffer_load_dwordx4 v130, s[8:11], s50 offen offset:2048  lds
    s_waitcnt lgkmcnt(0)
    v_mfma_f32_16x16x32_bf16 v[0:3], a[128:131], a[96:99], v[0:3]
    v_mfma_f32_16x16x32_bf16 v[0:3], a[160:163], a[100:103], v[0:3]
    v_mfma_f32_16x16x32_bf16 v[4:7], a[132:135], a[96:99], v[4:7]
    buffer_load_dwordx4 v131, s[8:11], s50 offen offset:3072  lds
    v_mfma_f32_16x16x32_bf16 v[4:7], a[164:167], a[100:103], v[4:7]
    v_mfma_f32_16x16x32_bf16 v[8:11], a[136:139], a[96:99], v[8:11]
    s_lshl_b32 s39, s38, 7
    v_mfma_f32_16x16x32_bf16 v[8:11], a[168:171], a[100:103], v[8:11]
    s_lshl_b32 s40, s38, 19
    s_add_u32 m0, s41, 98304
    v_mfma_f32_16x16x32_bf16 v[12:15], a[140:143], a[96:99], v[12:15]
    buffer_load_dwordx4 v136, s[12:15], s40 offen offset:0  lds
    v_mfma_f32_16x16x32_bf16 v[12:15], a[172:175], a[100:103], v[12:15]
    s_add_u32 s38, s38, 1
    v_mfma_f32_16x16x32_bf16 v[16:19], a[144:147], a[96:99], v[16:19]
    s_cmp_eq_u32 s38, 9
    s_cselect_b32 s38, 0, s38
    v_mfma_f32_16x16x32_bf16 v[16:19], a[176:179], a[100:103], v[16:19]
    buffer_load_dwordx4 v137, s[12:15], s40 offen offset:1024  lds
    v_mfma_f32_16x16x32_bf16 v[20:23], a[148:151], a[96:99], v[20:23]
    v_mfma_f32_16x16x32_bf16 v[20:23], a[180:183], a[100:103], v[20:23]
    v_mfma_f32_16x16x32_bf16 v[24:27], a[152:155], a[96:99], v[24:27]
    v_mfma_f32_16x16x32_bf16 v[24:27], a[184:187], a[100:103], v[24:27]
    buffer_load_dwordx4 v138, s[12:15], s40 offen offset:2048  lds
    v_mfma_f32_16x16x32_bf16 v[28:31], a[156:159], a[96:99], v[28:31]
    v_mfma_f32_16x16x32_bf16 v[28:31], a[188:191], a[100:103], v[28:31]
    v_mfma_f32_16x16x32_bf16 v[32:35], a[128:131], a[104:107], v[32:35]
    s_waitcnt vmcnt(15)
    s_barrier
    buffer_load_dwordx4 v139, s[12:15], s40 offen offset:3072  lds
    v_mfma_f32_16x16x32_bf16 v[32:35], a[160:163], a[108:111], v[32:35]
    ds_read_b64_tr_b16 a[192:193], v160 offset:32768
    v_mfma_f32_16x16x32_bf16 v[36:39], a[132:135], a[104:107], v[36:39]
    ds_read_b64_tr_b16 a[194:195], v160 offset:33792
    v_mfma_f32_16x16x32_bf16 v[36:39], a[164:167], a[108:111], v[36:39]
    ds_read_b64_tr_b16 a[224:225], v160 offset:40960
    s_mov_b32 m0, s44
    v_mfma_f32_16x16x32_bf16 v[40:43], a[136:139], a[104:107], v[40:43]
    buffer_load_dwordx4 v128, s[8:11], s39 offen offset:0  lds
    v_mfma_f32_16x16x32_bf16 v[40:43], a[168:171], a[108:111], v[40:43]
    ds_read_b64_tr_b16 a[226:227], v160 offset:41984
    v_mfma_f32_16x16x32_bf16 v[44:47], a[140:143], a[104:107], v[44:47]
    ds_read_b64_tr_b16 a[196:197], v160 offset:32776
    v_mfma_f32_16x16x32_bf16 v[44:47], a[172:175], a[108:111], v[44:47]
    buffer_load_dwordx4 v129, s[8:11], s39 offen offset:1024  lds
    v_mfma_f32_16x16x32_bf16 v[48:51], a[144:147], a[104:107], v[48:51]
    ds_read_b64_tr_b16 a[198:199], v160 offset:33800
    v_mfma_f32_16x16x32_bf16 v[48:51], a[176:179], a[108:111], v[48:51]
    ds_read_b64_tr_b16 a[228:229], v160 offset:40968
    v_mfma_f32_16x16x32_bf16 v[52:55], a[148:151], a[104:107], v[52:55]
    ds_read_b64_tr_b16 a[230:231], v160 offset:41992
    v_mfma_f32_16x16x32_bf16 v[52:55], a[180:183], a[108:111], v[52:55]
    buffer_load_dwordx4 v130, s[8:11], s39 offen offset:2048  lds
    v_mfma_f32_16x16x32_bf16 v[56:59], a[152:155], a[104:107], v[56:59]
    ds_read_b64_tr_b16 a[200:201], v161 offset:32768
    v_mfma_f32_16x16x32_bf16 v[56:59], a[184:187], a[108:111], v[56:59]
    ds_read_b64_tr_b16 a[202:203], v161 offset:33792
    v_mfma_f32_16x16x32_bf16 v[60:63], a[156:159], a[104:107], v[60:63]
    buffer_load_dwordx4 v131, s[8:11], s39 offen offset:3072  lds
    v_mfma_f32_16x16x32_bf16 v[60:63], a[188:191], a[108:111], v[60:63]
    ds_read_b64_tr_b16 a[232:233], v161 offset:40960
    v_mfma_f32_16x16x32_bf16 v[64:67], a[128:131], a[112:115], v[64:67]
    ds_read_b64_tr_b16 a[234:235], v161 offset:41984
    v_mfma_f32_16x16x32_bf16 v[64:67], a[160:163], a[116:119], v[64:67]
    ds_read_b64_tr_b16 a[204:205], v161 offset:32776
    s_add_u32 m0, s44, 4096
    v_mfma_f32_16x16x32_bf16 v[68:71], a[132:135], a[112:115], v[68:71]
    buffer_load_dwordx4 v132, s[8:11], s39 offen offset:0  lds
    v_mfma_f32_16x16x32_bf16 v[68:71], a[164:167], a[116:119], v[68:71]
    s_waitcnt vmcnt(9)
    ds_read_b128 a[8:11], v146 offset:0
    v_mfma_f32_16x16x32_bf16 v[72:75], a[136:139], a[112:115], v[72:75]
    ds_read_b64_tr_b16 a[206:207], v161 offset:33800
    v_mfma_f32_16x16x32_bf16 v[72:75], a[168:171], a[116:119], v[72:75]
    ds_read_b128 a[12:15], v147 offset:0
    buffer_load_dwordx4 v133, s[8:11], s39 offen offset:1024  lds
    v_mfma_f32_16x16x32_bf16 v[76:79], a[140:143], a[112:115], v[76:79]
    ds_read_b64_tr_b16 a[236:237], v161 offset:40968
    ds_read_b128 a[24:27], v146 offset:2048
    v_mfma_f32_16x16x32_bf16 v[76:79], a[172:175], a[116:119], v[76:79]
    ds_read_b64_tr_b16 a[238:239], v161 offset:41992
    ds_read_b128 a[28:31], v147 offset:2048
    v_mfma_f32_16x16x32_bf16 v[80:83], a[144:147], a[112:115], v[80:83]
    ds_read_b64_tr_b16 a[208:209], v162 offset:32768
    v_mfma_f32_16x16x32_bf16 v[80:83], a[176:179], a[116:119], v[80:83]
    buffer_load_dwordx4 v134, s[8:11], s39 offen offset:2048  lds
    v_mfma_f32_16x16x32_bf16 v[84:87], a[148:151], a[112:115], v[84:87]
    ds_read_b64_tr_b16 a[210:211], v162 offset:33792
    v_mfma_f32_16x16x32_bf16 v[84:87], a[180:183], a[116:119], v[84:87]
    ds_read_b64_tr_b16 a[240:241], v162 offset:40960
    v_mfma_f32_16x16x32_bf16 v[88:91], a[152:155], a[112:115], v[88:91]
    ds_read_b64_tr_b16 a[242:243], v162 offset:41984
    buffer_load_dwordx4 v135, s[8:11], s39 offen offset:3072  lds
    v_mfma_f32_16x16x32_bf16 v[88:91], a[184:187], a[116:119], v[88:91]
    ds_read_b64_tr_b16 a[212:213], v162 offset:32776
    v_mfma_f32_16x16x32_bf16 v[92:95], a[156:159], a[112:115], v[92:95]
    ds_read_b64_tr_b16 a[214:215], v162 offset:33800
    v_mfma_f32_16x16x32_bf16 v[92:95], a[188:191], a[116:119], v[92:95]
    ds_read_b64_tr_b16 a[244:245], v162 offset:40968
    s_waitcnt lgkmcnt(7)
    s_mov_b32 m0, s41
    ds_read_b128 a[64:67], v142 offset:0
    buffer_load_dwordx4 v132, s[8:11], s50 offen offset:0  lds
    ds_read_b128 a[68:71], v143 offset:0
    ds_read_b64_tr_b16 a[246:247], v162 offset:41992
    ds_read_b64_tr_b16 a[216:217], v163 offset:32768
    buffer_load_dwordx4 v133, s[8:11], s50 offen offset:1024  lds
    ds_read_b128 a[72:75], v142 offset:2048
    ds_read_b64_tr_b16 a[218:219], v163 offset:33792
    ds_read_b128 a[76:79], v143 offset:2048
    ds_read_b64_tr_b16 a[248:249], v163 offset:40960
    ds_read_b128 a[80:83], v142 offset:4096
    ds_read_b64_tr_b16 a[250:251], v163 offset:41984
    buffer_load_dwordx4 v134, s[8:11], s50 offen offset:2048  lds
    ds_read_b128 a[84:87], v143 offset:4096
    ds_read_b64_tr_b16 a[220:221], v163 offset:32776
    ds_read_b128 a[88:91], v142 offset:6144
    ds_read_b64_tr_b16 a[222:223], v163 offset:33800
    buffer_load_dwordx4 v135, s[8:11], s50 offen offset:3072  lds
    ds_read_b128 a[92:95], v143 offset:6144
    ds_read_b64_tr_b16 a[252:253], v163 offset:40968
    ds_read_b64_tr_b16 a[254:255], v163 offset:41992
    s_lshl_b32 s39, s38, 7
    s_lshl_b32 s40, s38, 19
    s_add_u32 m0, s41, 114688
    s_nop 0
    buffer_load_dwordx4 v136, s[12:15], s40 offen offset:0  lds
    s_add_u32 s38, s38, 1
    s_waitcnt lgkmcnt(0)
    v_mfma_f32_16x16x32_bf16 v[0:3], a[192:195], a[64:67], v[0:3]
    s_cmp_eq_u32 s38, 9
    s_cselect_b32 s38, 0, s38
    v_mfma_f32_16x16x32_bf16 v[0:3], a[224:227], a[68:71], v[0:3]
    buffer_load_dwordx4 v137, s[12:15], s40 offen offset:1024  lds
    v_mfma_f32_16x16x32_bf16 v[4:7], a[196:199], a[64:67], v[4:7]
    v_mfma_f32_16x16x32_bf16 v[4:7], a[228:231], a[68:71], v[4:7]
    v_mfma_f32_16x16x32_bf16 v[8:11], a[200:203], a[64:67], v[8:11]
    v_mfma_f32_16x16x32_bf16 v[8:11], a[232:235], a[68:71], v[8:11]
    buffer_load_dwordx4 v138, s[12:15], s40 offen offset:2048  lds
    v_mfma_f32_16x16x32_bf16 v[12:15], a[204:207], a[64:67], v[12:15]
    v_mfma_f32_16x16x32_bf16 v[12:15], a[236:239], a[68:71], v[12:15]
    v_mfma_f32_16x16x32_bf16 v[16:19], a[208:211], a[64:67], v[16:19]
    buffer_load_dwordx4 v139, s[12:15], s40 offen offset:3072  lds
    v_mfma_f32_16x16x32_bf16 v[16:19], a[240:243], a[68:71], v[16:19]
    v_mfma_f32_16x16x32_bf16 v[20:23], a[212:215], a[64:67], v[20:23]
    v_mfma_f32_16x16x32_bf16 v[20:23], a[244:247], a[68:71], v[20:23]
    s_mov_b32 m0, s42
    v_mfma_f32_16x16x32_bf16 v[24:27], a[216:219], a[64:67], v[24:27]
    buffer_load_dwordx4 v128, s[8:11], s39 offen offset:0  lds
    v_mfma_f32_16x16x32_bf16 v[24:27], a[248:251], a[68:71], v[24:27]
    v_mfma_f32_16x16x32_bf16 v[28:31], a[220:223], a[64:67], v[28:31]
    v_mfma_f32_16x16x32_bf16 v[28:31], a[252:255], a[68:71], v[28:31]
    buffer_load_dwordx4 v129, s[8:11], s39 offen offset:1024  lds
    v_mfma_f32_16x16x32_bf16 v[32:35], a[192:195], a[72:75], v[32:35]
    s_waitcnt vmcnt(18)
    s_barrier
    v_mfma_f32_16x16x32_bf16 v[32:35], a[224:227], a[76:79], v[32:35]
    ds_read_b64_tr_b16 a[128:129], v160 offset:0
    v_mfma_f32_16x16x32_bf16 v[36:39], a[196:199], a[72:75], v[36:39]
    ds_read_b64_tr_b16 a[130:131], v160 offset:1024
    v_mfma_f32_16x16x32_bf16 v[36:39], a[228:231], a[76:79], v[36:39]
    buffer_load_dwordx4 v130, s[8:11], s39 offen offset:2048  lds
    v_mfma_f32_16x16x32_bf16 v[40:43], a[200:203], a[72:75], v[40:43]
    ds_read_b64_tr_b16 a[160:161], v160 offset:8192
    v_mfma_f32_16x16x32_bf16 v[40:43], a[232:235], a[76:79], v[40:43]
    ds_read_b64_tr_b16 a[162:163], v160 offset:9216
    v_mfma_f32_16x16x32_bf16 v[44:47], a[204:207], a[72:75], v[44:47]
    buffer_load_dwordx4 v131, s[8:11], s39 offen offset:3072  lds
    v_mfma_f32_16x16x32_bf16 v[44:47], a[236:239], a[76:79], v[44:47]
    ds_read_b64_tr_b16 a[132:133], v160 offset:8
    v_mfma_f32_16x16x32_bf16 v[48:51], a[208:211], a[72:75], v[48:51]
    ds_read_b64_tr_b16 a[134:135], v160 offset:1032
    v_mfma_f32_16x16x32_bf16 v[48:51], a[240:243], a[76:79], v[48:51]
    ds_read_b64_tr_b16 a[164:165], v160 offset:8200
    s_add_u32 m0, s42, 4096
    v_mfma_f32_16x16x32_bf16 v[52:55], a[212:215], a[72:75], v[52:55]
    buffer_load_dwordx4 v132, s[8:11], s39 offen offset:0  lds
    v_mfma_f32_16x16x32_bf16 v[52:55], a[244:247], a[76:79], v[52:55]
    s_waitcnt vmcnt(9)
    ds_read_b128 a[40:43], v146 offset:0
    v_mfma_f32_16x16x32_bf16 v[56:59], a[216:219], a[72:75], v[56:59]
    ds_read_b64_tr_b16 a[166:167], v160 offset:9224
    v_mfma_f32_16x16x32_bf16 v[56:59], a[248:251], a[76:79], v[56:59]
    ds_read_b128 a[44:47], v147 offset:0
    buffer_load_dwordx4 v133, s[8:11], s39 offen offset:1024  lds
    v_mfma_f32_16x16x32_bf16 v[60:63], a[220:223], a[72:75], v[60:63]
    ds_read_b64_tr_b16 a[136:137], v161 offset:0
    ds_read_b128 a[56:59], v146 offset:2048
    v_mfma_f32_16x16x32_bf16 v[60:63], a[252:255], a[76:79], v[60:63]
    ds_read_b64_tr_b16 a[138:139], v161 offset:1024
    ds_read_b128 a[60:63], v147 offset:2048
    v_mfma_f32_16x16x32_bf16 v[64:67], a[192:195], a[80:83], v[64:67]
    ds_read_b64_tr_b16 a[168:169], v161 offset:8192
    v_mfma_f32_16x16x32_bf16 v[64:67], a[224:227], a[84:87], v[64:67]
    buffer_load_dwordx4 v134, s[8:11], s39 offen offset:2048  lds
    v_mfma_f32_16x16x32_bf16 v[68:71], a[196:199], a[80:83], v[68:71]
    ds_read_b64_tr_b16 a[170:171], v161 offset:9216
    v_mfma_f32_16x16x32_bf16 v[68:71], a[228:231], a[84:87], v[68:71]
    ds_read_b64_tr_b16 a[140:141], v161 offset:8
    v_mfma_f32_16x16x32_bf16 v[72:75], a[200:203], a[80:83], v[72:75]
    buffer_load_dwordx4 v135, s[8:11], s39 offen offset:3072  lds
    v_mfma_f32_16x16x32_bf16 v[72:75], a[232:235], a[84:87], v[72:75]
    ds_read_b64_tr_b16 a[142:143], v161 offset:1032
    v_mfma_f32_16x16x32_bf16 v[76:79], a[204:207], a[80:83], v[76:79]
    ds_read_b64_tr_b16 a[172:173], v161 offset:8200
    s_lshl_b32 s39, s38, 7
    v_mfma_f32_16x16x32_bf16 v[76:79], a[236:239], a[84:87], v[76:79]
    ds_read_b64_tr_b16 a[174:175], v161 offset:9224
    s_lshl_b32 s40, s38, 19
    s_add_u32 m0, s41, 131072
    v_mfma_f32_16x16x32_bf16 v[80:83], a[208:211], a[80:83], v[80:83]
    ds_read_b64_tr_b16 a[144:145], v162 offset:0
    buffer_load_dwordx4 v136, s[12:15], s40 offen offset:0  lds
    v_mfma_f32_16x16x32_bf16 v[80:83], a[240:243], a[84:87], v[80:83]
    ds_read_b64_tr_b16 a[146:147], v162 offset:1024
    s_add_u32 s38, s38, 1
    v_mfma_f32_16x16x32_bf16 v[84:87], a[212:215], a[80:83], v[84:87]
    ds_read_b64_tr_b16 a[176:177], v162 offset:8192
    s_cmp_eq_u32 s38, 9
    s_cselect_b32 s38, 0, s38
    v_mfma_f32_16x16x32_bf16 v[84:87], a[244:247], a[84:87], v[84:87]
    buffer_load_dwordx4 v137, s[12:15], s40 offen offset:1024  lds
    v_mfma_f32_16x16x32_bf16 v[88:91], a[216:219], a[80:83], v[88:91]
    ds_read_b64_tr_b16 a[178:179], v162 offset:9216
    v_mfma_f32_16x16x32_bf16 v[88:91], a[248:251], a[84:87], v[88:91]
    ds_read_b64_tr_b16 a[148:149], v162 offset:8
    v_mfma_f32_16x16x32_bf16 v[92:95], a[220:223], a[80:83], v[92:95]
    ds_read_b64_tr_b16 a[150:151], v162 offset:1032
    v_mfma_f32_16x16x32_bf16 v[92:95], a[252:255], a[84:87], v[92:95]
    buffer_load_dwordx4 v138, s[12:15], s40 offen offset:2048  lds
    ds_read_b64_tr_b16 a[180:181], v162 offset:8200
    ds_read_b128 a[96:99], v144 offset:0
    ds_read_b128 a[100:103], v145 offset:0
    ds_read_b64_tr_b16 a[182:183], v162 offset:9224
    buffer_load_dwordx4 v139, s[12:15], s40 offen offset:3072  lds
    ds_read_b64_tr_b16 a[152:153], v163 offset:0
    ds_read_b128 a[104:107], v144 offset:2048
    ds_read_b64_tr_b16 a[154:155], v163 offset:1024
    ds_read_b128 a[108:111], v145 offset:2048
    s_lshl_b32 s39, s38, 7
    ds_read_b64_tr_b16 a[184:185], v163 offset:8192
    s_lshl_b32 s40, s38, 19
    s_add_u32 m0, s41, 147456
    ds_read_b128 a[112:115], v144 offset:4096
    buffer_load_dwordx4 v136, s[12:15], s40 offen offset:0  lds
    ds_read_b64_tr_b16 a[186:187], v163 offset:9216
    ds_read_b128 a[116:119], v145 offset:4096
    s_add_u32 s38, s38, 1
    ds_read_b64_tr_b16 a[156:157], v163 offset:8
    s_cmp_eq_u32 s38, 9
    s_cselect_b32 s38, 0, s38
    ds_read_b128 a[120:123], v144 offset:6144
    buffer_load_dwordx4 v137, s[12:15], s40 offen offset:1024  lds
    ds_read_b64_tr_b16 a[158:159], v163 offset:1032
    ds_read_b128 a[124:127], v145 offset:6144
    ds_read_b64_tr_b16 a[188:189], v163 offset:8200
    ds_read_b64_tr_b16 a[190:191], v163 offset:9224
    buffer_load_dwordx4 v138, s[12:15], s40 offen offset:2048  lds
    s_waitcnt lgkmcnt(0)
    v_mfma_f32_16x16x32_bf16 v[0:3], a[128:131], a[96:99], v[0:3]
    buffer_load_dwordx4 v139, s[12:15], s40 offen offset:3072  lds
    v_mfma_f32_16x16x32_bf16 v[0:3], a[160:163], a[100:103], v[0:3]
    v_mfma_f32_16x16x32_bf16 v[4:7], a[132:135], a[96:99], v[4:7]
    v_mfma_f32_16x16x32_bf16 v[4:7], a[164:167], a[100:103], v[4:7]
    s_add_u32 m0, s41, 0
    v_mfma_f32_16x16x32_bf16 v[8:11], a[136:139], a[96:99], v[8:11]
    buffer_load_dwordx4 v232, s[16:19], s45 offen offset:0 nt lds
    v_mfma_f32_16x16x32_bf16 v[8:11], a[168:171], a[100:103], v[8:11]
    v_mfma_f32_16x16x32_bf16 v[12:15], a[140:143], a[96:99], v[12:15]
    v_mfma_f32_16x16x32_bf16 v[12:15], a[172:175], a[100:103], v[12:15]
    v_mfma_f32_16x16x32_bf16 v[16:19], a[144:147], a[96:99], v[16:19]
    v_mfma_f32_16x16x32_bf16 v[16:19], a[176:179], a[100:103], v[16:19]
    v_mfma_f32_16x16x32_bf16 v[20:23], a[148:151], a[96:99], v[20:23]
    v_mfma_f32_16x16x32_bf16 v[20:23], a[180:183], a[100:103], v[20:23]
    v_mfma_f32_16x16x32_bf16 v[24:27], a[152:155], a[96:99], v[24:27]
    v_mfma_f32_16x16x32_bf16 v[24:27], a[184:187], a[100:103], v[24:27]
    v_mfma_f32_16x16x32_bf16 v[28:31], a[156:159], a[96:99], v[28:31]
    v_mfma_f32_16x16x32_bf16 v[28:31], a[188:191], a[100:103], v[28:31]
    buffer_load_dwordx4 v232, s[16:19], s45 offen offset:1024 nt lds
    v_mfma_f32_16x16x32_bf16 v[32:35], a[128:131], a[104:107], v[32:35]
    s_waitcnt vmcnt(18)
    s_barrier
    v_mfma_f32_16x16x32_bf16 v[32:35], a[160:163], a[108:111], v[32:35]
    ds_read_b64_tr_b16 a[192:193], v160 offset:16384
    v_mfma_f32_16x16x32_bf16 v[36:39], a[132:135], a[104:107], v[36:39]
    ds_read_b64_tr_b16 a[194:195], v160 offset:17408
    v_mfma_f32_16x16x32_bf16 v[36:39], a[164:167], a[108:111], v[36:39]
    ds_read_b64_tr_b16 a[224:225], v160 offset:24576
    v_mfma_f32_16x16x32_bf16 v[40:43], a[136:139], a[104:107], v[40:43]
    ds_read_b64_tr_b16 a[226:227], v160 offset:25600
    v_mfma_f32_16x16x32_bf16 v[40:43], a[168:171], a[108:111], v[40:43]
    v_mfma_f32_16x16x32_bf16 v[44:47], a[140:143], a[104:107], v[44:47]
    ds_read_b64_tr_b16 a[196:197], v160 offset:16392
    v_mfma_f32_16x16x32_bf16 v[44:47], a[172:175], a[108:111], v[44:47]
    ds_read_b64_tr_b16 a[198:199], v160 offset:17416
    v_mfma_f32_16x16x32_bf16 v[48:51], a[144:147], a[104:107], v[48:51]
    ds_read_b64_tr_b16 a[228:229], v160 offset:24584
    v_mfma_f32_16x16x32_bf16 v[48:51], a[176:179], a[108:111], v[48:51]
    v_mfma_f32_16x16x32_bf16 v[52:55], a[148:151], a[104:107], v[52:55]
    buffer_load_dwordx4 v233, s[16:19], s45 offen offset:2048 nt lds
    v_mfma_f32_16x16x32_bf16 v[52:55], a[180:183], a[108:111], v[52:55]
    ds_read_b64_tr_b16 a[230:231], v160 offset:25608
    v_mfma_f32_16x16x32_bf16 v[56:59], a[152:155], a[104:107], v[56:59]
    ds_read_b64_tr_b16 a[200:201], v161 offset:16384
    v_mfma_f32_16x16x32_bf16 v[56:59], a[184:187], a[108:111], v[56:59]
    ds_read_b64_tr_b16 a[202:203], v161 offset:17408
    v_mfma_f32_16x16x32_bf16 v[60:63], a[156:159], a[104:107], v[60:63]
    ds_read_b64_tr_b16 a[232:233], v161 offset:24576
    v_mfma_f32_16x16x32_bf16 v[60:63], a[188:191], a[108:111], v[60:63]
    ds_read_b64_tr_b16 a[234:235], v161 offset:25600
    v_mfma_f32_16x16x32_bf16 v[64:67], a[128:131], a[112:115], v[64:67]
    ds_read_b64_tr_b16 a[204:205], v161 offset:16392
    v_mfma_f32_16x16x32_bf16 v[64:67], a[160:163], a[116:119], v[64:67]
    v_mfma_f32_16x16x32_bf16 v[68:71], a[132:135], a[112:115], v[68:71]
    ds_read_b64_tr_b16 a[206:207], v161 offset:17416
    v_mfma_f32_16x16x32_bf16 v[68:71], a[164:167], a[116:119], v[68:71]
    ds_read_b64_tr_b16 a[236:237], v161 offset:24584
    v_mfma_f32_16x16x32_bf16 v[72:75], a[136:139], a[112:115], v[72:75]
    ds_read_b64_tr_b16 a[238:239], v161 offset:25608
    v_mfma_f32_16x16x32_bf16 v[72:75], a[168:171], a[116:119], v[72:75]
    buffer_load_dwordx4 v233, s[16:19], s45 offen offset:3072 nt lds
    v_mfma_f32_16x16x32_bf16 v[76:79], a[140:143], a[112:115], v[76:79]
    ds_read_b64_tr_b16 a[208:209], v162 offset:16384
    v_mfma_f32_16x16x32_bf16 v[76:79], a[172:175], a[116:119], v[76:79]
    ds_read_b64_tr_b16 a[210:211], v162 offset:17408
    v_mfma_f32_16x16x32_bf16 v[80:83], a[144:147], a[112:115], v[80:83]
    ds_read_b64_tr_b16 a[240:241], v162 offset:24576
    v_mfma_f32_16x16x32_bf16 v[80:83], a[176:179], a[116:119], v[80:83]
    ds_read_b64_tr_b16 a[242:243], v162 offset:25600
    v_mfma_f32_16x16x32_bf16 v[84:87], a[148:151], a[112:115], v[84:87]
    v_mfma_f32_16x16x32_bf16 v[84:87], a[180:183], a[116:119], v[84:87]
    ds_read_b64_tr_b16 a[212:213], v162 offset:16392
    v_mfma_f32_16x16x32_bf16 v[88:91], a[152:155], a[112:115], v[88:91]
    ds_read_b64_tr_b16 a[214:215], v162 offset:17416
    v_mfma_f32_16x16x32_bf16 v[88:91], a[184:187], a[116:119], v[88:91]
    ds_read_b64_tr_b16 a[244:245], v162 offset:24584
    v_mfma_f32_16x16x32_bf16 v[92:95], a[156:159], a[112:115], v[92:95]
    s_waitcnt vmcnt(16)
    ds_read_b128 a[64:67], v140 offset:0
    v_mfma_f32_16x16x32_bf16 v[92:95], a[188:191], a[116:119], v[92:95]
    ds_read_b128 a[68:71], v141 offset:0
    s_add_u32 m0, s41, 65536
    s_nop 0
    buffer_load_dwordx4 v234, s[20:23], s46 offen offset:0 nt lds
    ds_read_b64_tr_b16 a[246:247], v162 offset:25608
    ds_read_b64_tr_b16 a[216:217], v163 offset:16384
    ds_read_b128 a[72:75], v140 offset:2048
    ds_read_b64_tr_b16 a[218:219], v163 offset:17408
    ds_read_b128 a[76:79], v141 offset:2048
    ds_read_b64_tr_b16 a[248:249], v163 offset:24576
    s_waitcnt vmcnt(13)
    ds_read_b128 a[80:83], v140 offset:4096
    ds_read_b64_tr_b16 a[250:251], v163 offset:25600
    ds_read_b128 a[84:87], v141 offset:4096
    ds_read_b64_tr_b16 a[220:221], v163 offset:16392
    ds_read_b128 a[88:91], v140 offset:6144
    ds_read_b64_tr_b16 a[222:223], v163 offset:17416
    ds_read_b128 a[92:95], v141 offset:6144
    ds_read_b64_tr_b16 a[252:253], v163 offset:24584
    buffer_load_dwordx4 v234, s[20:23], s46 offen offset:1024 nt lds
    ds_read_b64_tr_b16 a[254:255], v163 offset:25608
    s_waitcnt lgkmcnt(0)
    v_mfma_f32_16x16x32_bf16 v[0:3], a[192:195], a[64:67], v[0:3]
    v_mfma_f32_16x16x32_bf16 v[0:3], a[224:227], a[68:71], v[0:3]
    v_mfma_f32_16x16x32_bf16 v[4:7], a[196:199], a[64:67], v[4:7]
    v_mfma_f32_16x16x32_bf16 v[4:7], a[228:231], a[68:71], v[4:7]
    v_mfma_f32_16x16x32_bf16 v[8:11], a[200:203], a[64:67], v[8:11]
    v_mfma_f32_16x16x32_bf16 v[8:11], a[232:235], a[68:71], v[8:11]
    v_mfma_f32_16x16x32_bf16 v[12:15], a[204:207], a[64:67], v[12:15]
    buffer_load_dwordx4 v235, s[20:23], s46 offen offset:2048 nt lds
    v_mfma_f32_16x16x32_bf16 v[12:15], a[236:239], a[68:71], v[12:15]
    v_mfma_f32_16x16x32_bf16 v[16:19], a[208:211], a[64:67], v[16:19]
    v_mfma_f32_16x16x32_bf16 v[16:19], a[240:243], a[68:71], v[16:19]
    v_mfma_f32_16x16x32_bf16 v[20:23], a[212:215], a[64:67], v[20:23]
    v_mfma_f32_16x16x32_bf16 v[20:23], a[244:247], a[68:71], v[20:23]
    v_mfma_f32_16x16x32_bf16 v[24:27], a[216:219], a[64:67], v[24:27]
    v_mfma_f32_16x16x32_bf16 v[24:27], a[248:251], a[68:71], v[24:27]
    v_mfma_f32_16x16x32_bf16 v[28:31], a[220:223], a[64:67], v[28:31]
    v_mfma_f32_16x16x32_bf16 v[28:31], a[252:255], a[68:71], v[28:31]
    v_mfma_f32_16x16x32_bf16 v[32:35], a[192:195], a[72:75], v[32:35]
    s_waitcnt vmcnt(7)
    s_barrier
    v_mfma_f32_16x16x32_bf16 v[32:35], a[224:227], a[76:79], v[32:35]
    ds_read_b64_tr_b16 a[128:129], v160 offset:32768
    v_mfma_f32_16x16x32_bf16 v[36:39], a[196:199], a[72:75], v[36:39]
    buffer_load_dwordx4 v235, s[20:23], s46 offen offset:3072 nt lds
    v_mfma_f32_16x16x32_bf16 v[36:39], a[228:231], a[76:79], v[36:39]
    ds_read_b64_tr_b16 a[130:131], v160 offset:33792
    v_mfma_f32_16x16x32_bf16 v[40:43], a[200:203], a[72:75], v[40:43]
    ds_read_b64_tr_b16 a[160:161], v160 offset:40960
    v_mfma_f32_16x16x32_bf16 v[40:43], a[232:235], a[76:79], v[40:43]
    ds_read_b64_tr_b16 a[162:163], v160 offset:41984
    v_mfma_f32_16x16x32_bf16 v[44:47], a[204:207], a[72:75], v[44:47]
    ds_read_b64_tr_b16 a[132:133], v160 offset:32776
    v_mfma_f32_16x16x32_bf16 v[44:47], a[236:239], a[76:79], v[44:47]
    ds_read_b64_tr_b16 a[134:135], v160 offset:33800
    v_mfma_f32_16x16x32_bf16 v[48:51], a[208:211], a[72:75], v[48:51]
    ds_read_b64_tr_b16 a[164:165], v160 offset:40968
    v_mfma_f32_16x16x32_bf16 v[48:51], a[240:243], a[76:79], v[48:51]
    ds_read_b64_tr_b16 a[166:167], v160 offset:41992
    v_mfma_f32_16x16x32_bf16 v[52:55], a[212:215], a[72:75], v[52:55]
    ds_read_b64_tr_b16 a[136:137], v161 offset:32768
    v_mfma_f32_16x16x32_bf16 v[52:55], a[244:247], a[76:79], v[52:55]
    ds_read_b64_tr_b16 a[138:139], v161 offset:33792
    v_mfma_f32_16x16x32_bf16 v[56:59], a[216:219], a[72:75], v[56:59]
    ds_read_b64_tr_b16 a[168:169], v161 offset:40960
    ds_read_b64_tr_b16 a[170:171], v161 offset:41984
    v_mfma_f32_16x16x32_bf16 v[56:59], a[248:251], a[76:79], v[56:59]
    s_add_u32 s45, s45, 16384
    s_add_u32 m0, s41, 16384
    s_nop 0
    buffer_load_dwordx4 v232, s[16:19], s45 offen offset:0 nt lds
    v_mfma_f32_16x16x32_bf16 v[60:63], a[220:223], a[72:75], v[60:63]
    ds_read_b64_tr_b16 a[140:141], v161 offset:32776
    v_mfma_f32_16x16x32_bf16 v[60:63], a[252:255], a[76:79], v[60:63]
    ds_read_b64_tr_b16 a[142:143], v161 offset:33800
    v_mfma_f32_16x16x32_bf16 v[64:67], a[192:195], a[80:83], v[64:67]
    ds_read_b64_tr_b16 a[172:173], v161 offset:40968
    v_mfma_f32_16x16x32_bf16 v[64:67], a[224:227], a[84:87], v[64:67]
    ds_read_b64_tr_b16 a[174:175], v161 offset:41992
    v_mfma_f32_16x16x32_bf16 v[68:71], a[196:199], a[80:83], v[68:71]
    ds_read_b64_tr_b16 a[144:145], v162 offset:32768
    v_mfma_f32_16x16x32_bf16 v[68:71], a[228:231], a[84:87], v[68:71]
    ds_read_b64_tr_b16 a[146:147], v162 offset:33792
    v_mfma_f32_16x16x32_bf16 v[72:75], a[200:203], a[80:83], v[72:75]
    ds_read_b64_tr_b16 a[176:177], v162 offset:40960
    v_mfma_f32_16x16x32_bf16 v[72:75], a[232:235], a[84:87], v[72:75]
    ds_read_b64_tr_b16 a[178:179], v162 offset:41984
    v_mfma_f32_16x16x32_bf16 v[76:79], a[204:207], a[80:83], v[76:79]
    ds_read_b64_tr_b16 a[148:149], v162 offset:32776
    v_mfma_f32_16x16x32_bf16 v[76:79], a[236:239], a[84:87], v[76:79]
    ds_read_b64_tr_b16 a[150:151], v162 offset:33800
    ds_read_b64_tr_b16 a[180:181], v162 offset:40968
    v_mfma_f32_16x16x32_bf16 v[80:83], a[208:211], a[80:83], v[80:83]
    buffer_load_dwordx4 v232, s[16:19], s45 offen offset:1024 nt lds
    v_mfma_f32_16x16x32_bf16 v[80:83], a[240:243], a[84:87], v[80:83]
    ds_read_b64_tr_b16 a[182:183], v162 offset:41992
    v_mfma_f32_16x16x32_bf16 v[84:87], a[212:215], a[80:83], v[84:87]
    ds_read_b64_tr_b16 a[152:153], v163 offset:32768
    v_mfma_f32_16x16x32_bf16 v[84:87], a[244:247], a[84:87], v[84:87]
    ds_read_b64_tr_b16 a[154:155], v163 offset:33792
    v_mfma_f32_16x16x32_bf16 v[88:91], a[216:219], a[80:83], v[88:91]
    ds_read_b64_tr_b16 a[184:185], v163 offset:40960
    v_mfma_f32_16x16x32_bf16 v[88:91], a[248:251], a[84:87], v[88:91]
    ds_read_b64_tr_b16 a[186:187], v163 offset:41984
    v_mfma_f32_16x16x32_bf16 v[92:95], a[220:223], a[80:83], v[92:95]
    ds_read_b64_tr_b16 a[156:157], v163 offset:32776
    v_mfma_f32_16x16x32_bf16 v[92:95], a[252:255], a[84:87], v[92:95]
    ds_read_b64_tr_b16 a[158:159], v163 offset:33800
    ds_read_b64_tr_b16 a[188:189], v163 offset:40968
    ds_read_b64_tr_b16 a[190:191], v163 offset:41992
    buffer_load_dwordx4 v233, s[16:19], s45 offen offset:2048 nt lds
    ds_read_b64_tr_b16 a[192:193], v160 offset:49152
    ds_read_b64_tr_b16 a[194:195], v160 offset:50176
    ds_read_b64_tr_b16 a[224:225], v160 offset:57344
    ds_read_b64_tr_b16 a[226:227], v160 offset:58368
    ds_read_b64_tr_b16 a[196:197], v160 offset:49160
    ds_read_b64_tr_b16 a[198:199], v160 offset:50184
    ds_read_b64_tr_b16 a[228:229], v160 offset:57352
    ds_read_b64_tr_b16 a[230:231], v160 offset:58376
    ds_read_b64_tr_b16 a[200:201], v161 offset:49152
    ds_read_b64_tr_b16 a[202:203], v161 offset:50176
    ds_read_b64_tr_b16 a[232:233], v161 offset:57344
    buffer_load_dwordx4 v233, s[16:19], s45 offen offset:3072 nt lds
    ds_read_b64_tr_b16 a[234:235], v161 offset:58368
    s_waitcnt lgkmcnt(12)
    v_mfma_f32_16x16x32_bf16 v[0:3], a[128:131], a[0:3], v[0:3]
    ds_read_b64_tr_b16 a[204:205], v161 offset:49160
    v_mfma_f32_16x16x32_bf16 v[0:3], a[160:163], a[4:7], v[0:3]
    ds_read_b64_tr_b16 a[206:207], v161 offset:50184
    v_mfma_f32_16x16x32_bf16 v[4:7], a[132:135], a[0:3], v[4:7]
    ds_read_b64_tr_b16 a[236:237], v161 offset:57352
    v_mfma_f32_16x16x32_bf16 v[4:7], a[164:167], a[4:7], v[4:7]
    ds_read_b64_tr_b16 a[238:239], v161 offset:58376
    v_mfma_f32_16x16x32_bf16 v[8:11], a[136:139], a[0:3], v[8:11]
    ds_read_b64_tr_b16 a[208:209], v162 offset:49152
    v_mfma_f32_16x16x32_bf16 v[8:11], a[168:171], a[4:7], v[8:11]
    ds_read_b64_tr_b16 a[210:211], v162 offset:50176
    v_mfma_f32_16x16x32_bf16 v[12:15], a[140:143], a[0:3], v[12:15]
    ds_read_b64_tr_b16 a[240:241], v162 offset:57344
    v_mfma_f32_16x16x32_bf16 v[12:15], a[172:175], a[4:7], v[12:15]
    ds_read_b64_tr_b16 a[242:243], v162 offset:58368
    v_mfma_f32_16x16x32_bf16 v[16:19], a[144:147], a[0:3], v[16:19]
    ds_read_b64_tr_b16 a[212:213], v162 offset:49160
    ds_read_b64_tr_b16 a[214:215], v162 offset:50184
    v_mfma_f32_16x16x32_bf16 v[16:19], a[176:179], a[4:7], v[16:19]
    s_add_u32 s46, s46, 16384
    s_add_u32 m0, s41, 81920
    s_nop 0
    buffer_load_dwordx4 v234, s[20:23], s46 offen offset:0 nt lds
    v_mfma_f32_16x16x32_bf16 v[20:23], a[148:151], a[0:3], v[20:23]
    ds_read_b64_tr_b16 a[244:245], v162 offset:57352
    v_mfma_f32_16x16x32_bf16 v[20:23], a[180:183], a[4:7], v[20:23]
    ds_read_b64_tr_b16 a[246:247], v162 offset:58376
    v_mfma_f32_16x16x32_bf16 v[24:27], a[152:155], a[0:3], v[24:27]
    ds_read_b64_tr_b16 a[216:217], v163 offset:49152
    v_mfma_f32_16x16x32_bf16 v[24:27], a[184:187], a[4:7], v[24:27]
    ds_read_b64_tr_b16 a[218:219], v163 offset:50176
    v_mfma_f32_16x16x32_bf16 v[28:31], a[156:159], a[0:3], v[28:31]
    ds_read_b64_tr_b16 a[248:249], v163 offset:57344
    v_mfma_f32_16x16x32_bf16 v[28:31], a[188:191], a[4:7], v[28:31]
    ds_read_b64_tr_b16 a[250:251], v163 offset:58368
    s_waitcnt lgkmcnt(15)
    v_mfma_f32_16x16x32_bf16 v[0:3], a[192:195], a[8:11], v[0:3]
    ds_read_b64_tr_b16 a[220:221], v163 offset:49160
    v_mfma_f32_16x16x32_bf16 v[0:3], a[224:227], a[12:15], v[0:3]
    ds_read_b64_tr_b16 a[222:223], v163 offset:50184
    v_mfma_f32_16x16x32_bf16 v[4:7], a[196:199], a[8:11], v[4:7]
    ds_read_b64_tr_b16 a[252:253], v163 offset:57352
    v_mfma_f32_16x16x32_bf16 v[4:7], a[228:231], a[12:15], v[4:7]
    ds_read_b64_tr_b16 a[254:255], v163 offset:58376
    s_waitcnt lgkmcnt(15)
    v_mfma_f32_16x16x32_bf16 v[8:11], a[200:203], a[8:11], v[8:11]
    buffer_load_dwordx4 v234, s[20:23], s46 offen offset:1024 nt lds
    v_mfma_f32_16x16x32_bf16 v[8:11], a[232:235], a[12:15], v[8:11]
    v_mfma_f32_16x16x32_bf16 v[12:15], a[204:207], a[8:11], v[12:15]
    v_mfma_f32_16x16x32_bf16 v[12:15], a[236:239], a[12:15], v[12:15]
    s_waitcnt lgkmcnt(8)
    v_mfma_f32_16x16x32_bf16 v[16:19], a[208:211], a[8:11], v[16:19]
    v_mfma_f32_16x16x32_bf16 v[16:19], a[240:243], a[12:15], v[16:19]
    v_mfma_f32_16x16x32_bf16 v[20:23], a[212:215], a[8:11], v[20:23]
    v_mfma_f32_16x16x32_bf16 v[20:23], a[244:247], a[12:15], v[20:23]
    s_waitcnt lgkmcnt(0)
    v_mfma_f32_16x16x32_bf16 v[24:27], a[216:219], a[8:11], v[24:27]
    v_mfma_f32_16x16x32_bf16 v[24:27], a[248:251], a[12:15], v[24:27]
    v_mfma_f32_16x16x32_bf16 v[28:31], a[220:223], a[8:11], v[28:31]
    buffer_load_dwordx4 v235, s[20:23], s46 offen offset:2048 nt lds
    v_mfma_f32_16x16x32_bf16 v[28:31], a[252:255], a[12:15], v[28:31]
    v_mfma_f32_16x16x32_bf16 v[32:35], a[128:131], a[16:19], v[32:35]
    v_mfma_f32_16x16x32_bf16 v[32:35], a[160:163], a[20:23], v[32:35]
    v_mfma_f32_16x16x32_bf16 v[32:35], a[192:195], a[24:27], v[32:35]
    v_mul_f32 v0, s48, v0
    v_mul_f32 v1, s48, v1
    v_mfma_f32_16x16x32_bf16 v[32:35], a[224:227], a[28:31], v[32:35]
    v_mul_f32 v2, s48, v2
    v_mul_f32 v3, s48, v3
    v_mfma_f32_16x16x32_bf16 v[36:39], a[132:135], a[16:19], v[36:39]
    v_mul_f32 v4, s48, v4
    v_mul_f32 v5, s48, v5
    v_mfma_f32_16x16x32_bf16 v[36:39], a[164:167], a[20:23], v[36:39]
    v_mul_f32 v6, s48, v6
    v_mul_f32 v7, s48, v7
    v_mfma_f32_16x16x32_bf16 v[36:39], a[196:199], a[24:27], v[36:39]
    v_cvt_pk_bf16_f32 v0, v0, v1
    v_cvt_pk_bf16_f32 v1, v2, v3
    v_mfma_f32_16x16x32_bf16 v[36:39], a[228:231], a[28:31], v[36:39]
    v_cvt_pk_bf16_f32 v2, v4, v5
    v_cvt_pk_bf16_f32 v3, v6, v7
    v_mfma_f32_16x16x32_bf16 v[40:43], a[136:139], a[16:19], v[40:43]
    v_mul_f32 v8, s48, v8
    v_mul_f32 v9, s48, v9
    v_mul_f32 v10, s48, v10
    v_mfma_f32_16x16x32_bf16 v[40:43], a[168:171], a[20:23], v[40:43]
    buffer_load_dwordx4 v235, s[20:23], s46 offen offset:3072 nt lds
    v_mul_f32 v11, s48, v11
    v_mfma_f32_16x16x32_bf16 v[40:43], a[200:203], a[24:27], v[40:43]
    v_mul_f32 v12, s48, v12
    v_mul_f32 v13, s48, v13
    v_mfma_f32_16x16x32_bf16 v[40:43], a[232:235], a[28:31], v[40:43]
    v_mul_f32 v14, s48, v14
    v_mul_f32 v15, s48, v15
    v_mfma_f32_16x16x32_bf16 v[44:47], a[140:143], a[16:19], v[44:47]
    v_cvt_pk_bf16_f32 v4, v8, v9
    v_cvt_pk_bf16_f32 v5, v10, v11
    v_mfma_f32_16x16x32_bf16 v[44:47], a[172:175], a[20:23], v[44:47]
    v_cvt_pk_bf16_f32 v6, v12, v13
    v_cvt_pk_bf16_f32 v7, v14, v15
    v_mfma_f32_16x16x32_bf16 v[44:47], a[204:207], a[24:27], v[44:47]
    s_waitcnt vmcnt(8)
    s_barrier
    v_mul_f32 v16, s48, v16
    v_mfma_f32_16x16x32_bf16 v[44:47], a[236:239], a[28:31], v[44:47]
    ds_read_b128 a[64:67], v220 offset:0
    v_mul_f32 v17, s48, v17
    v_mul_f32 v18, s48, v18
    v_mfma_f32_16x16x32_bf16 v[48:51], a[144:147], a[16:19], v[48:51]
    ds_read_b128 a[68:71], v221 offset:0
    v_mul_f32 v19, s48, v19
    v_mfma_f32_16x16x32_bf16 v[48:51], a[176:179], a[20:23], v[48:51]
    v_mul_f32 v20, s48, v20
    v_mul_f32 v21, s48, v21
    v_mfma_f32_16x16x32_bf16 v[48:51], a[208:211], a[24:27], v[48:51]
    ds_read_b128 a[72:75], v222 offset:0
    v_mul_f32 v22, s48, v22
    v_mfma_f32_16x16x32_bf16 v[48:51], a[240:243], a[28:31], v[48:51]
    ds_read_b128 a[76:79], v223 offset:0
    v_mul_f32 v23, s48, v23
    v_mfma_f32_16x16x32_bf16 v[52:55], a[148:151], a[16:19], v[52:55]
    s_add_u32 s45, s45, 16384
    s_add_u32 m0, s41, 32768
    s_nop 0
    buffer_load_dwordx4 v232, s[16:19], s45 offen offset:0 nt lds
    v_cvt_pk_bf16_f32 v8, v16, v17
    v_mfma_f32_16x16x32_bf16 v[52:55], a[180:183], a[20:23], v[52:55]
    ds_read_b128 a[80:83], v220 offset:1024
    v_cvt_pk_bf16_f32 v9, v18, v19
    v_cvt_pk_bf16_f32 v10, v20, v21
    v_mfma_f32_16x16x32_bf16 v[52:55], a[212:215], a[24:27], v[52:55]
    ds_read_b128 a[84:87], v221 offset:1024
    v_cvt_pk_bf16_f32 v11, v22, v23
    v_mfma_f32_16x16x32_bf16 v[52:55], a[244:247], a[28:31], v[52:55]
    v_mul_f32 v24, s48, v24
    v_mul_f32 v25, s48, v25
    v_mfma_f32_16x16x32_bf16 v[56:59], a[152:155], a[16:19], v[56:59]
    ds_read_b128 a[88:91], v222 offset:1024
    v_mul_f32 v26, s48, v26
    v_mfma_f32_16x16x32_bf16 v[56:59], a[184:187], a[20:23], v[56:59]
    ds_read_b128 a[92:95], v223 offset:1024
    v_mul_f32 v27, s48, v27
    v_mfma_f32_16x16x32_bf16 v[56:59], a[216:219], a[24:27], v[56:59]
    v_mul_f32 v28, s48, v28
    v_mul_f32 v29, s48, v29
    v_mfma_f32_16x16x32_bf16 v[56:59], a[248:251], a[28:31], v[56:59]
    v_mul_f32 v30, s48, v30
    v_mul_f32 v31, s48, v31
    v_mfma_f32_16x16x32_bf16 v[60:63], a[156:159], a[16:19], v[60:63]
    v_cvt_pk_bf16_f32 v12, v24, v25
    v_cvt_pk_bf16_f32 v13, v26, v27
    v_cvt_pk_bf16_f32 v14, v28, v29
    v_mfma_f32_16x16x32_bf16 v[60:63], a[188:191], a[20:23], v[60:63]
    v_cvt_pk_bf16_f32 v15, v30, v31
    v_mfma_f32_16x16x32_bf16 v[60:63], a[220:223], a[24:27], v[60:63]
    v_mfma_f32_16x16x32_bf16 v[60:63], a[252:255], a[28:31], v[60:63]
    buffer_load_dwordx4 v232, s[16:19], s45 offen offset:1024 nt lds
    s_waitcnt lgkmcnt(0)
    v_mfma_f32_16x16x32_bf16 v[128:131], a[64:67], v[0:3], v[176:179]
    v_mfma_f32_16x16x32_bf16 v[128:131], a[68:71], v[4:7], v[128:131]
    v_mfma_f32_16x16x32_bf16 v[128:131], a[72:75], v[8:11], v[128:131]
    v_mul_f32 v32, s48, v32
    v_mul_f32 v33, s48, v33
    v_mul_f32 v34, s48, v34
    v_mfma_f32_16x16x32_bf16 v[128:131], a[76:79], v[12:15], v[128:131]
    v_mul_f32 v35, s48, v35
    v_mul_f32 v36, s48, v36
    v_mfma_f32_16x16x32_bf16 v[132:135], a[80:83], v[0:3], v[176:179]
    ds_read_b128 a[96:99], v220 offset:8192
    v_mul_f32 v37, s48, v37
    v_mfma_f32_16x16x32_bf16 v[132:135], a[84:87], v[4:7], v[132:135]
    v_mul_f32 v38, s48, v38
    v_mul_f32 v39, s48, v39
    v_mfma_f32_16x16x32_bf16 v[132:135], a[88:91], v[8:11], v[132:135]
    v_cvt_pk_bf16_f32 v16, v32, v33
    v_cvt_pk_bf16_f32 v17, v34, v35
    v_mfma_f32_16x16x32_bf16 v[132:135], a[92:95], v[12:15], v[132:135]
    ds_read_b128 a[100:103], v221 offset:8192
    v_cvt_pk_bf16_f32 v18, v36, v37
    v_cvt_pk_bf16_f32 v19, v38, v39
    v_mfma_f32_16x16x32_bf16 v[64:67], a[128:131], a[32:35], v[64:67]
    v_mul_f32 v40, s48, v40
    v_mul_f32 v41, s48, v41
    v_mfma_f32_16x16x32_bf16 v[64:67], a[160:163], a[36:39], v[64:67]
    v_mul_f32 v42, s48, v42
    v_mul_f32 v43, s48, v43
    v_mfma_f32_16x16x32_bf16 v[64:67], a[192:195], a[40:43], v[64:67]
    ds_read_b128 a[104:107], v222 offset:8192
    v_mul_f32 v44, s48, v44
    v_mfma_f32_16x16x32_bf16 v[64:67], a[224:227], a[44:47], v[64:67]
    buffer_load_dwordx4 v233, s[16:19], s45 offen offset:2048 nt lds
    v_mul_f32 v45, s48, v45
    v_mfma_f32_16x16x32_bf16 v[68:71], a[132:135], a[32:35], v[68:71]
    v_mul_f32 v46, s48, v46
    v_mul_f32 v47, s48, v47
    v_cvt_pk_bf16_f32 v20, v40, v41
    v_mfma_f32_16x16x32_bf16 v[68:71], a[164:167], a[36:39], v[68:71]
    ds_read_b128 a[108:111], v223 offset:8192
    v_cvt_pk_bf16_f32 v21, v42, v43
    v_mfma_f32_16x16x32_bf16 v[68:71], a[196:199], a[40:43], v[68:71]
    v_cvt_pk_bf16_f32 v22, v44, v45
    v_cvt_pk_bf16_f32 v23, v46, v47
    v_mfma_f32_16x16x32_bf16 v[68:71], a[228:231], a[44:47], v[68:71]
    v_mul_f32 v48, s48, v48
    v_mul_f32 v49, s48, v49
    v_mfma_f32_16x16x32_bf16 v[72:75], a[136:139], a[32:35], v[72:75]
    ds_read_b128 a[112:115], v220 offset:9216
    v_mul_f32 v50, s48, v50
    v_mfma_f32_16x16x32_bf16 v[72:75], a[168:171], a[36:39], v[72:75]
    v_mul_f32 v51, s48, v51
    v_mul_f32 v52, s48, v52
    v_mul_f32 v53, s48, v53
    v_mfma_f32_16x16x32_bf16 v[72:75], a[200:203], a[40:43], v[72:75]
    v_mul_f32 v54, s48, v54
    v_mul_f32 v55, s48, v55
    v_mfma_f32_16x16x32_bf16 v[72:75], a[232:235], a[44:47], v[72:75]
    ds_read_b128 a[116:119], v221 offset:9216
    v_cvt_pk_bf16_f32 v24, v48, v49
    v_mfma_f32_16x16x32_bf16 v[76:79], a[140:143], a[32:35], v[76:79]
    v_cvt_pk_bf16_f32 v25, v50, v51
    v_cvt_pk_bf16_f32 v26, v52, v53
    v_mfma_f32_16x16x32_bf16 v[76:79], a[172:175], a[36:39], v[76:79]
    buffer_load_dwordx4 v233, s[16:19], s45 offen offset:3072 nt lds
    v_cvt_pk_bf16_f32 v27, v54, v55
    v_mfma_f32_16x16x32_bf16 v[76:79], a[204:207], a[40:43], v[76:79]
    ds_read_b128 a[120:123], v222 offset:9216
    v_mul_f32 v56, s48, v56
    v_mul_f32 v57, s48, v57
    v_mfma_f32_16x16x32_bf16 v[76:79], a[236:239], a[44:47], v[76:79]
    v_mul_f32 v58, s48, v58
    v_mul_f32 v59, s48, v59
    v_mfma_f32_16x16x32_bf16 v[80:83], a[144:147], a[32:35], v[80:83]
    v_mul_f32 v60, s48, v60
    v_mul_f32 v61, s48, v61
    v_mfma_f32_16x16x32_bf16 v[80:83], a[176:179], a[36:39], v[80:83]
    ds_read_b128 a[124:127], v223 offset:9216
    v_mul_f32 v62, s48, v62
    v_mfma_f32_16x16x32_bf16 v[80:83], a[208:211], a[40:43], v[80:83]
    v_mul_f32 v63, s48, v63
    v_cvt_pk_bf16_f32 v28, v56, v57
    v_mfma_f32_16x16x32_bf16 v[80:83], a[240:243], a[44:47], v[80:83]
    v_cvt_pk_bf16_f32 v29, v58, v59
    v_cvt_pk_bf16_f32 v30, v60, v61
    v_cvt_pk_bf16_f32 v31, v62, v63
    v_mfma_f32_16x16x32_bf16 v[84:87], a[148:151], a[32:35], v[84:87]
    v_exp_f32 v208, v128
    v_mfma_f32_16x16x32_bf16 v[84:87], a[180:183], a[36:39], v[84:87]
    v_exp_f32 v209, v129
    v_mfma_f32_16x16x32_bf16 v[84:87], a[212:215], a[40:43], v[84:87]
    v_exp_f32 v210, v130
    v_mfma_f32_16x16x32_bf16 v[84:87], a[244:247], a[44:47], v[84:87]
    v_cvt_pk_bf16_f32 v160, v208, v209
    v_mfma_f32_16x16x32_bf16 v[88:91], a[152:155], a[32:35], v[88:91]
    s_add_u32 s46, s46, 16384
    s_add_u32 m0, s41, 98304
    s_nop 0
    buffer_load_dwordx4 v234, s[20:23], s46 offen offset:0 nt lds
    v_exp_f32 v211, v131
    v_mfma_f32_16x16x32_bf16 v[88:91], a[184:187], a[36:39], v[88:91]
    v_exp_f32 v212, v132
    v_mfma_f32_16x16x32_bf16 v[88:91], a[216:219], a[40:43], v[88:91]
    v_cvt_pk_bf16_f32 v161, v210, v211
    v_mfma_f32_16x16x32_bf16 v[88:91], a[248:251], a[44:47], v[88:91]
    v_exp_f32 v213, v133
    v_mfma_f32_16x16x32_bf16 v[92:95], a[156:159], a[32:35], v[92:95]
    v_exp_f32 v214, v134
    v_cvt_pk_bf16_f32 v162, v212, v213
    v_mfma_f32_16x16x32_bf16 v[92:95], a[188:191], a[36:39], v[92:95]
    v_exp_f32 v215, v135
    v_mfma_f32_16x16x32_bf16 v[92:95], a[220:223], a[40:43], v[92:95]
    v_cvt_pk_bf16_f32 v163, v214, v215
    v_mfma_f32_16x16x32_bf16 v[92:95], a[252:255], a[44:47], v[92:95]
    v_mfma_f32_16x16x32_bf16 v[136:139], a[64:67], v[16:19], v[180:183]
    v_mfma_f32_16x16x32_bf16 v[136:139], a[68:71], v[20:23], v[136:139]
    v_mfma_f32_16x16x32_bf16 v[136:139], a[72:75], v[24:27], v[136:139]
    v_mul_f32 v64, s48, v64
    v_mul_f32 v65, s48, v65
    v_mul_f32 v66, s48, v66
    v_mfma_f32_16x16x32_bf16 v[136:139], a[76:79], v[28:31], v[136:139]
    buffer_load_dwordx4 v234, s[20:23], s46 offen offset:1024 nt lds
    v_mul_f32 v67, s48, v67
    v_mfma_f32_16x16x32_bf16 v[140:143], a[80:83], v[16:19], v[180:183]
    v_mul_f32 v68, s48, v68
    v_mul_f32 v69, s48, v69
    v_mfma_f32_16x16x32_bf16 v[140:143], a[84:87], v[20:23], v[140:143]
    v_mul_f32 v70, s48, v70
    v_mul_f32 v71, s48, v71
    v_cvt_pk_bf16_f32 v32, v64, v65
    v_mfma_f32_16x16x32_bf16 v[140:143], a[88:91], v[24:27], v[140:143]
    v_cvt_pk_bf16_f32 v33, v66, v67
    v_cvt_pk_bf16_f32 v34, v68, v69
    v_mfma_f32_16x16x32_bf16 v[140:143], a[92:95], v[28:31], v[140:143]
    v_cvt_pk_bf16_f32 v35, v70, v71
    v_mul_f32 v72, s48, v72
    v_mul_f32 v73, s48, v73
    v_mul_f32 v74, s48, v74
    v_mul_f32 v75, s48, v75
    v_mul_f32 v76, s48, v76
    v_mul_f32 v77, s48, v77
    v_mul_f32 v78, s48, v78
    v_mul_f32 v79, s48, v79
    v_cvt_pk_bf16_f32 v36, v72, v73
    v_cvt_pk_bf16_f32 v37, v74, v75
    v_cvt_pk_bf16_f32 v38, v76, v77
    v_cvt_pk_bf16_f32 v39, v78, v79
    v_mul_f32 v80, s48, v80
    ds_read_b64_tr_b16 a[128:129], v224 offset:0
    v_mul_f32 v81, s48, v81
    buffer_load_dwordx4 v235, s[20:23], s46 offen offset:2048 nt lds
    v_mul_f32 v82, s48, v82
    ds_read_b64_tr_b16 a[130:131], v224 offset:1024
    v_mul_f32 v83, s48, v83
    v_mul_f32 v84, s48, v84
    v_mul_f32 v85, s48, v85
    v_mul_f32 v86, s48, v86
    ds_read_b64_tr_b16 a[132:133], v225 offset:0
    v_mul_f32 v87, s48, v87
    v_cvt_pk_bf16_f32 v40, v80, v81
    v_cvt_pk_bf16_f32 v41, v82, v83
    ds_read_b64_tr_b16 a[134:135], v225 offset:1024
    v_cvt_pk_bf16_f32 v42, v84, v85
    v_cvt_pk_bf16_f32 v43, v86, v87
    v_mul_f32 v88, s48, v88
    v_mul_f32 v89, s48, v89
    ds_read_b64_tr_b16 a[136:137], v226 offset:0
    v_mul_f32 v90, s48, v90
    v_mul_f32 v91, s48, v91
    v_mul_f32 v92, s48, v92
    ds_read_b64_tr_b16 a[138:139], v226 offset:1024
    v_mul_f32 v93, s48, v93
    v_mul_f32 v94, s48, v94
    v_mul_f32 v95, s48, v95
    v_cvt_pk_bf16_f32 v44, v88, v89
    buffer_load_dwordx4 v235, s[20:23], s46 offen offset:3072 nt lds
    v_cvt_pk_bf16_f32 v45, v90, v91
    ds_read_b64_tr_b16 a[140:141], v227 offset:0
    v_cvt_pk_bf16_f32 v46, v92, v93
    ds_read_b64_tr_b16 a[142:143], v227 offset:1024
    v_cvt_pk_bf16_f32 v47, v94, v95
    v_exp_f32 v208, v136
    ds_read_b64_tr_b16 a[144:145], v228 offset:0
    v_exp_f32 v209, v137
    v_exp_f32 v210, v138
    ds_read_b64_tr_b16 a[146:147], v228 offset:1024
    v_cvt_pk_bf16_f32 v164, v208, v209
    v_exp_f32 v211, v139
    ds_read_b64_tr_b16 a[148:149], v229 offset:0
    v_exp_f32 v212, v140
    v_cvt_pk_bf16_f32 v165, v210, v211
    ds_read_b64_tr_b16 a[150:151], v229 offset:1024
    v_exp_f32 v213, v141
    s_add_u32 s45, s45, 16384
    s_add_u32 m0, s41, 49152
    s_nop 0
    buffer_load_dwordx4 v232, s[16:19], s45 offen offset:0 nt lds
    ds_read_b64_tr_b16 a[152:153], v230 offset:0
    v_exp_f32 v214, v142
    v_cvt_pk_bf16_f32 v166, v212, v213
    ds_read_b64_tr_b16 a[154:155], v230 offset:1024
    v_exp_f32 v215, v143
    v_mfma_f32_16x16x32_bf16 v[144:147], a[64:67], v[32:35], v[184:187]
    v_cvt_pk_bf16_f32 v167, v214, v215
    v_mfma_f32_16x16x32_bf16 v[144:147], a[68:71], v[36:39], v[144:147]
    ds_read_b64_tr_b16 a[156:157], v231 offset:0
    v_mfma_f32_16x16x32_bf16 v[144:147], a[72:75], v[40:43], v[144:147]
    v_mfma_f32_16x16x32_bf16 v[144:147], a[76:79], v[44:47], v[144:147]
    ds_read_b64_tr_b16 a[158:159], v231 offset:1024
    v_mfma_f32_16x16x32_bf16 v[148:151], a[80:83], v[32:35], v[184:187]
    v_mfma_f32_16x16x32_bf16 v[148:151], a[84:87], v[36:39], v[148:151]
    v_mfma_f32_16x16x32_bf16 v[148:151], a[88:91], v[40:43], v[148:151]
    v_mfma_f32_16x16x32_bf16 v[148:151], a[92:95], v[44:47], v[148:151]
    buffer_load_dwordx4 v232, s[16:19], s45 offen offset:1024 nt lds
    s_waitcnt lgkmcnt(15)
    v_mfma_f32_16x16x32_bf16 v[128:131], a[96:99], v[0:3], v[176:179]
    v_mfma_f32_16x16x32_bf16 v[128:131], a[100:103], v[4:7], v[128:131]
    v_mfma_f32_16x16x32_bf16 v[128:131], a[104:107], v[8:11], v[128:131]
    v_mfma_f32_16x16x32_bf16 v[128:131], a[108:111], v[12:15], v[128:131]
    v_mfma_f32_16x16x32_bf16 v[132:135], a[112:115], v[0:3], v[176:179]
    v_mfma_f32_16x16x32_bf16 v[132:135], a[116:119], v[4:7], v[132:135]
    v_mfma_f32_16x16x32_bf16 v[132:135], a[120:123], v[8:11], v[132:135]
    ds_read_b64_tr_b16 a[160:161], v224 offset:8192
    v_mfma_f32_16x16x32_bf16 v[132:135], a[124:127], v[12:15], v[132:135]
    s_waitcnt lgkmcnt(1)
    v_mfma_f32_16x16x32_bf16 a[0:3], a[128:131], v[160:163], 0
    v_mfma_f32_16x16x32_bf16 a[4:7], a[132:135], v[160:163], 0
    v_mfma_f32_16x16x32_bf16 a[8:11], a[136:139], v[160:163], 0
    buffer_load_dwordx4 v233, s[16:19], s45 offen offset:2048 nt lds
    v_mfma_f32_16x16x32_bf16 a[12:15], a[140:143], v[160:163], 0
    ds_read_b64_tr_b16 a[162:163], v224 offset:9216
    v_mfma_f32_16x16x32_bf16 a[16:19], a[144:147], v[160:163], 0
    v_mfma_f32_16x16x32_bf16 a[20:23], a[148:151], v[160:163], 0
    v_mfma_f32_16x16x32_bf16 a[24:27], a[152:155], v[160:163], 0
    ds_read_b64_tr_b16 a[164:165], v225 offset:8192
    v_mfma_f32_16x16x32_bf16 a[28:31], a[156:159], v[160:163], 0
    v_mfma_f32_16x16x32_bf16 v[192:195], v[216:219], v[160:163], 0
    v_exp_f32 v208, v144
    ds_read_b64_tr_b16 a[166:167], v225 offset:9216
    v_exp_f32 v209, v145
    v_exp_f32 v210, v146
    v_cvt_pk_bf16_f32 v168, v208, v209
    buffer_load_dwordx4 v233, s[16:19], s45 offen offset:3072 nt lds
    v_exp_f32 v211, v147
    ds_read_b64_tr_b16 a[168:169], v226 offset:8192
    v_exp_f32 v212, v148
    v_cvt_pk_bf16_f32 v169, v210, v211
    v_exp_f32 v213, v149
    v_mfma_f32_16x16x32_bf16 v[136:139], a[96:99], v[16:19], v[180:183]
    s_waitcnt vmcnt(12)
    s_barrier
    v_exp_f32 v214, v150
    v_mfma_f32_16x16x32_bf16 v[136:139], a[100:103], v[20:23], v[136:139]
    ds_read_b64_tr_b16 a[170:171], v226 offset:9216
    v_cvt_pk_bf16_f32 v170, v212, v213
    v_mfma_f32_16x16x32_bf16 v[136:139], a[104:107], v[24:27], v[136:139]
    s_cmp_eq_u32 s100, 1
    s_cbranch_scc1 L_max
    s_mov_b32 s8, s96
    s_mov_b32 s9, s97
    s_mov_b32 s10, 256
    s_lshl_b32 s38, s36, 5
    s_mov_b32 s47, 0
    s_mov_b32 s59, 0
    v_mfma_f32_16x16x32_bf16 v[136:139], a[108:111], v[28:31], v[136:139]
    s_xor_b32 s58, s29, 1
    s_min_u32 s58, s58, 8
    s_lshl_b32 s58, s58, 7
    s_add_u32 s12, s32, s58
    s_addc_u32 s13, s33, 0
    s_sub_u32 s14, 4718592, s58
    s_lshr_b32 s58, 0x2affffff, s57
    s_and_b32 s58, s58, 1
    s_cselect_b32 s14, s14, 0
    v_exp_f32 v215, v151
    v_mfma_f32_16x16x32_bf16 v[140:143], a[112:115], v[16:19], v[180:183]
    ds_read_b128 a[64:67], v220 offset:16384
    v_cvt_pk_bf16_f32 v171, v214, v215
    v_mfma_f32_16x16x32_bf16 v[140:143], a[116:119], v[20:23], v[140:143]
    ds_read_b64_tr_b16 a[172:173], v227 offset:8192
    v_mfma_f32_16x16x32_bf16 v[140:143], a[120:123], v[24:27], v[140:143]
    s_xor_b32 s58, s30, 0
    s_mul_i32 s39, s58, 147456
    v_mfma_f32_16x16x32_bf16 v[140:143], a[124:127], v[28:31], v[140:143]
    ds_read_b128 a[68:71], v221 offset:16384
    v_mfma_f32_16x16x32_bf16 a[32:35], a[128:131], v[164:167], 0
    s_add_u32 s46, s46, 16384
    s_add_u32 m0, s41, 114688
    s_nop 0
    buffer_load_dwordx4 v234, s[20:23], s46 offen offset:0 nt lds
    v_mfma_f32_16x16x32_bf16 a[36:39], a[132:135], v[164:167], 0
    ds_read_b64_tr_b16 a[174:175], v227 offset:9216
    v_mfma_f32_16x16x32_bf16 a[40:43], a[136:139], v[164:167], 0
    s_xor_b32 s58, s30, 4
    s_mul_i32 s40, s58, 147456
    v_mfma_f32_16x16x32_bf16 a[44:47], a[140:143], v[164:167], 0
    ds_read_b128 a[72:75], v222 offset:16384
    v_mfma_f32_16x16x32_bf16 a[48:51], a[144:147], v[164:167], 0
    v_mfma_f32_16x16x32_bf16 a[52:55], a[148:151], v[164:167], 0
    s_xor_b32 s58, s30, 8
    s_mul_i32 s42, s58, 147456
    v_mfma_f32_16x16x32_bf16 a[56:59], a[152:155], v[164:167], 0
    ds_read_b128 a[76:79], v223 offset:16384
    v_mfma_f32_16x16x32_bf16 a[60:63], a[156:159], v[164:167], 0
    ds_read_b64_tr_b16 a[176:177], v228 offset:8192
    v_mfma_f32_16x16x32_bf16 v[196:199], v[216:219], v[164:167], 0
    v_mfma_f32_16x16x32_bf16 v[144:147], a[96:99], v[32:35], v[184:187]
    s_xor_b32 s58, s30, 12
    s_mul_i32 s43, s58, 147456
    v_mfma_f32_16x16x32_bf16 v[144:147], a[100:103], v[36:39], v[144:147]
    ds_read_b128 a[80:83], v220 offset:17408
    v_mfma_f32_16x16x32_bf16 v[144:147], a[104:107], v[40:43], v[144:147]
    buffer_load_dwordx4 v234, s[20:23], s46 offen offset:1024 nt lds
    v_mfma_f32_16x16x32_bf16 v[144:147], a[108:111], v[44:47], v[144:147]
    ds_read_b64_tr_b16 a[178:179], v228 offset:9216
    v_exp_f32 v208, v128
    v_mfma_f32_16x16x32_bf16 v[148:151], a[112:115], v[32:35], v[184:187]
    ds_read_b128 a[84:87], v221 offset:17408
    v_mfma_f32_16x16x32_bf16 v[148:151], a[116:119], v[36:39], v[148:151]
    ds_read_b64_tr_b16 a[180:181], v229 offset:8192
    v_exp_f32 v209, v129
    v_mfma_f32_16x16x32_bf16 v[148:151], a[120:123], v[40:43], v[148:151]
    v_exp_f32 v210, v130
    v_mfma_f32_16x16x32_bf16 v[148:151], a[124:127], v[44:47], v[148:151]
    ds_read_b128 a[88:91], v222 offset:17408
    v_cvt_pk_bf16_f32 v160, v208, v209
    v_mfma_f32_16x16x32_bf16 v[64:67], a[128:131], v[168:171], 0
    v_exp_f32 v211, v131
    v_mfma_f32_16x16x32_bf16 v[68:71], a[132:135], v[168:171], 0
    ds_read_b64_tr_b16 a[182:183], v229 offset:9216
    v_exp_f32 v212, v132
    v_mfma_f32_16x16x32_bf16 v[72:75], a[136:139], v[168:171], 0
    ds_read_b128 a[92:95], v223 offset:17408
    v_cvt_pk_bf16_f32 v161, v210, v211
    v_mfma_f32_16x16x32_bf16 v[76:79], a[140:143], v[168:171], 0
    v_exp_f32 v213, v133
    v_mfma_f32_16x16x32_bf16 v[80:83], a[144:147], v[168:171], 0
    buffer_load_dwordx4 v235, s[20:23], s46 offen offset:2048 nt lds
    v_exp_f32 v214, v134
    v_mfma_f32_16x16x32_bf16 v[84:87], a[148:151], v[168:171], 0
    ds_read_b64_tr_b16 a[184:185], v230 offset:8192
    v_cvt_pk_bf16_f32 v162, v212, v213
    v_mfma_f32_16x16x32_bf16 v[88:91], a[152:155], v[168:171], 0
    v_exp_f32 v215, v135
    v_mfma_f32_16x16x32_bf16 v[92:95], a[156:159], v[168:171], 0
    v_exp_f32 v208, v136
    v_cvt_pk_bf16_f32 v163, v214, v215
    v_mfma_f32_16x16x32_bf16 v[200:203], v[216:219], v[168:171], 0
    v_exp_f32 v209, v137
    ds_read_b64_tr_b16 a[186:187], v230 offset:9216
    v_exp_f32 v210, v138
    v_cvt_pk_bf16_f32 v164, v208, v209
    v_exp_f32 v211, v139
    v_exp_f32 v212, v140
    v_cvt_pk_bf16_f32 v165, v210, v211
    v_exp_f32 v213, v141
    ds_read_b64_tr_b16 a[188:189], v231 offset:8192
    v_exp_f32 v214, v142
    v_cvt_pk_bf16_f32 v166, v212, v213
    v_exp_f32 v215, v143
    buffer_load_dwordx4 v235, s[20:23], s46 offen offset:3072 nt lds
    v_exp_f32 v208, v144
    ds_read_b64_tr_b16 a[190:191], v231 offset:9216
    v_cvt_pk_bf16_f32 v167, v214, v215
    v_exp_f32 v209, v145
    v_exp_f32 v210, v146
    v_cvt_pk_bf16_f32 v168, v208, v209
    v_exp_f32 v211, v147
    v_exp_f32 v212, v148
    v_cvt_pk_bf16_f32 v169, v210, v211
    v_exp_f32 v213, v149
    v_exp_f32 v214, v150
    v_cvt_pk_bf16_f32 v170, v212, v213
    v_exp_f32 v215, v151
    s_nop 0
    v_cvt_pk_bf16_f32 v171, v214, v215
    s_waitcnt lgkmcnt(4)
L_loop3:
    v_mfma_f32_16x16x32_bf16 v[128:131], a[64:67], v[0:3], v[176:179]
    ds_read_b128 a[96:99], v220 offset:24576
    v_mfma_f32_16x16x32_bf16 v[128:131], a[68:71], v[4:7], v[128:131]
    v_mfma_f32_16x16x32_bf16 v[128:131], a[72:75], v[8:11], v[128:131]
    ds_read_b128 a[100:103], v221 offset:24576
    v_mfma_f32_16x16x32_bf16 v[128:131], a[76:79], v[12:15], v[128:131]
    v_mfma_f32_16x16x32_bf16 v[132:135], a[80:83], v[0:3], v[176:179]
    ds_read_b128 a[104:107], v222 offset:24576
    v_mfma_f32_16x16x32_bf16 v[132:135], a[84:87], v[4:7], v[132:135]
    v_mfma_f32_16x16x32_bf16 v[132:135], a[88:91], v[8:11], v[132:135]
    ds_read_b128 a[108:111], v223 offset:24576
    v_mfma_f32_16x16x32_bf16 v[132:135], a[92:95], v[12:15], v[132:135]
    s_waitcnt lgkmcnt(4)
    v_mfma_f32_16x16x32_bf16 a[0:3], a[160:163], v[160:163], a[0:3]
    ds_read_b128 a[112:115], v220 offset:25600
    v_mfma_f32_16x16x32_bf16 a[4:7], a[164:167], v[160:163], a[4:7]
    s_add_u32 s45, s45, 16384
    v_mfma_f32_16x16x32_bf16 a[8:11], a[168:171], v[160:163], a[8:11]
    ds_read_b128 a[116:119], v221 offset:25600
    v_mfma_f32_16x16x32_bf16 a[12:15], a[172:175], v[160:163], a[12:15]
    s_add_u32 m0, s41, 0
    v_mfma_f32_16x16x32_bf16 a[16:19], a[176:179], v[160:163], a[16:19]
    ds_read_b128 a[120:123], v222 offset:25600
    v_mfma_f32_16x16x32_bf16 a[20:23], a[180:183], v[160:163], a[20:23]
    buffer_load_dwordx4 v232, s[16:19], s45 offen offset:0 nt lds
    v_mfma_f32_16x16x32_bf16 a[24:27], a[184:187], v[160:163], a[24:27]
    v_exp_f32 v208, v128
    v_mfma_f32_16x16x32_bf16 a[28:31], a[188:191], v[160:163], a[28:31]
    ds_read_b128 a[124:127], v223 offset:25600
    v_mfma_f32_16x16x32_bf16 v[192:195], v[216:219], v[160:163], v[192:195]
    v_exp_f32 v209, v129
    v_mfma_f32_16x16x32_bf16 v[136:139], a[64:67], v[16:19], v[180:183]
    ds_read_b64_tr_b16 a[128:129], v224 offset:16384
    v_cvt_pk_bf16_f32 v160, v208, v209
    v_mfma_f32_16x16x32_bf16 v[136:139], a[68:71], v[20:23], v[136:139]
    v_exp_f32 v210, v130
    v_mfma_f32_16x16x32_bf16 v[136:139], a[72:75], v[24:27], v[136:139]
    ds_read_b64_tr_b16 a[130:131], v224 offset:17408
    v_mfma_f32_16x16x32_bf16 v[136:139], a[76:79], v[28:31], v[136:139]
    v_exp_f32 v211, v131
    v_mfma_f32_16x16x32_bf16 v[140:143], a[80:83], v[16:19], v[180:183]
    ds_read_b64_tr_b16 a[132:133], v225 offset:16384
    v_cvt_pk_bf16_f32 v161, v210, v211
    v_mfma_f32_16x16x32_bf16 v[140:143], a[84:87], v[20:23], v[140:143]
    v_exp_f32 v212, v132
    v_mfma_f32_16x16x32_bf16 v[140:143], a[88:91], v[24:27], v[140:143]
    ds_read_b64_tr_b16 a[134:135], v225 offset:17408
    v_mfma_f32_16x16x32_bf16 v[140:143], a[92:95], v[28:31], v[140:143]
    v_exp_f32 v213, v133
    v_mfma_f32_16x16x32_bf16 a[32:35], a[160:163], v[164:167], a[32:35]
    buffer_load_dwordx4 v232, s[16:19], s45 offen offset:1024 nt lds
    v_cvt_pk_bf16_f32 v162, v212, v213
    v_mfma_f32_16x16x32_bf16 a[36:39], a[164:167], v[164:167], a[36:39]
    v_exp_f32 v214, v134
    v_mfma_f32_16x16x32_bf16 a[40:43], a[168:171], v[164:167], a[40:43]
    ds_read_b64_tr_b16 a[136:137], v226 offset:16384
    v_mfma_f32_16x16x32_bf16 a[44:47], a[172:175], v[164:167], a[44:47]
    v_exp_f32 v215, v135
    v_mfma_f32_16x16x32_bf16 a[48:51], a[176:179], v[164:167], a[48:51]
    ds_read_b64_tr_b16 a[138:139], v226 offset:17408
    v_cvt_pk_bf16_f32 v163, v214, v215
    v_mfma_f32_16x16x32_bf16 a[52:55], a[180:183], v[164:167], a[52:55]
    ds_read_b64_tr_b16 a[140:141], v227 offset:16384
    v_mfma_f32_16x16x32_bf16 a[56:59], a[184:187], v[164:167], a[56:59]
    v_exp_f32 v208, v136
    v_mfma_f32_16x16x32_bf16 a[60:63], a[188:191], v[164:167], a[60:63]
    ds_read_b64_tr_b16 a[142:143], v227 offset:17408
    v_mfma_f32_16x16x32_bf16 v[196:199], v[216:219], v[164:167], v[196:199]
    v_exp_f32 v209, v137
    v_mfma_f32_16x16x32_bf16 v[144:147], a[64:67], v[32:35], v[184:187]
    ds_read_b64_tr_b16 a[144:145], v228 offset:16384
    v_cvt_pk_bf16_f32 v164, v208, v209
    v_mfma_f32_16x16x32_bf16 v[144:147], a[68:71], v[36:39], v[144:147]
    v_exp_f32 v210, v138
    v_mfma_f32_16x16x32_bf16 v[144:147], a[72:75], v[40:43], v[144:147]
    ds_read_b64_tr_b16 a[146:147], v228 offset:17408
    v_mfma_f32_16x16x32_bf16 v[144:147], a[76:79], v[44:47], v[144:147]
    v_exp_f32 v211, v139
    v_mfma_f32_16x16x32_bf16 v[148:151], a[80:83], v[32:35], v[184:187]
    buffer_load_dwordx4 v233, s[16:19], s45 offen offset:2048 nt lds
    v_cvt_pk_bf16_f32 v165, v210, v211
    v_mfma_f32_16x16x32_bf16 v[148:151], a[84:87], v[36:39], v[148:151]
    v_exp_f32 v212, v140
    v_mfma_f32_16x16x32_bf16 v[148:151], a[88:91], v[40:43], v[148:151]
    ds_read_b64_tr_b16 a[148:149], v229 offset:16384
    v_mfma_f32_16x16x32_bf16 v[148:151], a[92:95], v[44:47], v[148:151]
    v_exp_f32 v213, v141
    v_mfma_f32_16x16x32_bf16 v[64:67], a[160:163], v[168:171], v[64:67]
    ds_read_b64_tr_b16 a[150:151], v229 offset:17408
    v_cvt_pk_bf16_f32 v166, v212, v213
    v_mfma_f32_16x16x32_bf16 v[68:71], a[164:167], v[168:171], v[68:71]
    v_exp_f32 v214, v142
    v_mfma_f32_16x16x32_bf16 v[72:75], a[168:171], v[168:171], v[72:75]
    ds_read_b64_tr_b16 a[152:153], v230 offset:16384
    v_mfma_f32_16x16x32_bf16 v[76:79], a[172:175], v[168:171], v[76:79]
    v_exp_f32 v215, v143
    v_mfma_f32_16x16x32_bf16 v[80:83], a[176:179], v[168:171], v[80:83]
    ds_read_b64_tr_b16 a[154:155], v230 offset:17408
    v_cvt_pk_bf16_f32 v167, v214, v215
    v_mfma_f32_16x16x32_bf16 v[84:87], a[180:183], v[168:171], v[84:87]
    ds_read_b64_tr_b16 a[156:157], v231 offset:16384
    v_mfma_f32_16x16x32_bf16 v[88:91], a[184:187], v[168:171], v[88:91]
    v_exp_f32 v208, v144
    v_mfma_f32_16x16x32_bf16 v[92:95], a[188:191], v[168:171], v[92:95]
    ds_read_b64_tr_b16 a[158:159], v231 offset:17408
    v_mfma_f32_16x16x32_bf16 v[200:203], v[216:219], v[168:171], v[200:203]
    v_exp_f32 v209, v145
    buffer_load_dwordx4 v233, s[16:19], s45 offen offset:3072 nt lds
    v_cvt_pk_bf16_f32 v168, v208, v209
    v_exp_f32 v210, v146
    v_exp_f32 v211, v147
    s_nop 0
    v_cvt_pk_bf16_f32 v169, v210, v211
    v_exp_f32 v212, v148
    v_exp_f32 v213, v149
    s_nop 0
    v_cvt_pk_bf16_f32 v170, v212, v213
    v_exp_f32 v214, v150
    v_exp_f32 v215, v151
    s_nop 0
    v_cvt_pk_bf16_f32 v171, v214, v215
    s_waitcnt vmcnt(12) lgkmcnt(15)
    s_barrier
    v_mfma_f32_16x16x32_bf16 v[128:131], a[96:99], v[0:3], v[176:179]
    ds_read_b128 a[64:67], v220 offset:32768
    v_mfma_f32_16x16x32_bf16 v[128:131], a[100:103], v[4:7], v[128:131]
    v_mfma_f32_16x16x32_bf16 v[128:131], a[104:107], v[8:11], v[128:131]
    ds_read_b128 a[68:71], v221 offset:32768
    v_mfma_f32_16x16x32_bf16 v[128:131], a[108:111], v[12:15], v[128:131]
    v_mfma_f32_16x16x32_bf16 v[132:135], a[112:115], v[0:3], v[176:179]
    ds_read_b128 a[72:75], v222 offset:32768
    v_mfma_f32_16x16x32_bf16 v[132:135], a[116:119], v[4:7], v[132:135]
    v_mfma_f32_16x16x32_bf16 v[132:135], a[120:123], v[8:11], v[132:135]
    ds_read_b128 a[76:79], v223 offset:32768
    v_mfma_f32_16x16x32_bf16 v[132:135], a[124:127], v[12:15], v[132:135]
    s_waitcnt lgkmcnt(4)
    v_mfma_f32_16x16x32_bf16 a[0:3], a[128:131], v[160:163], a[0:3]
    ds_read_b128 a[80:83], v220 offset:33792
    v_mfma_f32_16x16x32_bf16 a[4:7], a[132:135], v[160:163], a[4:7]
    s_add_u32 s46, s46, 16384
    v_mfma_f32_16x16x32_bf16 a[8:11], a[136:139], v[160:163], a[8:11]
    ds_read_b128 a[84:87], v221 offset:33792
    v_mfma_f32_16x16x32_bf16 a[12:15], a[140:143], v[160:163], a[12:15]
    s_add_u32 m0, s41, 65536
    v_mfma_f32_16x16x32_bf16 a[16:19], a[144:147], v[160:163], a[16:19]
    ds_read_b128 a[88:91], v222 offset:33792
    v_mfma_f32_16x16x32_bf16 a[20:23], a[148:151], v[160:163], a[20:23]
    buffer_load_dwordx4 v234, s[20:23], s46 offen offset:0 nt lds
    v_mfma_f32_16x16x32_bf16 a[24:27], a[152:155], v[160:163], a[24:27]
    v_exp_f32 v208, v128
    v_mfma_f32_16x16x32_bf16 a[28:31], a[156:159], v[160:163], a[28:31]
    ds_read_b128 a[92:95], v223 offset:33792
    v_mfma_f32_16x16x32_bf16 v[192:195], v[216:219], v[160:163], v[192:195]
    v_exp_f32 v209, v129
    v_mfma_f32_16x16x32_bf16 v[136:139], a[96:99], v[16:19], v[180:183]
    ds_read_b64_tr_b16 a[160:161], v224 offset:24576
    v_cvt_pk_bf16_f32 v160, v208, v209
    v_mfma_f32_16x16x32_bf16 v[136:139], a[100:103], v[20:23], v[136:139]
    v_exp_f32 v210, v130
    v_mfma_f32_16x16x32_bf16 v[136:139], a[104:107], v[24:27], v[136:139]
    ds_read_b64_tr_b16 a[162:163], v224 offset:25600
    v_mfma_f32_16x16x32_bf16 v[136:139], a[108:111], v[28:31], v[136:139]
    v_exp_f32 v211, v131
    v_mfma_f32_16x16x32_bf16 v[140:143], a[112:115], v[16:19], v[180:183]
    ds_read_b64_tr_b16 a[164:165], v225 offset:24576
    v_cvt_pk_bf16_f32 v161, v210, v211
    v_mfma_f32_16x16x32_bf16 v[140:143], a[116:119], v[20:23], v[140:143]
    v_exp_f32 v212, v132
    v_mfma_f32_16x16x32_bf16 v[140:143], a[120:123], v[24:27], v[140:143]
    ds_read_b64_tr_b16 a[166:167], v225 offset:25600
    v_mfma_f32_16x16x32_bf16 v[140:143], a[124:127], v[28:31], v[140:143]
    v_exp_f32 v213, v133
    v_mfma_f32_16x16x32_bf16 a[32:35], a[128:131], v[164:167], a[32:35]
    buffer_load_dwordx4 v234, s[20:23], s46 offen offset:1024 nt lds
    v_cvt_pk_bf16_f32 v162, v212, v213
    v_mfma_f32_16x16x32_bf16 a[36:39], a[132:135], v[164:167], a[36:39]
    v_exp_f32 v214, v134
    v_mfma_f32_16x16x32_bf16 a[40:43], a[136:139], v[164:167], a[40:43]
    ds_read_b64_tr_b16 a[168:169], v226 offset:24576
    v_mfma_f32_16x16x32_bf16 a[44:47], a[140:143], v[164:167], a[44:47]
    v_exp_f32 v215, v135
    v_mfma_f32_16x16x32_bf16 a[48:51], a[144:147], v[164:167], a[48:51]
    ds_read_b64_tr_b16 a[170:171], v226 offset:25600
    v_cvt_pk_bf16_f32 v163, v214, v215
    v_mfma_f32_16x16x32_bf16 a[52:55], a[148:151], v[164:167], a[52:55]
    ds_read_b64_tr_b16 a[172:173], v227 offset:24576
    v_mfma_f32_16x16x32_bf16 a[56:59], a[152:155], v[164:167], a[56:59]
    v_exp_f32 v208, v136
    v_mfma_f32_16x16x32_bf16 a[60:63], a[156:159], v[164:167], a[60:63]
    ds_read_b64_tr_b16 a[174:175], v227 offset:25600
    v_mfma_f32_16x16x32_bf16 v[196:199], v[216:219], v[164:167], v[196:199]
    v_exp_f32 v209, v137
    v_mfma_f32_16x16x32_bf16 v[144:147], a[96:99], v[32:35], v[184:187]
    ds_read_b64_tr_b16 a[176:177], v228 offset:24576
    v_cvt_pk_bf16_f32 v164, v208, v209
    v_mfma_f32_16x16x32_bf16 v[144:147], a[100:103], v[36:39], v[144:147]
    v_exp_f32 v210, v138
    v_mfma_f32_16x16x32_bf16 v[144:147], a[104:107], v[40:43], v[144:147]
    ds_read_b64_tr_b16 a[178:179], v228 offset:25600
    v_mfma_f32_16x16x32_bf16 v[144:147], a[108:111], v[44:47], v[144:147]
    v_exp_f32 v211, v139
    v_mfma_f32_16x16x32_bf16 v[148:151], a[112:115], v[32:35], v[184:187]
    buffer_load_dwordx4 v235, s[20:23], s46 offen offset:2048 nt lds
    v_cvt_pk_bf16_f32 v165, v210, v211
    v_mfma_f32_16x16x32_bf16 v[148:151], a[116:119], v[36:39], v[148:151]
    v_exp_f32 v212, v140
    v_mfma_f32_16x16x32_bf16 v[148:151], a[120:123], v[40:43], v[148:151]
    ds_read_b64_tr_b16 a[180:181], v229 offset:24576
    v_mfma_f32_16x16x32_bf16 v[148:151], a[124:127], v[44:47], v[148:151]
    v_exp_f32 v213, v141
    v_mfma_f32_16x16x32_bf16 v[64:67], a[128:131], v[168:171], v[64:67]
    ds_read_b64_tr_b16 a[182:183], v229 offset:25600
    v_cvt_pk_bf16_f32 v166, v212, v213
    v_mfma_f32_16x16x32_bf16 v[68:71], a[132:135], v[168:171], v[68:71]
    v_exp_f32 v214, v142
    v_mfma_f32_16x16x32_bf16 v[72:75], a[136:139], v[168:171], v[72:75]
    ds_read_b64_tr_b16 a[184:185], v230 offset:24576
    v_mfma_f32_16x16x32_bf16 v[76:79], a[140:143], v[168:171], v[76:79]
    v_exp_f32 v215, v143
    v_mfma_f32_16x16x32_bf16 v[80:83], a[144:147], v[168:171], v[80:83]
    ds_read_b64_tr_b16 a[186:187], v230 offset:25600
    v_cvt_pk_bf16_f32 v167, v214, v215
    v_mfma_f32_16x16x32_bf16 v[84:87], a[148:151], v[168:171], v[84:87]
    ds_read_b64_tr_b16 a[188:189], v231 offset:24576
    v_mfma_f32_16x16x32_bf16 v[88:91], a[152:155], v[168:171], v[88:91]
    v_exp_f32 v208, v144
    v_mfma_f32_16x16x32_bf16 v[92:95], a[156:159], v[168:171], v[92:95]
    ds_read_b64_tr_b16 a[190:191], v231 offset:25600
    v_mfma_f32_16x16x32_bf16 v[200:203], v[216:219], v[168:171], v[200:203]
    v_exp_f32 v209, v145
    buffer_load_dwordx4 v235, s[20:23], s46 offen offset:3072 nt lds
    v_cvt_pk_bf16_f32 v168, v208, v209
    v_exp_f32 v210, v146
    v_exp_f32 v211, v147
    s_nop 0
    v_cvt_pk_bf16_f32 v169, v210, v211
    v_exp_f32 v212, v148
    v_exp_f32 v213, v149
    s_nop 0
    v_cvt_pk_bf16_f32 v170, v212, v213
    v_exp_f32 v214, v150
    v_exp_f32 v215, v151
    s_nop 0
    v_cvt_pk_bf16_f32 v171, v214, v215
    s_waitcnt lgkmcnt(15)
    v_mfma_f32_16x16x32_bf16 v[128:131], a[64:67], v[0:3], v[176:179]
    ds_read_b128 a[96:99], v220 offset:40960
    v_mfma_f32_16x16x32_bf16 v[128:131], a[68:71], v[4:7], v[128:131]
    v_mfma_f32_16x16x32_bf16 v[128:131], a[72:75], v[8:11], v[128:131]
    ds_read_b128 a[100:103], v221 offset:40960
    v_mfma_f32_16x16x32_bf16 v[128:131], a[76:79], v[12:15], v[128:131]
    v_mfma_f32_16x16x32_bf16 v[132:135], a[80:83], v[0:3], v[176:179]
    ds_read_b128 a[104:107], v222 offset:40960
    v_mfma_f32_16x16x32_bf16 v[132:135], a[84:87], v[4:7], v[132:135]
    v_mfma_f32_16x16x32_bf16 v[132:135], a[88:91], v[8:11], v[132:135]
    ds_read_b128 a[108:111], v223 offset:40960
    v_mfma_f32_16x16x32_bf16 v[132:135], a[92:95], v[12:15], v[132:135]
    s_waitcnt lgkmcnt(4)
    v_mfma_f32_16x16x32_bf16 a[0:3], a[160:163], v[160:163], a[0:3]
    ds_read_b128 a[112:115], v220 offset:41984
    v_mfma_f32_16x16x32_bf16 a[4:7], a[164:167], v[160:163], a[4:7]
    s_add_u32 s45, s45, 16384
    v_mfma_f32_16x16x32_bf16 a[8:11], a[168:171], v[160:163], a[8:11]
    ds_read_b128 a[116:119], v221 offset:41984
    v_mfma_f32_16x16x32_bf16 a[12:15], a[172:175], v[160:163], a[12:15]
    s_add_u32 m0, s41, 16384
    v_mfma_f32_16x16x32_bf16 a[16:19], a[176:179], v[160:163], a[16:19]
    ds_read_b128 a[120:123], v222 offset:41984
    v_mfma_f32_16x16x32_bf16 a[20:23], a[180:183], v[160:163], a[20:23]
    buffer_load_dwordx4 v232, s[16:19], s45 offen offset:0 nt lds
    v_mfma_f32_16x16x32_bf16 a[24:27], a[184:187], v[160:163], a[24:27]
    v_exp_f32 v208, v128
    v_mfma_f32_16x16x32_bf16 a[28:31], a[188:191], v[160:163], a[28:31]
    ds_read_b128 a[124:127], v223 offset:41984
    v_mfma_f32_16x16x32_bf16 v[192:195], v[216:219], v[160:163], v[192:195]
    v_exp_f32 v209, v129
    v_mfma_f32_16x16x32_bf16 v[136:139], a[64:67], v[16:19], v[180:183]
    ds_read_b64_tr_b16 a[128:129], v224 offset:32768
    v_cvt_pk_bf16_f32 v160, v208, v209
    v_mfma_f32_16x16x32_bf16 v[136:139], a[68:71], v[20:23], v[136:139]
    v_exp_f32 v210, v130
    v_mfma_f32_16x16x32_bf16 v[136:139], a[72:75], v[24:27], v[136:139]
    ds_read_b64_tr_b16 a[130:131], v224 offset:33792
    v_mfma_f32_16x16x32_bf16 v[136:139], a[76:79], v[28:31], v[136:139]
    v_exp_f32 v211, v131
    v_mfma_f32_16x16x32_bf16 v[140:143], a[80:83], v[16:19], v[180:183]
    ds_read_b64_tr_b16 a[132:133], v225 offset:32768
    v_cvt_pk_bf16_f32 v161, v210, v211
    v_mfma_f32_16x16x32_bf16 v[140:143], a[84:87], v[20:23], v[140:143]
    v_exp_f32 v212, v132
    v_mfma_f32_16x16x32_bf16 v[140:143], a[88:91], v[24:27], v[140:143]
    ds_read_b64_tr_b16 a[134:135], v225 offset:33792
    v_mfma_f32_16x16x32_bf16 v[140:143], a[92:95], v[28:31], v[140:143]
    v_exp_f32 v213, v133
    v_mfma_f32_16x16x32_bf16 a[32:35], a[160:163], v[164:167], a[32:35]
    buffer_load_dwordx4 v232, s[16:19], s45 offen offset:1024 nt lds
    v_cvt_pk_bf16_f32 v162, v212, v213
    v_mfma_f32_16x16x32_bf16 a[36:39], a[164:167], v[164:167], a[36:39]
    v_exp_f32 v214, v134
    v_mfma_f32_16x16x32_bf16 a[40:43], a[168:171], v[164:167], a[40:43]
    ds_read_b64_tr_b16 a[136:137], v226 offset:32768
    v_mfma_f32_16x16x32_bf16 a[44:47], a[172:175], v[164:167], a[44:47]
    v_exp_f32 v215, v135
    v_mfma_f32_16x16x32_bf16 a[48:51], a[176:179], v[164:167], a[48:51]
    ds_read_b64_tr_b16 a[138:139], v226 offset:33792
    v_cvt_pk_bf16_f32 v163, v214, v215
    v_mfma_f32_16x16x32_bf16 a[52:55], a[180:183], v[164:167], a[52:55]
    ds_read_b64_tr_b16 a[140:141], v227 offset:32768
    v_mfma_f32_16x16x32_bf16 a[56:59], a[184:187], v[164:167], a[56:59]
    v_exp_f32 v208, v136
    v_mfma_f32_16x16x32_bf16 a[60:63], a[188:191], v[164:167], a[60:63]
    ds_read_b64_tr_b16 a[142:143], v227 offset:33792
    v_mfma_f32_16x16x32_bf16 v[196:199], v[216:219], v[164:167], v[196:199]
    v_exp_f32 v209, v137
    v_mfma_f32_16x16x32_bf16 v[144:147], a[64:67], v[32:35], v[184:187]
    ds_read_b64_tr_b16 a[144:145], v228 offset:32768
    v_cvt_pk_bf16_f32 v164, v208, v209
    v_mfma_f32_16x16x32_bf16 v[144:147], a[68:71], v[36:39], v[144:147]
    v_exp_f32 v210, v138
    v_mfma_f32_16x16x32_bf16 v[144:147], a[72:75], v[40:43], v[144:147]
    ds_read_b64_tr_b16 a[146:147], v228 offset:33792
    v_mfma_f32_16x16x32_bf16 v[144:147], a[76:79], v[44:47], v[144:147]
    v_exp_f32 v211, v139
    v_mfma_f32_16x16x32_bf16 v[148:151], a[80:83], v[32:35], v[184:187]
    buffer_load_dwordx4 v233, s[16:19], s45 offen offset:2048 nt lds
    v_cvt_pk_bf16_f32 v165, v210, v211
    v_mfma_f32_16x16x32_bf16 v[148:151], a[84:87], v[36:39], v[148:151]
    v_exp_f32 v212, v140
    v_mfma_f32_16x16x32_bf16 v[148:151], a[88:91], v[40:43], v[148:151]
    ds_read_b64_tr_b16 a[148:149], v229 offset:32768
    v_mfma_f32_16x16x32_bf16 v[148:151], a[92:95], v[44:47], v[148:151]
    v_exp_f32 v213, v141
    v_mfma_f32_16x16x32_bf16 v[64:67], a[160:163], v[168:171], v[64:67]
    ds_read_b64_tr_b16 a[150:151], v229 offset:33792
    v_cvt_pk_bf16_f32 v166, v212, v213
    v_mfma_f32_16x16x32_bf16 v[68:71], a[164:167], v[168:171], v[68:71]
    v_exp_f32 v214, v142
    v_mfma_f32_16x16x32_bf16 v[72:75], a[168:171], v[168:171], v[72:75]
    ds_read_b64_tr_b16 a[152:153], v230 offset:32768
    v_mfma_f32_16x16x32_bf16 v[76:79], a[172:175], v[168:171], v[76:79]
    v_exp_f32 v215, v143
    v_mfma_f32_16x16x32_bf16 v[80:83], a[176:179], v[168:171], v[80:83]
    ds_read_b64_tr_b16 a[154:155], v230 offset:33792
    v_cvt_pk_bf16_f32 v167, v214, v215
    v_mfma_f32_16x16x32_bf16 v[84:87], a[180:183], v[168:171], v[84:87]
    ds_read_b64_tr_b16 a[156:157], v231 offset:32768
    v_mfma_f32_16x16x32_bf16 v[88:91], a[184:187], v[168:171], v[88:91]
    v_exp_f32 v208, v144
    v_mfma_f32_16x16x32_bf16 v[92:95], a[188:191], v[168:171], v[92:95]
    ds_read_b64_tr_b16 a[158:159], v231 offset:33792
    v_mfma_f32_16x16x32_bf16 v[200:203], v[216:219], v[168:171], v[200:203]
    v_exp_f32 v209, v145
    buffer_load_dwordx4 v233, s[16:19], s45 offen offset:3072 nt lds
    v_cvt_pk_bf16_f32 v168, v208, v209
    v_exp_f32 v210, v146
    v_exp_f32 v211, v147
    s_nop 0
    v_cvt_pk_bf16_f32 v169, v210, v211
    v_exp_f32 v212, v148
    v_exp_f32 v213, v149
    s_nop 0
    v_cvt_pk_bf16_f32 v170, v212, v213
    v_exp_f32 v214, v150
    v_exp_f32 v215, v151
    s_nop 0
    v_cvt_pk_bf16_f32 v171, v214, v215
    s_waitcnt vmcnt(12) lgkmcnt(15)
    s_barrier
    v_mfma_f32_16x16x32_bf16 v[128:131], a[96:99], v[0:3], v[176:179]
    ds_read_b128 a[64:67], v220 offset:49152
    v_mfma_f32_16x16x32_bf16 v[128:131], a[100:103], v[4:7], v[128:131]
    v_mfma_f32_16x16x32_bf16 v[128:131], a[104:107], v[8:11], v[128:131]
    ds_read_b128 a[68:71], v221 offset:49152
    v_mfma_f32_16x16x32_bf16 v[128:131], a[108:111], v[12:15], v[128:131]
    v_mfma_f32_16x16x32_bf16 v[132:135], a[112:115], v[0:3], v[176:179]
    ds_read_b128 a[72:75], v222 offset:49152
    v_mfma_f32_16x16x32_bf16 v[132:135], a[116:119], v[4:7], v[132:135]
    v_mfma_f32_16x16x32_bf16 v[132:135], a[120:123], v[8:11], v[132:135]
    ds_read_b128 a[76:79], v223 offset:49152
    v_mfma_f32_16x16x32_bf16 v[132:135], a[124:127], v[12:15], v[132:135]
    s_waitcnt lgkmcnt(4)
    v_mfma_f32_16x16x32_bf16 a[0:3], a[128:131], v[160:163], a[0:3]
    ds_read_b128 a[80:83], v220 offset:50176
    v_mfma_f32_16x16x32_bf16 a[4:7], a[132:135], v[160:163], a[4:7]
    s_add_u32 s46, s46, 16384
    v_mfma_f32_16x16x32_bf16 a[8:11], a[136:139], v[160:163], a[8:11]
    ds_read_b128 a[84:87], v221 offset:50176
    v_mfma_f32_16x16x32_bf16 a[12:15], a[140:143], v[160:163], a[12:15]
    s_add_u32 m0, s41, 81920
    v_mfma_f32_16x16x32_bf16 a[16:19], a[144:147], v[160:163], a[16:19]
    ds_read_b128 a[88:91], v222 offset:50176
    v_mfma_f32_16x16x32_bf16 a[20:23], a[148:151], v[160:163], a[20:23]
    buffer_load_dwordx4 v234, s[20:23], s46 offen offset:0 nt lds
    v_mfma_f32_16x16x32_bf16 a[24:27], a[152:155], v[160:163], a[24:27]
    v_exp_f32 v208, v128
    v_mfma_f32_16x16x32_bf16 a[28:31], a[156:159], v[160:163], a[28:31]
    ds_read_b128 a[92:95], v223 offset:50176
    v_mfma_f32_16x16x32_bf16 v[192:195], v[216:219], v[160:163], v[192:195]
    v_exp_f32 v209, v129
    v_mfma_f32_16x16x32_bf16 v[136:139], a[96:99], v[16:19], v[180:183]
    ds_read_b64_tr_b16 a[160:161], v224 offset:40960
    v_cvt_pk_bf16_f32 v160, v208, v209
    v_mfma_f32_16x16x32_bf16 v[136:139], a[100:103], v[20:23], v[136:139]
    v_exp_f32 v210, v130
    v_mfma_f32_16x16x32_bf16 v[136:139], a[104:107], v[24:27], v[136:139]
    ds_read_b64_tr_b16 a[162:163], v224 offset:41984
    v_mfma_f32_16x16x32_bf16 v[136:139], a[108:111], v[28:31], v[136:139]
    v_exp_f32 v211, v131
    v_mfma_f32_16x16x32_bf16 v[140:143], a[112:115], v[16:19], v[180:183]
    ds_read_b64_tr_b16 a[164:165], v225 offset:40960
    v_cvt_pk_bf16_f32 v161, v210, v211
    v_mfma_f32_16x16x32_bf16 v[140:143], a[116:119], v[20:23], v[140:143]
    v_exp_f32 v212, v132
    v_mfma_f32_16x16x32_bf16 v[140:143], a[120:123], v[24:27], v[140:143]
    ds_read_b64_tr_b16 a[166:167], v225 offset:41984
    v_mfma_f32_16x16x32_bf16 v[140:143], a[124:127], v[28:31], v[140:143]
    v_exp_f32 v213, v133
    v_mfma_f32_16x16x32_bf16 a[32:35], a[128:131], v[164:167], a[32:35]
    buffer_load_dwordx4 v234, s[20:23], s46 offen offset:1024 nt lds
    v_cvt_pk_bf16_f32 v162, v212, v213
    v_mfma_f32_16x16x32_bf16 a[36:39], a[132:135], v[164:167], a[36:39]
    v_exp_f32 v214, v134
    v_mfma_f32_16x16x32_bf16 a[40:43], a[136:139], v[164:167], a[40:43]
    ds_read_b64_tr_b16 a[168:169], v226 offset:40960
    v_mfma_f32_16x16x32_bf16 a[44:47], a[140:143], v[164:167], a[44:47]
    v_exp_f32 v215, v135
    v_mfma_f32_16x16x32_bf16 a[48:51], a[144:147], v[164:167], a[48:51]
    ds_read_b64_tr_b16 a[170:171], v226 offset:41984
    v_cvt_pk_bf16_f32 v163, v214, v215
    v_mfma_f32_16x16x32_bf16 a[52:55], a[148:151], v[164:167], a[52:55]
    ds_read_b64_tr_b16 a[172:173], v227 offset:40960
    v_mfma_f32_16x16x32_bf16 a[56:59], a[152:155], v[164:167], a[56:59]
    v_exp_f32 v208, v136
    v_mfma_f32_16x16x32_bf16 a[60:63], a[156:159], v[164:167], a[60:63]
    ds_read_b64_tr_b16 a[174:175], v227 offset:41984
    v_mfma_f32_16x16x32_bf16 v[196:199], v[216:219], v[164:167], v[196:199]
    v_exp_f32 v209, v137
    v_mfma_f32_16x16x32_bf16 v[144:147], a[96:99], v[32:35], v[184:187]
    ds_read_b64_tr_b16 a[176:177], v228 offset:40960
    v_cvt_pk_bf16_f32 v164, v208, v209
    v_mfma_f32_16x16x32_bf16 v[144:147], a[100:103], v[36:39], v[144:147]
    v_exp_f32 v210, v138
    v_mfma_f32_16x16x32_bf16 v[144:147], a[104:107], v[40:43], v[144:147]
    ds_read_b64_tr_b16 a[178:179], v228 offset:41984
    v_mfma_f32_16x16x32_bf16 v[144:147], a[108:111], v[44:47], v[144:147]
    v_exp_f32 v211, v139
    v_mfma_f32_16x16x32_bf16 v[148:151], a[112:115], v[32:35], v[184:187]
    buffer_load_dwordx4 v235, s[20:23], s46 offen offset:2048 nt lds
    v_cvt_pk_bf16_f32 v165, v210, v211
    v_mfma_f32_16x16x32_bf16 v[148:151], a[116:119], v[36:39], v[148:151]
    v_exp_f32 v212, v140
    v_mfma_f32_16x16x32_bf16 v[148:151], a[120:123], v[40:43], v[148:151]
    ds_read_b64_tr_b16 a[180:181], v229 offset:40960
    v_mfma_f32_16x16x32_bf16 v[148:151], a[124:127], v[44:47], v[148:151]
    v_exp_f32 v213, v141
    v_mfma_f32_16x16x32_bf16 v[64:67], a[128:131], v[168:171], v[64:67]
    ds_read_b64_tr_b16 a[182:183], v229 offset:41984
    v_cvt_pk_bf16_f32 v166, v212, v213
    v_mfma_f32_16x16x32_bf16 v[68:71], a[132:135], v[168:171], v[68:71]
    v_exp_f32 v214, v142
    v_mfma_f32_16x16x32_bf16 v[72:75], a[136:139], v[168:171], v[72:75]
    ds_read_b64_tr_b16 a[184:185], v230 offset:40960
    v_mfma_f32_16x16x32_bf16 v[76:79], a[140:143], v[168:171], v[76:79]
    v_exp_f32 v215, v143
    v_mfma_f32_16x16x32_bf16 v[80:83], a[144:147], v[168:171], v[80:83]
    ds_read_b64_tr_b16 a[186:187], v230 offset:41984
    v_cvt_pk_bf16_f32 v167, v214, v215
    v_mfma_f32_16x16x32_bf16 v[84:87], a[148:151], v[168:171], v[84:87]
    ds_read_b64_tr_b16 a[188:189], v231 offset:40960
    v_mfma_f32_16x16x32_bf16 v[88:91], a[152:155], v[168:171], v[88:91]
    v_exp_f32 v208, v144
    v_mfma_f32_16x16x32_bf16 v[92:95], a[156:159], v[168:171], v[92:95]
    ds_read_b64_tr_b16 a[190:191], v231 offset:41984
    v_mfma_f32_16x16x32_bf16 v[200:203], v[216:219], v[168:171], v[200:203]
    v_exp_f32 v209, v145
    buffer_load_dwordx4 v235, s[20:23], s46 offen offset:3072 nt lds
    v_cvt_pk_bf16_f32 v168, v208, v209
    v_exp_f32 v210, v146
    v_exp_f32 v211, v147
    s_nop 0
    v_cvt_pk_bf16_f32 v169, v210, v211
    v_exp_f32 v212, v148
    v_exp_f32 v213, v149
    s_nop 0
    v_cvt_pk_bf16_f32 v170, v212, v213
    v_exp_f32 v214, v150
    v_exp_f32 v215, v151
    s_nop 0
    v_cvt_pk_bf16_f32 v171, v214, v215
    s_waitcnt lgkmcnt(15)
    v_mfma_f32_16x16x32_bf16 v[128:131], a[64:67], v[0:3], v[176:179]
    ds_read_b128 a[96:99], v220 offset:57344
    v_mfma_f32_16x16x32_bf16 v[128:131], a[68:71], v[4:7], v[128:131]
    v_mfma_f32_16x16x32_bf16 v[128:131], a[72:75], v[8:11], v[128:131]
    ds_read_b128 a[100:103], v221 offset:57344
    v_mfma_f32_16x16x32_bf16 v[128:131], a[76:79], v[12:15], v[128:131]
    v_mfma_f32_16x16x32_bf16 v[132:135], a[80:83], v[0:3], v[176:179]
    ds_read_b128 a[104:107], v222 offset:57344
    v_mfma_f32_16x16x32_bf16 v[132:135], a[84:87], v[4:7], v[132:135]
    v_mfma_f32_16x16x32_bf16 v[132:135], a[88:91], v[8:11], v[132:135]
    ds_read_b128 a[108:111], v223 offset:57344
    v_mfma_f32_16x16x32_bf16 v[132:135], a[92:95], v[12:15], v[132:135]
    s_waitcnt lgkmcnt(4)
    v_mfma_f32_16x16x32_bf16 a[0:3], a[160:163], v[160:163], a[0:3]
    ds_read_b128 a[112:115], v220 offset:58368
    v_mfma_f32_16x16x32_bf16 a[4:7], a[164:167], v[160:163], a[4:7]
    s_add_u32 s45, s45, 16384
    v_mfma_f32_16x16x32_bf16 a[8:11], a[168:171], v[160:163], a[8:11]
    ds_read_b128 a[116:119], v221 offset:58368
    v_mfma_f32_16x16x32_bf16 a[12:15], a[172:175], v[160:163], a[12:15]
    s_add_u32 m0, s41, 32768
    v_mfma_f32_16x16x32_bf16 a[16:19], a[176:179], v[160:163], a[16:19]
    ds_read_b128 a[120:123], v222 offset:58368
    v_mfma_f32_16x16x32_bf16 a[20:23], a[180:183], v[160:163], a[20:23]
    buffer_load_dwordx4 v232, s[16:19], s45 offen offset:0 nt lds
    v_mfma_f32_16x16x32_bf16 a[24:27], a[184:187], v[160:163], a[24:27]
    v_exp_f32 v208, v128
    v_mfma_f32_16x16x32_bf16 a[28:31], a[188:191], v[160:163], a[28:31]
    ds_read_b128 a[124:127], v223 offset:58368
    v_mfma_f32_16x16x32_bf16 v[192:195], v[216:219], v[160:163], v[192:195]
    v_exp_f32 v209, v129
    v_mfma_f32_16x16x32_bf16 v[136:139], a[64:67], v[16:19], v[180:183]
    ds_read_b64_tr_b16 a[128:129], v224 offset:49152
    v_cvt_pk_bf16_f32 v160, v208, v209
    v_mfma_f32_16x16x32_bf16 v[136:139], a[68:71], v[20:23], v[136:139]
    v_exp_f32 v210, v130
    v_mfma_f32_16x16x32_bf16 v[136:139], a[72:75], v[24:27], v[136:139]
    ds_read_b64_tr_b16 a[130:131], v224 offset:50176
    v_mfma_f32_16x16x32_bf16 v[136:139], a[76:79], v[28:31], v[136:139]
    v_exp_f32 v211, v131
    v_mfma_f32_16x16x32_bf16 v[140:143], a[80:83], v[16:19], v[180:183]
    ds_read_b64_tr_b16 a[132:133], v225 offset:49152
    v_cvt_pk_bf16_f32 v161, v210, v211
    v_mfma_f32_16x16x32_bf16 v[140:143], a[84:87], v[20:23], v[140:143]
    v_exp_f32 v212, v132
    v_mfma_f32_16x16x32_bf16 v[140:143], a[88:91], v[24:27], v[140:143]
    ds_read_b64_tr_b16 a[134:135], v225 offset:50176
    v_mfma_f32_16x16x32_bf16 v[140:143], a[92:95], v[28:31], v[140:143]
    v_exp_f32 v213, v133
    v_mfma_f32_16x16x32_bf16 a[32:35], a[160:163], v[164:167], a[32:35]
    buffer_load_dwordx4 v232, s[16:19], s45 offen offset:1024 nt lds
    v_cvt_pk_bf16_f32 v162, v212, v213
    v_mfma_f32_16x16x32_bf16 a[36:39], a[164:167], v[164:167], a[36:39]
    v_exp_f32 v214, v134
    v_mfma_f32_16x16x32_bf16 a[40:43], a[168:171], v[164:167], a[40:43]
    ds_read_b64_tr_b16 a[136:137], v226 offset:49152
    v_mfma_f32_16x16x32_bf16 a[44:47], a[172:175], v[164:167], a[44:47]
    v_exp_f32 v215, v135
    v_mfma_f32_16x16x32_bf16 a[48:51], a[176:179], v[164:167], a[48:51]
    ds_read_b64_tr_b16 a[138:139], v226 offset:50176
    v_cvt_pk_bf16_f32 v163, v214, v215
    v_mfma_f32_16x16x32_bf16 a[52:55], a[180:183], v[164:167], a[52:55]
    ds_read_b64_tr_b16 a[140:141], v227 offset:49152
    v_mfma_f32_16x16x32_bf16 a[56:59], a[184:187], v[164:167], a[56:59]
    v_exp_f32 v208, v136
    v_mfma_f32_16x16x32_bf16 a[60:63], a[188:191], v[164:167], a[60:63]
    ds_read_b64_tr_b16 a[142:143], v227 offset:50176
    v_mfma_f32_16x16x32_bf16 v[196:199], v[216:219], v[164:167], v[196:199]
    v_exp_f32 v209, v137
    v_mfma_f32_16x16x32_bf16 v[144:147], a[64:67], v[32:35], v[184:187]
    ds_read_b64_tr_b16 a[144:145], v228 offset:49152
    v_cvt_pk_bf16_f32 v164, v208, v209
    v_mfma_f32_16x16x32_bf16 v[144:147], a[68:71], v[36:39], v[144:147]
    v_exp_f32 v210, v138
    v_mfma_f32_16x16x32_bf16 v[144:147], a[72:75], v[40:43], v[144:147]
    ds_read_b64_tr_b16 a[146:147], v228 offset:50176
    v_mfma_f32_16x16x32_bf16 v[144:147], a[76:79], v[44:47], v[144:147]
    v_exp_f32 v211, v139
    v_mfma_f32_16x16x32_bf16 v[148:151], a[80:83], v[32:35], v[184:187]
    buffer_load_dwordx4 v233, s[16:19], s45 offen offset:2048 nt lds
    v_cvt_pk_bf16_f32 v165, v210, v211
    v_mfma_f32_16x16x32_bf16 v[148:151], a[84:87], v[36:39], v[148:151]
    v_exp_f32 v212, v140
    v_mfma_f32_16x16x32_bf16 v[148:151], a[88:91], v[40:43], v[148:151]
    ds_read_b64_tr_b16 a[148:149], v229 offset:49152
    v_mfma_f32_16x16x32_bf16 v[148:151], a[92:95], v[44:47], v[148:151]
    v_exp_f32 v213, v141
    v_mfma_f32_16x16x32_bf16 v[64:67], a[160:163], v[168:171], v[64:67]
    ds_read_b64_tr_b16 a[150:151], v229 offset:50176
    v_cvt_pk_bf16_f32 v166, v212, v213
    v_mfma_f32_16x16x32_bf16 v[68:71], a[164:167], v[168:171], v[68:71]
    v_exp_f32 v214, v142
    v_mfma_f32_16x16x32_bf16 v[72:75], a[168:171], v[168:171], v[72:75]
    ds_read_b64_tr_b16 a[152:153], v230 offset:49152
    v_mfma_f32_16x16x32_bf16 v[76:79], a[172:175], v[168:171], v[76:79]
    v_exp_f32 v215, v143
    v_mfma_f32_16x16x32_bf16 v[80:83], a[176:179], v[168:171], v[80:83]
    ds_read_b64_tr_b16 a[154:155], v230 offset:50176
    v_cvt_pk_bf16_f32 v167, v214, v215
    v_mfma_f32_16x16x32_bf16 v[84:87], a[180:183], v[168:171], v[84:87]
    ds_read_b64_tr_b16 a[156:157], v231 offset:49152
    v_mfma_f32_16x16x32_bf16 v[88:91], a[184:187], v[168:171], v[88:91]
    v_exp_f32 v208, v144
    v_mfma_f32_16x16x32_bf16 v[92:95], a[188:191], v[168:171], v[92:95]
    ds_read_b64_tr_b16 a[158:159], v231 offset:50176
    v_mfma_f32_16x16x32_bf16 v[200:203], v[216:219], v[168:171], v[200:203]
    v_exp_f32 v209, v145
    buffer_load_dwordx4 v233, s[16:19], s45 offen offset:3072 nt lds
    v_cvt_pk_bf16_f32 v168, v208, v209
    v_exp_f32 v210, v146
    v_exp_f32 v211, v147
    s_nop 0
    v_cvt_pk_bf16_f32 v169, v210, v211
    v_exp_f32 v212, v148
    v_exp_f32 v213, v149
    s_nop 0
    v_cvt_pk_bf16_f32 v170, v212, v213
    v_exp_f32 v214, v150
    v_exp_f32 v215, v151
    s_nop 0
    v_cvt_pk_bf16_f32 v171, v214, v215
    s_waitcnt vmcnt(12) lgkmcnt(15)
    s_barrier
    v_mfma_f32_16x16x32_bf16 v[128:131], a[96:99], v[0:3], v[176:179]
    ds_read_b128 a[64:67], v220 offset:0
    v_mfma_f32_16x16x32_bf16 v[128:131], a[100:103], v[4:7], v[128:131]
    v_mfma_f32_16x16x32_bf16 v[128:131], a[104:107], v[8:11], v[128:131]
    ds_read_b128 a[68:71], v221 offset:0
    v_mfma_f32_16x16x32_bf16 v[128:131], a[108:111], v[12:15], v[128:131]
    v_mfma_f32_16x16x32_bf16 v[132:135], a[112:115], v[0:3], v[176:179]
    ds_read_b128 a[72:75], v222 offset:0
    v_mfma_f32_16x16x32_bf16 v[132:135], a[116:119], v[4:7], v[132:135]
    v_mfma_f32_16x16x32_bf16 v[132:135], a[120:123], v[8:11], v[132:135]
    ds_read_b128 a[76:79], v223 offset:0
    v_mfma_f32_16x16x32_bf16 v[132:135], a[124:127], v[12:15], v[132:135]
    s_waitcnt lgkmcnt(4)
    v_mfma_f32_16x16x32_bf16 a[0:3], a[128:131], v[160:163], a[0:3]
    ds_read_b128 a[80:83], v220 offset:1024
    v_mfma_f32_16x16x32_bf16 a[4:7], a[132:135], v[160:163], a[4:7]
    s_add_u32 s46, s46, 16384
    v_mfma_f32_16x16x32_bf16 a[8:11], a[136:139], v[160:163], a[8:11]
    ds_read_b128 a[84:87], v221 offset:1024
    v_mfma_f32_16x16x32_bf16 a[12:15], a[140:143], v[160:163], a[12:15]
    s_add_u32 m0, s41, 98304
    v_mfma_f32_16x16x32_bf16 a[16:19], a[144:147], v[160:163], a[16:19]
    ds_read_b128 a[88:91], v222 offset:1024
    v_mfma_f32_16x16x32_bf16 a[20:23], a[148:151], v[160:163], a[20:23]
    buffer_load_dwordx4 v234, s[20:23], s46 offen offset:0 nt lds
    v_mfma_f32_16x16x32_bf16 a[24:27], a[152:155], v[160:163], a[24:27]
    v_exp_f32 v208, v128
    v_mfma_f32_16x16x32_bf16 a[28:31], a[156:159], v[160:163], a[28:31]
    ds_read_b128 a[92:95], v223 offset:1024
    v_mfma_f32_16x16x32_bf16 v[192:195], v[216:219], v[160:163], v[192:195]
    v_exp_f32 v209, v129
    v_mfma_f32_16x16x32_bf16 v[136:139], a[96:99], v[16:19], v[180:183]
    ds_read_b64_tr_b16 a[160:161], v224 offset:57344
    v_cvt_pk_bf16_f32 v160, v208, v209
    v_mfma_f32_16x16x32_bf16 v[136:139], a[100:103], v[20:23], v[136:139]
    v_exp_f32 v210, v130
    v_mfma_f32_16x16x32_bf16 v[136:139], a[104:107], v[24:27], v[136:139]
    ds_read_b64_tr_b16 a[162:163], v224 offset:58368
    v_mfma_f32_16x16x32_bf16 v[136:139], a[108:111], v[28:31], v[136:139]
    v_exp_f32 v211, v131
    v_mfma_f32_16x16x32_bf16 v[140:143], a[112:115], v[16:19], v[180:183]
    ds_read_b64_tr_b16 a[164:165], v225 offset:57344
    v_cvt_pk_bf16_f32 v161, v210, v211
    v_mfma_f32_16x16x32_bf16 v[140:143], a[116:119], v[20:23], v[140:143]
    v_exp_f32 v212, v132
    v_mfma_f32_16x16x32_bf16 v[140:143], a[120:123], v[24:27], v[140:143]
    ds_read_b64_tr_b16 a[166:167], v225 offset:58368
    v_mfma_f32_16x16x32_bf16 v[140:143], a[124:127], v[28:31], v[140:143]
    v_exp_f32 v213, v133
    v_mfma_f32_16x16x32_bf16 a[32:35], a[128:131], v[164:167], a[32:35]
    buffer_load_dwordx4 v234, s[20:23], s46 offen offset:1024 nt lds
    v_cvt_pk_bf16_f32 v162, v212, v213
    v_mfma_f32_16x16x32_bf16 a[36:39], a[132:135], v[164:167], a[36:39]
    v_exp_f32 v214, v134
    v_mfma_f32_16x16x32_bf16 a[40:43], a[136:139], v[164:167], a[40:43]
    ds_read_b64_tr_b16 a[168:169], v226 offset:57344
    v_mfma_f32_16x16x32_bf16 a[44:47], a[140:143], v[164:167], a[44:47]
    v_exp_f32 v215, v135
    v_mfma_f32_16x16x32_bf16 a[48:51], a[144:147], v[164:167], a[48:51]
    ds_read_b64_tr_b16 a[170:171], v226 offset:58368
    v_cvt_pk_bf16_f32 v163, v214, v215
    v_mfma_f32_16x16x32_bf16 a[52:55], a[148:151], v[164:167], a[52:55]
    ds_read_b64_tr_b16 a[172:173], v227 offset:57344
    v_mfma_f32_16x16x32_bf16 a[56:59], a[152:155], v[164:167], a[56:59]
    v_exp_f32 v208, v136
    v_mfma_f32_16x16x32_bf16 a[60:63], a[156:159], v[164:167], a[60:63]
    ds_read_b64_tr_b16 a[174:175], v227 offset:58368
    v_mfma_f32_16x16x32_bf16 v[196:199], v[216:219], v[164:167], v[196:199]
    v_exp_f32 v209, v137
    v_mfma_f32_16x16x32_bf16 v[144:147], a[96:99], v[32:35], v[184:187]
    ds_read_b64_tr_b16 a[176:177], v228 offset:57344
    v_cvt_pk_bf16_f32 v164, v208, v209
    v_mfma_f32_16x16x32_bf16 v[144:147], a[100:103], v[36:39], v[144:147]
    v_exp_f32 v210, v138
    v_mfma_f32_16x16x32_bf16 v[144:147], a[104:107], v[40:43], v[144:147]
    ds_read_b64_tr_b16 a[178:179], v228 offset:58368
    v_mfma_f32_16x16x32_bf16 v[144:147], a[108:111], v[44:47], v[144:147]
    v_exp_f32 v211, v139
    v_mfma_f32_16x16x32_bf16 v[148:151], a[112:115], v[32:35], v[184:187]
    buffer_load_dwordx4 v235, s[20:23], s46 offen offset:2048 nt lds
    v_cvt_pk_bf16_f32 v165, v210, v211
    v_mfma_f32_16x16x32_bf16 v[148:151], a[116:119], v[36:39], v[148:151]
    v_exp_f32 v212, v140
    v_mfma_f32_16x16x32_bf16 v[148:151], a[120:123], v[40:43], v[148:151]
    ds_read_b64_tr_b16 a[180:181], v229 offset:57344
    v_mfma_f32_16x16x32_bf16 v[148:151], a[124:127], v[44:47], v[148:151]
    v_exp_f32 v213, v141
    v_mfma_f32_16x16x32_bf16 v[64:67], a[128:131], v[168:171], v[64:67]
    ds_read_b64_tr_b16 a[182:183], v229 offset:58368
    v_cvt_pk_bf16_f32 v166, v212, v213
    v_mfma_f32_16x16x32_bf16 v[68:71], a[132:135], v[168:171], v[68:71]
    v_exp_f32 v214, v142
    v_mfma_f32_16x16x32_bf16 v[72:75], a[136:139], v[168:171], v[72:75]
    ds_read_b64_tr_b16 a[184:185], v230 offset:57344
    v_mfma_f32_16x16x32_bf16 v[76:79], a[140:143], v[168:171], v[76:79]
    v_exp_f32 v215, v143
    v_mfma_f32_16x16x32_bf16 v[80:83], a[144:147], v[168:171], v[80:83]
    ds_read_b64_tr_b16 a[186:187], v230 offset:58368
    v_cvt_pk_bf16_f32 v167, v214, v215
    v_mfma_f32_16x16x32_bf16 v[84:87], a[148:151], v[168:171], v[84:87]
    ds_read_b64_tr_b16 a[188:189], v231 offset:57344
    v_mfma_f32_16x16x32_bf16 v[88:91], a[152:155], v[168:171], v[88:91]
    v_exp_f32 v208, v144
    v_mfma_f32_16x16x32_bf16 v[92:95], a[156:159], v[168:171], v[92:95]
    ds_read_b64_tr_b16 a[190:191], v231 offset:58368
    v_mfma_f32_16x16x32_bf16 v[200:203], v[216:219], v[168:171], v[200:203]
    v_exp_f32 v209, v145
    buffer_load_dwordx4 v235, s[20:23], s46 offen offset:3072 nt lds
    v_cvt_pk_bf16_f32 v168, v208, v209
    v_exp_f32 v210, v146
    v_exp_f32 v211, v147
    s_nop 0
    v_cvt_pk_bf16_f32 v169, v210, v211
    v_exp_f32 v212, v148
    v_exp_f32 v213, v149
    s_nop 0
    v_cvt_pk_bf16_f32 v170, v212, v213
    v_exp_f32 v214, v150
    v_exp_f32 v215, v151
    s_nop 0
    v_cvt_pk_bf16_f32 v171, v214, v215
    s_waitcnt lgkmcnt(15)
    v_mfma_f32_16x16x32_bf16 v[128:131], a[64:67], v[0:3], v[176:179]
    ds_read_b128 a[96:99], v220 offset:8192
    v_mfma_f32_16x16x32_bf16 v[128:131], a[68:71], v[4:7], v[128:131]
    v_mfma_f32_16x16x32_bf16 v[128:131], a[72:75], v[8:11], v[128:131]
    ds_read_b128 a[100:103], v221 offset:8192
    v_mfma_f32_16x16x32_bf16 v[128:131], a[76:79], v[12:15], v[128:131]
    v_mfma_f32_16x16x32_bf16 v[132:135], a[80:83], v[0:3], v[176:179]
    ds_read_b128 a[104:107], v222 offset:8192
    v_mfma_f32_16x16x32_bf16 v[132:135], a[84:87], v[4:7], v[132:135]
    v_mfma_f32_16x16x32_bf16 v[132:135], a[88:91], v[8:11], v[132:135]
    ds_read_b128 a[108:111], v223 offset:8192
    v_mfma_f32_16x16x32_bf16 v[132:135], a[92:95], v[12:15], v[132:135]
    s_waitcnt lgkmcnt(4)
    v_mfma_f32_16x16x32_bf16 a[0:3], a[160:163], v[160:163], a[0:3]
    ds_read_b128 a[112:115], v220 offset:9216
    v_mfma_f32_16x16x32_bf16 a[4:7], a[164:167], v[160:163], a[4:7]
    s_add_u32 s45, s45, 16384
    v_mfma_f32_16x16x32_bf16 a[8:11], a[168:171], v[160:163], a[8:11]
    ds_read_b128 a[116:119], v221 offset:9216
    v_mfma_f32_16x16x32_bf16 a[12:15], a[172:175], v[160:163], a[12:15]
    s_add_u32 m0, s41, 49152
    v_mfma_f32_16x16x32_bf16 a[16:19], a[176:179], v[160:163], a[16:19]
    ds_read_b128 a[120:123], v222 offset:9216
    v_mfma_f32_16x16x32_bf16 a[20:23], a[180:183], v[160:163], a[20:23]
    buffer_load_dwordx4 v232, s[16:19], s45 offen offset:0 nt lds
    v_mfma_f32_16x16x32_bf16 a[24:27], a[184:187], v[160:163], a[24:27]
    v_exp_f32 v208, v128
    v_mfma_f32_16x16x32_bf16 a[28:31], a[188:191], v[160:163], a[28:31]
    ds_read_b128 a[124:127], v223 offset:9216
    v_mfma_f32_16x16x32_bf16 v[192:195], v[216:219], v[160:163], v[192:195]
    v_exp_f32 v209, v129
    v_mfma_f32_16x16x32_bf16 v[136:139], a[64:67], v[16:19], v[180:183]
    ds_read_b64_tr_b16 a[128:129], v224 offset:0
    v_cvt_pk_bf16_f32 v160, v208, v209
    v_mfma_f32_16x16x32_bf16 v[136:139], a[68:71], v[20:23], v[136:139]
    v_exp_f32 v210, v130
    v_mfma_f32_16x16x32_bf16 v[136:139], a[72:75], v[24:27], v[136:139]
    ds_read_b64_tr_b16 a[130:131], v224 offset:1024
    v_mfma_f32_16x16x32_bf16 v[136:139], a[76:79], v[28:31], v[136:139]
    v_exp_f32 v211, v131
    v_mfma_f32_16x16x32_bf16 v[140:143], a[80:83], v[16:19], v[180:183]
    ds_read_b64_tr_b16 a[132:133], v225 offset:0
    v_cvt_pk_bf16_f32 v161, v210, v211
    v_mfma_f32_16x16x32_bf16 v[140:143], a[84:87], v[20:23], v[140:143]
    v_exp_f32 v212, v132
    v_mfma_f32_16x16x32_bf16 v[140:143], a[88:91], v[24:27], v[140:143]
    ds_read_b64_tr_b16 a[134:135], v225 offset:1024
    v_mfma_f32_16x16x32_bf16 v[140:143], a[92:95], v[28:31], v[140:143]
    v_exp_f32 v213, v133
    v_mfma_f32_16x16x32_bf16 a[32:35], a[160:163], v[164:167], a[32:35]
    buffer_load_dwordx4 v232, s[16:19], s45 offen offset:1024 nt lds
    v_cvt_pk_bf16_f32 v162, v212, v213
    v_mfma_f32_16x16x32_bf16 a[36:39], a[164:167], v[164:167], a[36:39]
    v_exp_f32 v214, v134
    v_mfma_f32_16x16x32_bf16 a[40:43], a[168:171], v[164:167], a[40:43]
    ds_read_b64_tr_b16 a[136:137], v226 offset:0
    v_mfma_f32_16x16x32_bf16 a[44:47], a[172:175], v[164:167], a[44:47]
    v_exp_f32 v215, v135
    v_mfma_f32_16x16x32_bf16 a[48:51], a[176:179], v[164:167], a[48:51]
    ds_read_b64_tr_b16 a[138:139], v226 offset:1024
    v_cvt_pk_bf16_f32 v163, v214, v215
    v_mfma_f32_16x16x32_bf16 a[52:55], a[180:183], v[164:167], a[52:55]
    ds_read_b64_tr_b16 a[140:141], v227 offset:0
    v_mfma_f32_16x16x32_bf16 a[56:59], a[184:187], v[164:167], a[56:59]
    v_exp_f32 v208, v136
    v_mfma_f32_16x16x32_bf16 a[60:63], a[188:191], v[164:167], a[60:63]
    ds_read_b64_tr_b16 a[142:143], v227 offset:1024
    v_mfma_f32_16x16x32_bf16 v[196:199], v[216:219], v[164:167], v[196:199]
    v_exp_f32 v209, v137
    v_mfma_f32_16x16x32_bf16 v[144:147], a[64:67], v[32:35], v[184:187]
    ds_read_b64_tr_b16 a[144:145], v228 offset:0
    v_cvt_pk_bf16_f32 v164, v208, v209
    v_mfma_f32_16x16x32_bf16 v[144:147], a[68:71], v[36:39], v[144:147]
    v_exp_f32 v210, v138
    v_mfma_f32_16x16x32_bf16 v[144:147], a[72:75], v[40:43], v[144:147]
    ds_read_b64_tr_b16 a[146:147], v228 offset:1024
    v_mfma_f32_16x16x32_bf16 v[144:147], a[76:79], v[44:47], v[144:147]
    v_exp_f32 v211, v139
    v_mfma_f32_16x16x32_bf16 v[148:151], a[80:83], v[32:35], v[184:187]
    buffer_load_dwordx4 v233, s[16:19], s45 offen offset:2048 nt lds
    v_cvt_pk_bf16_f32 v165, v210, v211
    v_mfma_f32_16x16x32_bf16 v[148:151], a[84:87], v[36:39], v[148:151]
    v_exp_f32 v212, v140
    v_mfma_f32_16x16x32_bf16 v[148:151], a[88:91], v[40:43], v[148:151]
    ds_read_b64_tr_b16 a[148:149], v229 offset:0
    v_mfma_f32_16x16x32_bf16 v[148:151], a[92:95], v[44:47], v[148:151]
    v_exp_f32 v213, v141
    v_mfma_f32_16x16x32_bf16 v[64:67], a[160:163], v[168:171], v[64:67]
    ds_read_b64_tr_b16 a[150:151], v229 offset:1024
    v_cvt_pk_bf16_f32 v166, v212, v213
    v_mfma_f32_16x16x32_bf16 v[68:71], a[164:167], v[168:171], v[68:71]
    v_exp_f32 v214, v142
    v_mfma_f32_16x16x32_bf16 v[72:75], a[168:171], v[168:171], v[72:75]
    ds_read_b64_tr_b16 a[152:153], v230 offset:0
    v_mfma_f32_16x16x32_bf16 v[76:79], a[172:175], v[168:171], v[76:79]
    v_exp_f32 v215, v143
    v_mfma_f32_16x16x32_bf16 v[80:83], a[176:179], v[168:171], v[80:83]
    ds_read_b64_tr_b16 a[154:155], v230 offset:1024
    v_cvt_pk_bf16_f32 v167, v214, v215
    v_mfma_f32_16x16x32_bf16 v[84:87], a[180:183], v[168:171], v[84:87]
    ds_read_b64_tr_b16 a[156:157], v231 offset:0
    v_mfma_f32_16x16x32_bf16 v[88:91], a[184:187], v[168:171], v[88:91]
    v_exp_f32 v208, v144
    v_mfma_f32_16x16x32_bf16 v[92:95], a[188:191], v[168:171], v[92:95]
    ds_read_b64_tr_b16 a[158:159], v231 offset:1024
    v_mfma_f32_16x16x32_bf16 v[200:203], v[216:219], v[168:171], v[200:203]
    v_exp_f32 v209, v145
    buffer_load_dwordx4 v233, s[16:19], s45 offen offset:3072 nt lds
    v_cvt_pk_bf16_f32 v168, v208, v209
    v_exp_f32 v210, v146
    v_exp_f32 v211, v147
    s_nop 0
    v_cvt_pk_bf16_f32 v169, v210, v211
    v_exp_f32 v212, v148
    v_exp_f32 v213, v149
    s_nop 0
    v_cvt_pk_bf16_f32 v170, v212, v213
    v_exp_f32 v214, v150
    v_exp_f32 v215, v151
    s_nop 0
    v_cvt_pk_bf16_f32 v171, v214, v215
    s_waitcnt vmcnt(12) lgkmcnt(15)
    s_barrier
    v_mfma_f32_16x16x32_bf16 v[128:131], a[96:99], v[0:3], v[176:179]
    ds_read_b128 a[64:67], v220 offset:16384
    v_mfma_f32_16x16x32_bf16 v[128:131], a[100:103], v[4:7], v[128:131]
    v_mfma_f32_16x16x32_bf16 v[128:131], a[104:107], v[8:11], v[128:131]
    ds_read_b128 a[68:71], v221 offset:16384
    v_mfma_f32_16x16x32_bf16 v[128:131], a[108:111], v[12:15], v[128:131]
    v_mfma_f32_16x16x32_bf16 v[132:135], a[112:115], v[0:3], v[176:179]
    ds_read_b128 a[72:75], v222 offset:16384
    v_mfma_f32_16x16x32_bf16 v[132:135], a[116:119], v[4:7], v[132:135]
    v_mfma_f32_16x16x32_bf16 v[132:135], a[120:123], v[8:11], v[132:135]
    ds_read_b128 a[76:79], v223 offset:16384
    v_mfma_f32_16x16x32_bf16 v[132:135], a[124:127], v[12:15], v[132:135]
    s_waitcnt lgkmcnt(4)
    v_mfma_f32_16x16x32_bf16 a[0:3], a[128:131], v[160:163], a[0:3]
    ds_read_b128 a[80:83], v220 offset:17408
    v_mfma_f32_16x16x32_bf16 a[4:7], a[132:135], v[160:163], a[4:7]
    s_add_u32 s46, s46, 16384
    v_mfma_f32_16x16x32_bf16 a[8:11], a[136:139], v[160:163], a[8:11]
    ds_read_b128 a[84:87], v221 offset:17408
    v_mfma_f32_16x16x32_bf16 a[12:15], a[140:143], v[160:163], a[12:15]
    s_add_u32 m0, s41, 114688
    v_mfma_f32_16x16x32_bf16 a[16:19], a[144:147], v[160:163], a[16:19]
    ds_read_b128 a[88:91], v222 offset:17408
    v_mfma_f32_16x16x32_bf16 a[20:23], a[148:151], v[160:163], a[20:23]
    buffer_load_dwordx4 v234, s[20:23], s46 offen offset:0 nt lds
    v_mfma_f32_16x16x32_bf16 a[24:27], a[152:155], v[160:163], a[24:27]
    v_exp_f32 v208, v128
    v_mfma_f32_16x16x32_bf16 a[28:31], a[156:159], v[160:163], a[28:31]
    ds_read_b128 a[92:95], v223 offset:17408
    v_mfma_f32_16x16x32_bf16 v[192:195], v[216:219], v[160:163], v[192:195]
    v_exp_f32 v209, v129
    v_mfma_f32_16x16x32_bf16 v[136:139], a[96:99], v[16:19], v[180:183]
    ds_read_b64_tr_b16 a[160:161], v224 offset:8192
    v_cvt_pk_bf16_f32 v160, v208, v209
    v_mfma_f32_16x16x32_bf16 v[136:139], a[100:103], v[20:23], v[136:139]
    v_exp_f32 v210, v130
    v_mfma_f32_16x16x32_bf16 v[136:139], a[104:107], v[24:27], v[136:139]
    ds_read_b64_tr_b16 a[162:163], v224 offset:9216
    v_mfma_f32_16x16x32_bf16 v[136:139], a[108:111], v[28:31], v[136:139]
    v_exp_f32 v211, v131
    v_mfma_f32_16x16x32_bf16 v[140:143], a[112:115], v[16:19], v[180:183]
    ds_read_b64_tr_b16 a[164:165], v225 offset:8192
    v_cvt_pk_bf16_f32 v161, v210, v211
    v_mfma_f32_16x16x32_bf16 v[140:143], a[116:119], v[20:23], v[140:143]
    v_exp_f32 v212, v132
    v_mfma_f32_16x16x32_bf16 v[140:143], a[120:123], v[24:27], v[140:143]
    ds_read_b64_tr_b16 a[166:167], v225 offset:9216
    v_mfma_f32_16x16x32_bf16 v[140:143], a[124:127], v[28:31], v[140:143]
    v_exp_f32 v213, v133
    v_mfma_f32_16x16x32_bf16 a[32:35], a[128:131], v[164:167], a[32:35]
    buffer_load_dwordx4 v234, s[20:23], s46 offen offset:1024 nt lds
    v_cvt_pk_bf16_f32 v162, v212, v213
    v_mfma_f32_16x16x32_bf16 a[36:39], a[132:135], v[164:167], a[36:39]
    v_exp_f32 v214, v134
    v_mfma_f32_16x16x32_bf16 a[40:43], a[136:139], v[164:167], a[40:43]
    ds_read_b64_tr_b16 a[168:169], v226 offset:8192
    v_mfma_f32_16x16x32_bf16 a[44:47], a[140:143], v[164:167], a[44:47]
    v_exp_f32 v215, v135
    v_mfma_f32_16x16x32_bf16 a[48:51], a[144:147], v[164:167], a[48:51]
    ds_read_b64_tr_b16 a[170:171], v226 offset:9216
    v_cvt_pk_bf16_f32 v163, v214, v215
    v_mfma_f32_16x16x32_bf16 a[52:55], a[148:151], v[164:167], a[52:55]
    ds_read_b64_tr_b16 a[172:173], v227 offset:8192
    v_mfma_f32_16x16x32_bf16 a[56:59], a[152:155], v[164:167], a[56:59]
    v_exp_f32 v208, v136
    v_mfma_f32_16x16x32_bf16 a[60:63], a[156:159], v[164:167], a[60:63]
    ds_read_b64_tr_b16 a[174:175], v227 offset:9216
    v_mfma_f32_16x16x32_bf16 v[196:199], v[216:219], v[164:167], v[196:199]
    v_exp_f32 v209, v137
    v_mfma_f32_16x16x32_bf16 v[144:147], a[96:99], v[32:35], v[184:187]
    ds_read_b64_tr_b16 a[176:177], v228 offset:8192
    v_cvt_pk_bf16_f32 v164, v208, v209
    v_mfma_f32_16x16x32_bf16 v[144:147], a[100:103], v[36:39], v[144:147]
    v_exp_f32 v210, v138
    v_mfma_f32_16x16x32_bf16 v[144:147], a[104:107], v[40:43], v[144:147]
    ds_read_b64_tr_b16 a[178:179], v228 offset:9216
    v_mfma_f32_16x16x32_bf16 v[144:147], a[108:111], v[44:47], v[144:147]
    v_exp_f32 v211, v139
    v_mfma_f32_16x16x32_bf16 v[148:151], a[112:115], v[32:35], v[184:187]
    buffer_load_dwordx4 v235, s[20:23], s46 offen offset:2048 nt lds
    v_cvt_pk_bf16_f32 v165, v210, v211
    v_mfma_f32_16x16x32_bf16 v[148:151], a[116:119], v[36:39], v[148:151]
    v_exp_f32 v212, v140
    v_mfma_f32_16x16x32_bf16 v[148:151], a[120:123], v[40:43], v[148:151]
    ds_read_b64_tr_b16 a[180:181], v229 offset:8192
    v_mfma_f32_16x16x32_bf16 v[148:151], a[124:127], v[44:47], v[148:151]
    v_exp_f32 v213, v141
    v_mfma_f32_16x16x32_bf16 v[64:67], a[128:131], v[168:171], v[64:67]
    ds_read_b64_tr_b16 a[182:183], v229 offset:9216
    v_cvt_pk_bf16_f32 v166, v212, v213
    v_mfma_f32_16x16x32_bf16 v[68:71], a[132:135], v[168:171], v[68:71]
    v_exp_f32 v214, v142
    v_mfma_f32_16x16x32_bf16 v[72:75], a[136:139], v[168:171], v[72:75]
    ds_read_b64_tr_b16 a[184:185], v230 offset:8192
    v_mfma_f32_16x16x32_bf16 v[76:79], a[140:143], v[168:171], v[76:79]
    v_exp_f32 v215, v143
    v_mfma_f32_16x16x32_bf16 v[80:83], a[144:147], v[168:171], v[80:83]
    ds_read_b64_tr_b16 a[186:187], v230 offset:9216
    v_cvt_pk_bf16_f32 v167, v214, v215
    v_mfma_f32_16x16x32_bf16 v[84:87], a[148:151], v[168:171], v[84:87]
    ds_read_b64_tr_b16 a[188:189], v231 offset:8192
    v_mfma_f32_16x16x32_bf16 v[88:91], a[152:155], v[168:171], v[88:91]
    v_exp_f32 v208, v144
    v_mfma_f32_16x16x32_bf16 v[92:95], a[156:159], v[168:171], v[92:95]
    ds_read_b64_tr_b16 a[190:191], v231 offset:9216
    v_mfma_f32_16x16x32_bf16 v[200:203], v[216:219], v[168:171], v[200:203]
    v_exp_f32 v209, v145
    buffer_load_dwordx4 v235, s[20:23], s46 offen offset:3072 nt lds
    v_cvt_pk_bf16_f32 v168, v208, v209
    v_exp_f32 v210, v146
    v_exp_f32 v211, v147
    s_nop 0
    v_cvt_pk_bf16_f32 v169, v210, v211
    v_exp_f32 v212, v148
    v_exp_f32 v213, v149
    s_nop 0
    v_cvt_pk_bf16_f32 v170, v212, v213
    v_exp_f32 v214, v150
    s_waitcnt lgkmcnt(15)
    v_exp_f32 v215, v151
    s_nop 0
    v_cvt_pk_bf16_f32 v171, v214, v215
    s_add_u32 s47, s47, 1
    s_cmp_eq_u32 s47, s63
    s_cmp_lg_u32 s47, 3
    s_cbranch_scc1 L_loop3
    v_mfma_f32_16x16x32_bf16 v[128:131], a[64:67], v[0:3], v[176:179]
    ds_read_b128 a[96:99], v220 offset:24576
    v_mfma_f32_16x16x32_bf16 v[128:131], a[68:71], v[4:7], v[128:131]
    s_add_u32 s61, s39, 0
    s_add_u32 m0, s41, 131072
    v_mfma_f32_16x16x32_bf16 v[128:131], a[72:75], v[8:11], v[128:131]
    buffer_load_dwordx4 v237, s[12:15], s61 offen offset:0  lds
    ds_read_b128 a[100:103], v221 offset:24576
    v_mfma_f32_16x16x32_bf16 v[128:131], a[76:79], v[12:15], v[128:131]
    v_mfma_f32_16x16x32_bf16 v[132:135], a[80:83], v[0:3], v[176:179]
    ds_read_b128 a[104:107], v222 offset:24576
    v_mfma_f32_16x16x32_bf16 v[132:135], a[84:87], v[4:7], v[132:135]
    v_mfma_f32_16x16x32_bf16 v[132:135], a[88:91], v[8:11], v[132:135]
    buffer_load_dwordx4 v238, s[12:15], s61 offen offset:1024  lds
    ds_read_b128 a[108:111], v223 offset:24576
    v_mfma_f32_16x16x32_bf16 v[132:135], a[92:95], v[12:15], v[132:135]
    s_waitcnt lgkmcnt(4)
    v_mfma_f32_16x16x32_bf16 a[0:3], a[160:163], v[160:163], a[0:3]
    ds_read_b128 a[112:115], v220 offset:25600
    v_mfma_f32_16x16x32_bf16 a[4:7], a[164:167], v[160:163], a[4:7]
    v_mfma_f32_16x16x32_bf16 a[8:11], a[168:171], v[160:163], a[8:11]
    buffer_load_dwordx4 v239, s[12:15], s61 offen offset:2048  lds
    ds_read_b128 a[116:119], v221 offset:25600
    v_mfma_f32_16x16x32_bf16 a[12:15], a[172:175], v[160:163], a[12:15]
    v_mfma_f32_16x16x32_bf16 a[16:19], a[176:179], v[160:163], a[16:19]
    ds_read_b128 a[120:123], v222 offset:25600
    v_mfma_f32_16x16x32_bf16 a[20:23], a[180:183], v[160:163], a[20:23]
    buffer_load_dwordx4 v240, s[12:15], s61 offen offset:3072  lds
    ds_read_b128 a[124:127], v223 offset:25600
    v_mfma_f32_16x16x32_bf16 a[24:27], a[184:187], v[160:163], a[24:27]
    s_add_u32 s61, s39, 36864
    s_add_u32 m0, s41, 147456
    v_exp_f32 v208, v128
    v_mfma_f32_16x16x32_bf16 a[28:31], a[188:191], v[160:163], a[28:31]
    ds_read_b64_tr_b16 a[128:129], v224 offset:16384
    buffer_load_dwordx4 v237, s[12:15], s61 offen offset:0  lds
    v_mfma_f32_16x16x32_bf16 v[192:195], v[216:219], v[160:163], v[192:195]
    v_exp_f32 v209, v129
    v_mfma_f32_16x16x32_bf16 v[136:139], a[64:67], v[16:19], v[180:183]
    ds_read_b64_tr_b16 a[130:131], v224 offset:17408
    v_cvt_pk_bf16_f32 v160, v208, v209
    v_mfma_f32_16x16x32_bf16 v[136:139], a[68:71], v[20:23], v[136:139]
    v_exp_f32 v210, v130
    v_mfma_f32_16x16x32_bf16 v[136:139], a[72:75], v[24:27], v[136:139]
    ds_read_b64_tr_b16 a[132:133], v225 offset:16384
    buffer_load_dwordx4 v238, s[12:15], s61 offen offset:1024  lds
    v_mfma_f32_16x16x32_bf16 v[136:139], a[76:79], v[28:31], v[136:139]
    v_exp_f32 v211, v131
    v_mfma_f32_16x16x32_bf16 v[140:143], a[80:83], v[16:19], v[180:183]
    ds_read_b64_tr_b16 a[134:135], v225 offset:17408
    v_cvt_pk_bf16_f32 v161, v210, v211
    v_mfma_f32_16x16x32_bf16 v[140:143], a[84:87], v[20:23], v[140:143]
    v_exp_f32 v212, v132
    v_mfma_f32_16x16x32_bf16 v[140:143], a[88:91], v[24:27], v[140:143]
    ds_read_b64_tr_b16 a[136:137], v226 offset:16384
    buffer_load_dwordx4 v239, s[12:15], s61 offen offset:2048  lds
    v_mfma_f32_16x16x32_bf16 v[140:143], a[92:95], v[28:31], v[140:143]
    v_exp_f32 v213, v133
    v_mfma_f32_16x16x32_bf16 a[32:35], a[160:163], v[164:167], a[32:35]
    ds_read_b64_tr_b16 a[138:139], v226 offset:17408
    v_cvt_pk_bf16_f32 v162, v212, v213
    v_mfma_f32_16x16x32_bf16 a[36:39], a[164:167], v[164:167], a[36:39]
    v_exp_f32 v214, v134
    v_mfma_f32_16x16x32_bf16 a[40:43], a[168:171], v[164:167], a[40:43]
    ds_read_b64_tr_b16 a[140:141], v227 offset:16384
    buffer_load_dwordx4 v240, s[12:15], s61 offen offset:3072  lds
    v_mfma_f32_16x16x32_bf16 a[44:47], a[172:175], v[164:167], a[44:47]
    s_add_u32 s61, s39, 0
    v_exp_f32 v215, v135
    v_mfma_f32_16x16x32_bf16 a[48:51], a[176:179], v[164:167], a[48:51]
    ds_read_b64_tr_b16 a[142:143], v227 offset:17408
    v_cvt_pk_bf16_f32 v163, v214, v215
    v_mfma_f32_16x16x32_bf16 a[52:55], a[180:183], v[164:167], a[52:55]
    ds_read_b64_tr_b16 a[144:145], v228 offset:16384
    v_mfma_f32_16x16x32_bf16 a[56:59], a[184:187], v[164:167], a[56:59]
    s_add_u32 m0, s41, 0
    v_exp_f32 v208, v136
    v_mfma_f32_16x16x32_bf16 a[60:63], a[188:191], v[164:167], a[60:63]
    buffer_load_dwordx4 v237, s[52:55], s61 offen offset:0  lds
    v_mfma_f32_16x16x32_bf16 v[196:199], v[216:219], v[164:167], v[196:199]
    v_exp_f32 v209, v137
    v_mfma_f32_16x16x32_bf16 v[144:147], a[64:67], v[32:35], v[184:187]
    ds_read_b64_tr_b16 a[146:147], v228 offset:17408
    v_cvt_pk_bf16_f32 v164, v208, v209
    v_mfma_f32_16x16x32_bf16 v[144:147], a[68:71], v[36:39], v[144:147]
    v_exp_f32 v210, v138
    v_mfma_f32_16x16x32_bf16 v[144:147], a[72:75], v[40:43], v[144:147]
    ds_read_b64_tr_b16 a[148:149], v229 offset:16384
    v_mfma_f32_16x16x32_bf16 v[144:147], a[76:79], v[44:47], v[144:147]
    v_exp_f32 v211, v139
    v_mfma_f32_16x16x32_bf16 v[148:151], a[80:83], v[32:35], v[184:187]
    buffer_load_dwordx4 v238, s[52:55], s61 offen offset:1024  lds
    v_cvt_pk_bf16_f32 v165, v210, v211
    v_mfma_f32_16x16x32_bf16 v[148:151], a[84:87], v[36:39], v[148:151]
    v_exp_f32 v212, v140
    v_mfma_f32_16x16x32_bf16 v[148:151], a[88:91], v[40:43], v[148:151]
    ds_read_b64_tr_b16 a[150:151], v229 offset:17408
    v_mfma_f32_16x16x32_bf16 v[148:151], a[92:95], v[44:47], v[148:151]
    v_exp_f32 v213, v141
    v_mfma_f32_16x16x32_bf16 v[64:67], a[160:163], v[168:171], v[64:67]
    ds_read_b64_tr_b16 a[152:153], v230 offset:16384
    v_cvt_pk_bf16_f32 v166, v212, v213
    v_mfma_f32_16x16x32_bf16 v[68:71], a[164:167], v[168:171], v[68:71]
    v_exp_f32 v214, v142
    v_mfma_f32_16x16x32_bf16 v[72:75], a[168:171], v[168:171], v[72:75]
    buffer_load_dwordx4 v239, s[52:55], s61 offen offset:2048  lds
    v_mfma_f32_16x16x32_bf16 v[76:79], a[172:175], v[168:171], v[76:79]
    v_exp_f32 v215, v143
    v_mfma_f32_16x16x32_bf16 v[80:83], a[176:179], v[168:171], v[80:83]
    ds_read_b64_tr_b16 a[154:155], v230 offset:17408
    v_cvt_pk_bf16_f32 v167, v214, v215
    v_mfma_f32_16x16x32_bf16 v[84:87], a[180:183], v[168:171], v[84:87]
    ds_read_b64_tr_b16 a[156:157], v231 offset:16384
    v_mfma_f32_16x16x32_bf16 v[88:91], a[184:187], v[168:171], v[88:91]
    v_exp_f32 v208, v144
    v_mfma_f32_16x16x32_bf16 v[92:95], a[188:191], v[168:171], v[92:95]
    buffer_load_dwordx4 v240, s[52:55], s61 offen offset:3072  lds
    v_mfma_f32_16x16x32_bf16 v[200:203], v[216:219], v[168:171], v[200:203]
    v_exp_f32 v209, v145
    ds_read_b64_tr_b16 a[158:159], v231 offset:17408
    v_cvt_pk_bf16_f32 v168, v208, v209
    v_exp_f32 v210, v146
    v_exp_f32 v211, v147
    s_nop 0
    v_cvt_pk_bf16_f32 v169, v210, v211
    v_exp_f32 v212, v148
    v_exp_f32 v213, v149
    s_nop 0
    v_cvt_pk_bf16_f32 v170, v212, v213
    v_exp_f32 v214, v150
    v_exp_f32 v215, v151
    s_nop 0
    v_cvt_pk_bf16_f32 v171, v214, v215
    s_waitcnt vmcnt(20) lgkmcnt(15)
    s_barrier
    v_mfma_f32_16x16x32_bf16 v[128:131], a[96:99], v[0:3], v[176:179]
    ds_read_b128 a[64:67], v220 offset:32768
    v_mfma_f32_16x16x32_bf16 v[128:131], a[100:103], v[4:7], v[128:131]
    s_add_u32 s61, s39, 36864
    s_add_u32 m0, s41, 16384
    v_mfma_f32_16x16x32_bf16 v[128:131], a[104:107], v[8:11], v[128:131]
    ds_read_b128 a[68:71], v221 offset:32768
    buffer_load_dwordx4 v237, s[52:55], s61 offen offset:0  lds
    v_mfma_f32_16x16x32_bf16 v[128:131], a[108:111], v[12:15], v[128:131]
    v_mfma_f32_16x16x32_bf16 v[132:135], a[112:115], v[0:3], v[176:179]
    ds_read_b128 a[72:75], v222 offset:32768
    v_mfma_f32_16x16x32_bf16 v[132:135], a[116:119], v[4:7], v[132:135]
    v_mfma_f32_16x16x32_bf16 v[132:135], a[120:123], v[8:11], v[132:135]
    ds_read_b128 a[76:79], v223 offset:32768
    ds_read_b128 a[80:83], v220 offset:33792
    v_mfma_f32_16x16x32_bf16 v[132:135], a[124:127], v[12:15], v[132:135]
    s_waitcnt lgkmcnt(5)
    v_mfma_f32_16x16x32_bf16 a[0:3], a[128:131], v[160:163], a[0:3]
    buffer_load_dwordx4 v238, s[52:55], s61 offen offset:1024  lds
    v_mfma_f32_16x16x32_bf16 a[4:7], a[132:135], v[160:163], a[4:7]
    v_mfma_f32_16x16x32_bf16 a[8:11], a[136:139], v[160:163], a[8:11]
    ds_read_b128 a[84:87], v221 offset:33792
    ds_read_b128 a[88:91], v222 offset:33792
    v_mfma_f32_16x16x32_bf16 a[12:15], a[140:143], v[160:163], a[12:15]
    v_mfma_f32_16x16x32_bf16 a[16:19], a[144:147], v[160:163], a[16:19]
    ds_read_b128 a[92:95], v223 offset:33792
    v_mfma_f32_16x16x32_bf16 a[20:23], a[148:151], v[160:163], a[20:23]
    buffer_load_dwordx4 v239, s[52:55], s61 offen offset:2048  lds
    ds_read_b64_tr_b16 a[160:161], v224 offset:24576
    v_mfma_f32_16x16x32_bf16 a[24:27], a[152:155], v[160:163], a[24:27]
    v_exp_f32 v208, v128
    v_mfma_f32_16x16x32_bf16 a[28:31], a[156:159], v[160:163], a[28:31]
    ds_read_b64_tr_b16 a[162:163], v224 offset:25600
    v_mfma_f32_16x16x32_bf16 v[192:195], v[216:219], v[160:163], v[192:195]
    v_exp_f32 v209, v129
    v_mfma_f32_16x16x32_bf16 v[136:139], a[96:99], v[16:19], v[180:183]
    ds_read_b64_tr_b16 a[164:165], v225 offset:24576
    v_cvt_pk_bf16_f32 v160, v208, v209
    v_mfma_f32_16x16x32_bf16 v[136:139], a[100:103], v[20:23], v[136:139]
    v_exp_f32 v210, v130
    v_mfma_f32_16x16x32_bf16 v[136:139], a[104:107], v[24:27], v[136:139]
    buffer_load_dwordx4 v240, s[52:55], s61 offen offset:3072  lds
    v_mfma_f32_16x16x32_bf16 v[136:139], a[108:111], v[28:31], v[136:139]
    v_exp_f32 v211, v131
    v_mfma_f32_16x16x32_bf16 v[140:143], a[112:115], v[16:19], v[180:183]
    ds_read_b64_tr_b16 a[166:167], v225 offset:25600
    v_cvt_pk_bf16_f32 v161, v210, v211
    v_mfma_f32_16x16x32_bf16 v[140:143], a[116:119], v[20:23], v[140:143]
    v_exp_f32 v212, v132
    v_mfma_f32_16x16x32_bf16 v[140:143], a[120:123], v[24:27], v[140:143]
    ds_read_b64_tr_b16 a[168:169], v226 offset:24576
    v_mfma_f32_16x16x32_bf16 v[140:143], a[124:127], v[28:31], v[140:143]
    s_add_u32 s61, s39, 73728
    v_exp_f32 v213, v133
    v_mfma_f32_16x16x32_bf16 a[32:35], a[128:131], v[164:167], a[32:35]
    ds_read_b64_tr_b16 a[170:171], v226 offset:25600
    v_cvt_pk_bf16_f32 v162, v212, v213
    v_mfma_f32_16x16x32_bf16 a[36:39], a[132:135], v[164:167], a[36:39]
    s_add_u32 m0, s41, 65536
    v_exp_f32 v214, v134
    v_mfma_f32_16x16x32_bf16 a[40:43], a[136:139], v[164:167], a[40:43]
    buffer_load_dwordx4 v237, s[12:15], s61 offen offset:0  lds
    v_mfma_f32_16x16x32_bf16 a[44:47], a[140:143], v[164:167], a[44:47]
    v_exp_f32 v215, v135
    v_mfma_f32_16x16x32_bf16 a[48:51], a[144:147], v[164:167], a[48:51]
    ds_read_b64_tr_b16 a[172:173], v227 offset:24576
    v_cvt_pk_bf16_f32 v163, v214, v215
    v_mfma_f32_16x16x32_bf16 a[52:55], a[148:151], v[164:167], a[52:55]
    ds_read_b64_tr_b16 a[174:175], v227 offset:25600
    v_mfma_f32_16x16x32_bf16 a[56:59], a[152:155], v[164:167], a[56:59]
    v_exp_f32 v208, v136
    v_mfma_f32_16x16x32_bf16 a[60:63], a[156:159], v[164:167], a[60:63]
    ds_read_b64_tr_b16 a[176:177], v228 offset:24576
    v_mfma_f32_16x16x32_bf16 v[196:199], v[216:219], v[164:167], v[196:199]
    v_exp_f32 v209, v137
    v_mfma_f32_16x16x32_bf16 v[144:147], a[96:99], v[32:35], v[184:187]
    buffer_load_dwordx4 v238, s[12:15], s61 offen offset:1024  lds
    v_cvt_pk_bf16_f32 v164, v208, v209
    v_mfma_f32_16x16x32_bf16 v[144:147], a[100:103], v[36:39], v[144:147]
    v_exp_f32 v210, v138
    v_mfma_f32_16x16x32_bf16 v[144:147], a[104:107], v[40:43], v[144:147]
    ds_read_b64_tr_b16 a[178:179], v228 offset:25600
    v_mfma_f32_16x16x32_bf16 v[144:147], a[108:111], v[44:47], v[144:147]
    v_exp_f32 v211, v139
    v_mfma_f32_16x16x32_bf16 v[148:151], a[112:115], v[32:35], v[184:187]
    ds_read_b64_tr_b16 a[180:181], v229 offset:24576
    v_cvt_pk_bf16_f32 v165, v210, v211
    v_mfma_f32_16x16x32_bf16 v[148:151], a[116:119], v[36:39], v[148:151]
    v_exp_f32 v212, v140
    v_mfma_f32_16x16x32_bf16 v[148:151], a[120:123], v[40:43], v[148:151]
    ds_read_b64_tr_b16 a[182:183], v229 offset:25600
    v_mfma_f32_16x16x32_bf16 v[148:151], a[124:127], v[44:47], v[148:151]
    v_exp_f32 v213, v141
    v_mfma_f32_16x16x32_bf16 v[64:67], a[128:131], v[168:171], v[64:67]
    buffer_load_dwordx4 v239, s[12:15], s61 offen offset:2048  lds
    v_cvt_pk_bf16_f32 v166, v212, v213
    v_mfma_f32_16x16x32_bf16 v[68:71], a[132:135], v[168:171], v[68:71]
    v_exp_f32 v214, v142
    v_mfma_f32_16x16x32_bf16 v[72:75], a[136:139], v[168:171], v[72:75]
    ds_read_b64_tr_b16 a[184:185], v230 offset:24576
    v_mfma_f32_16x16x32_bf16 v[76:79], a[140:143], v[168:171], v[76:79]
    v_exp_f32 v215, v143
    v_mfma_f32_16x16x32_bf16 v[80:83], a[144:147], v[168:171], v[80:83]
    ds_read_b64_tr_b16 a[186:187], v230 offset:25600
    v_cvt_pk_bf16_f32 v167, v214, v215
    v_mfma_f32_16x16x32_bf16 v[84:87], a[148:151], v[168:171], v[84:87]
    ds_read_b64_tr_b16 a[188:189], v231 offset:24576
    v_mfma_f32_16x16x32_bf16 v[88:91], a[152:155], v[168:171], v[88:91]
    v_exp_f32 v208, v144
    v_mfma_f32_16x16x32_bf16 v[92:95], a[156:159], v[168:171], v[92:95]
    buffer_load_dwordx4 v240, s[12:15], s61 offen offset:3072  lds
    v_mfma_f32_16x16x32_bf16 v[200:203], v[216:219], v[168:171], v[200:203]
    v_exp_f32 v209, v145
    ds_read_b64_tr_b16 a[190:191], v231 offset:25600
    v_cvt_pk_bf16_f32 v168, v208, v209
    v_exp_f32 v210, v146
    v_exp_f32 v211, v147
    s_nop 0
    v_cvt_pk_bf16_f32 v169, v210, v211
    v_exp_f32 v212, v148
    v_exp_f32 v213, v149
    s_nop 0
    v_cvt_pk_bf16_f32 v170, v212, v213
    v_exp_f32 v214, v150
    v_exp_f32 v215, v151
    s_nop 0
    v_cvt_pk_bf16_f32 v171, v214, v215
    s_waitcnt lgkmcnt(15)
    v_mfma_f32_16x16x32_bf16 v[128:131], a[64:67], v[0:3], v[176:179]
    ds_read_b128 a[96:99], v220 offset:40960
    v_mfma_f32_16x16x32_bf16 v[128:131], a[68:71], v[4:7], v[128:131]
    s_waitcnt vmcnt(16)
    v_mfma_f32_16x16x32_bf16 v[128:131], a[72:75], v[8:11], v[128:131]
    ds_read_b64_tr_b16 a[192:193], v249 offset:0
    ds_read_b128 a[100:103], v221 offset:40960
    v_mfma_f32_16x16x32_bf16 v[128:131], a[76:79], v[12:15], v[128:131]
    v_mfma_f32_16x16x32_bf16 v[132:135], a[80:83], v[0:3], v[176:179]
    ds_read_b64_tr_b16 a[194:195], v249 offset:2048
    v_mfma_f32_16x16x32_bf16 v[132:135], a[84:87], v[4:7], v[132:135]
    v_mfma_f32_16x16x32_bf16 v[132:135], a[88:91], v[8:11], v[132:135]
    ds_read_b128 a[104:107], v222 offset:40960
    ds_read_b64_tr_b16 a[196:197], v250 offset:0
    v_mfma_f32_16x16x32_bf16 v[132:135], a[92:95], v[12:15], v[132:135]
    s_waitcnt lgkmcnt(6)
    v_mfma_f32_16x16x32_bf16 a[0:3], a[160:163], v[160:163], a[0:3]
    ds_read_b128 a[108:111], v223 offset:40960
    v_mfma_f32_16x16x32_bf16 a[4:7], a[164:167], v[160:163], a[4:7]
    v_mfma_f32_16x16x32_bf16 a[8:11], a[168:171], v[160:163], a[8:11]
    ds_read_b64_tr_b16 a[198:199], v250 offset:2048
    ds_read_b128 a[112:115], v220 offset:41984
    v_mfma_f32_16x16x32_bf16 a[12:15], a[172:175], v[160:163], a[12:15]
    v_mfma_f32_16x16x32_bf16 a[16:19], a[176:179], v[160:163], a[16:19]
    ds_read_b64_tr_b16 a[200:201], v251 offset:0
    v_mfma_f32_16x16x32_bf16 a[20:23], a[180:183], v[160:163], a[20:23]
    ds_read_b128 a[116:119], v221 offset:41984
    ds_read_b64_tr_b16 a[202:203], v251 offset:2048
    v_mfma_f32_16x16x32_bf16 a[24:27], a[184:187], v[160:163], a[24:27]
    v_exp_f32 v208, v128
    v_mfma_f32_16x16x32_bf16 a[28:31], a[188:191], v[160:163], a[28:31]
    ds_read_b128 a[120:123], v222 offset:41984
    ds_read_b64_tr_b16 a[204:205], v252 offset:0
    v_mfma_f32_16x16x32_bf16 v[192:195], v[216:219], v[160:163], v[192:195]
    v_exp_f32 v209, v129
    v_mfma_f32_16x16x32_bf16 v[136:139], a[64:67], v[16:19], v[180:183]
    ds_read_b128 a[124:127], v223 offset:41984
    v_cvt_pk_bf16_f32 v160, v208, v209
    v_mfma_f32_16x16x32_bf16 v[136:139], a[68:71], v[20:23], v[136:139]
    v_exp_f32 v210, v130
    v_mfma_f32_16x16x32_bf16 v[136:139], a[72:75], v[24:27], v[136:139]
    ds_read_b64_tr_b16 a[206:207], v252 offset:2048
    ds_read_b64_tr_b16 a[128:129], v224 offset:32768
    v_mfma_f32_16x16x32_bf16 v[136:139], a[76:79], v[28:31], v[136:139]
    s_waitcnt vmcnt(12)
    v_exp_f32 v211, v131
    v_mfma_f32_16x16x32_bf16 v[140:143], a[80:83], v[16:19], v[180:183]
    ds_read_b64_tr_b16 a[208:209], v249 offset:16384
    v_cvt_pk_bf16_f32 v161, v210, v211
    v_mfma_f32_16x16x32_bf16 v[140:143], a[84:87], v[20:23], v[140:143]
    v_exp_f32 v212, v132
    v_mfma_f32_16x16x32_bf16 v[140:143], a[88:91], v[24:27], v[140:143]
    ds_read_b64_tr_b16 a[130:131], v224 offset:33792
    ds_read_b64_tr_b16 a[210:211], v249 offset:18432
    v_mfma_f32_16x16x32_bf16 v[140:143], a[92:95], v[28:31], v[140:143]
    v_exp_f32 v213, v133
    v_mfma_f32_16x16x32_bf16 a[32:35], a[160:163], v[164:167], a[32:35]
    ds_read_b64_tr_b16 a[132:133], v225 offset:32768
    v_cvt_pk_bf16_f32 v162, v212, v213
    v_mfma_f32_16x16x32_bf16 a[36:39], a[164:167], v[164:167], a[36:39]
    v_exp_f32 v214, v134
    v_mfma_f32_16x16x32_bf16 a[40:43], a[168:171], v[164:167], a[40:43]
    ds_read_b64_tr_b16 a[212:213], v250 offset:16384
    ds_read_b64_tr_b16 a[134:135], v225 offset:33792
    v_mfma_f32_16x16x32_bf16 a[44:47], a[172:175], v[164:167], a[44:47]
    v_exp_f32 v215, v135
    v_mfma_f32_16x16x32_bf16 a[48:51], a[176:179], v[164:167], a[48:51]
    ds_read_b64_tr_b16 a[214:215], v250 offset:18432
    v_cvt_pk_bf16_f32 v163, v214, v215
    v_mfma_f32_16x16x32_bf16 a[52:55], a[180:183], v[164:167], a[52:55]
    ds_read_b64_tr_b16 a[136:137], v226 offset:32768
    ds_read_b64_tr_b16 a[216:217], v251 offset:16384
    v_mfma_f32_16x16x32_bf16 a[56:59], a[184:187], v[164:167], a[56:59]
    v_exp_f32 v208, v136
    v_mfma_f32_16x16x32_bf16 a[60:63], a[188:191], v[164:167], a[60:63]
    ds_read_b64_tr_b16 a[138:139], v226 offset:33792
    ds_read_b64_tr_b16 a[218:219], v251 offset:18432
    v_mfma_f32_16x16x32_bf16 v[196:199], v[216:219], v[164:167], v[196:199]
    v_exp_f32 v209, v137
    v_mfma_f32_16x16x32_bf16 v[144:147], a[64:67], v[32:35], v[184:187]
    ds_read_b64_tr_b16 a[140:141], v227 offset:32768
    v_cvt_pk_bf16_f32 v164, v208, v209
    v_mfma_f32_16x16x32_bf16 v[144:147], a[68:71], v[36:39], v[144:147]
    v_exp_f32 v210, v138
    v_mfma_f32_16x16x32_bf16 v[144:147], a[72:75], v[40:43], v[144:147]
    ds_read_b64_tr_b16 a[220:221], v252 offset:16384
    ds_read_b64_tr_b16 a[142:143], v227 offset:33792
    v_mfma_f32_16x16x32_bf16 v[144:147], a[76:79], v[44:47], v[144:147]
    v_exp_f32 v211, v139
    v_mfma_f32_16x16x32_bf16 v[148:151], a[80:83], v[32:35], v[184:187]
    ds_read_b64_tr_b16 a[222:223], v252 offset:18432
    v_cvt_pk_bf16_f32 v165, v210, v211
    v_mfma_f32_16x16x32_bf16 v[148:151], a[84:87], v[36:39], v[148:151]
    s_add_u32 s61, s39, 110592
    s_add_u32 m0, s41, 131072
    s_waitcnt lgkmcnt(15)
    v_exp_f32 v212, v140
    v_mfma_f32_16x16x32_bf16 v[148:151], a[88:91], v[40:43], v[148:151]
    ds_read_b64_tr_b16 a[144:145], v228 offset:32768
    buffer_load_dwordx4 v237, s[12:15], s61 offen offset:0  lds
    v_mfma_f32_16x16x32_bf16 v[148:151], a[92:95], v[44:47], v[148:151]
    v_exp_f32 v213, v141
    v_mfma_f32_16x16x32_bf16 v[64:67], a[160:163], v[168:171], v[64:67]
    ds_read_b64_tr_b16 a[146:147], v228 offset:33792
    v_cvt_pk_bf16_f32 v166, v212, v213
    v_mfma_f32_16x16x32_bf16 v[68:71], a[164:167], v[168:171], v[68:71]
    v_exp_f32 v214, v142
    v_mfma_f32_16x16x32_bf16 v[72:75], a[168:171], v[168:171], v[72:75]
    buffer_load_dwordx4 v238, s[12:15], s61 offen offset:1024  lds
    ds_read_b64_tr_b16 a[148:149], v229 offset:32768
    v_mfma_f32_16x16x32_bf16 v[76:79], a[172:175], v[168:171], v[76:79]
    v_exp_f32 v215, v143
    v_mfma_f32_16x16x32_bf16 v[80:83], a[176:179], v[168:171], v[80:83]
    buffer_load_dwordx4 v239, s[12:15], s61 offen offset:2048  lds
    v_cvt_pk_bf16_f32 v167, v214, v215
    v_mfma_f32_16x16x32_bf16 v[84:87], a[180:183], v[168:171], v[84:87]
    ds_read_b64_tr_b16 a[150:151], v229 offset:33792
    buffer_load_dwordx4 v240, s[12:15], s61 offen offset:3072  lds
    v_mfma_f32_16x16x32_bf16 v[88:91], a[184:187], v[168:171], v[88:91]
    s_add_u32 s61, s39, 73728
    s_add_u32 m0, s41, 147456
    s_waitcnt lgkmcnt(4)
    v_exp_f32 v208, v144
    v_mfma_f32_16x16x32_bf16 v[92:95], a[188:191], v[168:171], v[92:95]
    ds_read_b64_tr_b16 a[152:153], v230 offset:32768
    buffer_load_dwordx4 v237, s[52:55], s61 offen offset:0  lds
    v_mfma_f32_16x16x32_bf16 v[200:203], v[216:219], v[168:171], v[200:203]
    v_exp_f32 v209, v145
    ds_read_b64_tr_b16 a[154:155], v230 offset:33792
    v_cvt_pk_bf16_f32 v168, v208, v209
    v_exp_f32 v210, v146
    buffer_load_dwordx4 v238, s[52:55], s61 offen offset:1024  lds
    v_exp_f32 v211, v147
    ds_read_b64_tr_b16 a[156:157], v231 offset:32768
    v_cvt_pk_bf16_f32 v169, v210, v211
    v_exp_f32 v212, v148
    buffer_load_dwordx4 v239, s[52:55], s61 offen offset:2048  lds
    v_exp_f32 v213, v149
    ds_read_b64_tr_b16 a[158:159], v231 offset:33792
    v_cvt_pk_bf16_f32 v170, v212, v213
    v_exp_f32 v214, v150
    buffer_load_dwordx4 v240, s[52:55], s61 offen offset:3072  lds
    v_exp_f32 v215, v151
    s_nop 0
    v_cvt_pk_bf16_f32 v171, v214, v215
    s_barrier
    v_mfma_f32_16x16x32_bf16 v[128:131], a[96:99], v[0:3], v[176:179]
    ds_read_b128 a[64:67], v220 offset:49152
    v_mfma_f32_16x16x32_bf16 v[128:131], a[100:103], v[4:7], v[128:131]
    s_waitcnt vmcnt(16)
    v_mfma_f32_16x16x32_bf16 v[128:131], a[104:107], v[8:11], v[128:131]
    ds_read_b64_tr_b16 a[224:225], v241 offset:0
    ds_read_b128 a[68:71], v221 offset:49152
    v_mfma_f32_16x16x32_bf16 v[128:131], a[108:111], v[12:15], v[128:131]
    v_mfma_f32_16x16x32_bf16 v[132:135], a[112:115], v[0:3], v[176:179]
    ds_read_b64_tr_b16 a[226:227], v241 offset:2048
    v_mfma_f32_16x16x32_bf16 v[132:135], a[116:119], v[4:7], v[132:135]
    v_mfma_f32_16x16x32_bf16 v[132:135], a[120:123], v[8:11], v[132:135]
    ds_read_b128 a[72:75], v222 offset:49152
    ds_read_b64_tr_b16 a[228:229], v242 offset:0
    v_mfma_f32_16x16x32_bf16 v[132:135], a[124:127], v[12:15], v[132:135]
    s_waitcnt lgkmcnt(6)
    v_mfma_f32_16x16x32_bf16 a[0:3], a[128:131], v[160:163], a[0:3]
    ds_read_b128 a[76:79], v223 offset:49152
    v_mfma_f32_16x16x32_bf16 a[4:7], a[132:135], v[160:163], a[4:7]
    v_mfma_f32_16x16x32_bf16 a[8:11], a[136:139], v[160:163], a[8:11]
    ds_read_b64_tr_b16 a[230:231], v242 offset:2048
    ds_read_b128 a[80:83], v220 offset:50176
    v_mfma_f32_16x16x32_bf16 a[12:15], a[140:143], v[160:163], a[12:15]
    v_mfma_f32_16x16x32_bf16 a[16:19], a[144:147], v[160:163], a[16:19]
    ds_read_b64_tr_b16 a[232:233], v243 offset:0
    v_mfma_f32_16x16x32_bf16 a[20:23], a[148:151], v[160:163], a[20:23]
    ds_read_b128 a[84:87], v221 offset:50176
    ds_read_b64_tr_b16 a[234:235], v243 offset:2048
    v_mfma_f32_16x16x32_bf16 a[24:27], a[152:155], v[160:163], a[24:27]
    v_exp_f32 v208, v128
    v_mfma_f32_16x16x32_bf16 a[28:31], a[156:159], v[160:163], a[28:31]
    ds_read_b128 a[88:91], v222 offset:50176
    ds_read_b64_tr_b16 a[236:237], v244 offset:0
    v_mfma_f32_16x16x32_bf16 v[192:195], v[216:219], v[160:163], v[192:195]
    v_exp_f32 v209, v129
    v_mfma_f32_16x16x32_bf16 v[136:139], a[96:99], v[16:19], v[180:183]
    ds_read_b128 a[92:95], v223 offset:50176
    v_cvt_pk_bf16_f32 v160, v208, v209
    v_mfma_f32_16x16x32_bf16 v[136:139], a[100:103], v[20:23], v[136:139]
    v_exp_f32 v210, v130
    v_mfma_f32_16x16x32_bf16 v[136:139], a[104:107], v[24:27], v[136:139]
    ds_read_b64_tr_b16 a[238:239], v244 offset:2048
    ds_read_b64_tr_b16 a[160:161], v224 offset:40960
    v_mfma_f32_16x16x32_bf16 v[136:139], a[108:111], v[28:31], v[136:139]
    s_waitcnt vmcnt(12)
    v_exp_f32 v211, v131
    v_mfma_f32_16x16x32_bf16 v[140:143], a[112:115], v[16:19], v[180:183]
    ds_read_b64_tr_b16 a[240:241], v241 offset:16384
    v_cvt_pk_bf16_f32 v161, v210, v211
    v_mfma_f32_16x16x32_bf16 v[140:143], a[116:119], v[20:23], v[140:143]
    v_exp_f32 v212, v132
    v_mfma_f32_16x16x32_bf16 v[140:143], a[120:123], v[24:27], v[140:143]
    ds_read_b64_tr_b16 a[162:163], v224 offset:41984
    ds_read_b64_tr_b16 a[242:243], v241 offset:18432
    v_mfma_f32_16x16x32_bf16 v[140:143], a[124:127], v[28:31], v[140:143]
    v_exp_f32 v213, v133
    v_mfma_f32_16x16x32_bf16 a[32:35], a[128:131], v[164:167], a[32:35]
    ds_read_b64_tr_b16 a[164:165], v225 offset:40960
    v_cvt_pk_bf16_f32 v162, v212, v213
    v_mfma_f32_16x16x32_bf16 a[36:39], a[132:135], v[164:167], a[36:39]
    v_exp_f32 v214, v134
    v_mfma_f32_16x16x32_bf16 a[40:43], a[136:139], v[164:167], a[40:43]
    ds_read_b64_tr_b16 a[244:245], v242 offset:16384
    ds_read_b64_tr_b16 a[166:167], v225 offset:41984
    v_mfma_f32_16x16x32_bf16 a[44:47], a[140:143], v[164:167], a[44:47]
    v_exp_f32 v215, v135
    v_mfma_f32_16x16x32_bf16 a[48:51], a[144:147], v[164:167], a[48:51]
    ds_read_b64_tr_b16 a[246:247], v242 offset:18432
    v_cvt_pk_bf16_f32 v163, v214, v215
    v_mfma_f32_16x16x32_bf16 a[52:55], a[148:151], v[164:167], a[52:55]
    ds_read_b64_tr_b16 a[168:169], v226 offset:40960
    ds_read_b64_tr_b16 a[248:249], v243 offset:16384
    v_mfma_f32_16x16x32_bf16 a[56:59], a[152:155], v[164:167], a[56:59]
    v_exp_f32 v208, v136
    v_mfma_f32_16x16x32_bf16 a[60:63], a[156:159], v[164:167], a[60:63]
    ds_read_b64_tr_b16 a[170:171], v226 offset:41984
    ds_read_b64_tr_b16 a[250:251], v243 offset:18432
    v_mfma_f32_16x16x32_bf16 v[196:199], v[216:219], v[164:167], v[196:199]
    v_exp_f32 v209, v137
    v_mfma_f32_16x16x32_bf16 v[144:147], a[96:99], v[32:35], v[184:187]
    ds_read_b64_tr_b16 a[172:173], v227 offset:40960
    v_cvt_pk_bf16_f32 v164, v208, v209
    v_mfma_f32_16x16x32_bf16 v[144:147], a[100:103], v[36:39], v[144:147]
    v_exp_f32 v210, v138
    v_mfma_f32_16x16x32_bf16 v[144:147], a[104:107], v[40:43], v[144:147]
    ds_read_b64_tr_b16 a[252:253], v244 offset:16384
    ds_read_b64_tr_b16 a[174:175], v227 offset:41984
    v_mfma_f32_16x16x32_bf16 v[144:147], a[108:111], v[44:47], v[144:147]
    v_exp_f32 v211, v139
    v_mfma_f32_16x16x32_bf16 v[148:151], a[112:115], v[32:35], v[184:187]
    ds_read_b64_tr_b16 a[254:255], v244 offset:18432
    v_cvt_pk_bf16_f32 v165, v210, v211
    v_mfma_f32_16x16x32_bf16 v[148:151], a[116:119], v[36:39], v[148:151]
    s_add_u32 s61, s39, 110592
    s_add_u32 m0, s41, 32768
    v_exp_f32 v212, v140
    v_mfma_f32_16x16x32_bf16 v[148:151], a[120:123], v[40:43], v[148:151]
    ds_read_b64_tr_b16 a[176:177], v228 offset:40960
    buffer_load_dwordx4 v237, s[52:55], s61 offen offset:0  lds
    v_mfma_f32_16x16x32_bf16 v[148:151], a[124:127], v[44:47], v[148:151]
    v_exp_f32 v213, v141
    v_mfma_f32_16x16x32_bf16 v[64:67], a[128:131], v[168:171], v[64:67]
    ds_read_b64_tr_b16 a[178:179], v228 offset:41984
    v_cvt_pk_bf16_f32 v166, v212, v213
    v_mfma_f32_16x16x32_bf16 v[68:71], a[132:135], v[168:171], v[68:71]
    v_exp_f32 v214, v142
    v_mfma_f32_16x16x32_bf16 v[72:75], a[136:139], v[168:171], v[72:75]
    buffer_load_dwordx4 v238, s[52:55], s61 offen offset:1024  lds
    ds_read_b64_tr_b16 a[180:181], v229 offset:40960
    v_mfma_f32_16x16x32_bf16 v[76:79], a[140:143], v[168:171], v[76:79]
    v_exp_f32 v215, v143
    v_mfma_f32_16x16x32_bf16 v[80:83], a[144:147], v[168:171], v[80:83]
    buffer_load_dwordx4 v239, s[52:55], s61 offen offset:2048  lds
    v_cvt_pk_bf16_f32 v167, v214, v215
    v_mfma_f32_16x16x32_bf16 v[84:87], a[148:151], v[168:171], v[84:87]
    ds_read_b64_tr_b16 a[182:183], v229 offset:41984
    buffer_load_dwordx4 v240, s[52:55], s61 offen offset:3072  lds
    v_mfma_f32_16x16x32_bf16 v[88:91], a[152:155], v[168:171], v[88:91]
    s_add_u32 s61, s40, 0
    s_add_u32 m0, s41, 81920
    v_exp_f32 v208, v144
    v_mfma_f32_16x16x32_bf16 v[92:95], a[156:159], v[168:171], v[92:95]
    ds_read_b64_tr_b16 a[184:185], v230 offset:40960
    buffer_load_dwordx4 v237, s[12:15], s61 offen offset:0  lds
    v_mfma_f32_16x16x32_bf16 v[200:203], v[216:219], v[168:171], v[200:203]
    v_exp_f32 v209, v145
    ds_read_b64_tr_b16 a[186:187], v230 offset:41984
    v_cvt_pk_bf16_f32 v168, v208, v209
    v_exp_f32 v210, v146
    buffer_load_dwordx4 v238, s[12:15], s61 offen offset:1024  lds
    v_exp_f32 v211, v147
    ds_read_b64_tr_b16 a[188:189], v231 offset:40960
    v_cvt_pk_bf16_f32 v169, v210, v211
    v_exp_f32 v212, v148
    buffer_load_dwordx4 v239, s[12:15], s61 offen offset:2048  lds
    v_exp_f32 v213, v149
    ds_read_b64_tr_b16 a[190:191], v231 offset:41984
    v_cvt_pk_bf16_f32 v170, v212, v213
    v_exp_f32 v214, v150
    buffer_load_dwordx4 v240, s[12:15], s61 offen offset:3072  lds
    v_exp_f32 v215, v151
    s_nop 0
    v_cvt_pk_bf16_f32 v171, v214, v215
    s_waitcnt lgkmcnt(15)
    v_mfma_f32_16x16x32_bf16 v[128:131], a[64:67], v[0:3], v[176:179]
    ds_read_b128 a[96:99], v220 offset:57344
    v_mfma_f32_16x16x32_bf16 v[128:131], a[68:71], v[4:7], v[128:131]
    s_add_u32 s61, s40, 36864
    s_add_u32 m0, s41, 0
    v_mfma_f32_16x16x32_bf16 v[128:131], a[72:75], v[8:11], v[128:131]
    ds_read_b128 a[100:103], v221 offset:57344
    buffer_load_dwordx4 v237, s[12:15], s61 offen offset:0  lds
    v_mfma_f32_16x16x32_bf16 v[128:131], a[76:79], v[12:15], v[128:131]
    v_mfma_f32_16x16x32_bf16 v[132:135], a[80:83], v[0:3], v[176:179]
    ds_read_b128 a[104:107], v222 offset:57344
    v_mfma_f32_16x16x32_bf16 v[132:135], a[84:87], v[4:7], v[132:135]
    v_mfma_f32_16x16x32_bf16 v[132:135], a[88:91], v[8:11], v[132:135]
    ds_read_b128 a[108:111], v223 offset:57344
    ds_read_b128 a[112:115], v220 offset:58368
    v_mfma_f32_16x16x32_bf16 v[132:135], a[92:95], v[12:15], v[132:135]
    s_waitcnt lgkmcnt(5)
    v_mfma_f32_16x16x32_bf16 a[0:3], a[160:163], v[160:163], a[0:3]
    buffer_load_dwordx4 v238, s[12:15], s61 offen offset:1024  lds
    v_mfma_f32_16x16x32_bf16 a[4:7], a[164:167], v[160:163], a[4:7]
    v_mfma_f32_16x16x32_bf16 a[8:11], a[168:171], v[160:163], a[8:11]
    ds_read_b128 a[116:119], v221 offset:58368
    ds_read_b128 a[120:123], v222 offset:58368
    v_mfma_f32_16x16x32_bf16 a[12:15], a[172:175], v[160:163], a[12:15]
    v_mfma_f32_16x16x32_bf16 a[16:19], a[176:179], v[160:163], a[16:19]
    ds_read_b128 a[124:127], v223 offset:58368
    v_mfma_f32_16x16x32_bf16 a[20:23], a[180:183], v[160:163], a[20:23]
    buffer_load_dwordx4 v239, s[12:15], s61 offen offset:2048  lds
    ds_read_b64_tr_b16 a[128:129], v224 offset:49152
    v_mfma_f32_16x16x32_bf16 a[24:27], a[184:187], v[160:163], a[24:27]
    v_exp_f32 v208, v128
    v_mfma_f32_16x16x32_bf16 a[28:31], a[188:191], v[160:163], a[28:31]
    ds_read_b64_tr_b16 a[130:131], v224 offset:50176
    v_mfma_f32_16x16x32_bf16 v[192:195], v[216:219], v[160:163], v[192:195]
    v_exp_f32 v209, v129
    v_mfma_f32_16x16x32_bf16 v[136:139], a[64:67], v[16:19], v[180:183]
    ds_read_b64_tr_b16 a[132:133], v225 offset:49152
    v_cvt_pk_bf16_f32 v160, v208, v209
    v_mfma_f32_16x16x32_bf16 v[136:139], a[68:71], v[20:23], v[136:139]
    v_exp_f32 v210, v130
    v_mfma_f32_16x16x32_bf16 v[136:139], a[72:75], v[24:27], v[136:139]
    buffer_load_dwordx4 v240, s[12:15], s61 offen offset:3072  lds
    v_mfma_f32_16x16x32_bf16 v[136:139], a[76:79], v[28:31], v[136:139]
    v_exp_f32 v211, v131
    v_mfma_f32_16x16x32_bf16 v[140:143], a[80:83], v[16:19], v[180:183]
    ds_read_b64_tr_b16 a[134:135], v225 offset:50176
    v_cvt_pk_bf16_f32 v161, v210, v211
    v_mfma_f32_16x16x32_bf16 v[140:143], a[84:87], v[20:23], v[140:143]
    s_add_u32 s61, s40, 0
    v_exp_f32 v212, v132
    v_mfma_f32_16x16x32_bf16 v[140:143], a[88:91], v[24:27], v[140:143]
    ds_read_b64_tr_b16 a[136:137], v226 offset:49152
    v_mfma_f32_16x16x32_bf16 v[140:143], a[92:95], v[28:31], v[140:143]
    s_add_u32 m0, s41, 16384
    v_exp_f32 v213, v133
    v_mfma_f32_16x16x32_bf16 a[32:35], a[160:163], v[164:167], a[32:35]
    ds_read_b64_tr_b16 a[138:139], v226 offset:50176
    v_cvt_pk_bf16_f32 v162, v212, v213
    v_mfma_f32_16x16x32_bf16 a[36:39], a[164:167], v[164:167], a[36:39]
    v_exp_f32 v214, v134
    v_mfma_f32_16x16x32_bf16 a[40:43], a[168:171], v[164:167], a[40:43]
    buffer_load_dwordx4 v237, s[52:55], s61 offen offset:0  lds
    v_mfma_f32_16x16x32_bf16 a[44:47], a[172:175], v[164:167], a[44:47]
    v_exp_f32 v215, v135
    v_mfma_f32_16x16x32_bf16 a[48:51], a[176:179], v[164:167], a[48:51]
    ds_read_b64_tr_b16 a[140:141], v227 offset:49152
    v_cvt_pk_bf16_f32 v163, v214, v215
    v_mfma_f32_16x16x32_bf16 a[52:55], a[180:183], v[164:167], a[52:55]
    ds_read_b64_tr_b16 a[142:143], v227 offset:50176
    v_mfma_f32_16x16x32_bf16 a[56:59], a[184:187], v[164:167], a[56:59]
    v_exp_f32 v208, v136
    v_mfma_f32_16x16x32_bf16 a[60:63], a[188:191], v[164:167], a[60:63]
    ds_read_b64_tr_b16 a[144:145], v228 offset:49152
    v_mfma_f32_16x16x32_bf16 v[196:199], v[216:219], v[164:167], v[196:199]
    v_exp_f32 v209, v137
    v_mfma_f32_16x16x32_bf16 v[144:147], a[64:67], v[32:35], v[184:187]
    buffer_load_dwordx4 v238, s[52:55], s61 offen offset:1024  lds
    v_cvt_pk_bf16_f32 v164, v208, v209
    v_mfma_f32_16x16x32_bf16 v[144:147], a[68:71], v[36:39], v[144:147]
    v_exp_f32 v210, v138
    v_mfma_f32_16x16x32_bf16 v[144:147], a[72:75], v[40:43], v[144:147]
    ds_read_b64_tr_b16 a[146:147], v228 offset:50176
    v_mfma_f32_16x16x32_bf16 v[144:147], a[76:79], v[44:47], v[144:147]
    v_exp_f32 v211, v139
    v_mfma_f32_16x16x32_bf16 v[148:151], a[80:83], v[32:35], v[184:187]
    ds_read_b64_tr_b16 a[148:149], v229 offset:49152
    v_cvt_pk_bf16_f32 v165, v210, v211
    v_mfma_f32_16x16x32_bf16 v[148:151], a[84:87], v[36:39], v[148:151]
    v_exp_f32 v212, v140
    v_mfma_f32_16x16x32_bf16 v[148:151], a[88:91], v[40:43], v[148:151]
    ds_read_b64_tr_b16 a[150:151], v229 offset:50176
    v_mfma_f32_16x16x32_bf16 v[148:151], a[92:95], v[44:47], v[148:151]
    v_exp_f32 v213, v141
    v_mfma_f32_16x16x32_bf16 v[64:67], a[160:163], v[168:171], v[64:67]
    buffer_load_dwordx4 v239, s[52:55], s61 offen offset:2048  lds
    v_cvt_pk_bf16_f32 v166, v212, v213
    v_mfma_f32_16x16x32_bf16 v[68:71], a[164:167], v[168:171], v[68:71]
    v_exp_f32 v214, v142
    v_mfma_f32_16x16x32_bf16 v[72:75], a[168:171], v[168:171], v[72:75]
    ds_read_b64_tr_b16 a[152:153], v230 offset:49152
    v_mfma_f32_16x16x32_bf16 v[76:79], a[172:175], v[168:171], v[76:79]
    v_exp_f32 v215, v143
    v_mfma_f32_16x16x32_bf16 v[80:83], a[176:179], v[168:171], v[80:83]
    ds_read_b64_tr_b16 a[154:155], v230 offset:50176
    v_cvt_pk_bf16_f32 v167, v214, v215
    v_mfma_f32_16x16x32_bf16 v[84:87], a[180:183], v[168:171], v[84:87]
    ds_read_b64_tr_b16 a[156:157], v231 offset:49152
    v_mfma_f32_16x16x32_bf16 v[88:91], a[184:187], v[168:171], v[88:91]
    v_exp_f32 v208, v144
    v_mfma_f32_16x16x32_bf16 v[92:95], a[188:191], v[168:171], v[92:95]
    buffer_load_dwordx4 v240, s[52:55], s61 offen offset:3072  lds
    v_mfma_f32_16x16x32_bf16 v[200:203], v[216:219], v[168:171], v[200:203]
    v_exp_f32 v209, v145
    ds_read_b64_tr_b16 a[158:159], v231 offset:50176
    v_cvt_pk_bf16_f32 v168, v208, v209
    v_exp_f32 v210, v146
    v_exp_f32 v211, v147
    s_nop 0
    v_cvt_pk_bf16_f32 v169, v210, v211
    v_exp_f32 v212, v148
    v_exp_f32 v213, v149
    s_nop 0
    v_cvt_pk_bf16_f32 v170, v212, v213
    v_exp_f32 v214, v150
    v_exp_f32 v215, v151
    s_nop 0
    v_cvt_pk_bf16_f32 v171, v214, v215
    s_waitcnt lgkmcnt(0)
    s_barrier
    s_lshl_b32 s47, s3, 19
    s_lshl_b32 s50, s37, 12
    s_add_u32 s47, s47, s50
    v_lshlrev_b32 v254, 1, v236
    v_and_b32 v254, 0xe0, v254
    s_cmp_lg_u32 s3, 0
    s_cbranch_scc1 L_nochk3
    buffer_load_dword v255, v254, s[8:11], 0 offen sc1
L_nochk3:
    v_mfma_f32_16x16x32_bf16 v[128:131], a[96:99], v[0:3], v[176:179]
    ds_read_b64_tr_b16 a[160:161], v224 offset:57344
    v_mfma_f32_16x16x32_bf16 v[128:131], a[100:103], v[4:7], v[128:131]
    s_add_u32 s61, s40, 36864
    s_add_u32 m0, s41, 49152
    s_nop 0
    buffer_load_dwordx4 v237, s[52:55], s61 offen offset:0  lds
    ds_read_b64_tr_b16 a[162:163], v224 offset:58368
    v_mfma_f32_16x16x32_bf16 v[128:131], a[104:107], v[8:11], v[128:131]
    v_mfma_f32_16x16x32_bf16 v[128:131], a[108:111], v[12:15], v[128:131]
    ds_read_b64_tr_b16 a[164:165], v225 offset:57344
    v_mfma_f32_16x16x32_bf16 v[132:135], a[112:115], v[0:3], v[176:179]
    v_mfma_f32_16x16x32_bf16 v[132:135], a[116:119], v[4:7], v[132:135]
    buffer_load_dwordx4 v238, s[52:55], s61 offen offset:1024  lds
    ds_read_b64_tr_b16 a[166:167], v225 offset:58368
    v_mfma_f32_16x16x32_bf16 v[132:135], a[120:123], v[8:11], v[132:135]
    ds_read_b64_tr_b16 a[168:169], v226 offset:57344
    v_mfma_f32_16x16x32_bf16 v[132:135], a[124:127], v[12:15], v[132:135]
    v_mfma_f32_16x16x32_bf16 a[0:3], a[128:131], v[160:163], a[0:3]
    ds_read_b64_tr_b16 a[170:171], v226 offset:58368
    v_mfma_f32_16x16x32_bf16 a[4:7], a[132:135], v[160:163], a[4:7]
    buffer_load_dwordx4 v239, s[52:55], s61 offen offset:2048  lds
    v_mfma_f32_16x16x32_bf16 a[8:11], a[136:139], v[160:163], a[8:11]
    ds_read_b64_tr_b16 a[172:173], v227 offset:57344
    v_exp_f32 v208, v128
    v_mfma_f32_16x16x32_bf16 a[12:15], a[140:143], v[160:163], a[12:15]
    ds_read_b64_tr_b16 a[174:175], v227 offset:58368
    v_exp_f32 v209, v129
    v_mfma_f32_16x16x32_bf16 a[16:19], a[144:147], v[160:163], a[16:19]
    v_exp_f32 v210, v130
    v_mfma_f32_16x16x32_bf16 a[20:23], a[148:151], v[160:163], a[20:23]
    buffer_load_dwordx4 v240, s[52:55], s61 offen offset:3072  lds
    ds_read_b64_tr_b16 a[176:177], v228 offset:57344
    v_mfma_f32_16x16x32_bf16 a[24:27], a[152:155], v[160:163], a[24:27]
    v_mfma_f32_16x16x32_bf16 a[28:31], a[156:159], v[160:163], a[28:31]
    ds_read_b64_tr_b16 a[178:179], v228 offset:58368
    v_mfma_f32_16x16x32_bf16 v[192:195], v[216:219], v[160:163], v[192:195]
    v_mfma_f32_16x16x32_bf16 v[136:139], a[96:99], v[16:19], v[180:183]
    s_add_u32 s61, s40, 73728
    s_add_u32 m0, s41, 98304
    s_nop 0
    buffer_load_dwordx4 v237, s[12:15], s61 offen offset:0  lds
    ds_read_b64_tr_b16 a[180:181], v229 offset:57344
    v_cvt_pk_bf16_f32 v160, v208, v209
    v_mfma_f32_16x16x32_bf16 v[136:139], a[100:103], v[20:23], v[136:139]
    ds_read_b64_tr_b16 a[182:183], v229 offset:58368
    v_exp_f32 v211, v131
    v_mfma_f32_16x16x32_bf16 v[136:139], a[104:107], v[24:27], v[136:139]
    v_exp_f32 v212, v132
    v_cvt_pk_bf16_f32 v161, v210, v211
    v_mfma_f32_16x16x32_bf16 v[136:139], a[108:111], v[28:31], v[136:139]
    ds_read_b64_tr_b16 a[184:185], v230 offset:57344
    v_exp_f32 v213, v133
    v_mfma_f32_16x16x32_bf16 v[140:143], a[112:115], v[16:19], v[180:183]
    buffer_load_dwordx4 v238, s[12:15], s61 offen offset:1024  lds
    v_exp_f32 v214, v134
    v_cvt_pk_bf16_f32 v162, v212, v213
    v_mfma_f32_16x16x32_bf16 v[140:143], a[116:119], v[20:23], v[140:143]
    ds_read_b64_tr_b16 a[186:187], v230 offset:58368
    v_exp_f32 v215, v135
    s_nop 0
    v_cvt_pk_bf16_f32 v163, v214, v215
    v_mfma_f32_16x16x32_bf16 v[140:143], a[120:123], v[24:27], v[140:143]
    ds_read_b64_tr_b16 a[188:189], v231 offset:57344
    v_mfma_f32_16x16x32_bf16 v[140:143], a[124:127], v[28:31], v[140:143]
    v_mfma_f32_16x16x32_bf16 a[32:35], a[128:131], v[164:167], a[32:35]
    buffer_load_dwordx4 v239, s[12:15], s61 offen offset:2048  lds
    ds_read_b64_tr_b16 a[190:191], v231 offset:58368
    v_mfma_f32_16x16x32_bf16 a[36:39], a[132:135], v[164:167], a[36:39]
    v_mfma_f32_16x16x32_bf16 a[40:43], a[136:139], v[164:167], a[40:43]
    v_exp_f32 v208, v136
    v_exp_f32 v209, v137
    v_mfma_f32_16x16x32_bf16 a[44:47], a[140:143], v[164:167], a[44:47]
    v_exp_f32 v210, v138
    v_mfma_f32_16x16x32_bf16 a[48:51], a[144:147], v[164:167], a[48:51]
    buffer_load_dwordx4 v240, s[12:15], s61 offen offset:3072  lds
    v_mfma_f32_16x16x32_bf16 a[52:55], a[148:151], v[164:167], a[52:55]
    v_mfma_f32_16x16x32_bf16 a[56:59], a[152:155], v[164:167], a[56:59]
    v_mfma_f32_16x16x32_bf16 a[60:63], a[156:159], v[164:167], a[60:63]
    v_mfma_f32_16x16x32_bf16 v[196:199], v[216:219], v[164:167], v[196:199]
    s_waitcnt vmcnt(32)
    ds_read_b64_tr_b16 a[64:65], v245 offset:0
    s_waitcnt lgkmcnt(1)
    v_mfma_f32_16x16x32_bf16 a[0:3], a[160:163], v[160:163], a[0:3]
    ds_read_b64_tr_b16 a[66:67], v245 offset:2048
    v_cvt_pk_bf16_f32 v164, v208, v209
    v_exp_f32 v211, v139
    v_mfma_f32_16x16x32_bf16 a[4:7], a[164:167], v[160:163], a[4:7]
    ds_read_b64_tr_b16 a[68:69], v246 offset:0
    v_exp_f32 v212, v140
    v_cvt_pk_bf16_f32 v165, v210, v211
    v_mfma_f32_16x16x32_bf16 a[8:11], a[168:171], v[160:163], a[8:11]
    ds_read_b64_tr_b16 a[70:71], v246 offset:2048
    v_exp_f32 v213, v141
    v_mfma_f32_16x16x32_bf16 a[12:15], a[172:175], v[160:163], a[12:15]
    ds_read_b64_tr_b16 a[72:73], v247 offset:0
    v_exp_f32 v214, v142
    v_cvt_pk_bf16_f32 v166, v212, v213
    v_mfma_f32_16x16x32_bf16 a[16:19], a[176:179], v[160:163], a[16:19]
    ds_read_b64_tr_b16 a[74:75], v247 offset:2048
    v_exp_f32 v215, v143
    s_nop 0
    v_cvt_pk_bf16_f32 v167, v214, v215
    v_mfma_f32_16x16x32_bf16 a[20:23], a[180:183], v[160:163], a[20:23]
    ds_read_b64_tr_b16 a[76:77], v248 offset:0
    v_mfma_f32_16x16x32_bf16 a[24:27], a[184:187], v[160:163], a[24:27]
    ds_read_b64_tr_b16 a[78:79], v248 offset:2048
    v_mfma_f32_16x16x32_bf16 a[28:31], a[188:191], v[160:163], a[28:31]
    s_add_u32 s61, s40, 110592
    s_add_u32 m0, s41, 65536
    s_waitcnt lgkmcnt(0)
    buffer_load_dwordx4 v237, s[12:15], s61 offen offset:0  lds
    v_mfma_f32_16x16x32_bf16 v[192:195], v[216:219], v[160:163], v[192:195]
    v_mfma_f32_16x16x32_bf16 a[32:35], a[160:163], v[164:167], a[32:35]
    v_mfma_f32_16x16x32_bf16 a[36:39], a[164:167], v[164:167], a[36:39]
    buffer_load_dwordx4 v238, s[12:15], s61 offen offset:1024  lds
    v_mfma_f32_16x16x32_bf16 a[40:43], a[168:171], v[164:167], a[40:43]
    s_nop 3
    v_rcp_f32 v193, v192
    s_add_u32 s50, s47, 0
    v_accvgpr_read_b32 v176, a0
    v_accvgpr_read_b32 v177, a1
    v_mfma_f32_16x16x32_bf16 a[44:47], a[172:175], v[164:167], a[44:47]
    v_accvgpr_read_b32 v178, a2
    v_accvgpr_read_b32 v179, a3
    v_accvgpr_read_b32 v180, a4
    v_accvgpr_read_b32 v181, a5
    v_mfma_f32_16x16x32_bf16 a[48:51], a[176:179], v[164:167], a[48:51]
    buffer_load_dwordx4 v239, s[12:15], s61 offen offset:2048  lds
    v_accvgpr_read_b32 v182, a6
    v_accvgpr_read_b32 v183, a7
    v_mul_f32 v176, v193, v176
    v_mfma_f32_16x16x32_bf16 a[52:55], a[180:183], v[164:167], a[52:55]
    v_mul_f32 v177, v193, v177
    v_mul_f32 v178, v193, v178
    v_mul_f32 v179, v193, v179
    v_mul_f32 v180, v193, v180
    v_mfma_f32_16x16x32_bf16 a[56:59], a[184:187], v[164:167], a[56:59]
    v_mul_f32 v181, v193, v181
    v_mul_f32 v182, v193, v182
    v_mul_f32 v183, v193, v183
    v_cvt_pk_bf16_f32 v128, v176, v177
    v_mfma_f32_16x16x32_bf16 a[60:63], a[188:191], v[164:167], a[60:63]
    buffer_load_dwordx4 v240, s[12:15], s61 offen offset:3072  lds
    v_cvt_pk_bf16_f32 v129, v178, v179
    v_cvt_pk_bf16_f32 v130, v180, v181
    v_cvt_pk_bf16_f32 v131, v182, v183
    v_mfma_f32_16x16x32_bf16 v[196:199], v[216:219], v[164:167], v[196:199]
    buffer_store_dwordx4 v[128:131], v236, s[24:27], s50 offen offset:0 sc1
    v_accvgpr_read_b32 v176, a8
    v_accvgpr_read_b32 v177, a9
    v_accvgpr_read_b32 v178, a10
    v_mfma_f32_16x16x32_bf16 v[144:147], a[96:99], v[32:35], v[184:187]
    v_accvgpr_read_b32 v179, a11
    v_accvgpr_read_b32 v180, a12
    v_accvgpr_read_b32 v181, a13
    v_accvgpr_read_b32 v182, a14
    v_mfma_f32_16x16x32_bf16 v[144:147], a[100:103], v[36:39], v[144:147]
    s_waitcnt vmcnt(33)
    ds_read_b64_tr_b16 a[80:81], v249 offset:0
    v_accvgpr_read_b32 v183, a15
    v_mul_f32 v176, v193, v176
    v_mul_f32 v177, v193, v177
    v_mfma_f32_16x16x32_bf16 v[144:147], a[104:107], v[40:43], v[144:147]
    ds_read_b64_tr_b16 a[82:83], v249 offset:2048
    v_mul_f32 v178, v193, v178
    v_mul_f32 v179, v193, v179
    v_mul_f32 v180, v193, v180
    v_mfma_f32_16x16x32_bf16 v[144:147], a[108:111], v[44:47], v[144:147]
    ds_read_b64_tr_b16 a[84:85], v250 offset:0
    v_mul_f32 v181, v193, v181
    v_mul_f32 v182, v193, v182
    v_mul_f32 v183, v193, v183
    v_mfma_f32_16x16x32_bf16 v[148:151], a[112:115], v[32:35], v[184:187]
    ds_read_b64_tr_b16 a[86:87], v250 offset:2048
    v_cvt_pk_bf16_f32 v132, v176, v177
    v_cvt_pk_bf16_f32 v133, v178, v179
    v_cvt_pk_bf16_f32 v134, v180, v181
    v_mfma_f32_16x16x32_bf16 v[148:151], a[116:119], v[36:39], v[148:151]
    ds_read_b64_tr_b16 a[88:89], v251 offset:0
    v_cvt_pk_bf16_f32 v135, v182, v183
    buffer_store_dwordx4 v[132:135], v236, s[24:27], s50 offen offset:1024 sc1
    v_accvgpr_read_b32 v176, a16
    v_mfma_f32_16x16x32_bf16 v[148:151], a[120:123], v[40:43], v[148:151]
    ds_read_b64_tr_b16 a[90:91], v251 offset:2048
    v_accvgpr_read_b32 v177, a17
    v_accvgpr_read_b32 v178, a18
    v_accvgpr_read_b32 v179, a19
    v_mfma_f32_16x16x32_bf16 v[148:151], a[124:127], v[44:47], v[148:151]
    ds_read_b64_tr_b16 a[92:93], v252 offset:0
    v_accvgpr_read_b32 v180, a20
    v_accvgpr_read_b32 v181, a21
    v_accvgpr_read_b32 v182, a22
    v_mfma_f32_16x16x32_bf16 v[64:67], a[128:131], v[168:171], v[64:67]
    ds_read_b64_tr_b16 a[94:95], v252 offset:2048
    v_accvgpr_read_b32 v183, a23
    v_mul_f32 v176, v193, v176
    v_mul_f32 v177, v193, v177
    v_mfma_f32_16x16x32_bf16 v[68:71], a[132:135], v[168:171], v[68:71]
    s_waitcnt vmcnt(30)
    ds_read_b64_tr_b16 v[0:1], v249 offset:16384
    v_mul_f32 v178, v193, v178
    v_mul_f32 v179, v193, v179
    v_mul_f32 v180, v193, v180
    v_mfma_f32_16x16x32_bf16 v[72:75], a[136:139], v[168:171], v[72:75]
    ds_read_b64_tr_b16 v[2:3], v249 offset:18432
    v_mul_f32 v181, v193, v181
    v_mul_f32 v182, v193, v182
    v_mul_f32 v183, v193, v183
    v_mfma_f32_16x16x32_bf16 v[76:79], a[140:143], v[168:171], v[76:79]
    ds_read_b64_tr_b16 v[4:5], v250 offset:16384
    v_cvt_pk_bf16_f32 v128, v176, v177
    v_cvt_pk_bf16_f32 v129, v178, v179
    v_cvt_pk_bf16_f32 v130, v180, v181
    v_mfma_f32_16x16x32_bf16 v[80:83], a[144:147], v[168:171], v[80:83]
    ds_read_b64_tr_b16 v[6:7], v250 offset:18432
    v_cvt_pk_bf16_f32 v131, v182, v183
    buffer_store_dwordx4 v[128:131], v236, s[24:27], s50 offen offset:2048 sc1
    v_accvgpr_read_b32 v176, a24
    v_mfma_f32_16x16x32_bf16 v[84:87], a[148:151], v[168:171], v[84:87]
    ds_read_b64_tr_b16 v[8:9], v251 offset:16384
    v_accvgpr_read_b32 v177, a25
    v_accvgpr_read_b32 v178, a26
    v_accvgpr_read_b32 v179, a27
    v_mfma_f32_16x16x32_bf16 v[88:91], a[152:155], v[168:171], v[88:91]
    ds_read_b64_tr_b16 v[10:11], v251 offset:18432
    v_accvgpr_read_b32 v180, a28
    v_accvgpr_read_b32 v181, a29
    v_accvgpr_read_b32 v182, a30
    v_mfma_f32_16x16x32_bf16 v[92:95], a[156:159], v[168:171], v[92:95]
    ds_read_b64_tr_b16 v[12:13], v252 offset:16384
    v_accvgpr_read_b32 v183, a31
    v_mul_f32 v176, v193, v176
    v_mul_f32 v177, v193, v177
    v_mfma_f32_16x16x32_bf16 v[200:203], v[216:219], v[168:171], v[200:203]
    ds_read_b64_tr_b16 v[14:15], v252 offset:18432
    v_mul_f32 v178, v193, v178
    v_mul_f32 v179, v193, v179
    v_mul_f32 v180, v193, v180
    s_waitcnt vmcnt(27)
    ds_read_b64_tr_b16 v[16:17], v241 offset:32768
    v_mul_f32 v181, v193, v181
    v_mul_f32 v182, v193, v182
    v_mul_f32 v183, v193, v183
    ds_read_b64_tr_b16 v[18:19], v241 offset:34816
    v_cvt_pk_bf16_f32 v132, v176, v177
    v_cvt_pk_bf16_f32 v133, v178, v179
    v_cvt_pk_bf16_f32 v134, v180, v181
    ds_read_b64_tr_b16 v[20:21], v242 offset:32768
    v_cvt_pk_bf16_f32 v135, v182, v183
    buffer_store_dwordx4 v[132:135], v236, s[24:27], s50 offen offset:3072 sc1
    v_rcp_f32 v197, v196
    ds_read_b64_tr_b16 v[22:23], v242 offset:34816
    s_add_u32 s50, s47, 131072
    v_accvgpr_read_b32 v176, a32
    v_accvgpr_read_b32 v177, a33
    ds_read_b64_tr_b16 v[24:25], v243 offset:32768
    v_accvgpr_read_b32 v178, a34
    v_accvgpr_read_b32 v179, a35
    v_accvgpr_read_b32 v180, a36
    ds_read_b64_tr_b16 v[26:27], v243 offset:34816
    v_accvgpr_read_b32 v181, a37
    v_accvgpr_read_b32 v182, a38
    v_accvgpr_read_b32 v183, a39
    ds_read_b64_tr_b16 v[28:29], v244 offset:32768
    v_mul_f32 v176, v197, v176
    v_mul_f32 v177, v197, v177
    v_mul_f32 v178, v197, v178
    ds_read_b64_tr_b16 v[30:31], v244 offset:34816
    v_mul_f32 v179, v197, v179
    v_mul_f32 v180, v197, v180
    v_mul_f32 v181, v197, v181
    s_waitcnt vmcnt(24)
    ds_read_b64_tr_b16 v[32:33], v245 offset:16384
    v_mul_f32 v182, v197, v182
    v_mul_f32 v183, v197, v183
    v_cvt_pk_bf16_f32 v128, v176, v177
    ds_read_b64_tr_b16 v[34:35], v245 offset:18432
    v_cvt_pk_bf16_f32 v129, v178, v179
    v_cvt_pk_bf16_f32 v130, v180, v181
    v_cvt_pk_bf16_f32 v131, v182, v183
    ds_read_b64_tr_b16 v[36:37], v246 offset:16384
    buffer_store_dwordx4 v[128:131], v236, s[24:27], s50 offen offset:0 sc1
    v_accvgpr_read_b32 v176, a40
    v_accvgpr_read_b32 v177, a41
    ds_read_b64_tr_b16 v[38:39], v246 offset:18432
    v_accvgpr_read_b32 v178, a42
    v_accvgpr_read_b32 v179, a43
    v_accvgpr_read_b32 v180, a44
    ds_read_b64_tr_b16 v[40:41], v247 offset:16384
    v_accvgpr_read_b32 v181, a45
    v_accvgpr_read_b32 v182, a46
    v_accvgpr_read_b32 v183, a47
    ds_read_b64_tr_b16 v[42:43], v247 offset:18432
    v_mul_f32 v176, v197, v176
    v_mul_f32 v177, v197, v177
    v_mul_f32 v178, v197, v178
    ds_read_b64_tr_b16 v[44:45], v248 offset:16384
    v_mul_f32 v179, v197, v179
    v_mul_f32 v180, v197, v180
    v_mul_f32 v181, v197, v181
    ds_read_b64_tr_b16 v[46:47], v248 offset:18432
    v_mul_f32 v182, v197, v182
    v_mul_f32 v183, v197, v183
    v_cvt_pk_bf16_f32 v132, v176, v177
    s_waitcnt vmcnt(21)
    ds_read_b64_tr_b16 v[48:49], v241 offset:0
    v_cvt_pk_bf16_f32 v133, v178, v179
    v_cvt_pk_bf16_f32 v134, v180, v181
    v_cvt_pk_bf16_f32 v135, v182, v183
    buffer_store_dwordx4 v[132:135], v236, s[24:27], s50 offen offset:1024 sc1
    v_accvgpr_read_b32 v176, a48
    v_accvgpr_read_b32 v177, a49
    v_accvgpr_read_b32 v178, a50
    v_accvgpr_read_b32 v179, a51
    v_accvgpr_read_b32 v180, a52
    v_accvgpr_read_b32 v181, a53
    v_accvgpr_read_b32 v182, a54
    v_accvgpr_read_b32 v183, a55
    v_mul_f32 v176, v197, v176
    v_mul_f32 v177, v197, v177
    v_mul_f32 v178, v197, v178
    v_mul_f32 v179, v197, v179
    v_mul_f32 v180, v197, v180
    v_mul_f32 v181, v197, v181
    v_mul_f32 v182, v197, v182
    v_mul_f32 v183, v197, v183
    v_cvt_pk_bf16_f32 v128, v176, v177
    v_cvt_pk_bf16_f32 v129, v178, v179
    v_cvt_pk_bf16_f32 v130, v180, v181
    v_cvt_pk_bf16_f32 v131, v182, v183
    buffer_store_dwordx4 v[128:131], v236, s[24:27], s50 offen offset:2048 sc1
    v_accvgpr_read_b32 v176, a56
    v_accvgpr_read_b32 v177, a57
    v_accvgpr_read_b32 v178, a58
    v_accvgpr_read_b32 v179, a59
    v_accvgpr_read_b32 v180, a60
    v_accvgpr_read_b32 v181, a61
    v_accvgpr_read_b32 v182, a62
    v_accvgpr_read_b32 v183, a63
    v_mul_f32 v176, v197, v176
    v_mul_f32 v177, v197, v177
    v_mul_f32 v178, v197, v178
    v_mul_f32 v179, v197, v179
    v_mul_f32 v180, v197, v180
    v_mul_f32 v181, v197, v181
    v_mul_f32 v182, v197, v182
    v_mul_f32 v183, v197, v183
    v_cvt_pk_bf16_f32 v132, v176, v177
    v_cvt_pk_bf16_f32 v133, v178, v179
    v_cvt_pk_bf16_f32 v134, v180, v181
    v_cvt_pk_bf16_f32 v135, v182, v183
    buffer_store_dwordx4 v[132:135], v236, s[24:27], s50 offen offset:3072 sc1
    v_exp_f32 v208, v144
    v_exp_f32 v209, v145
    v_exp_f32 v210, v146
    v_cvt_pk_bf16_f32 v168, v208, v209
    v_exp_f32 v211, v147
    v_exp_f32 v212, v148
    v_cvt_pk_bf16_f32 v169, v210, v211
    v_exp_f32 v213, v149
    v_exp_f32 v214, v150
    v_cvt_pk_bf16_f32 v170, v212, v213
    v_exp_f32 v215, v151
    s_nop 0
    v_cvt_pk_bf16_f32 v171, v214, v215
    s_nop 1
    v_mfma_f32_16x16x32_bf16 v[64:67], a[160:163], v[168:171], v[64:67]
    ds_read_b64_tr_b16 v[50:51], v241 offset:2048
    v_mfma_f32_16x16x32_bf16 v[68:71], a[164:167], v[168:171], v[68:71]
    ds_read_b64_tr_b16 v[52:53], v242 offset:0
    v_mfma_f32_16x16x32_bf16 v[72:75], a[168:171], v[168:171], v[72:75]
    ds_read_b64_tr_b16 v[54:55], v242 offset:2048
    v_mfma_f32_16x16x32_bf16 v[76:79], a[172:175], v[168:171], v[76:79]
    ds_read_b64_tr_b16 v[56:57], v243 offset:0
    v_mfma_f32_16x16x32_bf16 v[80:83], a[176:179], v[168:171], v[80:83]
    ds_read_b64_tr_b16 v[58:59], v243 offset:2048
    v_mfma_f32_16x16x32_bf16 v[84:87], a[180:183], v[168:171], v[84:87]
    ds_read_b64_tr_b16 v[60:61], v244 offset:0
    v_mfma_f32_16x16x32_bf16 v[88:91], a[184:187], v[168:171], v[88:91]
    ds_read_b64_tr_b16 v[62:63], v244 offset:2048
    v_mfma_f32_16x16x32_bf16 v[92:95], a[188:191], v[168:171], v[92:95]
    s_waitcnt vmcnt(20)
    ds_read_b64_tr_b16 a[96:97], v241 offset:16384
    v_mfma_f32_16x16x32_bf16 v[200:203], v[216:219], v[168:171], v[200:203]
    ds_read_b64_tr_b16 a[98:99], v241 offset:18432
    ds_read_b64_tr_b16 a[100:101], v242 offset:16384
    ds_read_b64_tr_b16 a[102:103], v242 offset:18432
    ds_read_b64_tr_b16 a[104:105], v243 offset:16384
    s_nop 3
    v_rcp_f32 v201, v200
    s_add_u32 s50, s47, 262144
    v_mul_f32 v64, v201, v64
    ds_read_b64_tr_b16 a[106:107], v243 offset:18432
    v_mul_f32 v65, v201, v65
    v_mul_f32 v66, v201, v66
    v_mul_f32 v67, v201, v67
    ds_read_b64_tr_b16 a[108:109], v244 offset:16384
    v_mul_f32 v68, v201, v68
    v_mul_f32 v69, v201, v69
    v_mul_f32 v70, v201, v70
    ds_read_b64_tr_b16 a[110:111], v244 offset:18432
    v_mul_f32 v71, v201, v71
    v_cvt_pk_bf16_f32 v128, v64, v65
    v_cvt_pk_bf16_f32 v129, v66, v67
    s_waitcnt vmcnt(16)
    ds_read_b64_tr_b16 a[112:113], v241 offset:49152
    v_cvt_pk_bf16_f32 v130, v68, v69
    v_cvt_pk_bf16_f32 v131, v70, v71
    buffer_store_dwordx4 v[128:131], v236, s[24:27], s50 offen offset:0 sc1
    ds_read_b64_tr_b16 a[114:115], v241 offset:51200
    v_mul_f32 v72, v201, v72
    v_mul_f32 v73, v201, v73
    v_mul_f32 v74, v201, v74
    ds_read_b64_tr_b16 a[116:117], v242 offset:49152
    v_mul_f32 v75, v201, v75
    v_mul_f32 v76, v201, v76
    v_mul_f32 v77, v201, v77
    v_mul_f32 v78, v201, v78
    v_mul_f32 v79, v201, v79
    v_cvt_pk_bf16_f32 v132, v72, v73
    v_cvt_pk_bf16_f32 v133, v74, v75
    v_cvt_pk_bf16_f32 v134, v76, v77
    v_cvt_pk_bf16_f32 v135, v78, v79
    buffer_store_dwordx4 v[132:135], v236, s[24:27], s50 offen offset:1024 sc1
    v_mul_f32 v80, v201, v80
    v_mul_f32 v81, v201, v81
    v_mul_f32 v82, v201, v82
    v_mul_f32 v83, v201, v83
    v_mul_f32 v84, v201, v84
    v_mul_f32 v85, v201, v85
    v_mul_f32 v86, v201, v86
    v_mul_f32 v87, v201, v87
    v_cvt_pk_bf16_f32 v128, v80, v81
    v_cvt_pk_bf16_f32 v129, v82, v83
    v_cvt_pk_bf16_f32 v130, v84, v85
    v_cvt_pk_bf16_f32 v131, v86, v87
    buffer_store_dwordx4 v[128:131], v236, s[24:27], s50 offen offset:2048 sc1
    v_mul_f32 v88, v201, v88
    v_mul_f32 v89, v201, v89
    v_mul_f32 v90, v201, v90
    v_mul_f32 v91, v201, v91
    v_mul_f32 v92, v201, v92
    v_mul_f32 v93, v201, v93
    v_mul_f32 v94, v201, v94
    v_mul_f32 v95, v201, v95
    v_cvt_pk_bf16_f32 v132, v88, v89
    v_cvt_pk_bf16_f32 v133, v90, v91
    v_cvt_pk_bf16_f32 v134, v92, v93
    v_cvt_pk_bf16_f32 v135, v94, v95
    buffer_store_dwordx4 v[132:135], v236, s[24:27], s50 offen offset:3072 sc1
    v_subrev_u32 v194, 0x3a800000, v192
    v_subrev_u32 v198, 0x3a800000, v196
    v_subrev_u32 v202, 0x3a800000, v200
    v_subrev_u32 v206, 0x3a800000, v204
    v_max3_u32 v194, v194, v198, v202
    v_max_u32 v194, v194, v206
    v_cmp_lt_u32 vcc, 0x15000000, v194
    s_lshl_b32 s58, s3, 2
    s_add_u32 s58, s58, 114688
    v_mov_b32 v195, s58
    s_cmp_lg_u64 vcc, 0
    s_cselect_b32 s58, 1, 0
    v_mov_b32 v194, s58
    ds_write_b32 v195, v194
    v_mov_b32 v199, 114688
    s_add_u32 s50, s47, 393216
    buffer_store_dwordx4 v[128:131], v236, s[24:27], s50 offen offset:0 sc1
    s_waitcnt lgkmcnt(0)
    s_barrier
    ds_read_b128 v[208:211], v199
    buffer_store_dwordx4 v[132:135], v236, s[24:27], s50 offen offset:1024 sc1
    buffer_store_dwordx4 v[128:131], v236, s[24:27], s50 offen offset:2048 sc1
    buffer_store_dwordx4 v[132:135], v236, s[24:27], s50 offen offset:3072 sc1
    s_waitcnt lgkmcnt(0)
    v_or3_b32 v208, v208, v209, v210
    v_or_b32 v208, v208, v211
    s_nop 0
    v_readfirstlane_b32 s49, v208
    ds_read_b64_tr_b16 a[118:119], v242 offset:51200
    ds_read_b64_tr_b16 a[120:121], v243 offset:49152
    ds_read_b64_tr_b16 a[122:123], v243 offset:51200
    ds_read_b64_tr_b16 a[124:125], v244 offset:49152
    ds_read_b64_tr_b16 a[126:127], v244 offset:51200
    s_waitcnt vmcnt(20)
    ds_read_b64_tr_b16 a[128:129], v245 offset:32768
    ds_read_b64_tr_b16 a[130:131], v245 offset:34816
    ds_read_b64_tr_b16 a[132:133], v246 offset:32768
    ds_read_b64_tr_b16 a[134:135], v246 offset:34816
    ds_read_b64_tr_b16 a[136:137], v247 offset:32768
    ds_read_b64_tr_b16 a[138:139], v247 offset:34816
    ds_read_b64_tr_b16 a[140:141], v248 offset:32768
    ds_read_b64_tr_b16 a[142:143], v248 offset:34816
    s_waitcnt vmcnt(16)
    ds_read_b64_tr_b16 a[144:145], v245 offset:0
    ds_read_b64_tr_b16 a[146:147], v245 offset:2048
    ds_read_b64_tr_b16 a[148:149], v246 offset:0
    ds_read_b64_tr_b16 a[150:151], v246 offset:2048
    ds_read_b64_tr_b16 a[152:153], v247 offset:0
    ds_read_b64_tr_b16 a[154:155], v247 offset:2048
    ds_read_b64_tr_b16 a[156:157], v248 offset:0
    ds_read_b64_tr_b16 a[158:159], v248 offset:2048
    s_branch L_join
L_codeend:
L_max:
    s_waitcnt vmcnt(0) lgkmcnt(0)
    s_mov_b32 s45, 0
    s_mov_b32 m0, s41
    v_mov_b32 v192, 0xff800000
    v_mov_b32 v193, 0xff800000
    v_mov_b32 v194, 0xff800000
    v_mov_b32 v195, 0xff800000
L_maxloop:
    s_barrier
    buffer_load_dwordx4 v232, s[16:19], s45 offen offset:0 lds
    buffer_load_dwordx4 v232, s[16:19], s45 offen offset:1024 lds
    buffer_load_dwordx4 v233, s[16:19], s45 offen offset:2048 lds
    buffer_load_dwordx4 v233, s[16:19], s45 offen offset:3072 lds
    s_waitcnt vmcnt(0)
    s_barrier
    ds_read_b128 a[64:67], v220 offset:0
    ds_read_b128 a[68:71], v221 offset:0
    ds_read_b128 a[72:75], v222 offset:0
    ds_read_b128 a[76:79], v223 offset:0
    ds_read_b128 a[80:83], v220 offset:1024
    ds_read_b128 a[84:87], v221 offset:1024
    ds_read_b128 a[88:91], v222 offset:1024
    ds_read_b128 a[92:95], v223 offset:1024
    ds_read_b128 a[96:99], v220 offset:8192
    ds_read_b128 a[100:103], v221 offset:8192
    ds_read_b128 a[104:107], v222 offset:8192
    ds_read_b128 a[108:111], v223 offset:8192
    ds_read_b128 a[112:115], v220 offset:9216
    ds_read_b128 a[116:119], v221 offset:9216
    ds_read_b128 a[120:123], v222 offset:9216
    ds_read_b128 a[124:127], v223 offset:9216
    s_waitcnt lgkmcnt(0)
    v_mfma_f32_16x16x32_bf16 v[128:131], a[64:67], v[0:3], 0
    v_mfma_f32_16x16x32_bf16 v[128:131], a[68:71], v[4:7], v[128:131]
    v_mfma_f32_16x16x32_bf16 v[128:131], a[72:75], v[8:11], v[128:131]
    v_mfma_f32_16x16x32_bf16 v[128:131], a[76:79], v[12:15], v[128:131]
    v_mfma_f32_16x16x32_bf16 v[132:135], a[80:83], v[0:3], 0
    v_mfma_f32_16x16x32_bf16 v[132:135], a[84:87], v[4:7], v[132:135]
    v_mfma_f32_16x16x32_bf16 v[132:135], a[88:91], v[8:11], v[132:135]
    v_mfma_f32_16x16x32_bf16 v[132:135], a[92:95], v[12:15], v[132:135]
    v_mfma_f32_16x16x32_bf16 v[136:139], a[64:67], v[16:19], 0
    v_mfma_f32_16x16x32_bf16 v[136:139], a[68:71], v[20:23], v[136:139]
    v_mfma_f32_16x16x32_bf16 v[136:139], a[72:75], v[24:27], v[136:139]
    v_mfma_f32_16x16x32_bf16 v[136:139], a[76:79], v[28:31], v[136:139]
    v_mfma_f32_16x16x32_bf16 v[140:143], a[80:83], v[16:19], 0
    v_mfma_f32_16x16x32_bf16 v[140:143], a[84:87], v[20:23], v[140:143]
    v_mfma_f32_16x16x32_bf16 v[140:143], a[88:91], v[24:27], v[140:143]
    v_mfma_f32_16x16x32_bf16 v[140:143], a[92:95], v[28:31], v[140:143]
    v_mfma_f32_16x16x32_bf16 v[144:147], a[64:67], v[32:35], 0
    v_mfma_f32_16x16x32_bf16 v[144:147], a[68:71], v[36:39], v[144:147]
    v_mfma_f32_16x16x32_bf16 v[144:147], a[72:75], v[40:43], v[144:147]
    v_mfma_f32_16x16x32_bf16 v[144:147], a[76:79], v[44:47], v[144:147]
    v_mfma_f32_16x16x32_bf16 v[148:151], a[80:83], v[32:35], 0
    v_mfma_f32_16x16x32_bf16 v[148:151], a[84:87], v[36:39], v[148:151]
    v_mfma_f32_16x16x32_bf16 v[148:151], a[88:91], v[40:43], v[148:151]
    v_mfma_f32_16x16x32_bf16 v[148:151], a[92:95], v[44:47], v[148:151]
    v_mfma_f32_16x16x32_bf16 v[152:155], a[64:67], v[48:51], 0
    v_mfma_f32_16x16x32_bf16 v[152:155], a[68:71], v[52:55], v[152:155]
    v_mfma_f32_16x16x32_bf16 v[152:155], a[72:75], v[56:59], v[152:155]
    v_mfma_f32_16x16x32_bf16 v[152:155], a[76:79], v[60:63], v[152:155]
    v_mfma_f32_16x16x32_bf16 v[156:159], a[80:83], v[48:51], 0
    v_mfma_f32_16x16x32_bf16 v[156:159], a[84:87], v[52:55], v[156:159]
    v_mfma_f32_16x16x32_bf16 v[156:159], a[88:91], v[56:59], v[156:159]
    v_mfma_f32_16x16x32_bf16 v[156:159], a[92:95], v[60:63], v[156:159]
    v_max3_f32 v192, v192, v128, v129
    v_max3_f32 v192, v192, v130, v131
    v_max3_f32 v192, v192, v132, v133
    v_max3_f32 v192, v192, v134, v135
    v_max3_f32 v193, v193, v136, v137
    v_max3_f32 v193, v193, v138, v139
    v_max3_f32 v193, v193, v140, v141
    v_max3_f32 v193, v193, v142, v143
    v_max3_f32 v194, v194, v144, v145
    v_max3_f32 v194, v194, v146, v147
    v_max3_f32 v194, v194, v148, v149
    v_max3_f32 v194, v194, v150, v151
    v_max3_f32 v195, v195, v152, v153
    v_max3_f32 v195, v195, v154, v155
    v_max3_f32 v195, v195, v156, v157
    v_max3_f32 v195, v195, v158, v159
    v_mfma_f32_16x16x32_bf16 v[128:131], a[96:99], v[0:3], 0
    v_mfma_f32_16x16x32_bf16 v[128:131], a[100:103], v[4:7], v[128:131]
    v_mfma_f32_16x16x32_bf16 v[128:131], a[104:107], v[8:11], v[128:131]
    v_mfma_f32_16x16x32_bf16 v[128:131], a[108:111], v[12:15], v[128:131]
    v_mfma_f32_16x16x32_bf16 v[132:135], a[112:115], v[0:3], 0
    v_mfma_f32_16x16x32_bf16 v[132:135], a[116:119], v[4:7], v[132:135]
    v_mfma_f32_16x16x32_bf16 v[132:135], a[120:123], v[8:11], v[132:135]
    v_mfma_f32_16x16x32_bf16 v[132:135], a[124:127], v[12:15], v[132:135]
    v_mfma_f32_16x16x32_bf16 v[136:139], a[96:99], v[16:19], 0
    v_mfma_f32_16x16x32_bf16 v[136:139], a[100:103], v[20:23], v[136:139]
    v_mfma_f32_16x16x32_bf16 v[136:139], a[104:107], v[24:27], v[136:139]
    v_mfma_f32_16x16x32_bf16 v[136:139], a[108:111], v[28:31], v[136:139]
    v_mfma_f32_16x16x32_bf16 v[140:143], a[112:115], v[16:19], 0
    v_mfma_f32_16x16x32_bf16 v[140:143], a[116:119], v[20:23], v[140:143]
    v_mfma_f32_16x16x32_bf16 v[140:143], a[120:123], v[24:27], v[140:143]
    v_mfma_f32_16x16x32_bf16 v[140:143], a[124:127], v[28:31], v[140:143]
    v_mfma_f32_16x16x32_bf16 v[144:147], a[96:99], v[32:35], 0
    v_mfma_f32_16x16x32_bf16 v[144:147], a[100:103], v[36:39], v[144:147]
    v_mfma_f32_16x16x32_bf16 v[144:147], a[104:107], v[40:43], v[144:147]
    v_mfma_f32_16x16x32_bf16 v[144:147], a[108:111], v[44:47], v[144:147]
    v_mfma_f32_16x16x32_bf16 v[148:151], a[112:115], v[32:35], 0
    v_mfma_f32_16x16x32_bf16 v[148:151], a[116:119], v[36:39], v[148:151]
    v_mfma_f32_16x16x32_bf16 v[148:151], a[120:123], v[40:43], v[148:151]
    v_mfma_f32_16x16x32_bf16 v[148:151], a[124:127], v[44:47], v[148:151]
    v_mfma_f32_16x16x32_bf16 v[152:155], a[96:99], v[48:51], 0
    v_mfma_f32_16x16x32_bf16 v[152:155], a[100:103], v[52:55], v[152:155]
    v_mfma_f32_16x16x32_bf16 v[152:155], a[104:107], v[56:59], v[152:155]
    v_mfma_f32_16x16x32_bf16 v[152:155], a[108:111], v[60:63], v[152:155]
    v_mfma_f32_16x16x32_bf16 v[156:159], a[112:115], v[48:51], 0
    v_mfma_f32_16x16x32_bf16 v[156:159], a[116:119], v[52:55], v[156:159]
    v_mfma_f32_16x16x32_bf16 v[156:159], a[120:123], v[56:59], v[156:159]
    v_mfma_f32_16x16x32_bf16 v[156:159], a[124:127], v[60:63], v[156:159]
    v_max3_f32 v192, v192, v128, v129
    v_max3_f32 v192, v192, v130, v131
    v_max3_f32 v192, v192, v132, v133
    v_max3_f32 v192, v192, v134, v135
    v_max3_f32 v193, v193, v136, v137
    v_max3_f32 v193, v193, v138, v139
    v_max3_f32 v193, v193, v140, v141
    v_max3_f32 v193, v193, v142, v143
    v_max3_f32 v194, v194, v144, v145
    v_max3_f32 v194, v194, v146, v147
    v_max3_f32 v194, v194, v148, v149
    v_max3_f32 v194, v194, v150, v151
    v_max3_f32 v195, v195, v152, v153
    v_max3_f32 v195, v195, v154, v155
    v_max3_f32 v195, v195, v156, v157
    v_max3_f32 v195, v195, v158, v159
    s_add_u32 s45, s45, 16384
    s_cmp_lt_u32 s45, 0x40000
    s_cbranch_scc1 L_maxloop
    v_mov_b32 v196, v192
    s_nop 1
    v_permlane32_swap_b32 v192, v196
    v_max_f32 v192, v192, v196
    v_mov_b32 v196, v192
    s_nop 1
    v_permlane16_swap_b32 v192, v196
    v_max_f32 v192, v192, v196
    v_xor_b32 v176, 0x80000000, v192
    v_xor_b32 v177, 0x80000000, v192
    v_xor_b32 v178, 0x80000000, v192
    v_xor_b32 v179, 0x80000000, v192
    v_mov_b32 v197, v193
    s_nop 1
    v_permlane32_swap_b32 v193, v197
    v_max_f32 v193, v193, v197
    v_mov_b32 v197, v193
    s_nop 1
    v_permlane16_swap_b32 v193, v197
    v_max_f32 v193, v193, v197
    v_xor_b32 v180, 0x80000000, v193
    v_xor_b32 v181, 0x80000000, v193
    v_xor_b32 v182, 0x80000000, v193
    v_xor_b32 v183, 0x80000000, v193
    v_mov_b32 v198, v194
    s_nop 1
    v_permlane32_swap_b32 v194, v198
    v_max_f32 v194, v194, v198
    v_mov_b32 v198, v194
    s_nop 1
    v_permlane16_swap_b32 v194, v198
    v_max_f32 v194, v194, v198
    v_xor_b32 v184, 0x80000000, v194
    v_xor_b32 v185, 0x80000000, v194
    v_xor_b32 v186, 0x80000000, v194
    v_xor_b32 v187, 0x80000000, v194
    v_mov_b32 v199, v195
    s_nop 1
    v_permlane32_swap_b32 v195, v199
    v_max_f32 v195, v195, v199
    v_mov_b32 v199, v195
    s_nop 1
    v_permlane16_swap_b32 v195, v199
    v_max_f32 v195, v195, v199
    v_xor_b32 v188, 0x80000000, v195
    v_xor_b32 v189, 0x80000000, v195
    v_xor_b32 v190, 0x80000000, v195
    v_xor_b32 v191, 0x80000000, v195
L_redo:
    s_add_u32 s100, s100, 1
    s_waitcnt vmcnt(0) lgkmcnt(0)
    s_barrier
    v_mbcnt_lo_u32_b32 v0, -1, 0
    v_mbcnt_hi_u32_b32 v0, -1, v0
    s_lshl_b32 s58, s3, 6
    v_add_u32 v0, s58, v0
    s_branch L_start
.section .rodata,"a"
.p2align 6
.amdhsa_kernel standalone__mha_block_cached__near_ridge_kernel
  .amdhsa_next_free_vgpr 512
  .amdhsa_next_free_sgpr 102
  .amdhsa_accum_offset 256
  .amdhsa_group_segment_fixed_size 0
  .amdhsa_kernarg_size 64
  .amdhsa_user_sgpr_count 2
  .amdhsa_user_sgpr_kernarg_segment_ptr 1
  .amdhsa_system_sgpr_workgroup_id_x 1
.end_amdhsa_kernel
```
